```python
import torch

def _softmax(x, axis=-1):
    return torch.softmax(x, dim=axis)

def _gelu(x):
    return torch.nn.functional.gelu(x, approximate='tanh')

def _silu(x):
    return torch.nn.functional.silu(x)

def _sigmoid(x):
    return torch.sigmoid(x)

def _layernorm(x, axis=-1, eps=1e-05):
    m = x.mean(dim=axis, keepdim=True)
    v = x.var(dim=axis, keepdim=True, unbiased=False)
    return (x - m) / torch.sqrt(v + eps)

def _scatter_add(tgt, idx, src, axis=0):
    return tgt.clone().index_add_(axis, idx, src)

def _segment_sum(src, seg, n):
    out = torch.zeros((n,) + src.shape[1:], dtype=src.dtype)
    return out.index_add_(0, seg, src)

def _pad(x, pw):
    flat = tuple((v for pair in reversed(pw) for v in pair))
    return torch.nn.functional.pad(x, flat)
kernel_name = 'sequential_preLN__memory_aug_recurrent_mem_tr__mixer_gmlp__prompt'

def setup_inputs():

    _w = lambda a: (lambda t: t.to(torch.bfloat16) if t.is_floating_point() else t)(torch.as_tensor(a))

    def _A_setup():
        B, S, Dm = (1, 2048, 512)
        H, Dh = (32, 128)
        M, seg = (8, 32)
        seg = min(seg, S)
        S = S // seg * seg
        return {'x': _w((lambda *s: torch.randn(*s, dtype=torch.bfloat16) * 0.05)(B, S, Dm)), 'mem0': _w((lambda *s: torch.randn(*s, dtype=torch.bfloat16) * 0.2)(B, M, Dm)), 'Wq': _w((lambda *s: torch.randn(*s, dtype=torch.bfloat16) * 1.6)(Dm, H, Dh) * Dm ** (-0.5)), 'Wk': _w((lambda *s: torch.randn(*s, dtype=torch.bfloat16) * 1.6)(Dm, H, Dh) * Dm ** (-0.5)), 'Wv': _w((lambda *s: torch.randn(*s, dtype=torch.bfloat16) * 0.2)(Dm, H, Dh) * Dm ** (-0.5)), 'Wo': _w((lambda *s: torch.randn(*s, dtype=torch.bfloat16) * 0.2)(H, Dh, Dm) * (H * Dh) ** (-0.5)), 'seg_len': seg}
    _A_in = _A_setup()

    def _B_setup():
        B, S, D, F = (1, 2048, 512, 1376)
        Fh = F // 2
        return {'x': _w((lambda *s: torch.randn(*s, dtype=torch.bfloat16) * 0.05)(B, S, D)), 'w_in': _w((lambda *s: torch.randn(*s, dtype=torch.bfloat16) * 0.4)(D, 2 * Fh)), 'w_sp': _w(0.01 * (lambda *s: torch.randn(*s, dtype=torch.bfloat16) * 0.4)(S, S)), 'b_sp': _w(1.0 + 0.01 * (lambda *s: torch.randn(*s, dtype=torch.bfloat16) * 0.05)(S)), 'w_out': _w((lambda *s: torch.randn(*s, dtype=torch.bfloat16) * 0.05)(Fh, D))}
    _B_in = _B_setup()
    return {'A_x': _A_in['x'], 'A_mem0': _A_in['mem0'], 'A_Wq': _A_in['Wq'], 'A_Wk': _A_in['Wk'], 'A_Wv': _A_in['Wv'], 'A_Wo': _A_in['Wo'], 'A_seg_len': _A_in['seg_len'], 'B_x': _B_in['x'], 'B_w_in': _B_in['w_in'], 'B_w_sp': _B_in['w_sp'], 'B_b_sp': _B_in['b_sp'], 'B_w_out': _B_in['w_out']}

def reference(A_x, A_mem0, A_Wq, A_Wk, A_Wv, A_Wo, A_seg_len, B_x, B_w_in, B_w_sp, B_b_sp, B_w_out):

    def _A_ref(x, mem0, Wq, Wk, Wv, Wo, seg_len):
        B, S, Dm = x.shape
        H, Dh = (Wq.shape[1], Wq.shape[2])
        M = mem0.shape[1]
        scale = Dh ** (-0.5)
        n_seg = S // seg_len
        L = M + seg_len
        idx = torch.arange(L)
        mask = (idx[:, None] < M) | (idx[:, None] >= idx[None, :])
        mem = mem0
        outs = []
        for s in range(n_seg):
            xs = x[:, s * seg_len:(s + 1) * seg_len, :].clone()
            h = torch.concatenate([mem, xs], axis=1)
            q = torch.einsum('btd,dhe->bhte', h, Wq)
            k = torch.einsum('btd,dhe->bhte', h, Wk)
            v = torch.einsum('btd,dhe->bhte', h, Wv)
            scores = torch.einsum('bhqe,bhke->bhqk', q, k) * scale
            scores = torch.where(mask[None, None], scores, -1000000000.0)
            p = _softmax(scores, axis=-1)
            o = torch.einsum('bhqk,bhke->bhqe', p, v)
            o = torch.einsum('bhte,hed->btd', o, Wo)
            mem = o[:, :M, :].clone()
            outs.append(o[:, M:, :])
        return torch.concatenate(outs, axis=1)

    def _B_ref(x, w_in, w_sp, b_sp, w_out):
        B, S, D = x.shape
        F = w_in.shape[-1]
        Fh = F // 2
        z = _gelu(torch.einsum('bsd,df->bsf', x, w_in))
        z1 = z[..., :Fh].clone()
        z2 = _layernorm(z[..., Fh:], axis=-1)
        g = torch.einsum('ts,bsf->btf', w_sp, z2) + b_sp[None, :, None]
        return torch.einsum('bsf,fd->bsd', z1 * g, w_out)
    x = A_x
    h = x + _A_ref(_layernorm(x, axis=-1), A_mem0, A_Wq, A_Wk, A_Wv, A_Wo, A_seg_len)
    h2 = h + _B_ref(_layernorm(h, axis=-1), B_w_in, B_w_sp, B_b_sp, B_w_out)
    return h2
```

```asm
; @launch grid=(256,1,1) block=(256,1,1) lds=163840
.amdgcn_target "amdgcn-amd-amdhsa--gfx950"
.text
.globl sequential_preLN__memory_aug_recurrent_mem_tr__mixer_gmlp__prompt_kernel
.p2align 8
.type sequential_preLN__memory_aug_recurrent_mem_tr__mixer_gmlp__prompt_kernel,@function
sequential_preLN__memory_aug_recurrent_mem_tr__mixer_gmlp__prompt_kernel:
    s_load_dwordx2 s[4:5], s[0:1], 112
    s_load_dwordx2 s[12:13], s[0:1], 104
    s_load_dwordx4 s[48:51], s[0:1], 16
    s_load_dwordx4 s[52:55], s[0:1], 32
    s_load_dwordx4 s[56:59], s[0:1], 0
    s_cmp_ge_u32 s2, 256
    s_cbranch_scc1 L_end
    s_mov_b32 s6, 268435456
    s_mov_b32 s7, 0x20000
    s_mov_b32 s14, 256
    s_mov_b32 s15, 0x20000
    v_lshrrev_b32 v1, 6, v0
    v_mov_b32 v4, 163824
    v_readfirstlane_b32 s17, v1
    s_waitcnt lgkmcnt(0)
    s_getreg_b32 s24, hwreg(HW_REG_XCC_ID, 0, 4)
    s_sub_u32 s25, s24, 1
    s_and_b32 s25, s25, 7
    s_cmp_lt_u32 s24, 8
    s_cselect_b32 s24, s25, s24
    s_xor_b32 s25, s24, 2
    s_or_b32 s26, s24, 2
    s_cmp_eq_u32 s26, 7
    s_cselect_b32 s24, s25, s24
    s_cmp_eq_u32 s17, 0
    s_cbranch_scc1 L_elect
    s_getpc_b64 s[44:45]
L_pc:
    s_sub_u32 s44, s44, L_pc-sequential_preLN__memory_aug_recurrent_mem_tr__mixer_gmlp__prompt_kernel
    s_subb_u32 s45, s45, 0
    s_lshr_b32 s26, s2, 3
    s_mul_i32 s26, s26, 3072
    v_subrev_u32 v7, 64, v0
    v_lshlrev_b32 v7, 4, v7
    v_add_u32 v7, s26, v7
    v_min_u32 v7, L_end-sequential_preLN__memory_aug_recurrent_mem_tr__mixer_gmlp__prompt_kernel-16, v7
    global_load_dwordx4 v[224:227], v7, s[44:45]
    s_branch L_elect_wait
L_elect:
    s_and_b32 s25, s24, 1
    s_lshl_b32 s25, s25, 6
    s_lshr_b32 s26, s24, 1
    s_lshl_b32 s26, s26, 2
    s_add_u32 s25, s25, s26
    s_cmp_eq_u32 s24, 0
    s_cselect_b32 s25, 128, s25
    s_mov_b64 exec, 1
    v_mov_b32 v1, 1
    v_mov_b32 v2, s25
    buffer_atomic_add v1, v2, s[12:15], 0 offen sc0
    s_waitcnt vmcnt(0)
    v_readfirstlane_b32 s25, v1
    s_mov_b64 exec, -1
    s_mov_b32 s40, 0
    s_cmp_ge_u32 s24, 8
    s_cbranch_scc1 L_ovf
    s_cmp_lt_u32 s25, 32
    s_cbranch_scc1 L_elect_pub
L_ovf:
    s_mov_b64 exec, 1
    v_mov_b32 v1, 1
    v_mov_b32 v2, 192
    buffer_atomic_add v1, v2, s[12:15], 0 offen sc0
    s_waitcnt vmcnt(0)
    v_readfirstlane_b32 s26, v1
    s_mov_b64 exec, -1
    v_lshlrev_b32 v2, 2, v0
    s_mov_b32 s28, 0
L_ovf_poll:
    buffer_load_dword v1, v2, s[12:15], 0 offen sc1
    s_add_u32 s28, s28, 1
    s_waitcnt vmcnt(0)
    s_mov_b32 s27, 0
    v_readlane_b32 s25, v1, 32
    s_nop 0
    s_add_u32 s27, s27, s25
    v_readlane_b32 s25, v1, 16
    s_nop 0
    s_add_u32 s27, s27, s25
    v_readlane_b32 s25, v1, 1
    s_nop 0
    s_add_u32 s27, s27, s25
    v_readlane_b32 s25, v1, 17
    s_nop 0
    s_add_u32 s27, s27, s25
    v_readlane_b32 s25, v1, 2
    s_nop 0
    s_add_u32 s27, s27, s25
    v_readlane_b32 s25, v1, 18
    s_nop 0
    s_add_u32 s27, s27, s25
    v_readlane_b32 s25, v1, 3
    s_nop 0
    s_add_u32 s27, s27, s25
    v_readlane_b32 s25, v1, 19
    s_nop 0
    s_add_u32 s27, s27, s25
    v_readlane_b32 s25, v1, 4
    s_nop 0
    s_add_u32 s27, s27, s25
    v_readlane_b32 s25, v1, 20
    s_nop 0
    s_add_u32 s27, s27, s25
    v_readlane_b32 s25, v1, 5
    s_nop 0
    s_add_u32 s27, s27, s25
    v_readlane_b32 s25, v1, 21
    s_nop 0
    s_add_u32 s27, s27, s25
    v_readlane_b32 s25, v1, 6
    s_nop 0
    s_add_u32 s27, s27, s25
    v_readlane_b32 s25, v1, 22
    s_nop 0
    s_add_u32 s27, s27, s25
    v_readlane_b32 s25, v1, 7
    s_nop 0
    s_add_u32 s27, s27, s25
    v_readlane_b32 s25, v1, 23
    s_nop 0
    s_add_u32 s27, s27, s25
    s_cmp_gt_u32 s28, 262144
    s_cbranch_scc1 L_ovf_go
    s_cmp_lt_u32 s27, 256
    s_cbranch_scc1 L_ovf_poll
L_ovf_go:
    s_mov_b32 s40, 1
    v_readlane_b32 s25, v1, 32
    s_nop 0
    s_min_u32 s25, s25, 32
    s_add_u32 s25, s25, s26
    s_mov_b32 s24, 0
    s_cmp_lt_u32 s25, 32
    s_cbranch_scc1 L_elect_pub
    s_sub_u32 s26, s25, 32
    v_readlane_b32 s25, v1, 16
    s_nop 0
    s_min_u32 s25, s25, 32
    s_add_u32 s25, s25, s26
    s_mov_b32 s24, 1
    s_cmp_lt_u32 s25, 32
    s_cbranch_scc1 L_elect_pub
    s_sub_u32 s26, s25, 32
    v_readlane_b32 s25, v1, 1
    s_nop 0
    s_min_u32 s25, s25, 32
    s_add_u32 s25, s25, s26
    s_mov_b32 s24, 2
    s_cmp_lt_u32 s25, 32
    s_cbranch_scc1 L_elect_pub
    s_sub_u32 s26, s25, 32
    v_readlane_b32 s25, v1, 17
    s_nop 0
    s_min_u32 s25, s25, 32
    s_add_u32 s25, s25, s26
    s_mov_b32 s24, 3
    s_cmp_lt_u32 s25, 32
    s_cbranch_scc1 L_elect_pub
    s_sub_u32 s26, s25, 32
    v_readlane_b32 s25, v1, 2
    s_nop 0
    s_min_u32 s25, s25, 32
    s_add_u32 s25, s25, s26
    s_mov_b32 s24, 4
    s_cmp_lt_u32 s25, 32
    s_cbranch_scc1 L_elect_pub
    s_sub_u32 s26, s25, 32
    v_readlane_b32 s25, v1, 18
    s_nop 0
    s_min_u32 s25, s25, 32
    s_add_u32 s25, s25, s26
    s_mov_b32 s24, 5
    s_cmp_lt_u32 s25, 32
    s_cbranch_scc1 L_elect_pub
    s_sub_u32 s26, s25, 32
    v_readlane_b32 s25, v1, 3
    s_nop 0
    s_min_u32 s25, s25, 32
    s_add_u32 s25, s25, s26
    s_mov_b32 s24, 6
    s_cmp_lt_u32 s25, 32
    s_cbranch_scc1 L_elect_pub
    s_sub_u32 s26, s25, 32
    v_readlane_b32 s25, v1, 19
    s_nop 0
    s_min_u32 s25, s25, 32
    s_add_u32 s25, s25, s26
    s_mov_b32 s24, 7
    s_cmp_lt_u32 s25, 32
    s_cbranch_scc1 L_elect_pub
    s_sub_u32 s26, s25, 32
    s_mov_b32 s24, 8
L_elect_pub:
    s_lshl_b32 s24, s24, 8
    s_lshl_b32 s26, s40, 16
    s_add_u32 s24, s24, s25
    s_add_u32 s24, s24, s26
    v_mov_b32 v1, s24
    ds_write_b32 v4, v1
    s_waitcnt lgkmcnt(0)
L_elect_wait:
    s_barrier
    ds_read_b32 v1, v4
    s_waitcnt lgkmcnt(0)
    v_readfirstlane_b32 s24, v1
    s_nop 0
    s_and_b32 s16, s24, 31
    s_bfe_u32 s39, s24, 0x80008
    s_lshr_b32 s40, s24, 16
    s_cmp_ge_u32 s39, 8
    s_cbranch_scc1 L_end
    s_cmp_eq_u32 s39, 0
    s_cbranch_scc0 L_notchain
    v_lshrrev_b32 v49, 6, v0
    v_and_b32 v40, 63, v0
    v_readfirstlane_b32 s17, v49
    v_and_b32 v41, 15, v40
    v_lshrrev_b32 v42, 4, v40
    v_lshrrev_b32 v43, 2, v41
    v_and_b32 v44, 1, v43
    v_lshrrev_b32 v45, 1, v43
    v_and_b32 v46, 1, v42
    v_lshrrev_b32 v47, 1, v42
    v_and_b32 v48, 3, v41
    s_and_b32 s24, s17, 1
    s_lshl_b32 s24, s24, 2
    s_lshr_b32 s25, s17, 1
    s_lshl_b32 s25, s25, 4
    s_add_u32 s24, s24, s25
    v_add_u32 v20, s24, v42
    v_lshlrev_b32 v20, 13, v20
    s_lshl_b32 s24, s17, 2
    v_lshlrev_b32 v49, 1, v47
    v_or_b32 v49, s24, v49
    v_xor_b32 v49, v41, v49
    v_lshl_add_u32 v20, v49, 4, v20
    s_lshl_b32 s25, s16, 8
    v_add_u32 v20, s25, v20
    s_load_dwordx2 s[8:9], s[0:1], 24
    s_mov_b32 s10, 4194304
    s_mov_b32 s11, 0x20000
    s_waitcnt lgkmcnt(0)
    s_lshl_b32 s24, s17, 10
    s_add_u32 m0, s24, 0
    s_mov_b32 s25, 0
    buffer_load_dwordx4 v20, s[8:11], s25 offen lds
    s_add_u32 m0, s24, 4096
    s_mov_b32 s25, 262144
    buffer_load_dwordx4 v20, s[8:11], s25 offen lds
    s_add_u32 m0, s24, 8192
    s_mov_b32 s25, 524288
    buffer_load_dwordx4 v20, s[8:11], s25 offen lds
    s_add_u32 m0, s24, 12288
    s_mov_b32 s25, 786432
    buffer_load_dwordx4 v20, s[8:11], s25 offen lds
    s_add_u32 m0, s24, 16384
    s_mov_b32 s25, 1048576
    buffer_load_dwordx4 v20, s[8:11], s25 offen lds
    s_add_u32 m0, s24, 20480
    s_mov_b32 s25, 1310720
    buffer_load_dwordx4 v20, s[8:11], s25 offen lds
    s_add_u32 m0, s24, 24576
    s_mov_b32 s25, 1572864
    buffer_load_dwordx4 v20, s[8:11], s25 offen lds
    s_add_u32 m0, s24, 28672
    s_mov_b32 s25, 1835008
    buffer_load_dwordx4 v20, s[8:11], s25 offen lds
    s_add_u32 m0, s24, 32768
    s_mov_b32 s25, 2097152
    buffer_load_dwordx4 v20, s[8:11], s25 offen lds
    s_add_u32 m0, s24, 36864
    s_mov_b32 s25, 2359296
    buffer_load_dwordx4 v20, s[8:11], s25 offen lds
    s_add_u32 m0, s24, 40960
    s_mov_b32 s25, 2621440
    buffer_load_dwordx4 v20, s[8:11], s25 offen lds
    s_add_u32 m0, s24, 45056
    s_mov_b32 s25, 2883584
    buffer_load_dwordx4 v20, s[8:11], s25 offen lds
    s_add_u32 m0, s24, 49152
    s_mov_b32 s25, 3145728
    buffer_load_dwordx4 v20, s[8:11], s25 offen lds
    s_add_u32 m0, s24, 53248
    s_mov_b32 s25, 3407872
    buffer_load_dwordx4 v20, s[8:11], s25 offen lds
    s_add_u32 m0, s24, 57344
    s_mov_b32 s25, 3670016
    buffer_load_dwordx4 v20, s[8:11], s25 offen lds
    s_add_u32 m0, s24, 61440
    s_mov_b32 s25, 3932160
    buffer_load_dwordx4 v20, s[8:11], s25 offen lds
    s_load_dwordx2 s[44:45], s[0:1], 8
    s_mov_b32 s46, 8192
    s_mov_b32 s47, 0x20000
    v_and_b32 v50, 1, v41
    v_lshl_add_u32 v49, v43, 1, v50
    v_lshlrev_b32 v49, 10, v49
    v_lshl_add_u32 v49, v42, 8, v49
    v_and_b32 v50, 2, v41
    v_lshl_add_u32 v2, v50, 2, v49
    s_waitcnt lgkmcnt(0)
    buffer_load_dwordx2 v[60:61], v2, s[44:47], 0 offen offset:0
    buffer_load_dwordx2 v[62:63], v2, s[44:47], 0 offen offset:32
    buffer_load_dwordx2 v[64:65], v2, s[44:47], 0 offen offset:16
    buffer_load_dwordx2 v[66:67], v2, s[44:47], 0 offen offset:48
    buffer_load_dwordx2 v[68:69], v2, s[44:47], 0 offen offset:64
    buffer_load_dwordx2 v[70:71], v2, s[44:47], 0 offen offset:96
    buffer_load_dwordx2 v[72:73], v2, s[44:47], 0 offen offset:80
    buffer_load_dwordx2 v[74:75], v2, s[44:47], 0 offen offset:112
    buffer_load_dwordx2 v[76:77], v2, s[44:47], 0 offen offset:128
    buffer_load_dwordx2 v[78:79], v2, s[44:47], 0 offen offset:160
    buffer_load_dwordx2 v[80:81], v2, s[44:47], 0 offen offset:144
    buffer_load_dwordx2 v[82:83], v2, s[44:47], 0 offen offset:176
    buffer_load_dwordx2 v[84:85], v2, s[44:47], 0 offen offset:192
    buffer_load_dwordx2 v[86:87], v2, s[44:47], 0 offen offset:224
    buffer_load_dwordx2 v[88:89], v2, s[44:47], 0 offen offset:208
    buffer_load_dwordx2 v[90:91], v2, s[44:47], 0 offen offset:240
    v_lshlrev_b32 v28, 4, v0
    v_mov_b32 v32, -1
    v_mov_b32 v33, -1
    v_mov_b32 v34, -1
    v_mov_b32 v35, -1
    s_lshl_b32 s24, s16, 13
    s_add_u32 s24, s24, 50331648
    s_add_u32 s25, s24, 0
    buffer_store_dwordx4 v[32:35], v28, s[4:7], s25 offen sc1
    s_add_u32 s25, s24, 4096
    buffer_store_dwordx4 v[32:35], v28, s[4:7], s25 offen sc1
    s_add_u32 s25, s24, 262144
    buffer_store_dwordx4 v[32:35], v28, s[4:7], s25 offen sc1
    s_add_u32 s25, s24, 266240
    buffer_store_dwordx4 v[32:35], v28, s[4:7], s25 offen sc1
    v_lshlrev_b32 v28, 2, v0
    s_lshl_b32 s24, s16, 10
    s_add_u32 s24, s24, 51380224
    buffer_store_dword v32, v28, s[4:7], s24 offen sc1
    s_lshl_b32 s24, s17, 10
    s_add_u32 m0, s24, 65536
    s_mov_b32 s25, 65536
    buffer_load_dwordx4 v20, s[8:11], s25 offen lds
    s_add_u32 m0, s24, 69632
    s_mov_b32 s25, 327680
    buffer_load_dwordx4 v20, s[8:11], s25 offen lds
    s_add_u32 m0, s24, 73728
    s_mov_b32 s25, 589824
    buffer_load_dwordx4 v20, s[8:11], s25 offen lds
    s_add_u32 m0, s24, 77824
    s_mov_b32 s25, 851968
    buffer_load_dwordx4 v20, s[8:11], s25 offen lds
    s_add_u32 m0, s24, 81920
    s_mov_b32 s25, 1114112
    buffer_load_dwordx4 v20, s[8:11], s25 offen lds
    s_add_u32 m0, s24, 86016
    s_mov_b32 s25, 1376256
    buffer_load_dwordx4 v20, s[8:11], s25 offen lds
    s_add_u32 m0, s24, 90112
    s_mov_b32 s25, 1638400
    buffer_load_dwordx4 v20, s[8:11], s25 offen lds
    s_add_u32 m0, s24, 94208
    s_mov_b32 s25, 1900544
    buffer_load_dwordx4 v20, s[8:11], s25 offen lds
    s_add_u32 m0, s24, 98304
    s_mov_b32 s25, 2162688
    buffer_load_dwordx4 v20, s[8:11], s25 offen lds
    s_add_u32 m0, s24, 102400
    s_mov_b32 s25, 2424832
    buffer_load_dwordx4 v20, s[8:11], s25 offen lds
    s_add_u32 m0, s24, 106496
    s_mov_b32 s25, 2686976
    buffer_load_dwordx4 v20, s[8:11], s25 offen lds
    s_add_u32 m0, s24, 110592
    s_mov_b32 s25, 2949120
    buffer_load_dwordx4 v20, s[8:11], s25 offen lds
    s_add_u32 m0, s24, 114688
    s_mov_b32 s25, 3211264
    buffer_load_dwordx4 v20, s[8:11], s25 offen lds
    s_add_u32 m0, s24, 118784
    s_mov_b32 s25, 3473408
    buffer_load_dwordx4 v20, s[8:11], s25 offen lds
    s_add_u32 m0, s24, 122880
    s_mov_b32 s25, 3735552
    buffer_load_dwordx4 v20, s[8:11], s25 offen lds
    s_add_u32 m0, s24, 126976
    s_mov_b32 s25, 3997696
    buffer_load_dwordx4 v20, s[8:11], s25 offen lds
    s_and_b32 s24, s17, 1
    s_lshl_b32 s24, s24, 3
    v_xor_b32 v21, s24, v40
    v_xor_b32 v22, 4, v21
    s_lshl_b32 s25, s16, 17
    s_lshl_b32 s26, s17, 14
    s_add_u32 s25, s25, s26
    v_lshlrev_b32 v21, 4, v21
    v_lshlrev_b32 v22, 4, v22
    v_add_u32 v21, s25, v21
    v_add_u32 v22, s25, v22
    v_lshl_add_u32 v49, v45, 1, v46
    v_lshl_add_u32 v49, v44, 2, v49
    v_lshlrev_b32 v50, 9, v49
    v_lshl_add_u32 v50, v47, 14, v50
    v_lshl_add_u32 v50, v48, 3, v50
    s_lshl_b32 s25, s17, 1
    v_xor_b32 v49, s25, v49
    v_lshl_add_u32 v23, v49, 5, v50
    v_xor_b32 v24, 32, v23
    v_lshl_add_u32 v50, v47, 2, v44
    v_lshl_add_u32 v50, v46, 4, v50
    v_lshlrev_b32 v50, 10, v50
    v_lshl_add_u32 v50, v48, 3, v50
    v_lshl_add_u32 v49, v44, 1, v45
    v_lshl_add_u32 v49, v46, 2, v49
    v_lshl_add_u32 v50, v49, 5, v50
    s_lshl_b32 s25, s17, 8
    v_add_u32 v25, s25, v50
    v_lshlrev_b32 v1, 4, v40
    s_lshl_b32 s25, s17, 14
    v_add_u32 v11, s25, v1
    v_add_u32 v12, 0x10000, v11
    v_add_u32 v1, 131072, v1
    s_lshl_b32 s25, s17, 11
    v_add_u32 v4, s25, v1
    s_lshl_b32 s25, s17, 10
    v_add_u32 v10, s25, v1
    v_and_b32 v5, 0xffffffdf, v1
    v_lshlrev_b32 v49, 5, v41
    v_xor_b32 v50, v42, v43
    v_lshl_add_u32 v49, v50, 3, v49
    s_add_u32 s25, s25, 131072
    v_add_u32 v8, s25, v49
    v_xor_b32 v49, v40, v42
    v_lshlrev_b32 v49, 3, v49
    v_add_u32 v9, 131072, v49
    v_lshl_add_u32 v49, v45, 2, v42
    v_lshlrev_b32 v49, 13, v49
    v_and_b32 v50, 7, v41
    v_lshl_add_u32 v49, v50, 3, v49
    s_lshl_b32 s25, s17, 16
    s_lshl_b32 s26, s16, 6
    s_add_u32 s25, s25, s26
    v_add_u32 v13, s25, v49
    s_lshl_b32 s25, s17, 11
    s_and_b32 s26, s16, 4
    s_lshl_b32 s26, s26, 8
    s_add_u32 s25, s25, s26
    s_lshr_b32 s26, s16, 3
    s_lshl_b32 s26, s26, 8
    s_add_u32 s25, s25, s26
    s_and_b32 s26, s16, 3
    s_lshl_b32 s26, s26, 6
    s_add_u32 s25, s25, s26
    v_and_b32 v50, 1, v41
    v_and_b32 v51, 2, v41
    v_add_u32 v49, v51, v46
    v_lshlrev_b32 v49, 4, v49
    v_lshl_add_u32 v49, v50, 3, v49
    v_lshl_add_u32 v49, v47, 2, v49
    v_add_u32 v49, s25, v49
    v_mov_b32 v51, 0x40000000
    v_cmp_gt_u32 vcc, 4, v41
    s_nop 1
    v_cndmask_b32 v15, v51, v49, vcc
    s_mov_b32 s52, 0xf000f
    s_mov_b32 s53, 0xf000f
    s_mov_b32 s54, 0xf000f0
    s_mov_b32 s55, 0xf000f0
    s_mov_b32 s56, 0xf000f00
    s_mov_b32 s57, 0xf000f00
    s_mov_b32 s58, 0xf000f000
    s_mov_b32 s59, 0xf000f000
    v_lshlrev_b32 v51, 4, v50
    v_mov_b32 v49, 0x3f80
    v_lshlrev_b32 v7, v51, v49
    v_add_u32 v6, 16384, v1
    v_and_b32 v50, 2, v41
    v_mov_b32 v49, 0x44444444
    v_mov_b32 v51, 0xeeeeeeee
    v_cmp_eq_u32 vcc, 0, v50
    s_nop 1
    v_cndmask_b32 v0, v51, v49, vcc
    v_mov_b32 v16, 0
    v_mov_b32 v17, 0
    v_mov_b32 v18, 0
    v_mov_b32 v19, 0
    s_mov_b32 s25, 0x05040100
    s_mov_b32 s26, 0x07060302
    s_waitcnt vmcnt(16)
    v_perm_b32 v92, v62, v60, s25
    v_min_u32 v92, -2, v92
    v_perm_b32 v93, v62, v60, s26
    v_min_u32 v93, -2, v93
    v_perm_b32 v94, v63, v61, s25
    v_min_u32 v94, -2, v94
    v_perm_b32 v95, v63, v61, s26
    v_min_u32 v95, -2, v95
    v_perm_b32 v96, v66, v64, s25
    v_min_u32 v96, -2, v96
    v_perm_b32 v97, v66, v64, s26
    v_min_u32 v97, -2, v97
    v_perm_b32 v98, v67, v65, s25
    v_min_u32 v98, -2, v98
    v_perm_b32 v99, v67, v65, s26
    v_min_u32 v99, -2, v99
    v_perm_b32 v100, v70, v68, s25
    v_min_u32 v100, -2, v100
    v_perm_b32 v101, v70, v68, s26
    v_min_u32 v101, -2, v101
    v_perm_b32 v102, v71, v69, s25
    v_min_u32 v102, -2, v102
    v_perm_b32 v103, v71, v69, s26
    v_min_u32 v103, -2, v103
    v_perm_b32 v104, v74, v72, s25
    v_min_u32 v104, -2, v104
    v_perm_b32 v105, v74, v72, s26
    v_min_u32 v105, -2, v105
    v_perm_b32 v106, v75, v73, s25
    v_min_u32 v106, -2, v106
    v_perm_b32 v107, v75, v73, s26
    v_min_u32 v107, -2, v107
    v_perm_b32 v108, v78, v76, s25
    v_min_u32 v108, -2, v108
    v_perm_b32 v109, v78, v76, s26
    v_min_u32 v109, -2, v109
    v_perm_b32 v110, v79, v77, s25
    v_min_u32 v110, -2, v110
    v_perm_b32 v111, v79, v77, s26
    v_min_u32 v111, -2, v111
    v_perm_b32 v112, v82, v80, s25
    v_min_u32 v112, -2, v112
    v_perm_b32 v113, v82, v80, s26
    v_min_u32 v113, -2, v113
    v_perm_b32 v114, v83, v81, s25
    v_min_u32 v114, -2, v114
    v_perm_b32 v115, v83, v81, s26
    v_min_u32 v115, -2, v115
    v_perm_b32 v116, v86, v84, s25
    v_min_u32 v116, -2, v116
    v_perm_b32 v117, v86, v84, s26
    v_min_u32 v117, -2, v117
    v_perm_b32 v118, v87, v85, s25
    v_min_u32 v118, -2, v118
    v_perm_b32 v119, v87, v85, s26
    v_min_u32 v119, -2, v119
    v_perm_b32 v120, v90, v88, s25
    v_min_u32 v120, -2, v120
    v_perm_b32 v121, v90, v88, s26
    v_min_u32 v121, -2, v121
    v_perm_b32 v122, v91, v89, s25
    v_min_u32 v122, -2, v122
    v_perm_b32 v123, v91, v89, s26
    v_min_u32 v123, -2, v123
    ds_write_b128 v1, v[92:95] offset:0
    ds_write_b128 v1, v[96:99] offset:1024
    ds_write_b128 v1, v[100:103] offset:2048
    ds_write_b128 v1, v[104:107] offset:3072
    ds_write_b128 v1, v[108:111] offset:4096
    ds_write_b128 v1, v[112:115] offset:5120
    ds_write_b128 v1, v[116:119] offset:6144
    ds_write_b128 v1, v[120:123] offset:7168
    s_mov_b32 s20, 51380224
    s_mov_b32 s36, 51249152
    s_mov_b32 s18, 0
    s_mov_b32 s19, 50331648
    s_lshl_b32 s33, s16, 13
    s_sub_u32 s33, s33, 131072
    s_add_u32 s31, s33, 50593792
    s_mov_b32 s32, 51404800
    s_lshl_b32 s21, s16, 14
    s_add_u32 s21, s21, 1966080
    s_mul_i32 s22, s16, 266240
    s_add_u32 s22, s22, 37617664
    s_mov_b32 s23, 0
    s_mov_b32 s35, 0
    s_mov_b32 s28, 0x3e0293ee
    s_lshl_b32 s29, s17, 11
    s_add_u32 s30, s29, 139264
    s_add_u32 s29, s29, 147456
    s_mov_b64 s[50:51], -1
    s_waitcnt lgkmcnt(0)
    s_waitcnt vmcnt(16)
    s_barrier
    s_lshl_b32 s41, s40, 16
    s_add_u32 s41, s41, 1
    s_cmp_lg_u32 s17, 0
    s_cbranch_scc1 sig_1
    v_mov_b32 v2, s41
    v_mov_b32 v3, 204
    s_mov_b64 exec, 1
    buffer_atomic_add v2, v3, s[12:15], 0 offen
    s_mov_b64 exec, -1
sig_1:
    ds_read_b64_tr_b16 v[48:49], v23 offset:0
    ds_read_b64_tr_b16 v[50:51], v23 offset:256
    ds_read_b64_tr_b16 v[52:53], v23 offset:32768
    ds_read_b64_tr_b16 v[54:55], v23 offset:33024
    ds_read_b64_tr_b16 v[56:57], v24 offset:0
    ds_read_b64_tr_b16 v[58:59], v24 offset:256
    ds_read_b64_tr_b16 v[60:61], v24 offset:32768
    ds_read_b64_tr_b16 v[62:63], v24 offset:33024
    ds_read_b64_tr_b16 a[104:105], v23 offset:4096
    ds_read_b64_tr_b16 a[106:107], v23 offset:4352
    ds_read_b64_tr_b16 a[108:109], v23 offset:36864
    ds_read_b64_tr_b16 a[110:111], v23 offset:37120
    ds_read_b64_tr_b16 a[160:161], v24 offset:4096
    ds_read_b64_tr_b16 a[162:163], v24 offset:4352
    ds_read_b64_tr_b16 a[164:165], v24 offset:36864
    ds_read_b64_tr_b16 a[166:167], v24 offset:37120
    ds_read_b64_tr_b16 a[120:121], v23 offset:8192
    ds_read_b64_tr_b16 a[122:123], v23 offset:8448
    ds_read_b64_tr_b16 a[124:125], v23 offset:40960
    ds_read_b64_tr_b16 a[126:127], v23 offset:41216
    ds_read_b64_tr_b16 a[176:177], v24 offset:8192
    ds_read_b64_tr_b16 a[178:179], v24 offset:8448
    ds_read_b64_tr_b16 a[180:181], v24 offset:40960
    ds_read_b64_tr_b16 a[182:183], v24 offset:41216
    ds_read_b64_tr_b16 a[136:137], v23 offset:12288
    ds_read_b64_tr_b16 a[138:139], v23 offset:12544
    ds_read_b64_tr_b16 a[140:141], v23 offset:45056
    ds_read_b64_tr_b16 a[142:143], v23 offset:45312
    ds_read_b64_tr_b16 a[192:193], v24 offset:12288
    ds_read_b64_tr_b16 a[194:195], v24 offset:12544
    ds_read_b64_tr_b16 a[196:197], v24 offset:45056
    ds_read_b64_tr_b16 a[198:199], v24 offset:45312
    s_waitcnt lgkmcnt(0)
    v_xor_b32 v23, 0x10000, v23
    v_xor_b32 v24, 0x10000, v24
    s_barrier
    s_load_dwordx2 s[8:9], s[0:1], 32
    s_mov_b32 s10, 4194304
    s_mov_b32 s11, 0x20000
    s_waitcnt lgkmcnt(0)
    s_lshl_b32 s24, s17, 10
    s_add_u32 m0, s24, 0
    s_mov_b32 s25, 0
    buffer_load_dwordx4 v20, s[8:11], s25 offen lds
    s_add_u32 m0, s24, 4096
    s_mov_b32 s25, 262144
    buffer_load_dwordx4 v20, s[8:11], s25 offen lds
    s_add_u32 m0, s24, 8192
    s_mov_b32 s25, 524288
    buffer_load_dwordx4 v20, s[8:11], s25 offen lds
    s_add_u32 m0, s24, 12288
    s_mov_b32 s25, 786432
    buffer_load_dwordx4 v20, s[8:11], s25 offen lds
    s_add_u32 m0, s24, 16384
    s_mov_b32 s25, 1048576
    buffer_load_dwordx4 v20, s[8:11], s25 offen lds
    s_add_u32 m0, s24, 20480
    s_mov_b32 s25, 1310720
    buffer_load_dwordx4 v20, s[8:11], s25 offen lds
    s_add_u32 m0, s24, 24576
    s_mov_b32 s25, 1572864
    buffer_load_dwordx4 v20, s[8:11], s25 offen lds
    s_add_u32 m0, s24, 28672
    s_mov_b32 s25, 1835008
    buffer_load_dwordx4 v20, s[8:11], s25 offen lds
    s_add_u32 m0, s24, 32768
    s_mov_b32 s25, 2097152
    buffer_load_dwordx4 v20, s[8:11], s25 offen lds
    s_add_u32 m0, s24, 36864
    s_mov_b32 s25, 2359296
    buffer_load_dwordx4 v20, s[8:11], s25 offen lds
    s_add_u32 m0, s24, 40960
    s_mov_b32 s25, 2621440
    buffer_load_dwordx4 v20, s[8:11], s25 offen lds
    s_add_u32 m0, s24, 45056
    s_mov_b32 s25, 2883584
    buffer_load_dwordx4 v20, s[8:11], s25 offen lds
    s_add_u32 m0, s24, 49152
    s_mov_b32 s25, 3145728
    buffer_load_dwordx4 v20, s[8:11], s25 offen lds
    s_add_u32 m0, s24, 53248
    s_mov_b32 s25, 3407872
    buffer_load_dwordx4 v20, s[8:11], s25 offen lds
    s_add_u32 m0, s24, 57344
    s_mov_b32 s25, 3670016
    buffer_load_dwordx4 v20, s[8:11], s25 offen lds
    s_add_u32 m0, s24, 61440
    s_mov_b32 s25, 3932160
    buffer_load_dwordx4 v20, s[8:11], s25 offen lds
    s_waitcnt vmcnt(16)
    s_barrier
    ds_read_b64_tr_b16 a[96:97], v23 offset:0
    ds_read_b64_tr_b16 a[98:99], v23 offset:256
    ds_read_b64_tr_b16 a[100:101], v23 offset:32768
    ds_read_b64_tr_b16 a[102:103], v23 offset:33024
    ds_read_b64_tr_b16 a[152:153], v24 offset:0
    ds_read_b64_tr_b16 a[154:155], v24 offset:256
    ds_read_b64_tr_b16 a[156:157], v24 offset:32768
    ds_read_b64_tr_b16 a[158:159], v24 offset:33024
    ds_read_b64_tr_b16 a[112:113], v23 offset:4096
    ds_read_b64_tr_b16 a[114:115], v23 offset:4352
    ds_read_b64_tr_b16 a[116:117], v23 offset:36864
    ds_read_b64_tr_b16 a[118:119], v23 offset:37120
    ds_read_b64_tr_b16 a[168:169], v24 offset:4096
    ds_read_b64_tr_b16 a[170:171], v24 offset:4352
    ds_read_b64_tr_b16 a[172:173], v24 offset:36864
    ds_read_b64_tr_b16 a[174:175], v24 offset:37120
    ds_read_b64_tr_b16 a[128:129], v23 offset:8192
    ds_read_b64_tr_b16 a[130:131], v23 offset:8448
    ds_read_b64_tr_b16 a[132:133], v23 offset:40960
    ds_read_b64_tr_b16 a[134:135], v23 offset:41216
    ds_read_b64_tr_b16 a[184:185], v24 offset:8192
    ds_read_b64_tr_b16 a[186:187], v24 offset:8448
    ds_read_b64_tr_b16 a[188:189], v24 offset:40960
    ds_read_b64_tr_b16 a[190:191], v24 offset:41216
    ds_read_b64_tr_b16 a[144:145], v23 offset:12288
    ds_read_b64_tr_b16 a[146:147], v23 offset:12544
    ds_read_b64_tr_b16 a[148:149], v23 offset:45056
    ds_read_b64_tr_b16 a[150:151], v23 offset:45312
    ds_read_b64_tr_b16 a[200:201], v24 offset:12288
    ds_read_b64_tr_b16 a[202:203], v24 offset:12544
    ds_read_b64_tr_b16 a[204:205], v24 offset:45056
    ds_read_b64_tr_b16 a[206:207], v24 offset:45312
    s_waitcnt lgkmcnt(0)
    v_xor_b32 v23, 0x10000, v23
    v_xor_b32 v24, 0x10000, v24
    s_barrier
    s_lshl_b32 s24, s17, 10
    s_add_u32 m0, s24, 65536
    s_mov_b32 s25, 65536
    buffer_load_dwordx4 v20, s[8:11], s25 offen lds
    s_add_u32 m0, s24, 69632
    s_mov_b32 s25, 327680
    buffer_load_dwordx4 v20, s[8:11], s25 offen lds
    s_add_u32 m0, s24, 73728
    s_mov_b32 s25, 589824
    buffer_load_dwordx4 v20, s[8:11], s25 offen lds
    s_add_u32 m0, s24, 77824
    s_mov_b32 s25, 851968
    buffer_load_dwordx4 v20, s[8:11], s25 offen lds
    s_add_u32 m0, s24, 81920
    s_mov_b32 s25, 1114112
    buffer_load_dwordx4 v20, s[8:11], s25 offen lds
    s_add_u32 m0, s24, 86016
    s_mov_b32 s25, 1376256
    buffer_load_dwordx4 v20, s[8:11], s25 offen lds
    s_add_u32 m0, s24, 90112
    s_mov_b32 s25, 1638400
    buffer_load_dwordx4 v20, s[8:11], s25 offen lds
    s_add_u32 m0, s24, 94208
    s_mov_b32 s25, 1900544
    buffer_load_dwordx4 v20, s[8:11], s25 offen lds
    s_add_u32 m0, s24, 98304
    s_mov_b32 s25, 2162688
    buffer_load_dwordx4 v20, s[8:11], s25 offen lds
    s_add_u32 m0, s24, 102400
    s_mov_b32 s25, 2424832
    buffer_load_dwordx4 v20, s[8:11], s25 offen lds
    s_add_u32 m0, s24, 106496
    s_mov_b32 s25, 2686976
    buffer_load_dwordx4 v20, s[8:11], s25 offen lds
    s_add_u32 m0, s24, 110592
    s_mov_b32 s25, 2949120
    buffer_load_dwordx4 v20, s[8:11], s25 offen lds
    s_add_u32 m0, s24, 114688
    s_mov_b32 s25, 3211264
    buffer_load_dwordx4 v20, s[8:11], s25 offen lds
    s_add_u32 m0, s24, 118784
    s_mov_b32 s25, 3473408
    buffer_load_dwordx4 v20, s[8:11], s25 offen lds
    s_add_u32 m0, s24, 122880
    s_mov_b32 s25, 3735552
    buffer_load_dwordx4 v20, s[8:11], s25 offen lds
    s_add_u32 m0, s24, 126976
    s_mov_b32 s25, 3997696
    buffer_load_dwordx4 v20, s[8:11], s25 offen lds
    s_waitcnt vmcnt(16)
    s_barrier
    ds_read_b64_tr_b16 a[208:209], v23 offset:0
    ds_read_b64_tr_b16 a[210:211], v23 offset:256
    ds_read_b64_tr_b16 a[212:213], v23 offset:32768
    ds_read_b64_tr_b16 a[214:215], v23 offset:33024
    ds_read_b64_tr_b16 v[144:145], v24 offset:0
    ds_read_b64_tr_b16 v[146:147], v24 offset:256
    ds_read_b64_tr_b16 v[148:149], v24 offset:32768
    ds_read_b64_tr_b16 v[150:151], v24 offset:33024
    ds_read_b64_tr_b16 a[224:225], v23 offset:4096
    ds_read_b64_tr_b16 a[226:227], v23 offset:4352
    ds_read_b64_tr_b16 a[228:229], v23 offset:36864
    ds_read_b64_tr_b16 a[230:231], v23 offset:37120
    ds_read_b64_tr_b16 v[160:161], v24 offset:4096
    ds_read_b64_tr_b16 v[162:163], v24 offset:4352
    ds_read_b64_tr_b16 v[164:165], v24 offset:36864
    ds_read_b64_tr_b16 v[166:167], v24 offset:37120
    ds_read_b64_tr_b16 a[240:241], v23 offset:8192
    ds_read_b64_tr_b16 a[242:243], v23 offset:8448
    ds_read_b64_tr_b16 a[244:245], v23 offset:40960
    ds_read_b64_tr_b16 a[246:247], v23 offset:41216
    ds_read_b64_tr_b16 v[176:177], v24 offset:8192
    ds_read_b64_tr_b16 v[178:179], v24 offset:8448
    ds_read_b64_tr_b16 v[180:181], v24 offset:40960
    ds_read_b64_tr_b16 v[182:183], v24 offset:41216
    ds_read_b64_tr_b16 v[128:129], v23 offset:12288
    ds_read_b64_tr_b16 v[130:131], v23 offset:12544
    ds_read_b64_tr_b16 v[132:133], v23 offset:45056
    ds_read_b64_tr_b16 v[134:135], v23 offset:45312
    ds_read_b64_tr_b16 v[192:193], v24 offset:12288
    ds_read_b64_tr_b16 v[194:195], v24 offset:12544
    ds_read_b64_tr_b16 v[196:197], v24 offset:45056
    ds_read_b64_tr_b16 v[198:199], v24 offset:45312
    s_waitcnt lgkmcnt(0)
    v_xor_b32 v23, 0x10000, v23
    v_xor_b32 v24, 0x10000, v24
    s_barrier
    s_load_dwordx2 s[8:9], s[0:1], 16
    s_mov_b32 s10, 4194304
    s_mov_b32 s11, 0x20000
    s_waitcnt lgkmcnt(0)
    s_lshl_b32 s24, s17, 10
    s_add_u32 m0, s24, 0
    s_mov_b32 s25, 0
    buffer_load_dwordx4 v20, s[8:11], s25 offen lds
    s_add_u32 m0, s24, 4096
    s_mov_b32 s25, 262144
    buffer_load_dwordx4 v20, s[8:11], s25 offen lds
    s_add_u32 m0, s24, 8192
    s_mov_b32 s25, 524288
    buffer_load_dwordx4 v20, s[8:11], s25 offen lds
    s_add_u32 m0, s24, 12288
    s_mov_b32 s25, 786432
    buffer_load_dwordx4 v20, s[8:11], s25 offen lds
    s_add_u32 m0, s24, 16384
    s_mov_b32 s25, 1048576
    buffer_load_dwordx4 v20, s[8:11], s25 offen lds
    s_add_u32 m0, s24, 20480
    s_mov_b32 s25, 1310720
    buffer_load_dwordx4 v20, s[8:11], s25 offen lds
    s_add_u32 m0, s24, 24576
    s_mov_b32 s25, 1572864
    buffer_load_dwordx4 v20, s[8:11], s25 offen lds
    s_add_u32 m0, s24, 28672
    s_mov_b32 s25, 1835008
    buffer_load_dwordx4 v20, s[8:11], s25 offen lds
    s_add_u32 m0, s24, 32768
    s_mov_b32 s25, 2097152
    buffer_load_dwordx4 v20, s[8:11], s25 offen lds
    s_add_u32 m0, s24, 36864
    s_mov_b32 s25, 2359296
    buffer_load_dwordx4 v20, s[8:11], s25 offen lds
    s_add_u32 m0, s24, 40960
    s_mov_b32 s25, 2621440
    buffer_load_dwordx4 v20, s[8:11], s25 offen lds
    s_add_u32 m0, s24, 45056
    s_mov_b32 s25, 2883584
    buffer_load_dwordx4 v20, s[8:11], s25 offen lds
    s_add_u32 m0, s24, 49152
    s_mov_b32 s25, 3145728
    buffer_load_dwordx4 v20, s[8:11], s25 offen lds
    s_add_u32 m0, s24, 53248
    s_mov_b32 s25, 3407872
    buffer_load_dwordx4 v20, s[8:11], s25 offen lds
    s_add_u32 m0, s24, 57344
    s_mov_b32 s25, 3670016
    buffer_load_dwordx4 v20, s[8:11], s25 offen lds
    s_add_u32 m0, s24, 61440
    s_mov_b32 s25, 3932160
    buffer_load_dwordx4 v20, s[8:11], s25 offen lds
    s_waitcnt vmcnt(16)
    s_barrier
    ds_read_b64_tr_b16 a[216:217], v23 offset:0
    ds_read_b64_tr_b16 a[218:219], v23 offset:256
    ds_read_b64_tr_b16 a[220:221], v23 offset:32768
    ds_read_b64_tr_b16 a[222:223], v23 offset:33024
    ds_read_b64_tr_b16 v[152:153], v24 offset:0
    ds_read_b64_tr_b16 v[154:155], v24 offset:256
    ds_read_b64_tr_b16 v[156:157], v24 offset:32768
    ds_read_b64_tr_b16 v[158:159], v24 offset:33024
    ds_read_b64_tr_b16 a[232:233], v23 offset:4096
    ds_read_b64_tr_b16 a[234:235], v23 offset:4352
    ds_read_b64_tr_b16 a[236:237], v23 offset:36864
    ds_read_b64_tr_b16 a[238:239], v23 offset:37120
    ds_read_b64_tr_b16 v[168:169], v24 offset:4096
    ds_read_b64_tr_b16 v[170:171], v24 offset:4352
    ds_read_b64_tr_b16 v[172:173], v24 offset:36864
    ds_read_b64_tr_b16 v[174:175], v24 offset:37120
    ds_read_b64_tr_b16 a[248:249], v23 offset:8192
    ds_read_b64_tr_b16 a[250:251], v23 offset:8448
    ds_read_b64_tr_b16 a[252:253], v23 offset:40960
    ds_read_b64_tr_b16 a[254:255], v23 offset:41216
    ds_read_b64_tr_b16 v[184:185], v24 offset:8192
    ds_read_b64_tr_b16 v[186:187], v24 offset:8448
    ds_read_b64_tr_b16 v[188:189], v24 offset:40960
    ds_read_b64_tr_b16 v[190:191], v24 offset:41216
    ds_read_b64_tr_b16 v[136:137], v23 offset:12288
    ds_read_b64_tr_b16 v[138:139], v23 offset:12544
    ds_read_b64_tr_b16 v[140:141], v23 offset:45056
    ds_read_b64_tr_b16 v[142:143], v23 offset:45312
    ds_read_b64_tr_b16 v[200:201], v24 offset:12288
    ds_read_b64_tr_b16 v[202:203], v24 offset:12544
    ds_read_b64_tr_b16 v[204:205], v24 offset:45056
    ds_read_b64_tr_b16 v[206:207], v24 offset:45312
    s_waitcnt lgkmcnt(0)
    v_xor_b32 v23, 0x10000, v23
    v_xor_b32 v24, 0x10000, v24
    s_barrier
    s_lshl_b32 s24, s17, 10
    s_add_u32 m0, s24, 65536
    s_mov_b32 s25, 65536
    buffer_load_dwordx4 v20, s[8:11], s25 offen lds
    s_add_u32 m0, s24, 69632
    s_mov_b32 s25, 327680
    buffer_load_dwordx4 v20, s[8:11], s25 offen lds
    s_add_u32 m0, s24, 73728
    s_mov_b32 s25, 589824
    buffer_load_dwordx4 v20, s[8:11], s25 offen lds
    s_add_u32 m0, s24, 77824
    s_mov_b32 s25, 851968
    buffer_load_dwordx4 v20, s[8:11], s25 offen lds
    s_add_u32 m0, s24, 81920
    s_mov_b32 s25, 1114112
    buffer_load_dwordx4 v20, s[8:11], s25 offen lds
    s_add_u32 m0, s24, 86016
    s_mov_b32 s25, 1376256
    buffer_load_dwordx4 v20, s[8:11], s25 offen lds
    s_add_u32 m0, s24, 90112
    s_mov_b32 s25, 1638400
    buffer_load_dwordx4 v20, s[8:11], s25 offen lds
    s_add_u32 m0, s24, 94208
    s_mov_b32 s25, 1900544
    buffer_load_dwordx4 v20, s[8:11], s25 offen lds
    s_add_u32 m0, s24, 98304
    s_mov_b32 s25, 2162688
    buffer_load_dwordx4 v20, s[8:11], s25 offen lds
    s_add_u32 m0, s24, 102400
    s_mov_b32 s25, 2424832
    buffer_load_dwordx4 v20, s[8:11], s25 offen lds
    s_add_u32 m0, s24, 106496
    s_mov_b32 s25, 2686976
    buffer_load_dwordx4 v20, s[8:11], s25 offen lds
    s_add_u32 m0, s24, 110592
    s_mov_b32 s25, 2949120
    buffer_load_dwordx4 v20, s[8:11], s25 offen lds
    s_add_u32 m0, s24, 114688
    s_mov_b32 s25, 3211264
    buffer_load_dwordx4 v20, s[8:11], s25 offen lds
    s_add_u32 m0, s24, 118784
    s_mov_b32 s25, 3473408
    buffer_load_dwordx4 v20, s[8:11], s25 offen lds
    s_add_u32 m0, s24, 122880
    s_mov_b32 s25, 3735552
    buffer_load_dwordx4 v20, s[8:11], s25 offen lds
    s_add_u32 m0, s24, 126976
    s_mov_b32 s25, 3997696
    buffer_load_dwordx4 v20, s[8:11], s25 offen lds
    s_waitcnt vmcnt(16)
    s_barrier
    ds_read_b64_tr_b16 v[32:33], v23 offset:0
    ds_read_b64_tr_b16 v[34:35], v23 offset:256
    ds_read_b64_tr_b16 v[36:37], v23 offset:32768
    ds_read_b64_tr_b16 v[38:39], v23 offset:33024
    ds_read_b64_tr_b16 v[40:41], v24 offset:0
    ds_read_b64_tr_b16 v[42:43], v24 offset:256
    ds_read_b64_tr_b16 v[44:45], v24 offset:32768
    ds_read_b64_tr_b16 v[46:47], v24 offset:33024
    ds_read_b64_tr_b16 a[0:1], v23 offset:4096
    ds_read_b64_tr_b16 a[2:3], v23 offset:4352
    ds_read_b64_tr_b16 a[4:5], v23 offset:36864
    ds_read_b64_tr_b16 a[6:7], v23 offset:37120
    ds_read_b64_tr_b16 a[48:49], v24 offset:4096
    ds_read_b64_tr_b16 a[50:51], v24 offset:4352
    ds_read_b64_tr_b16 a[52:53], v24 offset:36864
    ds_read_b64_tr_b16 a[54:55], v24 offset:37120
    ds_read_b64_tr_b16 a[16:17], v23 offset:8192
    ds_read_b64_tr_b16 a[18:19], v23 offset:8448
    ds_read_b64_tr_b16 a[20:21], v23 offset:40960
    ds_read_b64_tr_b16 a[22:23], v23 offset:41216
    ds_read_b64_tr_b16 a[64:65], v24 offset:8192
    ds_read_b64_tr_b16 a[66:67], v24 offset:8448
    ds_read_b64_tr_b16 a[68:69], v24 offset:40960
    ds_read_b64_tr_b16 a[70:71], v24 offset:41216
    ds_read_b64_tr_b16 a[32:33], v23 offset:12288
    ds_read_b64_tr_b16 a[34:35], v23 offset:12544
    ds_read_b64_tr_b16 a[36:37], v23 offset:45056
    ds_read_b64_tr_b16 a[38:39], v23 offset:45312
    ds_read_b64_tr_b16 a[80:81], v24 offset:12288
    ds_read_b64_tr_b16 a[82:83], v24 offset:12544
    ds_read_b64_tr_b16 a[84:85], v24 offset:45056
    ds_read_b64_tr_b16 a[86:87], v24 offset:45312
    s_waitcnt lgkmcnt(0)
    v_xor_b32 v23, 0x10000, v23
    v_xor_b32 v24, 0x10000, v24
    s_barrier
    s_load_dwordx2 s[8:9], s[0:1], 40
    s_mov_b32 s10, 4194304
    s_mov_b32 s11, 0x20000
    s_waitcnt lgkmcnt(0)
    s_lshl_b32 s24, s17, 14
    s_add_u32 m0, s24, 0
    s_mov_b32 s25, 0
    buffer_load_dwordx4 v21, s[8:11], s25 offen lds
    s_add_u32 m0, s24, 1024
    s_mov_b32 s25, 1024
    buffer_load_dwordx4 v22, s[8:11], s25 offen lds
    s_add_u32 m0, s24, 2048
    s_mov_b32 s25, 2048
    buffer_load_dwordx4 v21, s[8:11], s25 offen lds
    s_add_u32 m0, s24, 3072
    s_mov_b32 s25, 3072
    buffer_load_dwordx4 v22, s[8:11], s25 offen lds
    s_add_u32 m0, s24, 4096
    s_mov_b32 s25, 4096
    buffer_load_dwordx4 v21, s[8:11], s25 offen lds
    s_add_u32 m0, s24, 5120
    s_mov_b32 s25, 5120
    buffer_load_dwordx4 v22, s[8:11], s25 offen lds
    s_add_u32 m0, s24, 6144
    s_mov_b32 s25, 6144
    buffer_load_dwordx4 v21, s[8:11], s25 offen lds
    s_add_u32 m0, s24, 7168
    s_mov_b32 s25, 7168
    buffer_load_dwordx4 v22, s[8:11], s25 offen lds
    s_add_u32 m0, s24, 8192
    s_mov_b32 s25, 65536
    buffer_load_dwordx4 v21, s[8:11], s25 offen lds
    s_add_u32 m0, s24, 9216
    s_mov_b32 s25, 66560
    buffer_load_dwordx4 v22, s[8:11], s25 offen lds
    s_add_u32 m0, s24, 10240
    s_mov_b32 s25, 67584
    buffer_load_dwordx4 v21, s[8:11], s25 offen lds
    s_add_u32 m0, s24, 11264
    s_mov_b32 s25, 68608
    buffer_load_dwordx4 v22, s[8:11], s25 offen lds
    s_add_u32 m0, s24, 12288
    s_mov_b32 s25, 69632
    buffer_load_dwordx4 v21, s[8:11], s25 offen lds
    s_add_u32 m0, s24, 13312
    s_mov_b32 s25, 70656
    buffer_load_dwordx4 v22, s[8:11], s25 offen lds
    s_add_u32 m0, s24, 14336
    s_mov_b32 s25, 71680
    buffer_load_dwordx4 v21, s[8:11], s25 offen lds
    s_add_u32 m0, s24, 15360
    s_mov_b32 s25, 72704
    buffer_load_dwordx4 v22, s[8:11], s25 offen lds
    v_mov_b32 v28, 200
    buffer_load_dwordx2 v[2:3], v28, s[12:15], 0 offen sc1
    s_waitcnt vmcnt(17)
    s_barrier
    ds_read_b64_tr_b16 v[64:65], v23 offset:0
    ds_read_b64_tr_b16 v[66:67], v23 offset:256
    ds_read_b64_tr_b16 v[68:69], v23 offset:32768
    ds_read_b64_tr_b16 v[70:71], v23 offset:33024
    ds_read_b64_tr_b16 v[72:73], v24 offset:0
    ds_read_b64_tr_b16 v[74:75], v24 offset:256
    ds_read_b64_tr_b16 v[76:77], v24 offset:32768
    ds_read_b64_tr_b16 v[78:79], v24 offset:33024
    ds_read_b64_tr_b16 a[8:9], v23 offset:4096
    ds_read_b64_tr_b16 a[10:11], v23 offset:4352
    ds_read_b64_tr_b16 a[12:13], v23 offset:36864
    ds_read_b64_tr_b16 a[14:15], v23 offset:37120
    ds_read_b64_tr_b16 a[56:57], v24 offset:4096
    ds_read_b64_tr_b16 a[58:59], v24 offset:4352
    ds_read_b64_tr_b16 a[60:61], v24 offset:36864
    ds_read_b64_tr_b16 a[62:63], v24 offset:37120
    ds_read_b64_tr_b16 a[24:25], v23 offset:8192
    ds_read_b64_tr_b16 a[26:27], v23 offset:8448
    ds_read_b64_tr_b16 a[28:29], v23 offset:40960
    ds_read_b64_tr_b16 a[30:31], v23 offset:41216
    ds_read_b64_tr_b16 a[72:73], v24 offset:8192
    ds_read_b64_tr_b16 a[74:75], v24 offset:8448
    ds_read_b64_tr_b16 a[76:77], v24 offset:40960
    ds_read_b64_tr_b16 a[78:79], v24 offset:41216
    ds_read_b64_tr_b16 a[40:41], v23 offset:12288
    ds_read_b64_tr_b16 a[42:43], v23 offset:12544
    ds_read_b64_tr_b16 a[44:45], v23 offset:45056
    ds_read_b64_tr_b16 a[46:47], v23 offset:45312
    ds_read_b64_tr_b16 a[88:89], v24 offset:12288
    ds_read_b64_tr_b16 a[90:91], v24 offset:12544
    ds_read_b64_tr_b16 a[92:93], v24 offset:45056
    ds_read_b64_tr_b16 a[94:95], v24 offset:45312
    s_waitcnt lgkmcnt(0)
    v_xor_b32 v23, 0x10000, v23
    v_xor_b32 v24, 0x10000, v24
    s_barrier
    s_lshl_b32 s24, s17, 14
    s_add_u32 m0, s24, 65536
    s_mov_b32 s25, 8192
    buffer_load_dwordx4 v21, s[8:11], s25 offen lds
    s_add_u32 m0, s24, 66560
    s_mov_b32 s25, 9216
    buffer_load_dwordx4 v22, s[8:11], s25 offen lds
    s_add_u32 m0, s24, 67584
    s_mov_b32 s25, 10240
    buffer_load_dwordx4 v21, s[8:11], s25 offen lds
    s_add_u32 m0, s24, 68608
    s_mov_b32 s25, 11264
    buffer_load_dwordx4 v22, s[8:11], s25 offen lds
    s_add_u32 m0, s24, 69632
    s_mov_b32 s25, 12288
    buffer_load_dwordx4 v21, s[8:11], s25 offen lds
    s_add_u32 m0, s24, 70656
    s_mov_b32 s25, 13312
    buffer_load_dwordx4 v22, s[8:11], s25 offen lds
    s_add_u32 m0, s24, 71680
    s_mov_b32 s25, 14336
    buffer_load_dwordx4 v21, s[8:11], s25 offen lds
    s_add_u32 m0, s24, 72704
    s_mov_b32 s25, 15360
    buffer_load_dwordx4 v22, s[8:11], s25 offen lds
    s_add_u32 m0, s24, 73728
    s_mov_b32 s25, 73728
    buffer_load_dwordx4 v21, s[8:11], s25 offen lds
    s_add_u32 m0, s24, 74752
    s_mov_b32 s25, 74752
    buffer_load_dwordx4 v22, s[8:11], s25 offen lds
    s_add_u32 m0, s24, 75776
    s_mov_b32 s25, 75776
    buffer_load_dwordx4 v21, s[8:11], s25 offen lds
    s_add_u32 m0, s24, 76800
    s_mov_b32 s25, 76800
    buffer_load_dwordx4 v22, s[8:11], s25 offen lds
    s_add_u32 m0, s24, 77824
    s_mov_b32 s25, 77824
    buffer_load_dwordx4 v21, s[8:11], s25 offen lds
    s_add_u32 m0, s24, 78848
    s_mov_b32 s25, 78848
    buffer_load_dwordx4 v22, s[8:11], s25 offen lds
    s_add_u32 m0, s24, 79872
    s_mov_b32 s25, 79872
    buffer_load_dwordx4 v21, s[8:11], s25 offen lds
    s_add_u32 m0, s24, 80896
    s_mov_b32 s25, 80896
    buffer_load_dwordx4 v22, s[8:11], s25 offen lds
    s_waitcnt vmcnt(16)
    s_barrier
    v_readfirstlane_b32 s43, v2
    v_readfirstlane_b32 s42, v3
    s_cmp_lt_u32 s43, 64
    s_cbranch_scc1 L_ch_slow
    s_and_b32 s43, s42, 0xffff
    s_cmp_ge_u32 s43, 32
    s_cbranch_scc1 L_ch_fast
L_ch_slow:
    v_mov_b32 v3, 200
wt_2:
    buffer_load_dword v2, v3, s[12:15], 0 offen sc1
    s_add_u32 s23, s23, 1
    s_waitcnt vmcnt(0)
    v_readfirstlane_b32 s42, v2
    s_cmp_gt_u32 s23, 262144
    s_cbranch_scc1 wte_3
    s_cmp_ge_u32 s42, 64
    s_cbranch_scc1 wte_3
    s_sleep 4
    s_branch wt_2
wte_3:
    v_mov_b32 v3, 204
wt_4:
    buffer_load_dword v2, v3, s[12:15], 0 offen sc1
    s_add_u32 s23, s23, 1
    s_waitcnt vmcnt(0)
    v_readfirstlane_b32 s42, v2
    s_cmp_gt_u32 s23, 262144
    s_cbranch_scc1 wte_5
    s_and_b32 s43, s42, 65535
    s_cmp_ge_u32 s43, 32
    s_cbranch_scc1 wte_5
    s_sleep 4
    s_branch wt_4
wte_5:
L_ch_fast:
    s_add_u32 m0, s29, 8192
    s_add_u32 s43, s33, 50331648
    buffer_load_dwordx4 v4, s[4:7], s43 offen offset:0 sc1 lds
    buffer_load_dwordx4 v4, s[4:7], s43 offen offset:1024 sc1 lds
    s_add_u32 s43, s33, 50593792
    buffer_load_dwordx4 v4, s[4:7], s43 offen offset:0 sc1 lds
    buffer_load_dwordx4 v4, s[4:7], s43 offen offset:1024 sc1 lds
    s_lshl_b32 s43, s16, 10
    s_add_u32 s43, s43, 51249152
    buffer_load_dwordx4 v1, s[4:7], s43 offen sc1 lds
    v_lshrrev_b32 v2, 2, v1
    s_lshl_b32 s27, s16, 8
    v_subrev_u32 v2, 32768, v2
    s_add_u32 s27, s27, 0
    buffer_load_dword v14, v2, s[4:7], s27 offen sc1
    s_xor_b32 s25, s17, 0
    s_lshr_b32 s26, s25, 1
    s_lshl_b32 s26, s26, 13
    s_and_b32 s25, s25, 1
    s_lshl_b32 s25, s25, 15
    s_add_u32 s25, s25, s26
    s_add_u32 s25, s25, 0
    v_add_u32 v26, s25, v25
    v_xor_b32 v27, 0, v26
    ds_read_b64_tr_b16 v[208:209], v27 offset:0
    ds_read_b64_tr_b16 v[210:211], v27 offset:2048
    v_xor_b32 v27, 64, v26
    ds_read_b64_tr_b16 v[232:233], v27 offset:0
    ds_read_b64_tr_b16 v[234:235], v27 offset:2048
    v_xor_b32 v27, 128, v26
    ds_read_b64_tr_b16 v[240:241], v27 offset:0
    ds_read_b64_tr_b16 v[242:243], v27 offset:2048
    v_xor_b32 v27, 192, v26
    ds_read_b64_tr_b16 v[248:249], v27 offset:0
    ds_read_b64_tr_b16 v[250:251], v27 offset:2048
    s_xor_b32 s25, s17, 1
    s_lshr_b32 s26, s25, 1
    s_lshl_b32 s26, s26, 13
    s_and_b32 s25, s25, 1
    s_lshl_b32 s25, s25, 15
    s_add_u32 s25, s25, s26
    s_add_u32 s25, s25, 0
    v_add_u32 v26, s25, v25
    v_xor_b32 v27, 0, v26
    ds_read_b64_tr_b16 v[216:217], v27 offset:0
    ds_read_b64_tr_b16 v[218:219], v27 offset:2048
    v_xor_b32 v27, 64, v26
    ds_read_b64_tr_b16 v[84:85], v27 offset:0
    ds_read_b64_tr_b16 v[86:87], v27 offset:2048
    v_xor_b32 v27, 128, v26
    ds_read_b64_tr_b16 v[96:97], v27 offset:0
    ds_read_b64_tr_b16 v[98:99], v27 offset:2048
    v_xor_b32 v27, 192, v26
    ds_read_b64_tr_b16 v[108:109], v27 offset:0
    ds_read_b64_tr_b16 v[110:111], v27 offset:2048
    s_xor_b32 s25, s17, 2
    s_lshr_b32 s26, s25, 1
    s_lshl_b32 s26, s26, 13
    s_and_b32 s25, s25, 1
    s_lshl_b32 s25, s25, 15
    s_add_u32 s25, s25, s26
    s_add_u32 s25, s25, 0
    v_add_u32 v26, s25, v25
    v_xor_b32 v27, 0, v26
    ds_read_b64_tr_b16 v[80:81], v27 offset:0
    ds_read_b64_tr_b16 v[82:83], v27 offset:2048
    v_xor_b32 v27, 64, v26
    ds_read_b64_tr_b16 v[92:93], v27 offset:0
    ds_read_b64_tr_b16 v[94:95], v27 offset:2048
    v_xor_b32 v27, 128, v26
    ds_read_b64_tr_b16 v[104:105], v27 offset:0
    ds_read_b64_tr_b16 v[106:107], v27 offset:2048
    v_xor_b32 v27, 192, v26
    ds_read_b64_tr_b16 v[116:117], v27 offset:0
    ds_read_b64_tr_b16 v[118:119], v27 offset:2048
    s_xor_b32 s25, s17, 3
    s_lshr_b32 s26, s25, 1
    s_lshl_b32 s26, s26, 13
    s_and_b32 s25, s25, 1
    s_lshl_b32 s25, s25, 15
    s_add_u32 s25, s25, s26
    s_add_u32 s25, s25, 0
    v_add_u32 v26, s25, v25
    v_xor_b32 v27, 0, v26
    ds_read_b64_tr_b16 v[224:225], v27 offset:0
    ds_read_b64_tr_b16 v[226:227], v27 offset:2048
    v_xor_b32 v27, 64, v26
    ds_read_b64_tr_b16 v[88:89], v27 offset:0
    ds_read_b64_tr_b16 v[90:91], v27 offset:2048
    v_xor_b32 v27, 128, v26
    ds_read_b64_tr_b16 v[100:101], v27 offset:0
    ds_read_b64_tr_b16 v[102:103], v27 offset:2048
    v_xor_b32 v27, 192, v26
    ds_read_b64_tr_b16 v[112:113], v27 offset:0
    ds_read_b64_tr_b16 v[114:115], v27 offset:2048
    s_waitcnt lgkmcnt(0)
    s_barrier
    ds_write_b128 v11, v[32:35] offset:0
    ds_write_b128 v11, v[40:43] offset:1024
    ds_write_b128 v11, v[48:51] offset:2048
    ds_write_b128 v11, v[56:59] offset:3072
    ds_write_b128 v11, v[64:67] offset:4096
    ds_write_b128 v11, v[72:75] offset:5120
    ds_write_b128 v11, v[80:83] offset:6144
    ds_write_b128 v11, v[84:87] offset:7168
    ds_write_b128 v11, v[88:91] offset:8192
    ds_write_b128 v11, v[92:95] offset:9216
    ds_write_b128 v11, v[96:99] offset:10240
    ds_write_b128 v11, v[100:103] offset:11264
    ds_write_b128 v11, v[104:107] offset:12288
    ds_write_b128 v11, v[108:111] offset:13312
    ds_write_b128 v11, v[112:115] offset:14336
    ds_write_b128 v11, v[116:119] offset:15360
    s_waitcnt lgkmcnt(0)
    s_waitcnt vmcnt(0)
    s_barrier
    s_branch CI_kve
CI_kvw:
    v_lshrrev_b32 v2, 2, v1
    s_lshl_b32 s27, s16, 8
    v_subrev_u32 v2, 32768, v2
    s_add_u32 s27, s27, 0
    buffer_load_dword v14, v2, s[4:7], s27 offen sc1
    s_add_u32 s23, s23, 1
    s_waitcnt vmcnt(0)
CI_kve:
    v_cmp_ne_u32 vcc, 0, v14
    s_nop 0
    s_ff0_i32_b64 s38, vcc
    s_cmp_gt_u32 s23, 262144
    s_cbranch_scc1 CI_kvw_done
    s_add_u32 s27, s18, 0
    s_cmp_ge_u32 s27, s38
    s_cbranch_scc1 CI_kvw
CI_kvw_done:
    s_mov_b32 m0, s29
    s_add_u32 s27, s21, 8192
    buffer_load_dwordx4 v4, s[4:7], s21 offen sc1 lds
    buffer_load_dwordx4 v4, s[4:7], s21 offen offset:1024 sc1 lds
    s_mov_b32 m0, s30
    s_xor_b32 s29, s29, 8192
    buffer_load_dwordx4 v4, s[4:7], s27 offen sc1 lds
    buffer_load_dwordx4 v4, s[4:7], s27 offen offset:1024 sc1 lds
    s_add_u32 s21, s21, 524288
    s_xor_b32 s25, s17, 0
    s_lshr_b32 s26, s25, 1
    s_lshl_b32 s26, s26, 13
    s_and_b32 s25, s25, 1
    s_lshl_b32 s25, s25, 15
    s_add_u32 s25, s25, s26
    s_add_u32 s25, s25, 65536
    v_add_u32 v26, s25, v25
    v_xor_b32 v27, 0, v26
    ds_read_b64_tr_b16 v[212:213], v27 offset:0
    ds_read_b64_tr_b16 v[214:215], v27 offset:2048
    v_xor_b32 v27, 64, v26
    ds_read_b64_tr_b16 v[236:237], v27 offset:0
    ds_read_b64_tr_b16 v[238:239], v27 offset:2048
    v_xor_b32 v27, 128, v26
    ds_read_b64_tr_b16 v[244:245], v27 offset:0
    ds_read_b64_tr_b16 v[246:247], v27 offset:2048
    v_xor_b32 v27, 192, v26
    ds_read_b64_tr_b16 v[252:253], v27 offset:0
    ds_read_b64_tr_b16 v[254:255], v27 offset:2048
    s_xor_b32 s25, s17, 1
    s_lshr_b32 s26, s25, 1
    s_lshl_b32 s26, s26, 13
    s_and_b32 s25, s25, 1
    s_lshl_b32 s25, s25, 15
    s_add_u32 s25, s25, s26
    s_add_u32 s25, s25, 65536
    v_add_u32 v26, s25, v25
    v_xor_b32 v27, 0, v26
    ds_read_b64_tr_b16 v[220:221], v27 offset:0
    ds_read_b64_tr_b16 v[222:223], v27 offset:2048
    v_xor_b32 v27, 64, v26
    ds_read_b64_tr_b16 v[84:85], v27 offset:0
    ds_read_b64_tr_b16 v[86:87], v27 offset:2048
    v_xor_b32 v27, 128, v26
    ds_read_b64_tr_b16 v[96:97], v27 offset:0
    ds_read_b64_tr_b16 v[98:99], v27 offset:2048
    v_xor_b32 v27, 192, v26
    ds_read_b64_tr_b16 v[108:109], v27 offset:0
    ds_read_b64_tr_b16 v[110:111], v27 offset:2048
    s_xor_b32 s25, s17, 2
    s_lshr_b32 s26, s25, 1
    s_lshl_b32 s26, s26, 13
    s_and_b32 s25, s25, 1
    s_lshl_b32 s25, s25, 15
    s_add_u32 s25, s25, s26
    s_add_u32 s25, s25, 65536
    v_add_u32 v26, s25, v25
    v_xor_b32 v27, 0, v26
    ds_read_b64_tr_b16 v[80:81], v27 offset:0
    ds_read_b64_tr_b16 v[82:83], v27 offset:2048
    v_xor_b32 v27, 64, v26
    ds_read_b64_tr_b16 v[92:93], v27 offset:0
    ds_read_b64_tr_b16 v[94:95], v27 offset:2048
    v_xor_b32 v27, 128, v26
    ds_read_b64_tr_b16 v[104:105], v27 offset:0
    ds_read_b64_tr_b16 v[106:107], v27 offset:2048
    v_xor_b32 v27, 192, v26
    ds_read_b64_tr_b16 v[116:117], v27 offset:0
    ds_read_b64_tr_b16 v[118:119], v27 offset:2048
    s_xor_b32 s25, s17, 3
    s_lshr_b32 s26, s25, 1
    s_lshl_b32 s26, s26, 13
    s_and_b32 s25, s25, 1
    s_lshl_b32 s25, s25, 15
    s_add_u32 s25, s25, s26
    s_add_u32 s25, s25, 65536
    v_add_u32 v26, s25, v25
    v_xor_b32 v27, 0, v26
    ds_read_b64_tr_b16 v[228:229], v27 offset:0
    ds_read_b64_tr_b16 v[230:231], v27 offset:2048
    v_xor_b32 v27, 64, v26
    ds_read_b64_tr_b16 v[88:89], v27 offset:0
    ds_read_b64_tr_b16 v[90:91], v27 offset:2048
    v_xor_b32 v27, 128, v26
    ds_read_b64_tr_b16 v[100:101], v27 offset:0
    ds_read_b64_tr_b16 v[102:103], v27 offset:2048
    v_xor_b32 v27, 192, v26
    ds_read_b64_tr_b16 v[112:113], v27 offset:0
    ds_read_b64_tr_b16 v[114:115], v27 offset:2048
    s_waitcnt lgkmcnt(0)
    s_barrier
    ds_write_b128 v12, v[36:39] offset:0
    ds_write_b128 v12, v[44:47] offset:1024
    ds_write_b128 v12, v[52:55] offset:2048
    ds_write_b128 v12, v[60:63] offset:3072
    ds_write_b128 v12, v[68:71] offset:4096
    ds_write_b128 v12, v[76:79] offset:5120
    ds_write_b128 v12, v[80:83] offset:6144
    ds_write_b128 v12, v[84:87] offset:7168
    ds_write_b128 v12, v[88:91] offset:8192
    ds_write_b128 v12, v[92:95] offset:9216
    ds_write_b128 v12, v[96:99] offset:10240
    ds_write_b128 v12, v[100:103] offset:11264
    ds_write_b128 v12, v[104:107] offset:12288
    ds_write_b128 v12, v[108:111] offset:13312
    ds_write_b128 v12, v[112:115] offset:14336
    ds_write_b128 v12, v[116:119] offset:15360
    s_waitcnt lgkmcnt(0)
    s_lshr_b32 s42, s42, 16
    s_cmp_lg_u32 s42, 0
    s_cbranch_scc1 L_chain_global
    s_cmp_eq_u32 s17, 0
    s_cbranch_scc1 CL0_entry
    s_cmp_eq_u32 s17, 1
    s_cbranch_scc1 CL1_entry
    s_cmp_eq_u32 s17, 2
    s_cbranch_scc1 CL2_entry
CL3_entry:
    s_waitcnt lgkmcnt(0)
    ds_read_b128 v[108:111], v11 offset:0
    ds_read_b128 v[112:115], v12 offset:0
    ds_read_b128 v[116:119], v11 offset:1024
    ds_read_b128 v[120:123], v12 offset:1024
    ds_read_b128 v[76:79], v11 offset:2048
    ds_read_b128 v[80:83], v12 offset:2048
    ds_read_b128 v[84:87], v11 offset:3072
    ds_read_b128 v[88:91], v12 offset:3072
    ds_read_b128 v[92:95], v11 offset:4096
    ds_read_b128 v[96:99], v12 offset:4096
    ds_read_b128 v[100:103], v11 offset:5120
    ds_read_b128 v[104:107], v12 offset:5120
    v_mov_b64 v[52:53], 0
    v_mov_b64 v[54:55], 0
    v_mov_b64 v[56:57], 0
    v_mov_b64 v[58:59], 0
    v_mov_b64 v[60:61], 0
    v_mov_b64 v[62:63], 0
    v_mov_b64 v[64:65], 0
    v_mov_b64 v[66:67], 0
    v_mov_b64 v[68:69], 0
    v_mov_b64 v[70:71], 0
    v_mov_b64 v[72:73], 0
    v_mov_b64 v[74:75], 0
    s_cmp_le_u32 s38, 1
    s_cselect_b64 s[50:51], -1, 0
    s_lshl_b32 s34, s16, 8
    s_add_u32 s34, s34, 0
    s_waitcnt vmcnt(0) lgkmcnt(0)
    s_branch CL3_e0
CL3_side:
    v_cmp_eq_u32 vcc, -1, v2
    s_cbranch_vccz CL3_side2
CL3_lateB:
    s_mov_b32 m0, 138240
    s_nop 0
    buffer_load_dwordx4 v10, s[4:7], s26 offen sc1 lds
    s_add_u32 s23, s23, 1
    s_cmp_gt_u32 s23, 262144
    s_waitcnt vmcnt(1)
    s_cbranch_scc1 CL3_lateB_ok
    ds_read_b128 v[36:39], v1 offset:4096
    ds_read_b128 v[40:43], v1 offset:5120
    ds_read_b128 v[44:47], v1 offset:6144
    ds_read_b128 v[48:51], v1 offset:7168
    s_waitcnt lgkmcnt(0)
    v_max3_u32 v2, v36, v37, v38
    v_max3_u32 v2, v2, v39, v40
    v_max3_u32 v2, v2, v41, v42
    v_max3_u32 v2, v2, v43, v44
    v_max3_u32 v2, v2, v45, v46
    v_max3_u32 v2, v2, v47, v48
    v_max3_u32 v2, v2, v49, v50
    v_max_u32 v2, v2, v51
    v_cmp_eq_u32 vcc, -1, v2
    s_cbranch_vccnz CL3_lateB
CL3_lateB_ok:
    s_waitcnt vmcnt(0)
CL3_side2:
    s_branch CL3_late_done
CL3_e1:
    buffer_load_dwordx4 v[36:39], v4, s[4:7], s36 offen offset:0 sc1
    buffer_load_dwordx4 v[40:43], v4, s[4:7], s36 offen offset:1024 sc1
    buffer_load_dwordx4 v4, s[4:7], s36 offen offset:0 sc1 lds
    buffer_load_dwordx4 v4, s[4:7], s36 offen offset:1024 sc1 lds
    s_waitcnt vmcnt(6)
    v_max3_u32 v2, v44, v45, v46
    v_max3_u32 v3, v47, v48, v49
    v_max3_u32 v2, v2, v50, v51
    v_max_u32 v2, v2, v3
    v_cmp_eq_u32 vcc, -1, v2
    s_waitcnt vmcnt(4)
    s_cbranch_vccz CL3_go
    buffer_load_dwordx4 v[44:47], v4, s[4:7], s36 offen offset:0 sc1
    buffer_load_dwordx4 v[48:51], v4, s[4:7], s36 offen offset:1024 sc1
    buffer_load_dwordx4 v4, s[4:7], s36 offen offset:0 sc1 lds
    buffer_load_dwordx4 v4, s[4:7], s36 offen offset:1024 sc1 lds
    s_add_u32 s23, s23, 1
    s_cmp_gt_u32 s23, 262144
    s_cbranch_scc1 CL3_go
CL3_e0:
    s_waitcnt vmcnt(0)
    s_cmp_eq_u32 s50, 0
    s_cbranch_scc1 CL3_kvgo
CL3_l_kvw:
    v_lshrrev_b32 v2, 2, v1
    s_lshl_b32 s27, s16, 8
    v_subrev_u32 v2, 32768, v2
    s_add_u32 s27, s27, 0
    buffer_load_dword v14, v2, s[4:7], s27 offen sc1
    s_add_u32 s23, s23, 1
    s_waitcnt vmcnt(0)
CL3_l_kve:
    v_cmp_ne_u32 vcc, 0, v14
    s_nop 0
    s_ff0_i32_b64 s38, vcc
    s_cmp_gt_u32 s23, 262144
    s_cbranch_scc1 CL3_l_kvw_done
    s_add_u32 s27, s18, 1
    s_cmp_ge_u32 s27, s38
    s_cbranch_scc1 CL3_l_kvw
CL3_l_kvw_done:
CL3_kvgo:
    s_cmp_eq_u32 s18, 0
    s_cbranch_scc0 CL3_go
    s_barrier
    s_branch CL3_b1
CL3_go:
    s_mov_b32 m0, 138240
    s_barrier
    buffer_load_dwordx4 v10, s[4:7], s26 offen sc1 lds
CL3_b1:
    ds_read_b128 v[20:23], v1 offset:0
    ds_read_b128 v[24:27], v1 offset:1024
    ds_read_b128 v[28:31], v1 offset:2048
    ds_read_b128 v[32:35], v1 offset:3072
    s_waitcnt lgkmcnt(3)
    v_smfmac_f32_16x16x64_bf16 v[52:55], v[20:23], v[108:115], v0
    s_add_u32 m0, s29, -2048
    s_add_u32 s27, s21, 4096
    v_smfmac_f32_16x16x64_bf16 v[56:59], v[20:23], v[116:123], v0
    v_smfmac_f32_16x16x64_bf16 v[60:63], v[20:23], v[76:83], v0
    s_waitcnt lgkmcnt(0)
    buffer_load_dwordx4 v1, s[4:7], s27 offen offset:0 sc1 lds
    v_smfmac_f32_16x16x64_bf16 v[64:67], v[20:23], v[84:91], v0
    v_mov_b64 v[120:121], -1
    v_smfmac_f32_16x16x64_bf16 v[52:55], v[24:27], v[92:99], v0
    buffer_load_dwordx4 v1, s[4:7], s27 offen offset:1024 sc1 lds
    v_mov_b64 v[122:123], -1
    v_smfmac_f32_16x16x64_bf16 v[56:59], v[24:27], v[100:107], v0
    ds_read_b128 v[108:111], v4 offset:8192
    v_smfmac_f32_16x16x64_bf16 v[60:63], v[24:27], a[96:103], v0
    ds_read_b128 v[112:115], v4 offset:9216
    buffer_load_dwordx4 v1, s[4:7], s27 offen offset:2048 sc1 lds
    v_smfmac_f32_16x16x64_bf16 v[64:67], v[24:27], a[152:159], v0
    ds_read_b128 v[76:79], v6 offset:0
    v_smfmac_f32_16x16x64_bf16 v[52:55], v[28:31], a[0:7], v0
    ds_read_b128 v[80:83], v6 offset:1024
    buffer_load_dwordx4 v1, s[4:7], s27 offen offset:3072 sc1 lds
    v_smfmac_f32_16x16x64_bf16 v[56:59], v[28:31], a[48:55], v0
    s_mov_b32 m0, 143360
    s_add_u32 s27, s21, 12288
    s_waitcnt vmcnt(4) lgkmcnt(2)
    s_barrier
    v_smfmac_f32_16x16x64_bf16 v[60:63], v[28:31], a[104:111], v0
    ds_read_b128 v[36:39], v1 offset:4096
    v_smfmac_f32_16x16x64_bf16 v[64:67], v[28:31], a[160:167], v0
    ds_read_b128 v[40:43], v1 offset:5120
    buffer_load_dwordx4 v1, s[4:7], s27 offen offset:0 sc1 lds
    v_smfmac_f32_16x16x64_bf16 v[52:55], v[32:35], a[8:15], v0
    ds_read_b128 v[44:47], v1 offset:6144
    v_smfmac_f32_16x16x64_bf16 v[56:59], v[32:35], a[56:63], v0
    ds_read_b128 v[48:51], v1 offset:7168
    buffer_load_dwordx4 v1, s[4:7], s27 offen offset:1024 sc1 lds
    v_smfmac_f32_16x16x64_bf16 v[60:63], v[32:35], a[112:119], v0
    s_waitcnt lgkmcnt(2)
    v_max3_u32 v2, v36, v37, v38
    v_smfmac_f32_16x16x64_bf16 v[64:67], v[32:35], a[168:175], v0
    buffer_load_dwordx4 v1, s[4:7], s27 offen offset:2048 sc1 lds
    v_max3_u32 v2, v2, v39, v40
    v_smfmac_f32_16x16x64_bf16 v[68:71], v[20:23], a[208:215], v0
    v_max3_u32 v2, v2, v41, v42
    v_smfmac_f32_16x16x64_bf16 v[72:75], v[20:23], v[144:151], v0
    s_waitcnt lgkmcnt(0)
    buffer_load_dwordx4 v1, s[4:7], s27 offen offset:3072 sc1 lds
    v_max3_u32 v2, v2, v43, v44
    v_smfmac_f32_16x16x64_bf16 v[68:71], v[24:27], a[216:223], v0
    ds_read_b128 v[84:87], v6 offset:2048
    v_max3_u32 v2, v2, v45, v46
    v_smfmac_f32_16x16x64_bf16 v[72:75], v[24:27], v[152:159], v0
    ds_read_b128 v[88:91], v6 offset:3072
    v_max3_u32 v2, v2, v47, v48
    v_smfmac_f32_16x16x64_bf16 v[68:71], v[28:31], a[224:231], v0
    ds_read_b128 v[92:95], v6 offset:4096
    v_max3_u32 v2, v2, v49, v50
    v_smfmac_f32_16x16x64_bf16 v[72:75], v[28:31], v[160:167], v0
    ds_read_b128 v[96:99], v6 offset:5120
    v_max_u32 v2, v2, v51
    v_smfmac_f32_16x16x64_bf16 v[68:71], v[32:35], a[232:239], v0
    ds_read_b128 v[100:103], v6 offset:6144
    v_cmp_eq_u32 vcc, -1, v2
    v_smfmac_f32_16x16x64_bf16 v[72:75], v[32:35], v[168:175], v0
    s_cbranch_vccnz CL3_side
CL3_late_done:
    v_smfmac_f32_16x16x64_bf16 v[52:55], v[36:39], a[16:23], v0
    ds_read_b128 v[104:107], v6 offset:7168
    v_lshrrev_b32 v2, 2, v1
    v_smfmac_f32_16x16x64_bf16 v[52:55], v[40:43], a[24:31], v0
    buffer_store_dwordx4 v[120:123], v4, s[4:7], s31 offen
    v_subrev_u32 v2, 32768, v2
    v_smfmac_f32_16x16x64_bf16 v[52:55], v[44:47], a[32:39], v0
    v_smfmac_f32_16x16x64_bf16 v[52:55], v[48:51], a[40:47], v0
    buffer_store_dwordx4 v[120:123], v4, s[4:7], s31 offen offset:1024
    v_smfmac_f32_16x16x64_bf16 v[56:59], v[36:39], a[64:71], v0
    s_nop 2
    v_smfmac_f32_16x16x64_bf16 v[56:59], v[40:43], a[72:79], v0
    buffer_store_dwordx4 v[124:127], v10, s[4:7], s22 offen sc1
    v_smfmac_f32_16x16x64_bf16 v[56:59], v[44:47], a[80:87], v0
    v_add_f32 v52, v52, v54
    v_smfmac_f32_16x16x64_bf16 v[56:59], v[48:51], a[88:95], v0
    v_add_f32 v53, v53, v55
    v_smfmac_f32_16x16x64_bf16 v[60:63], v[36:39], a[120:127], v0
    s_nop 0
    v_cvt_pk_bf16_f32 v52, v52, v53
    v_smfmac_f32_16x16x64_bf16 v[60:63], v[40:43], a[128:135], v0
    s_nop 2
    v_smfmac_f32_16x16x64_bf16 v[60:63], v[44:47], a[136:143], v0
    v_add_f32 v56, v56, v58
    v_smfmac_f32_16x16x64_bf16 v[60:63], v[48:51], a[144:151], v0
    v_add_f32 v57, v57, v59
    v_smfmac_f32_16x16x64_bf16 v[64:67], v[36:39], a[176:183], v0
    buffer_store_dword v120, v15, s[4:7], s32 offen
    v_cvt_pk_bf16_f32 v53, v56, v57
    v_smfmac_f32_16x16x64_bf16 v[64:67], v[40:43], a[184:191], v0
    ds_write2_b32 v8, v52, v53 offset0:0 offset1:128
    v_smfmac_f32_16x16x64_bf16 v[64:67], v[44:47], a[192:199], v0
    s_nop 0
    v_add_f32 v60, v60, v62
    v_smfmac_f32_16x16x64_bf16 v[64:67], v[48:51], a[200:207], v0
    buffer_load_dword v14, v2, s[4:7], s34 offen sc1
    v_add_f32 v61, v61, v63
    v_smfmac_f32_16x16x64_bf16 v[68:71], v[36:39], a[240:247], v0
    s_xor_b32 s29, s29, 8192
    s_add_u32 s21, s21, 524288
    s_cmp_ge_u32 s18, 61
    v_cvt_pk_bf16_f32 v60, v60, v61
    v_smfmac_f32_16x16x64_bf16 v[72:75], v[36:39], v[176:183], v0
    s_nop 2
    v_smfmac_f32_16x16x64_bf16 v[68:71], v[40:43], a[248:255], v0
    s_waitcnt lgkmcnt(0)
    s_barrier
    v_add_f32 v64, v64, v66
    v_smfmac_f32_16x16x64_bf16 v[72:75], v[40:43], v[184:191], v0
    ds_read_b64_tr_b16 v[20:21], v9 offset:0
    ds_read_b64_tr_b16 v[22:23], v9 offset:512
    v_add_f32 v65, v65, v67
    v_smfmac_f32_16x16x64_bf16 v[68:71], v[44:47], v[128:135], v0
    ds_read_b64_tr_b16 v[24:25], v9 offset:1024
    ds_read_b64_tr_b16 v[26:27], v9 offset:1536
    v_cvt_pk_bf16_f32 v61, v64, v65
    v_smfmac_f32_16x16x64_bf16 v[72:75], v[44:47], v[192:199], v0
    ds_write2_b32 v8, v60, v61 offset0:1 offset1:129
    ds_read_b64_tr_b16 v[28:29], v9 offset:2048
    ds_read_b64_tr_b16 v[30:31], v9 offset:2560
    v_smfmac_f32_16x16x64_bf16 v[68:71], v[48:51], v[136:143], v0
    ds_read_b64_tr_b16 v[32:33], v9 offset:3072
    ds_read_b64_tr_b16 v[34:35], v9 offset:3584
    v_smfmac_f32_16x16x64_bf16 v[72:75], v[48:51], v[200:207], v0
    s_waitcnt lgkmcnt(7)
    v_mfma_f32_16x16x32_bf16 v[124:127], v[92:95], v[20:23], 0
    ds_read_b128 v[44:47], v11 offset:6144
    s_waitcnt lgkmcnt(6)
    v_mfma_f32_16x16x32_bf16 v[124:127], v[96:99], v[24:27], v[124:127]
    ds_read_b128 v[48:51], v12 offset:6144
    s_waitcnt lgkmcnt(4)
    v_mfma_f32_16x16x32_bf16 v[124:127], v[100:103], v[28:31], v[124:127]
    s_waitcnt lgkmcnt(2)
    s_waitcnt lgkmcnt(6)
    s_barrier
    v_mfma_f32_16x16x32_bf16 v[124:127], v[104:107], v[32:35], v[124:127]
    ds_read_b64_tr_b16 v[52:53], v9 offset:0
    ds_read_b64_tr_b16 v[54:55], v9 offset:512
    v_add_f32 v68, v68, v70
    v_mfma_f32_16x16x32_bf16 v[120:123], v[76:79], v[20:23], 0
    ds_read_b64_tr_b16 v[56:57], v9 offset:1024
    ds_read_b64_tr_b16 v[58:59], v9 offset:1536
    v_add_f32 v69, v69, v71
    v_mfma_f32_16x16x32_bf16 v[120:123], v[80:83], v[24:27], v[120:123]
    ds_read_b64_tr_b16 v[36:37], v9 offset:2048
    ds_read_b64_tr_b16 v[38:39], v9 offset:2560
    v_add_f32 v72, v72, v74
    v_mfma_f32_16x16x32_bf16 v[120:123], v[84:87], v[28:31], v[120:123]
    ds_read_b64_tr_b16 v[40:41], v9 offset:3072
    ds_read_b64_tr_b16 v[42:43], v9 offset:3584
    v_add_f32 v73, v73, v75
    v_mfma_f32_16x16x32_bf16 v[120:123], v[88:91], v[32:35], v[120:123]
    ds_read_b128 v[92:95], v11 offset:7168
    s_waitcnt lgkmcnt(7)
    v_cvt_pk_bf16_f32 v62, v68, v69
    v_mfma_f32_16x16x32_bf16 v[116:119], v[52:55], v[20:23], 0
    ds_read_b128 v[96:99], v12 offset:7168
    s_waitcnt lgkmcnt(6)
    v_cvt_pk_bf16_f32 v63, v72, v73
    v_mfma_f32_16x16x32_bf16 v[116:119], v[56:59], v[24:27], v[116:119]
    ds_read_b128 v[100:103], v11 offset:8192
    s_waitcnt lgkmcnt(5)
    v_mfma_f32_16x16x32_bf16 v[116:119], v[36:39], v[28:31], v[116:119]
    ds_read_b128 v[104:107], v12 offset:8192
    s_waitcnt lgkmcnt(4)
    v_max3_f32 v64, v124, v125, v126
    v_mfma_f32_16x16x32_bf16 v[116:119], v[40:43], v[32:35], v[116:119]
    ds_read_b128 v[76:79], v11 offset:9216
    v_max3_f32 v64, v64, v127, v120
    s_cbranch_scc1 CL3_done
CL3_resume:
    ds_read_b128 v[80:83], v12 offset:9216
    v_max3_f32 v64, v64, v121, v122
    v_max_f32 v64, v64, v123
    v_mov_b32 v66, s28
    v_xor_b32 v6, 8192, v6
    v_max3_f32 v65, v64, v118, v119
    v_max3_f32 v64, v64, v118, v119
    v_mov_b32 v68, 0x3f803f80
    v_mov_b32 v69, 0x3f803f80
    v_permlane32_swap_b32 v64, v65
    v_max_f32 v64, v64, v65
    v_mov_b32 v65, v64
    v_mov_b64 v[70:71], v[68:69]
    v_mov_b64 v[72:73], 0
    v_permlane16_swap_b32 v64, v65
    v_max_f32 v64, v64, v65
    v_mul_f32 v64, s28, v64
    v_pk_fma_f32 v[118:119], v[118:119], v[66:67], v[64:65] op_sel_hi:[1,0,0] neg_lo:[0,0,1] neg_hi:[0,0,1]
    v_pk_fma_f32 v[120:121], v[120:121], v[66:67], v[64:65] op_sel_hi:[1,0,0] neg_lo:[0,0,1] neg_hi:[0,0,1]
    v_pk_fma_f32 v[122:123], v[122:123], v[66:67], v[64:65] op_sel_hi:[1,0,0] neg_lo:[0,0,1] neg_hi:[0,0,1]
    v_pk_fma_f32 v[124:125], v[124:125], v[66:67], v[64:65] op_sel_hi:[1,0,0] neg_lo:[0,0,1] neg_hi:[0,0,1]
    v_pk_fma_f32 v[126:127], v[126:127], v[66:67], v[64:65] op_sel_hi:[1,0,0] neg_lo:[0,0,1] neg_hi:[0,0,1]
    v_exp_f32 v118, v118
    v_exp_f32 v119, v119
    v_exp_f32 v120, v120
    v_cvt_pk_bf16_f32 v16, v118, v119
    v_cvt_pk_bf16_f32 v19, v118, v119
    v_exp_f32 v121, v121
    v_mfma_f32_16x16x16_bf16 v[52:55], v[62:63], v[16:17], 0
    ds_read_b128 v[84:87], v11 offset:10240
    v_exp_f32 v122, v122
    v_exp_f32 v123, v123
    v_mfma_f32_16x16x16_bf16 v[56:59], v[62:63], v[18:19], 0
    ds_read_b128 v[88:91], v12 offset:10240
    v_exp_f32 v124, v124
    v_exp_f32 v125, v125
    v_mfma_f32_16x16x16_bf16 v[64:67], v[68:69], v[16:17], 0
    ds_read_b128 v[20:23], v11 offset:11264
    v_exp_f32 v126, v126
    v_exp_f32 v127, v127
    v_cvt_pk_bf16_f32 v120, v120, v121
    v_cvt_pk_bf16_f32 v121, v122, v123
    v_cvt_pk_bf16_f32 v122, v124, v125
    v_cvt_pk_bf16_f32 v123, v126, v127
    v_mov_b64 v[124:125], v[60:61]
    v_mov_b64 v[126:127], v[62:63]
    v_mfma_f32_16x16x32_bf16 v[64:67], v[68:71], v[120:123], v[64:67]
    ds_read_b128 v[24:27], v12 offset:11264
    v_mov_b64 v[60:61], 0
    v_mfma_f32_16x16x32_bf16 v[52:55], v[108:111], v[120:123], v[52:55]
    ds_read_b128 v[28:31], v11 offset:12288
    v_mov_b64 v[62:63], 0
    v_mfma_f32_16x16x32_bf16 v[56:59], v[112:115], v[120:123], v[56:59]
    ds_read_b128 v[32:35], v12 offset:12288
    v_mov_b64 v[68:69], 0
    v_mov_b64 v[70:71], 0
    v_mov_b64 v[74:75], 0
    v_rcp_f32 v64, v64
    s_nop 0
    v_pk_mul_f32 v[52:53], v[52:53], v[64:65] op_sel_hi:[1,0]
    v_pk_mul_f32 v[54:55], v[54:55], v[64:65] op_sel_hi:[1,0]
    v_pk_mul_f32 v[56:57], v[56:57], v[64:65] op_sel_hi:[1,0]
    v_pk_mul_f32 v[58:59], v[58:59], v[64:65] op_sel_hi:[1,0]
    v_cvt_pk_bf16_f32 v52, v52, v53
    v_cvt_pk_bf16_f32 v53, v54, v55
    v_cvt_pk_bf16_f32 v54, v56, v57
    v_cvt_pk_bf16_f32 v55, v58, v59
    ds_write_b128 v10, v[52:55] offset:4096
    v_mov_b32_dpp v52, v52 quad_perm:[0,1,0,1] row_mask:0xf bank_mask:0xf
    v_mov_b32_dpp v53, v53 quad_perm:[0,1,0,1] row_mask:0xf bank_mask:0xf
    v_mov_b32_dpp v54, v54 quad_perm:[0,1,0,1] row_mask:0xf bank_mask:0xf
    v_mov_b32_dpp v55, v55 quad_perm:[0,1,0,1] row_mask:0xf bank_mask:0xf
    v_mov_b64 v[64:65], 0
    v_mov_b64 v[66:67], 0
    v_smfmac_f32_16x16x64_bf16 v[68:71], v[52:55], v[208:215], v0
    ds_read_b128 v[36:39], v11 offset:13312
    s_add_u32 s25, s19, 4096
    v_smfmac_f32_16x16x64_bf16 v[72:75], v[52:55], v[232:239], v0
    ds_read_b128 v[40:43], v12 offset:13312
    s_mov_b32 s32, s20
    s_add_u32 s20, s20, 8192
    s_waitcnt lgkmcnt(2)
    s_barrier
    ds_read_b128 v[56:59], v5 offset:6144
    ds_read_b128 v[112:115], v5 offset:4096
    ds_read_b128 v[108:111], v5 offset:5120
    v_smfmac_f32_16x16x64_bf16 v[60:63], v[52:55], v[240:247], v0
    v_smfmac_f32_16x16x64_bf16 v[64:67], v[52:55], v[248:255], v0
    s_waitcnt lgkmcnt(2)
    v_smfmac_f32_16x16x64_bf16 v[68:71], v[56:59], v[216:223], v0
    s_waitcnt lgkmcnt(1)
    ds_read_b128 v[116:119], v11 offset:14336
    v_smfmac_f32_16x16x64_bf16 v[68:71], v[112:115], v[224:231], v0
    s_waitcnt lgkmcnt(1)
    ds_read_b128 v[120:123], v12 offset:14336
    v_smfmac_f32_16x16x64_bf16 v[68:71], v[108:111], v[44:51], v0
    s_and_b32 s20, s20, 0xffff7fff
    s_sub_u32 s36, s20, 131072
    s_add_u32 s31, s33, s19
    v_smfmac_f32_16x16x64_bf16 v[72:75], v[56:59], v[92:99], v0
    s_add_u32 s22, s22, 4096
    s_add_u32 s18, s18, 1
    s_nop 1
    v_cvt_pk_bf16_f32 v68, v68, v70
    v_cvt_pk_bf16_f32 v69, v69, v71
    v_smfmac_f32_16x16x64_bf16 v[72:75], v[112:115], v[100:107], v0
    buffer_store_dwordx2 v[68:69], v13, s[4:7], s19 offen offset:0
    v_smfmac_f32_16x16x64_bf16 v[72:75], v[108:111], v[76:83], v0
    ds_read_b128 v[44:47], v11 offset:15360
    s_nop 0
    v_smfmac_f32_16x16x64_bf16 v[60:63], v[56:59], v[84:91], v0
    ds_read_b128 v[48:51], v12 offset:15360
    s_nop 0
    v_smfmac_f32_16x16x64_bf16 v[60:63], v[112:115], v[20:27], v0
    s_nop 1
    v_cvt_pk_bf16_f32 v72, v72, v74
    v_cvt_pk_bf16_f32 v73, v73, v75
    v_smfmac_f32_16x16x64_bf16 v[60:63], v[108:111], v[28:35], v0
    buffer_store_dwordx2 v[72:73], v13, s[4:7], s19 offen offset:2048
    v_smfmac_f32_16x16x64_bf16 v[64:67], v[56:59], v[36:43], v0
    s_waitcnt lgkmcnt(0)
    s_nop 1
    v_smfmac_f32_16x16x64_bf16 v[64:67], v[112:115], v[116:123], v0
    s_nop 0
    s_nop 0
    v_cvt_pk_bf16_f32 v60, v60, v62
    v_cvt_pk_bf16_f32 v61, v61, v63
    v_smfmac_f32_16x16x64_bf16 v[64:67], v[108:111], v[44:51], v0
    buffer_store_dwordx2 v[60:61], v13, s[4:7], s25 offen offset:0
    s_nop 6
    v_cvt_pk_bf16_f32 v64, v64, v66
    v_cvt_pk_bf16_f32 v65, v65, v67
    buffer_store_dwordx2 v[64:65], v13, s[4:7], s25 offen offset:2048
    s_barrier
    s_nop 15
    s_nop 15
    s_nop 15
    s_nop 11
    buffer_load_dwordx4 v[20:23], v4, s[4:7], s31 offen sc1
    buffer_load_dwordx4 v[24:27], v4, s[4:7], s31 offen offset:1024 sc1
    v_mov_b64 v[52:53], 0
    v_mov_b64 v[54:55], 0
    v_mov_b64 v[56:57], 0
    v_mov_b64 v[58:59], 0
    v_mov_b64 v[60:61], 0
    v_mov_b64 v[62:63], 0
    v_mov_b64 v[64:65], 0
    v_mov_b64 v[66:67], 0
    v_mov_b64 v[68:69], 0
    v_mov_b64 v[70:71], 0
    v_mov_b64 v[72:73], 0
    v_mov_b64 v[74:75], 0
    v_cndmask_b32 v36, 0, v7, s[52:53]
    v_cndmask_b32 v37, 0, v7, s[54:55]
    v_cndmask_b32 v38, 0, v7, s[56:57]
    v_cndmask_b32 v39, 0, v7, s[58:59]
    s_nop 13
    buffer_load_dwordx4 v[28:31], v4, s[4:7], s31 offen sc1
    buffer_load_dwordx4 v[32:35], v4, s[4:7], s31 offen offset:1024 sc1
    s_xor_b32 s19, s19, 262144
    s_mov_b32 m0, 137216
    s_add_u32 s26, s36, 4096
    s_branch CL3_waitA
CL3_pollA_retry:
    buffer_load_dwordx4 v[20:23], v4, s[4:7], s31 offen sc1
    buffer_load_dwordx4 v[24:27], v4, s[4:7], s31 offen offset:1024 sc1
    s_add_u32 s35, s35, 1
    s_waitcnt vmcnt(2)
    v_mfma_f32_16x16x32_bf16 v[40:43], v[36:39], v[28:31], 0
    v_max3_u32 v2, v28, v29, v30
    v_max3_u32 v3, v31, v32, v33
    v_mfma_f32_16x16x32_bf16 v[40:43], v[36:39], v[32:35], v[40:43]
    v_max3_u32 v2, v2, v34, v35
    v_max_u32 v2, v2, v3
    v_cmp_eq_u32 vcc, -1, v2
    s_cbranch_vccz CL3_goA
    buffer_load_dwordx4 v[28:31], v4, s[4:7], s31 offen sc1
    buffer_load_dwordx4 v[32:35], v4, s[4:7], s31 offen offset:1024 sc1
    s_cmp_gt_u32 s35, 262144
    s_cbranch_scc1 CL3_goA
CL3_waitA:
    s_waitcnt vmcnt(2)
    v_mfma_f32_16x16x32_bf16 v[40:43], v[36:39], v[20:23], 0
    v_max3_u32 v2, v20, v21, v22
    v_max3_u32 v3, v23, v24, v25
    v_mfma_f32_16x16x32_bf16 v[40:43], v[36:39], v[24:27], v[40:43]
    v_max3_u32 v2, v2, v26, v27
    v_max_u32 v2, v2, v3
    v_cmp_eq_u32 vcc, -1, v2
    s_nop 3
    s_cbranch_vccnz CL3_pollA_retry
CL3_goA_n:
    v_add_f32_dpp v40, v40, v40 row_ror:4 row_mask:0xf bank_mask:0xf
    v_add_f32_dpp v41, v41, v41 row_ror:4 row_mask:0xf bank_mask:0xf
    s_nop 0
    v_add_f32_dpp v40, v40, v40 row_ror:8 row_mask:0xf bank_mask:0xf
    v_add_f32_dpp v41, v41, v41 row_ror:8 row_mask:0xf bank_mask:0xf
    v_cvt_pk_bf16_f32 v40, v40, v41
    buffer_store_dword v40, v15, s[4:7], s20 offen
    ds_read_b128 v[108:111], v11 offset:0
    ds_read_b128 v[112:115], v12 offset:0
    ds_read_b128 v[116:119], v11 offset:1024
    ds_read_b128 v[120:123], v12 offset:1024
    ds_read_b128 v[76:79], v11 offset:2048
    ds_read_b128 v[80:83], v12 offset:2048
    ds_read_b128 v[84:87], v11 offset:3072
    ds_read_b128 v[88:91], v12 offset:3072
    s_cmp_gt_u32 s38, 64
    s_cbranch_scc1 CL3_kvall
    v_cmp_ne_u32 vcc, 0, v14
    s_nop 0
    s_ff0_i32_b64 s38, vcc
    s_add_u32 s27, s18, 1
    s_cmp_ge_u32 s27, s38
    s_cselect_b64 s[50:51], -1, 0
    s_cmp_gt_u32 s38, 64
    s_cselect_b32 s34, 0x40000000, s34
    s_branch CL3_kvdone
CL3_kvall:
    s_mov_b64 s[50:51], 0
CL3_kvdone:
    ds_read_b128 v[92:95], v11 offset:4096
    ds_read_b128 v[96:99], v12 offset:4096
    ds_read_b128 v[100:103], v11 offset:5120
    ds_read_b128 v[104:107], v12 offset:5120
    s_waitcnt lgkmcnt(0)
    s_branch CL3_e0
CL3_goA:
    s_nop 3
    s_branch CL3_goA_n
CL3_done:
    s_add_u32 s22, s22, 4096
    buffer_store_dwordx4 v[60:63], v10, s[4:7], s22 offen sc1
    s_sub_u32 s22, s22, 4096
    s_cmp_lt_u32 s18, 63
    s_cbranch_scc1 CL3_resume
    s_branch CL_exit
CL2_entry:
    s_waitcnt lgkmcnt(0)
    ds_read_b128 v[108:111], v11 offset:0
    ds_read_b128 v[112:115], v12 offset:0
    ds_read_b128 v[116:119], v11 offset:1024
    ds_read_b128 v[120:123], v12 offset:1024
    ds_read_b128 v[76:79], v11 offset:2048
    ds_read_b128 v[80:83], v12 offset:2048
    ds_read_b128 v[84:87], v11 offset:3072
    ds_read_b128 v[88:91], v12 offset:3072
    ds_read_b128 v[92:95], v11 offset:4096
    ds_read_b128 v[96:99], v12 offset:4096
    ds_read_b128 v[100:103], v11 offset:5120
    ds_read_b128 v[104:107], v12 offset:5120
    v_mov_b64 v[52:53], 0
    v_mov_b64 v[54:55], 0
    v_mov_b64 v[56:57], 0
    v_mov_b64 v[58:59], 0
    v_mov_b64 v[60:61], 0
    v_mov_b64 v[62:63], 0
    v_mov_b64 v[64:65], 0
    v_mov_b64 v[66:67], 0
    v_mov_b64 v[68:69], 0
    v_mov_b64 v[70:71], 0
    v_mov_b64 v[72:73], 0
    v_mov_b64 v[74:75], 0
    s_cmp_le_u32 s38, 1
    s_cselect_b64 s[50:51], -1, 0
    s_lshl_b32 s34, s16, 8
    s_add_u32 s34, s34, 0
    s_waitcnt vmcnt(0) lgkmcnt(0)
    s_branch CL2_e0
CL2_side:
    v_cmp_eq_u32 vcc, -1, v2
    s_cbranch_vccz CL2_side2
CL2_lateB:
    s_mov_b32 m0, 137216
    s_nop 0
    buffer_load_dwordx4 v10, s[4:7], s26 offen sc1 lds
    s_add_u32 s23, s23, 1
    s_cmp_gt_u32 s23, 262144
    s_waitcnt vmcnt(1)
    s_cbranch_scc1 CL2_lateB_ok
    ds_read_b128 v[36:39], v1 offset:4096
    ds_read_b128 v[40:43], v1 offset:5120
    ds_read_b128 v[44:47], v1 offset:6144
    ds_read_b128 v[48:51], v1 offset:7168
    s_waitcnt lgkmcnt(0)
    v_max3_u32 v2, v36, v37, v38
    v_max3_u32 v2, v2, v39, v40
    v_max3_u32 v2, v2, v41, v42
    v_max3_u32 v2, v2, v43, v44
    v_max3_u32 v2, v2, v45, v46
    v_max3_u32 v2, v2, v47, v48
    v_max3_u32 v2, v2, v49, v50
    v_max_u32 v2, v2, v51
    v_cmp_eq_u32 vcc, -1, v2
    s_cbranch_vccnz CL2_lateB
CL2_lateB_ok:
    s_waitcnt vmcnt(0)
CL2_side2:
    s_branch CL2_late_done
CL2_e1:
    buffer_load_dwordx4 v[36:39], v4, s[4:7], s36 offen offset:0 sc1
    buffer_load_dwordx4 v[40:43], v4, s[4:7], s36 offen offset:1024 sc1
    buffer_load_dwordx4 v4, s[4:7], s36 offen offset:0 sc1 lds
    buffer_load_dwordx4 v4, s[4:7], s36 offen offset:1024 sc1 lds
    s_waitcnt vmcnt(6)
    v_max3_u32 v2, v44, v45, v46
    v_max3_u32 v3, v47, v48, v49
    v_max3_u32 v2, v2, v50, v51
    v_max_u32 v2, v2, v3
    v_cmp_eq_u32 vcc, -1, v2
    s_waitcnt vmcnt(4)
    s_cbranch_vccz CL2_go
    buffer_load_dwordx4 v[44:47], v4, s[4:7], s36 offen offset:0 sc1
    buffer_load_dwordx4 v[48:51], v4, s[4:7], s36 offen offset:1024 sc1
    buffer_load_dwordx4 v4, s[4:7], s36 offen offset:0 sc1 lds
    buffer_load_dwordx4 v4, s[4:7], s36 offen offset:1024 sc1 lds
    s_add_u32 s23, s23, 1
    s_cmp_gt_u32 s23, 262144
    s_cbranch_scc1 CL2_go
CL2_e0:
    s_waitcnt vmcnt(0)
    s_cmp_eq_u32 s50, 0
    s_cbranch_scc1 CL2_kvgo
CL2_l_kvw:
    v_lshrrev_b32 v2, 2, v1
    s_lshl_b32 s27, s16, 8
    v_subrev_u32 v2, 32768, v2
    s_add_u32 s27, s27, 0
    buffer_load_dword v14, v2, s[4:7], s27 offen sc1
    s_add_u32 s23, s23, 1
    s_waitcnt vmcnt(0)
CL2_l_kve:
    v_cmp_ne_u32 vcc, 0, v14
    s_nop 0
    s_ff0_i32_b64 s38, vcc
    s_cmp_gt_u32 s23, 262144
    s_cbranch_scc1 CL2_l_kvw_done
    s_add_u32 s27, s18, 1
    s_cmp_ge_u32 s27, s38
    s_cbranch_scc1 CL2_l_kvw
CL2_l_kvw_done:
CL2_kvgo:
    s_cmp_eq_u32 s18, 0
    s_cbranch_scc0 CL2_go
    s_barrier
    s_branch CL2_b1
CL2_go:
    s_mov_b32 m0, 137216
    s_barrier
    buffer_load_dwordx4 v10, s[4:7], s26 offen sc1 lds
CL2_b1:
    ds_read_b128 v[20:23], v1 offset:0
    ds_read_b128 v[24:27], v1 offset:1024
    ds_read_b128 v[28:31], v1 offset:2048
    ds_read_b128 v[32:35], v1 offset:3072
    s_waitcnt lgkmcnt(3)
    v_smfmac_f32_16x16x64_bf16 v[52:55], v[20:23], v[108:115], v0
    s_add_u32 m0, s29, -4096
    s_add_u32 s27, s21, 0
    v_smfmac_f32_16x16x64_bf16 v[56:59], v[20:23], v[116:123], v0
    buffer_load_dwordx4 v1, s[4:7], s27 offen offset:0 sc1 lds
    v_smfmac_f32_16x16x64_bf16 v[60:63], v[20:23], v[76:83], v0
    s_waitcnt lgkmcnt(0)
    v_smfmac_f32_16x16x64_bf16 v[64:67], v[20:23], v[84:91], v0
    buffer_load_dwordx4 v1, s[4:7], s27 offen offset:1024 sc1 lds
    v_mov_b64 v[120:121], -1
    v_smfmac_f32_16x16x64_bf16 v[52:55], v[24:27], v[92:99], v0
    v_mov_b64 v[122:123], -1
    v_smfmac_f32_16x16x64_bf16 v[56:59], v[24:27], v[100:107], v0
    ds_read_b128 v[108:111], v4 offset:8192
    buffer_load_dwordx4 v1, s[4:7], s27 offen offset:2048 sc1 lds
    v_smfmac_f32_16x16x64_bf16 v[60:63], v[24:27], a[96:103], v0
    ds_read_b128 v[112:115], v4 offset:9216
    v_smfmac_f32_16x16x64_bf16 v[64:67], v[24:27], a[152:159], v0
    ds_read_b128 v[76:79], v6 offset:0
    buffer_load_dwordx4 v1, s[4:7], s27 offen offset:3072 sc1 lds
    v_smfmac_f32_16x16x64_bf16 v[52:55], v[28:31], a[0:7], v0
    ds_read_b128 v[80:83], v6 offset:1024
    v_smfmac_f32_16x16x64_bf16 v[56:59], v[28:31], a[48:55], v0
    s_mov_b32 m0, 139264
    s_add_u32 s27, s21, 8192
    s_waitcnt vmcnt(4) lgkmcnt(2)
    s_barrier
    v_smfmac_f32_16x16x64_bf16 v[60:63], v[28:31], a[104:111], v0
    ds_read_b128 v[36:39], v1 offset:4096
    buffer_load_dwordx4 v1, s[4:7], s27 offen offset:0 sc1 lds
    v_smfmac_f32_16x16x64_bf16 v[64:67], v[28:31], a[160:167], v0
    ds_read_b128 v[40:43], v1 offset:5120
    v_smfmac_f32_16x16x64_bf16 v[52:55], v[32:35], a[8:15], v0
    ds_read_b128 v[44:47], v1 offset:6144
    buffer_load_dwordx4 v1, s[4:7], s27 offen offset:1024 sc1 lds
    v_smfmac_f32_16x16x64_bf16 v[56:59], v[32:35], a[56:63], v0
    ds_read_b128 v[48:51], v1 offset:7168
    v_smfmac_f32_16x16x64_bf16 v[60:63], v[32:35], a[112:119], v0
    s_waitcnt lgkmcnt(2)
    buffer_load_dwordx4 v1, s[4:7], s27 offen offset:2048 sc1 lds
    v_max3_u32 v2, v36, v37, v38
    v_smfmac_f32_16x16x64_bf16 v[64:67], v[32:35], a[168:175], v0
    v_max3_u32 v2, v2, v39, v40
    v_smfmac_f32_16x16x64_bf16 v[68:71], v[20:23], a[208:215], v0
    buffer_load_dwordx4 v1, s[4:7], s27 offen offset:3072 sc1 lds
    v_max3_u32 v2, v2, v41, v42
    v_smfmac_f32_16x16x64_bf16 v[72:75], v[20:23], v[144:151], v0
    s_waitcnt lgkmcnt(0)
    v_max3_u32 v2, v2, v43, v44
    v_smfmac_f32_16x16x64_bf16 v[68:71], v[24:27], a[216:223], v0
    ds_read_b128 v[84:87], v6 offset:2048
    v_max3_u32 v2, v2, v45, v46
    v_smfmac_f32_16x16x64_bf16 v[72:75], v[24:27], v[152:159], v0
    ds_read_b128 v[88:91], v6 offset:3072
    v_max3_u32 v2, v2, v47, v48
    v_smfmac_f32_16x16x64_bf16 v[68:71], v[28:31], a[224:231], v0
    ds_read_b128 v[92:95], v6 offset:4096
    v_max3_u32 v2, v2, v49, v50
    v_smfmac_f32_16x16x64_bf16 v[72:75], v[28:31], v[160:167], v0
    ds_read_b128 v[96:99], v6 offset:5120
    v_max_u32 v2, v2, v51
    v_smfmac_f32_16x16x64_bf16 v[68:71], v[32:35], a[232:239], v0
    ds_read_b128 v[100:103], v6 offset:6144
    v_cmp_eq_u32 vcc, -1, v2
    v_smfmac_f32_16x16x64_bf16 v[72:75], v[32:35], v[168:175], v0
    s_cbranch_vccnz CL2_side
CL2_late_done:
    v_smfmac_f32_16x16x64_bf16 v[52:55], v[36:39], a[16:23], v0
    buffer_store_dwordx4 v[120:123], v4, s[4:7], s31 offen
    v_lshrrev_b32 v2, 2, v1
    v_smfmac_f32_16x16x64_bf16 v[52:55], v[40:43], a[24:31], v0
    ds_read_b128 v[104:107], v6 offset:7168
    v_subrev_u32 v2, 32768, v2
    v_smfmac_f32_16x16x64_bf16 v[52:55], v[44:47], a[32:39], v0
    buffer_store_dwordx4 v[120:123], v4, s[4:7], s31 offen offset:1024
    v_smfmac_f32_16x16x64_bf16 v[52:55], v[48:51], a[40:47], v0
    v_smfmac_f32_16x16x64_bf16 v[56:59], v[36:39], a[64:71], v0
    buffer_store_dwordx4 v[124:127], v10, s[4:7], s22 offen sc1
    v_smfmac_f32_16x16x64_bf16 v[56:59], v[40:43], a[72:79], v0
    s_nop 2
    v_smfmac_f32_16x16x64_bf16 v[56:59], v[44:47], a[80:87], v0
    s_nop 0
    v_add_f32 v52, v52, v54
    v_smfmac_f32_16x16x64_bf16 v[56:59], v[48:51], a[88:95], v0
    v_add_f32 v53, v53, v55
    v_smfmac_f32_16x16x64_bf16 v[60:63], v[36:39], a[120:127], v0
    s_nop 0
    v_cvt_pk_bf16_f32 v52, v52, v53
    v_smfmac_f32_16x16x64_bf16 v[60:63], v[40:43], a[128:135], v0
    s_nop 2
    v_smfmac_f32_16x16x64_bf16 v[60:63], v[44:47], a[136:143], v0
    v_add_f32 v56, v56, v58
    v_smfmac_f32_16x16x64_bf16 v[60:63], v[48:51], a[144:151], v0
    buffer_store_dword v120, v15, s[4:7], s32 offen
    v_add_f32 v57, v57, v59
    v_smfmac_f32_16x16x64_bf16 v[64:67], v[36:39], a[176:183], v0
    s_nop 0
    v_cvt_pk_bf16_f32 v53, v56, v57
    v_smfmac_f32_16x16x64_bf16 v[64:67], v[40:43], a[184:191], v0
    ds_write2_b32 v8, v52, v53 offset0:0 offset1:128
    v_smfmac_f32_16x16x64_bf16 v[64:67], v[44:47], a[192:199], v0
    buffer_load_dword v14, v2, s[4:7], s34 offen sc1
    v_add_f32 v60, v60, v62
    v_smfmac_f32_16x16x64_bf16 v[64:67], v[48:51], a[200:207], v0
    v_add_f32 v61, v61, v63
    v_smfmac_f32_16x16x64_bf16 v[68:71], v[36:39], a[240:247], v0
    s_xor_b32 s29, s29, 8192
    s_add_u32 s21, s21, 524288
    s_cmp_ge_u32 s18, 61
    v_cvt_pk_bf16_f32 v60, v60, v61
    v_smfmac_f32_16x16x64_bf16 v[72:75], v[36:39], v[176:183], v0
    s_nop 2
    v_smfmac_f32_16x16x64_bf16 v[68:71], v[40:43], a[248:255], v0
    s_waitcnt lgkmcnt(0)
    s_barrier
    v_add_f32 v64, v64, v66
    v_smfmac_f32_16x16x64_bf16 v[72:75], v[40:43], v[184:191], v0
    ds_read_b64_tr_b16 v[20:21], v9 offset:0
    ds_read_b64_tr_b16 v[22:23], v9 offset:512
    v_add_f32 v65, v65, v67
    v_smfmac_f32_16x16x64_bf16 v[68:71], v[44:47], v[128:135], v0
    ds_read_b64_tr_b16 v[24:25], v9 offset:1024
    ds_read_b64_tr_b16 v[26:27], v9 offset:1536
    v_cvt_pk_bf16_f32 v61, v64, v65
    v_smfmac_f32_16x16x64_bf16 v[72:75], v[44:47], v[192:199], v0
    ds_write2_b32 v8, v60, v61 offset0:1 offset1:129
    ds_read_b64_tr_b16 v[28:29], v9 offset:2048
    ds_read_b64_tr_b16 v[30:31], v9 offset:2560
    v_smfmac_f32_16x16x64_bf16 v[68:71], v[48:51], v[136:143], v0
    ds_read_b64_tr_b16 v[32:33], v9 offset:3072
    ds_read_b64_tr_b16 v[34:35], v9 offset:3584
    v_smfmac_f32_16x16x64_bf16 v[72:75], v[48:51], v[200:207], v0
    s_waitcnt lgkmcnt(7)
    v_mfma_f32_16x16x32_bf16 v[124:127], v[92:95], v[20:23], 0
    ds_read_b128 v[44:47], v11 offset:6144
    s_waitcnt lgkmcnt(6)
    v_mfma_f32_16x16x32_bf16 v[124:127], v[96:99], v[24:27], v[124:127]
    ds_read_b128 v[48:51], v12 offset:6144
    s_waitcnt lgkmcnt(4)
    v_mfma_f32_16x16x32_bf16 v[124:127], v[100:103], v[28:31], v[124:127]
    s_waitcnt lgkmcnt(2)
    s_waitcnt lgkmcnt(6)
    s_barrier
    v_mfma_f32_16x16x32_bf16 v[124:127], v[104:107], v[32:35], v[124:127]
    ds_read_b64_tr_b16 v[52:53], v9 offset:0
    ds_read_b64_tr_b16 v[54:55], v9 offset:512
    v_add_f32 v68, v68, v70
    v_mfma_f32_16x16x32_bf16 v[120:123], v[76:79], v[20:23], 0
    ds_read_b64_tr_b16 v[56:57], v9 offset:1024
    ds_read_b64_tr_b16 v[58:59], v9 offset:1536
    v_add_f32 v69, v69, v71
    v_mfma_f32_16x16x32_bf16 v[120:123], v[80:83], v[24:27], v[120:123]
    ds_read_b64_tr_b16 v[36:37], v9 offset:2048
    ds_read_b64_tr_b16 v[38:39], v9 offset:2560
    v_add_f32 v72, v72, v74
    v_mfma_f32_16x16x32_bf16 v[120:123], v[84:87], v[28:31], v[120:123]
    ds_read_b64_tr_b16 v[40:41], v9 offset:3072
    ds_read_b64_tr_b16 v[42:43], v9 offset:3584
    v_add_f32 v73, v73, v75
    v_mfma_f32_16x16x32_bf16 v[120:123], v[88:91], v[32:35], v[120:123]
    ds_read_b128 v[92:95], v11 offset:7168
    s_waitcnt lgkmcnt(7)
    v_cvt_pk_bf16_f32 v62, v68, v69
    v_mfma_f32_16x16x32_bf16 v[116:119], v[52:55], v[20:23], 0
    ds_read_b128 v[96:99], v12 offset:7168
    s_waitcnt lgkmcnt(6)
    v_cvt_pk_bf16_f32 v63, v72, v73
    v_mfma_f32_16x16x32_bf16 v[116:119], v[56:59], v[24:27], v[116:119]
    ds_read_b128 v[100:103], v11 offset:8192
    s_waitcnt lgkmcnt(5)
    v_mfma_f32_16x16x32_bf16 v[116:119], v[36:39], v[28:31], v[116:119]
    ds_read_b128 v[104:107], v12 offset:8192
    s_waitcnt lgkmcnt(4)
    v_max3_f32 v64, v124, v125, v126
    v_mfma_f32_16x16x32_bf16 v[116:119], v[40:43], v[32:35], v[116:119]
    ds_read_b128 v[76:79], v11 offset:9216
    v_max3_f32 v64, v64, v127, v120
    s_cbranch_scc1 CL2_done
CL2_resume:
    ds_read_b128 v[80:83], v12 offset:9216
    v_max3_f32 v64, v64, v121, v122
    v_max_f32 v64, v64, v123
    v_mov_b32 v66, s28
    v_xor_b32 v6, 8192, v6
    v_max3_f32 v65, v64, v118, v119
    v_max3_f32 v64, v64, v118, v119
    v_mov_b32 v68, 0x3f803f80
    v_mov_b32 v69, 0x3f803f80
    v_permlane32_swap_b32 v64, v65
    v_max_f32 v64, v64, v65
    v_mov_b32 v65, v64
    v_mov_b64 v[70:71], v[68:69]
    v_mov_b64 v[72:73], 0
    v_permlane16_swap_b32 v64, v65
    v_max_f32 v64, v64, v65
    v_mul_f32 v64, s28, v64
    v_pk_fma_f32 v[118:119], v[118:119], v[66:67], v[64:65] op_sel_hi:[1,0,0] neg_lo:[0,0,1] neg_hi:[0,0,1]
    v_pk_fma_f32 v[120:121], v[120:121], v[66:67], v[64:65] op_sel_hi:[1,0,0] neg_lo:[0,0,1] neg_hi:[0,0,1]
    v_pk_fma_f32 v[122:123], v[122:123], v[66:67], v[64:65] op_sel_hi:[1,0,0] neg_lo:[0,0,1] neg_hi:[0,0,1]
    v_pk_fma_f32 v[124:125], v[124:125], v[66:67], v[64:65] op_sel_hi:[1,0,0] neg_lo:[0,0,1] neg_hi:[0,0,1]
    v_pk_fma_f32 v[126:127], v[126:127], v[66:67], v[64:65] op_sel_hi:[1,0,0] neg_lo:[0,0,1] neg_hi:[0,0,1]
    v_exp_f32 v118, v118
    v_exp_f32 v119, v119
    v_exp_f32 v120, v120
    v_cvt_pk_bf16_f32 v16, v118, v119
    v_cvt_pk_bf16_f32 v19, v118, v119
    v_exp_f32 v121, v121
    v_mfma_f32_16x16x16_bf16 v[52:55], v[62:63], v[16:17], 0
    ds_read_b128 v[84:87], v11 offset:10240
    v_exp_f32 v122, v122
    v_exp_f32 v123, v123
    v_mfma_f32_16x16x16_bf16 v[56:59], v[62:63], v[18:19], 0
    ds_read_b128 v[88:91], v12 offset:10240
    v_exp_f32 v124, v124
    v_exp_f32 v125, v125
    v_mfma_f32_16x16x16_bf16 v[64:67], v[68:69], v[16:17], 0
    ds_read_b128 v[20:23], v11 offset:11264
    v_exp_f32 v126, v126
    v_exp_f32 v127, v127
    v_cvt_pk_bf16_f32 v120, v120, v121
    v_cvt_pk_bf16_f32 v121, v122, v123
    v_cvt_pk_bf16_f32 v122, v124, v125
    v_cvt_pk_bf16_f32 v123, v126, v127
    v_mov_b64 v[124:125], v[60:61]
    v_mov_b64 v[126:127], v[62:63]
    v_mfma_f32_16x16x32_bf16 v[64:67], v[68:71], v[120:123], v[64:67]
    ds_read_b128 v[24:27], v12 offset:11264
    v_mov_b64 v[60:61], 0
    v_mfma_f32_16x16x32_bf16 v[52:55], v[108:111], v[120:123], v[52:55]
    ds_read_b128 v[28:31], v11 offset:12288
    v_mov_b64 v[62:63], 0
    v_mfma_f32_16x16x32_bf16 v[56:59], v[112:115], v[120:123], v[56:59]
    ds_read_b128 v[32:35], v12 offset:12288
    v_mov_b64 v[68:69], 0
    v_mov_b64 v[70:71], 0
    v_mov_b64 v[74:75], 0
    v_rcp_f32 v64, v64
    s_nop 0
    v_pk_mul_f32 v[52:53], v[52:53], v[64:65] op_sel_hi:[1,0]
    v_pk_mul_f32 v[54:55], v[54:55], v[64:65] op_sel_hi:[1,0]
    v_pk_mul_f32 v[56:57], v[56:57], v[64:65] op_sel_hi:[1,0]
    v_pk_mul_f32 v[58:59], v[58:59], v[64:65] op_sel_hi:[1,0]
    v_cvt_pk_bf16_f32 v52, v52, v53
    v_cvt_pk_bf16_f32 v53, v54, v55
    v_cvt_pk_bf16_f32 v54, v56, v57
    v_cvt_pk_bf16_f32 v55, v58, v59
    ds_write_b128 v10, v[52:55] offset:4096
    v_mov_b32_dpp v52, v52 quad_perm:[0,1,0,1] row_mask:0xf bank_mask:0xf
    v_mov_b32_dpp v53, v53 quad_perm:[0,1,0,1] row_mask:0xf bank_mask:0xf
    v_mov_b32_dpp v54, v54 quad_perm:[0,1,0,1] row_mask:0xf bank_mask:0xf
    v_mov_b32_dpp v55, v55 quad_perm:[0,1,0,1] row_mask:0xf bank_mask:0xf
    v_mov_b64 v[64:65], 0
    v_mov_b64 v[66:67], 0
    v_smfmac_f32_16x16x64_bf16 v[68:71], v[52:55], v[208:215], v0
    ds_read_b128 v[36:39], v11 offset:13312
    s_add_u32 s25, s19, 4096
    v_smfmac_f32_16x16x64_bf16 v[72:75], v[52:55], v[232:239], v0
    ds_read_b128 v[40:43], v12 offset:13312
    s_mov_b32 s32, s20
    s_add_u32 s20, s20, 8192
    s_waitcnt lgkmcnt(2)
    s_barrier
    ds_read_b128 v[56:59], v5 offset:7168
    ds_read_b128 v[112:115], v5 offset:5120
    ds_read_b128 v[108:111], v5 offset:4096
    v_smfmac_f32_16x16x64_bf16 v[60:63], v[52:55], v[240:247], v0
    v_smfmac_f32_16x16x64_bf16 v[64:67], v[52:55], v[248:255], v0
    s_waitcnt lgkmcnt(2)
    v_smfmac_f32_16x16x64_bf16 v[68:71], v[56:59], v[216:223], v0
    s_waitcnt lgkmcnt(1)
    ds_read_b128 v[116:119], v11 offset:14336
    v_smfmac_f32_16x16x64_bf16 v[68:71], v[112:115], v[224:231], v0
    s_waitcnt lgkmcnt(1)
    ds_read_b128 v[120:123], v12 offset:14336
    v_smfmac_f32_16x16x64_bf16 v[68:71], v[108:111], v[44:51], v0
    s_and_b32 s20, s20, 0xffff7fff
    s_sub_u32 s36, s20, 131072
    s_add_u32 s31, s33, s19
    v_smfmac_f32_16x16x64_bf16 v[72:75], v[56:59], v[92:99], v0
    s_add_u32 s22, s22, 4096
    s_add_u32 s18, s18, 1
    s_nop 1
    v_cvt_pk_bf16_f32 v68, v68, v70
    v_cvt_pk_bf16_f32 v69, v69, v71
    v_smfmac_f32_16x16x64_bf16 v[72:75], v[112:115], v[100:107], v0
    buffer_store_dwordx2 v[68:69], v13, s[4:7], s19 offen offset:0
    v_smfmac_f32_16x16x64_bf16 v[72:75], v[108:111], v[76:83], v0
    ds_read_b128 v[44:47], v11 offset:15360
    s_nop 0
    v_smfmac_f32_16x16x64_bf16 v[60:63], v[56:59], v[84:91], v0
    ds_read_b128 v[48:51], v12 offset:15360
    s_nop 0
    v_smfmac_f32_16x16x64_bf16 v[60:63], v[112:115], v[20:27], v0
    s_nop 1
    v_cvt_pk_bf16_f32 v72, v72, v74
    v_cvt_pk_bf16_f32 v73, v73, v75
    v_smfmac_f32_16x16x64_bf16 v[60:63], v[108:111], v[28:35], v0
    buffer_store_dwordx2 v[72:73], v13, s[4:7], s19 offen offset:2048
    v_smfmac_f32_16x16x64_bf16 v[64:67], v[56:59], v[36:43], v0
    s_waitcnt lgkmcnt(0)
    s_nop 1
    v_smfmac_f32_16x16x64_bf16 v[64:67], v[112:115], v[116:123], v0
    s_nop 0
    s_nop 0
    v_cvt_pk_bf16_f32 v60, v60, v62
    v_cvt_pk_bf16_f32 v61, v61, v63
    v_smfmac_f32_16x16x64_bf16 v[64:67], v[108:111], v[44:51], v0
    buffer_store_dwordx2 v[60:61], v13, s[4:7], s25 offen offset:0
    s_nop 6
    v_cvt_pk_bf16_f32 v64, v64, v66
    v_cvt_pk_bf16_f32 v65, v65, v67
    buffer_store_dwordx2 v[64:65], v13, s[4:7], s25 offen offset:2048
    s_barrier
    s_nop 15
    s_nop 15
    s_nop 15
    s_nop 1
    buffer_load_dwordx4 v[20:23], v4, s[4:7], s31 offen sc1
    buffer_load_dwordx4 v[24:27], v4, s[4:7], s31 offen offset:1024 sc1
    v_mov_b64 v[52:53], 0
    v_mov_b64 v[54:55], 0
    v_mov_b64 v[56:57], 0
    v_mov_b64 v[58:59], 0
    v_mov_b64 v[60:61], 0
    v_mov_b64 v[62:63], 0
    v_mov_b64 v[64:65], 0
    v_mov_b64 v[66:67], 0
    v_mov_b64 v[68:69], 0
    v_mov_b64 v[70:71], 0
    v_mov_b64 v[72:73], 0
    v_mov_b64 v[74:75], 0
    v_cndmask_b32 v36, 0, v7, s[52:53]
    v_cndmask_b32 v37, 0, v7, s[54:55]
    v_cndmask_b32 v38, 0, v7, s[56:57]
    v_cndmask_b32 v39, 0, v7, s[58:59]
    s_nop 13
    buffer_load_dwordx4 v[28:31], v4, s[4:7], s31 offen sc1
    buffer_load_dwordx4 v[32:35], v4, s[4:7], s31 offen offset:1024 sc1
    s_xor_b32 s19, s19, 262144
    s_mov_b32 m0, 135168
    s_add_u32 s26, s36, 4096
    s_branch CL2_waitA
CL2_pollA_retry:
    buffer_load_dwordx4 v[20:23], v4, s[4:7], s31 offen sc1
    buffer_load_dwordx4 v[24:27], v4, s[4:7], s31 offen offset:1024 sc1
    s_add_u32 s35, s35, 1
    s_waitcnt vmcnt(2)
    v_mfma_f32_16x16x32_bf16 v[40:43], v[36:39], v[28:31], 0
    v_max3_u32 v2, v28, v29, v30
    v_max3_u32 v3, v31, v32, v33
    v_mfma_f32_16x16x32_bf16 v[40:43], v[36:39], v[32:35], v[40:43]
    v_max3_u32 v2, v2, v34, v35
    v_max_u32 v2, v2, v3
    v_cmp_eq_u32 vcc, -1, v2
    s_cbranch_vccz CL2_goA
    buffer_load_dwordx4 v[28:31], v4, s[4:7], s31 offen sc1
    buffer_load_dwordx4 v[32:35], v4, s[4:7], s31 offen offset:1024 sc1
    s_cmp_gt_u32 s35, 262144
    s_cbranch_scc1 CL2_goA
CL2_waitA:
    s_waitcnt vmcnt(2)
    v_mfma_f32_16x16x32_bf16 v[40:43], v[36:39], v[20:23], 0
    v_max3_u32 v2, v20, v21, v22
    v_max3_u32 v3, v23, v24, v25
    v_mfma_f32_16x16x32_bf16 v[40:43], v[36:39], v[24:27], v[40:43]
    v_max3_u32 v2, v2, v26, v27
    v_max_u32 v2, v2, v3
    v_cmp_eq_u32 vcc, -1, v2
    s_nop 3
    s_cbranch_vccnz CL2_pollA_retry
CL2_goA_n:
    v_add_f32_dpp v40, v40, v40 row_ror:4 row_mask:0xf bank_mask:0xf
    v_add_f32_dpp v41, v41, v41 row_ror:4 row_mask:0xf bank_mask:0xf
    s_nop 0
    v_add_f32_dpp v40, v40, v40 row_ror:8 row_mask:0xf bank_mask:0xf
    v_add_f32_dpp v41, v41, v41 row_ror:8 row_mask:0xf bank_mask:0xf
    v_cvt_pk_bf16_f32 v40, v40, v41
    buffer_store_dword v40, v15, s[4:7], s20 offen
    ds_read_b128 v[108:111], v11 offset:0
    ds_read_b128 v[112:115], v12 offset:0
    ds_read_b128 v[116:119], v11 offset:1024
    ds_read_b128 v[120:123], v12 offset:1024
    ds_read_b128 v[76:79], v11 offset:2048
    ds_read_b128 v[80:83], v12 offset:2048
    ds_read_b128 v[84:87], v11 offset:3072
    ds_read_b128 v[88:91], v12 offset:3072
    s_cmp_gt_u32 s38, 64
    s_cbranch_scc1 CL2_kvall
    v_cmp_ne_u32 vcc, 0, v14
    s_nop 0
    s_ff0_i32_b64 s38, vcc
    s_add_u32 s27, s18, 1
    s_cmp_ge_u32 s27, s38
    s_cselect_b64 s[50:51], -1, 0
    s_cmp_gt_u32 s38, 64
    s_cselect_b32 s34, 0x40000000, s34
    s_branch CL2_kvdone
CL2_kvall:
    s_mov_b64 s[50:51], 0
CL2_kvdone:
    ds_read_b128 v[92:95], v11 offset:4096
    ds_read_b128 v[96:99], v12 offset:4096
    ds_read_b128 v[100:103], v11 offset:5120
    ds_read_b128 v[104:107], v12 offset:5120
    s_waitcnt lgkmcnt(0)
    s_branch CL2_e0
CL2_goA:
    s_nop 3
    s_branch CL2_goA_n
CL2_done:
    s_add_u32 s22, s22, 4096
    buffer_store_dwordx4 v[60:63], v10, s[4:7], s22 offen sc1
    s_sub_u32 s22, s22, 4096
    s_cmp_lt_u32 s18, 63
    s_cbranch_scc1 CL2_resume
    s_branch CL_exit
CL1_entry:
    s_waitcnt lgkmcnt(0)
    ds_read_b128 v[108:111], v11 offset:0
    ds_read_b128 v[112:115], v12 offset:0
    ds_read_b128 v[116:119], v11 offset:1024
    ds_read_b128 v[120:123], v12 offset:1024
    ds_read_b128 v[76:79], v11 offset:2048
    ds_read_b128 v[80:83], v12 offset:2048
    ds_read_b128 v[84:87], v11 offset:3072
    ds_read_b128 v[88:91], v12 offset:3072
    ds_read_b128 v[92:95], v11 offset:4096
    ds_read_b128 v[96:99], v12 offset:4096
    ds_read_b128 v[100:103], v11 offset:5120
    ds_read_b128 v[104:107], v12 offset:5120
    v_mov_b64 v[52:53], 0
    v_mov_b64 v[54:55], 0
    v_mov_b64 v[56:57], 0
    v_mov_b64 v[58:59], 0
    v_mov_b64 v[60:61], 0
    v_mov_b64 v[62:63], 0
    v_mov_b64 v[64:65], 0
    v_mov_b64 v[66:67], 0
    v_mov_b64 v[68:69], 0
    v_mov_b64 v[70:71], 0
    v_mov_b64 v[72:73], 0
    v_mov_b64 v[74:75], 0
    s_cmp_le_u32 s38, 1
    s_cselect_b64 s[50:51], -1, 0
    s_lshl_b32 s34, s16, 8
    s_add_u32 s34, s34, 0
    s_waitcnt vmcnt(0) lgkmcnt(0)
    s_barrier
    s_branch CL1_b1
CL1_side:
    v_cmp_eq_u32 vcc, -1, v2
    s_cbranch_vccz CL1_side2
CL1_lateB:
    s_mov_b32 m0, 136192
    s_nop 0
    buffer_load_dwordx4 v10, s[4:7], s26 offen sc1 lds
    s_add_u32 s23, s23, 1
    s_cmp_gt_u32 s23, 262144
    s_waitcnt vmcnt(1)
    s_cbranch_scc1 CL1_lateB_ok
    ds_read_b128 v[36:39], v1 offset:4096
    ds_read_b128 v[40:43], v1 offset:5120
    ds_read_b128 v[44:47], v1 offset:6144
    ds_read_b128 v[48:51], v1 offset:7168
    s_waitcnt lgkmcnt(0)
    v_max3_u32 v2, v36, v37, v38
    v_max3_u32 v2, v2, v39, v40
    v_max3_u32 v2, v2, v41, v42
    v_max3_u32 v2, v2, v43, v44
    v_max3_u32 v2, v2, v45, v46
    v_max3_u32 v2, v2, v47, v48
    v_max3_u32 v2, v2, v49, v50
    v_max_u32 v2, v2, v51
    v_cmp_eq_u32 vcc, -1, v2
    s_cbranch_vccnz CL1_lateB
CL1_lateB_ok:
    s_waitcnt vmcnt(0)
CL1_side2:
    s_branch CL1_late_done
CL1_e1:
    buffer_load_dwordx4 v[36:39], v4, s[4:7], s36 offen offset:0 sc1
    buffer_load_dwordx4 v[40:43], v4, s[4:7], s36 offen offset:1024 sc1
    buffer_load_dwordx4 v4, s[4:7], s36 offen offset:0 sc1 lds
    buffer_load_dwordx4 v4, s[4:7], s36 offen offset:1024 sc1 lds
    s_waitcnt vmcnt(6)
    v_max3_u32 v2, v44, v45, v46
    v_max3_u32 v3, v47, v48, v49
    v_max3_u32 v2, v2, v50, v51
    v_max_u32 v2, v2, v3
    v_cmp_eq_u32 vcc, -1, v2
    s_waitcnt vmcnt(4)
    s_cbranch_vccz CL1_go
    buffer_load_dwordx4 v[44:47], v4, s[4:7], s36 offen offset:0 sc1
    buffer_load_dwordx4 v[48:51], v4, s[4:7], s36 offen offset:1024 sc1
    buffer_load_dwordx4 v4, s[4:7], s36 offen offset:0 sc1 lds
    buffer_load_dwordx4 v4, s[4:7], s36 offen offset:1024 sc1 lds
    s_add_u32 s23, s23, 1
    s_cmp_gt_u32 s23, 262144
    s_cbranch_scc1 CL1_go
CL1_e0:
    s_waitcnt vmcnt(6)
    v_max3_u32 v2, v36, v37, v38
    v_max3_u32 v3, v39, v40, v41
    v_max3_u32 v2, v2, v42, v43
    v_max_u32 v2, v2, v3
    v_cmp_eq_u32 vcc, -1, v2
    s_waitcnt vmcnt(4)
    s_cbranch_vccnz CL1_e1
CL1_go:
    s_mov_b32 m0, 136192
    s_barrier
    buffer_load_dwordx4 v10, s[4:7], s26 offen sc1 lds
CL1_b1:
    ds_read_b128 v[20:23], v1 offset:0
    ds_read_b128 v[24:27], v1 offset:1024
    ds_read_b128 v[28:31], v1 offset:2048
    ds_read_b128 v[32:35], v1 offset:3072
    s_waitcnt lgkmcnt(3)
    v_smfmac_f32_16x16x64_bf16 v[52:55], v[20:23], v[108:115], v0
    v_smfmac_f32_16x16x64_bf16 v[56:59], v[20:23], v[116:123], v0
    v_smfmac_f32_16x16x64_bf16 v[60:63], v[20:23], v[76:83], v0
    s_waitcnt lgkmcnt(0)
    v_smfmac_f32_16x16x64_bf16 v[64:67], v[20:23], v[84:91], v0
    v_mov_b64 v[120:121], -1
    v_smfmac_f32_16x16x64_bf16 v[52:55], v[24:27], v[92:99], v0
    v_mov_b64 v[122:123], -1
    v_smfmac_f32_16x16x64_bf16 v[56:59], v[24:27], v[100:107], v0
    ds_read_b128 v[108:111], v4 offset:8192
    v_smfmac_f32_16x16x64_bf16 v[60:63], v[24:27], a[96:103], v0
    ds_read_b128 v[112:115], v4 offset:9216
    v_smfmac_f32_16x16x64_bf16 v[64:67], v[24:27], a[152:159], v0
    ds_read_b128 v[76:79], v6 offset:0
    v_smfmac_f32_16x16x64_bf16 v[52:55], v[28:31], a[0:7], v0
    ds_read_b128 v[80:83], v6 offset:1024
    v_smfmac_f32_16x16x64_bf16 v[56:59], v[28:31], a[48:55], v0
    s_waitcnt vmcnt(0) lgkmcnt(2)
    s_barrier
    v_smfmac_f32_16x16x64_bf16 v[60:63], v[28:31], a[104:111], v0
    ds_read_b128 v[36:39], v1 offset:4096
    v_smfmac_f32_16x16x64_bf16 v[64:67], v[28:31], a[160:167], v0
    ds_read_b128 v[40:43], v1 offset:5120
    v_smfmac_f32_16x16x64_bf16 v[52:55], v[32:35], a[8:15], v0
    ds_read_b128 v[44:47], v1 offset:6144
    v_smfmac_f32_16x16x64_bf16 v[56:59], v[32:35], a[56:63], v0
    ds_read_b128 v[48:51], v1 offset:7168
    v_smfmac_f32_16x16x64_bf16 v[60:63], v[32:35], a[112:119], v0
    s_waitcnt lgkmcnt(2)
    v_max3_u32 v2, v36, v37, v38
    v_smfmac_f32_16x16x64_bf16 v[64:67], v[32:35], a[168:175], v0
    v_max3_u32 v2, v2, v39, v40
    v_smfmac_f32_16x16x64_bf16 v[68:71], v[20:23], a[208:215], v0
    v_max3_u32 v2, v2, v41, v42
    v_smfmac_f32_16x16x64_bf16 v[72:75], v[20:23], v[144:151], v0
    s_waitcnt lgkmcnt(0)
    v_max3_u32 v2, v2, v43, v44
    v_smfmac_f32_16x16x64_bf16 v[68:71], v[24:27], a[216:223], v0
    ds_read_b128 v[84:87], v6 offset:2048
    v_max3_u32 v2, v2, v45, v46
    v_smfmac_f32_16x16x64_bf16 v[72:75], v[24:27], v[152:159], v0
    ds_read_b128 v[88:91], v6 offset:3072
    buffer_store_dwordx4 v[120:123], v4, s[4:7], s31 offen
    v_max3_u32 v2, v2, v47, v48
    v_smfmac_f32_16x16x64_bf16 v[68:71], v[28:31], a[224:231], v0
    ds_read_b128 v[92:95], v6 offset:4096
    v_max3_u32 v2, v2, v49, v50
    v_smfmac_f32_16x16x64_bf16 v[72:75], v[28:31], v[160:167], v0
    ds_read_b128 v[96:99], v6 offset:5120
    buffer_store_dwordx4 v[120:123], v4, s[4:7], s31 offen offset:1024
    v_max_u32 v2, v2, v51
    v_smfmac_f32_16x16x64_bf16 v[68:71], v[32:35], a[232:239], v0
    ds_read_b128 v[100:103], v6 offset:6144
    v_cmp_eq_u32 vcc, -1, v2
    v_smfmac_f32_16x16x64_bf16 v[72:75], v[32:35], v[168:175], v0
    s_cbranch_vccnz CL1_side
CL1_late_done:
    v_smfmac_f32_16x16x64_bf16 v[52:55], v[36:39], a[16:23], v0
    ds_read_b128 v[104:107], v6 offset:7168
    v_smfmac_f32_16x16x64_bf16 v[52:55], v[40:43], a[24:31], v0
    v_smfmac_f32_16x16x64_bf16 v[52:55], v[44:47], a[32:39], v0
    v_smfmac_f32_16x16x64_bf16 v[52:55], v[48:51], a[40:47], v0
    v_smfmac_f32_16x16x64_bf16 v[56:59], v[36:39], a[64:71], v0
    s_nop 2
    v_smfmac_f32_16x16x64_bf16 v[56:59], v[40:43], a[72:79], v0
    s_nop 2
    v_smfmac_f32_16x16x64_bf16 v[56:59], v[44:47], a[80:87], v0
    v_add_f32 v52, v52, v54
    v_smfmac_f32_16x16x64_bf16 v[56:59], v[48:51], a[88:95], v0
    buffer_store_dwordx4 v[124:127], v10, s[4:7], s22 offen sc1
    v_add_f32 v53, v53, v55
    v_smfmac_f32_16x16x64_bf16 v[60:63], v[36:39], a[120:127], v0
    s_nop 0
    v_cvt_pk_bf16_f32 v52, v52, v53
    v_smfmac_f32_16x16x64_bf16 v[60:63], v[40:43], a[128:135], v0
    s_nop 2
    v_smfmac_f32_16x16x64_bf16 v[60:63], v[44:47], a[136:143], v0
    buffer_store_dword v120, v15, s[4:7], s32 offen
    v_add_f32 v56, v56, v58
    v_smfmac_f32_16x16x64_bf16 v[60:63], v[48:51], a[144:151], v0
    v_add_f32 v57, v57, v59
    v_smfmac_f32_16x16x64_bf16 v[64:67], v[36:39], a[176:183], v0
    s_nop 0
    v_cvt_pk_bf16_f32 v53, v56, v57
    v_smfmac_f32_16x16x64_bf16 v[64:67], v[40:43], a[184:191], v0
    ds_write2_b32 v8, v52, v53 offset0:0 offset1:128
    v_smfmac_f32_16x16x64_bf16 v[64:67], v[44:47], a[192:199], v0
    s_nop 0
    v_add_f32 v60, v60, v62
    v_smfmac_f32_16x16x64_bf16 v[64:67], v[48:51], a[200:207], v0
    v_add_f32 v61, v61, v63
    v_smfmac_f32_16x16x64_bf16 v[68:71], v[36:39], a[240:247], v0
    s_cmp_ge_u32 s18, 61
    v_cvt_pk_bf16_f32 v60, v60, v61
    v_smfmac_f32_16x16x64_bf16 v[72:75], v[36:39], v[176:183], v0
    s_nop 2
    v_smfmac_f32_16x16x64_bf16 v[68:71], v[40:43], a[248:255], v0
    s_waitcnt lgkmcnt(0)
    s_barrier
    v_add_f32 v64, v64, v66
    v_smfmac_f32_16x16x64_bf16 v[72:75], v[40:43], v[184:191], v0
    ds_read_b64_tr_b16 v[20:21], v9 offset:0
    ds_read_b64_tr_b16 v[22:23], v9 offset:512
    v_add_f32 v65, v65, v67
    v_smfmac_f32_16x16x64_bf16 v[68:71], v[44:47], v[128:135], v0
    ds_read_b64_tr_b16 v[24:25], v9 offset:1024
    ds_read_b64_tr_b16 v[26:27], v9 offset:1536
    v_cvt_pk_bf16_f32 v61, v64, v65
    v_smfmac_f32_16x16x64_bf16 v[72:75], v[44:47], v[192:199], v0
    ds_write2_b32 v8, v60, v61 offset0:1 offset1:129
    ds_read_b64_tr_b16 v[28:29], v9 offset:2048
    ds_read_b64_tr_b16 v[30:31], v9 offset:2560
    v_smfmac_f32_16x16x64_bf16 v[68:71], v[48:51], v[136:143], v0
    ds_read_b64_tr_b16 v[32:33], v9 offset:3072
    ds_read_b64_tr_b16 v[34:35], v9 offset:3584
    v_smfmac_f32_16x16x64_bf16 v[72:75], v[48:51], v[200:207], v0
    s_waitcnt lgkmcnt(7)
    v_mfma_f32_16x16x32_bf16 v[124:127], v[92:95], v[20:23], 0
    ds_read_b128 v[44:47], v11 offset:6144
    s_waitcnt lgkmcnt(6)
    v_mfma_f32_16x16x32_bf16 v[124:127], v[96:99], v[24:27], v[124:127]
    ds_read_b128 v[48:51], v12 offset:6144
    s_waitcnt lgkmcnt(4)
    v_mfma_f32_16x16x32_bf16 v[124:127], v[100:103], v[28:31], v[124:127]
    s_waitcnt lgkmcnt(2)
    s_waitcnt lgkmcnt(6)
    s_barrier
    v_mfma_f32_16x16x32_bf16 v[124:127], v[104:107], v[32:35], v[124:127]
    ds_read_b64_tr_b16 v[52:53], v9 offset:0
    ds_read_b64_tr_b16 v[54:55], v9 offset:512
    v_add_f32 v68, v68, v70
    v_mfma_f32_16x16x32_bf16 v[120:123], v[76:79], v[20:23], 0
    ds_read_b64_tr_b16 v[56:57], v9 offset:1024
    ds_read_b64_tr_b16 v[58:59], v9 offset:1536
    v_add_f32 v69, v69, v71
    v_mfma_f32_16x16x32_bf16 v[120:123], v[80:83], v[24:27], v[120:123]
    ds_read_b64_tr_b16 v[36:37], v9 offset:2048
    ds_read_b64_tr_b16 v[38:39], v9 offset:2560
    v_add_f32 v72, v72, v74
    v_mfma_f32_16x16x32_bf16 v[120:123], v[84:87], v[28:31], v[120:123]
    ds_read_b64_tr_b16 v[40:41], v9 offset:3072
    ds_read_b64_tr_b16 v[42:43], v9 offset:3584
    v_add_f32 v73, v73, v75
    v_mfma_f32_16x16x32_bf16 v[120:123], v[88:91], v[32:35], v[120:123]
    ds_read_b128 v[92:95], v11 offset:7168
    s_waitcnt lgkmcnt(7)
    v_cvt_pk_bf16_f32 v62, v68, v69
    v_mfma_f32_16x16x32_bf16 v[116:119], v[52:55], v[20:23], 0
    ds_read_b128 v[96:99], v12 offset:7168
    s_waitcnt lgkmcnt(6)
    v_cvt_pk_bf16_f32 v63, v72, v73
    v_mfma_f32_16x16x32_bf16 v[116:119], v[56:59], v[24:27], v[116:119]
    ds_read_b128 v[100:103], v11 offset:8192
    s_waitcnt lgkmcnt(5)
    v_mfma_f32_16x16x32_bf16 v[116:119], v[36:39], v[28:31], v[116:119]
    ds_read_b128 v[104:107], v12 offset:8192
    s_waitcnt lgkmcnt(4)
    v_max3_f32 v64, v124, v125, v126
    v_mfma_f32_16x16x32_bf16 v[116:119], v[40:43], v[32:35], v[116:119]
    ds_read_b128 v[76:79], v11 offset:9216
    v_max3_f32 v64, v64, v127, v120
    s_cbranch_scc1 CL1_done
CL1_resume:
    ds_read_b128 v[80:83], v12 offset:9216
    v_max3_f32 v64, v64, v121, v122
    v_max_f32 v64, v64, v123
    v_mov_b32 v66, s28
    v_xor_b32 v6, 8192, v6
    v_max3_f32 v65, v64, v118, v119
    v_max3_f32 v64, v64, v118, v119
    v_mov_b32 v68, 0x3f803f80
    v_mov_b32 v69, 0x3f803f80
    v_permlane32_swap_b32 v64, v65
    v_max_f32 v64, v64, v65
    v_mov_b32 v65, v64
    v_mov_b64 v[70:71], v[68:69]
    v_mov_b64 v[72:73], 0
    v_permlane16_swap_b32 v64, v65
    v_max_f32 v64, v64, v65
    v_mul_f32 v64, s28, v64
    v_pk_fma_f32 v[118:119], v[118:119], v[66:67], v[64:65] op_sel_hi:[1,0,0] neg_lo:[0,0,1] neg_hi:[0,0,1]
    v_pk_fma_f32 v[120:121], v[120:121], v[66:67], v[64:65] op_sel_hi:[1,0,0] neg_lo:[0,0,1] neg_hi:[0,0,1]
    v_pk_fma_f32 v[122:123], v[122:123], v[66:67], v[64:65] op_sel_hi:[1,0,0] neg_lo:[0,0,1] neg_hi:[0,0,1]
    v_pk_fma_f32 v[124:125], v[124:125], v[66:67], v[64:65] op_sel_hi:[1,0,0] neg_lo:[0,0,1] neg_hi:[0,0,1]
    v_pk_fma_f32 v[126:127], v[126:127], v[66:67], v[64:65] op_sel_hi:[1,0,0] neg_lo:[0,0,1] neg_hi:[0,0,1]
    v_exp_f32 v118, v118
    v_exp_f32 v119, v119
    v_exp_f32 v120, v120
    v_cvt_pk_bf16_f32 v16, v118, v119
    v_cvt_pk_bf16_f32 v19, v118, v119
    v_exp_f32 v121, v121
    v_mfma_f32_16x16x16_bf16 v[52:55], v[62:63], v[16:17], 0
    ds_read_b128 v[84:87], v11 offset:10240
    v_exp_f32 v122, v122
    v_exp_f32 v123, v123
    v_mfma_f32_16x16x16_bf16 v[56:59], v[62:63], v[18:19], 0
    ds_read_b128 v[88:91], v12 offset:10240
    v_exp_f32 v124, v124
    v_exp_f32 v125, v125
    v_mfma_f32_16x16x16_bf16 v[64:67], v[68:69], v[16:17], 0
    ds_read_b128 v[20:23], v11 offset:11264
    v_exp_f32 v126, v126
    v_exp_f32 v127, v127
    v_cvt_pk_bf16_f32 v120, v120, v121
    v_cvt_pk_bf16_f32 v121, v122, v123
    v_cvt_pk_bf16_f32 v122, v124, v125
    v_cvt_pk_bf16_f32 v123, v126, v127
    v_mov_b64 v[124:125], v[60:61]
    v_mov_b64 v[126:127], v[62:63]
    v_mfma_f32_16x16x32_bf16 v[64:67], v[68:71], v[120:123], v[64:67]
    ds_read_b128 v[24:27], v12 offset:11264
    v_mov_b64 v[60:61], 0
    v_mfma_f32_16x16x32_bf16 v[52:55], v[108:111], v[120:123], v[52:55]
    ds_read_b128 v[28:31], v11 offset:12288
    v_mov_b64 v[62:63], 0
    v_mfma_f32_16x16x32_bf16 v[56:59], v[112:115], v[120:123], v[56:59]
    ds_read_b128 v[32:35], v12 offset:12288
    v_mov_b64 v[68:69], 0
    v_mov_b64 v[70:71], 0
    v_mov_b64 v[74:75], 0
    v_rcp_f32 v64, v64
    s_nop 0
    v_pk_mul_f32 v[52:53], v[52:53], v[64:65] op_sel_hi:[1,0]
    v_pk_mul_f32 v[54:55], v[54:55], v[64:65] op_sel_hi:[1,0]
    v_pk_mul_f32 v[56:57], v[56:57], v[64:65] op_sel_hi:[1,0]
    v_pk_mul_f32 v[58:59], v[58:59], v[64:65] op_sel_hi:[1,0]
    v_cvt_pk_bf16_f32 v52, v52, v53
    v_cvt_pk_bf16_f32 v53, v54, v55
    v_cvt_pk_bf16_f32 v54, v56, v57
    v_cvt_pk_bf16_f32 v55, v58, v59
    ds_write_b128 v10, v[52:55] offset:4096
    v_mov_b32_dpp v52, v52 quad_perm:[0,1,0,1] row_mask:0xf bank_mask:0xf
    v_mov_b32_dpp v53, v53 quad_perm:[0,1,0,1] row_mask:0xf bank_mask:0xf
    v_mov_b32_dpp v54, v54 quad_perm:[0,1,0,1] row_mask:0xf bank_mask:0xf
    v_mov_b32_dpp v55, v55 quad_perm:[0,1,0,1] row_mask:0xf bank_mask:0xf
    v_mov_b64 v[64:65], 0
    v_mov_b64 v[66:67], 0
    v_smfmac_f32_16x16x64_bf16 v[68:71], v[52:55], v[208:215], v0
    ds_read_b128 v[36:39], v11 offset:13312
    s_add_u32 s25, s19, 4096
    v_smfmac_f32_16x16x64_bf16 v[72:75], v[52:55], v[232:239], v0
    ds_read_b128 v[40:43], v12 offset:13312
    s_mov_b32 s32, s20
    s_add_u32 s20, s20, 8192
    s_waitcnt lgkmcnt(2)
    s_barrier
    ds_read_b128 v[56:59], v5 offset:4096
    ds_read_b128 v[112:115], v5 offset:6144
    ds_read_b128 v[108:111], v5 offset:7168
    v_smfmac_f32_16x16x64_bf16 v[60:63], v[52:55], v[240:247], v0
    v_smfmac_f32_16x16x64_bf16 v[64:67], v[52:55], v[248:255], v0
    s_waitcnt lgkmcnt(2)
    v_smfmac_f32_16x16x64_bf16 v[68:71], v[56:59], v[216:223], v0
    s_waitcnt lgkmcnt(1)
    ds_read_b128 v[116:119], v11 offset:14336
    v_smfmac_f32_16x16x64_bf16 v[68:71], v[112:115], v[224:231], v0
    s_waitcnt lgkmcnt(1)
    ds_read_b128 v[120:123], v12 offset:14336
    v_smfmac_f32_16x16x64_bf16 v[68:71], v[108:111], v[44:51], v0
    s_and_b32 s20, s20, 0xffff7fff
    s_sub_u32 s36, s20, 131072
    s_add_u32 s31, s33, s19
    v_smfmac_f32_16x16x64_bf16 v[72:75], v[56:59], v[92:99], v0
    s_add_u32 s22, s22, 4096
    s_add_u32 s18, s18, 1
    s_nop 1
    v_cvt_pk_bf16_f32 v68, v68, v70
    v_cvt_pk_bf16_f32 v69, v69, v71
    v_smfmac_f32_16x16x64_bf16 v[72:75], v[112:115], v[100:107], v0
    buffer_store_dwordx2 v[68:69], v13, s[4:7], s19 offen offset:0
    v_smfmac_f32_16x16x64_bf16 v[72:75], v[108:111], v[76:83], v0
    ds_read_b128 v[44:47], v11 offset:15360
    s_nop 0
    v_smfmac_f32_16x16x64_bf16 v[60:63], v[56:59], v[84:91], v0
    ds_read_b128 v[48:51], v12 offset:15360
    s_nop 0
    v_smfmac_f32_16x16x64_bf16 v[60:63], v[112:115], v[20:27], v0
    s_nop 1
    v_cvt_pk_bf16_f32 v72, v72, v74
    v_cvt_pk_bf16_f32 v73, v73, v75
    v_smfmac_f32_16x16x64_bf16 v[60:63], v[108:111], v[28:35], v0
    buffer_store_dwordx2 v[72:73], v13, s[4:7], s19 offen offset:2048
    v_smfmac_f32_16x16x64_bf16 v[64:67], v[56:59], v[36:43], v0
    s_waitcnt lgkmcnt(0)
    s_nop 1
    v_smfmac_f32_16x16x64_bf16 v[64:67], v[112:115], v[116:123], v0
    s_nop 0
    s_nop 0
    v_cvt_pk_bf16_f32 v60, v60, v62
    v_cvt_pk_bf16_f32 v61, v61, v63
    v_smfmac_f32_16x16x64_bf16 v[64:67], v[108:111], v[44:51], v0
    buffer_store_dwordx2 v[60:61], v13, s[4:7], s25 offen offset:0
    s_nop 6
    v_cvt_pk_bf16_f32 v64, v64, v66
    v_cvt_pk_bf16_f32 v65, v65, v67
    buffer_store_dwordx2 v[64:65], v13, s[4:7], s25 offen offset:2048
    s_barrier
    s_nop 15
    s_nop 15
    s_nop 3
    buffer_load_dwordx4 v[20:23], v4, s[4:7], s31 offen sc1
    buffer_load_dwordx4 v[24:27], v4, s[4:7], s31 offen offset:1024 sc1
    v_mov_b64 v[52:53], 0
    v_mov_b64 v[54:55], 0
    v_mov_b64 v[56:57], 0
    v_mov_b64 v[58:59], 0
    v_mov_b64 v[60:61], 0
    v_mov_b64 v[62:63], 0
    v_mov_b64 v[64:65], 0
    v_mov_b64 v[66:67], 0
    v_mov_b64 v[68:69], 0
    v_mov_b64 v[70:71], 0
    v_mov_b64 v[72:73], 0
    v_mov_b64 v[74:75], 0
    v_cndmask_b32 v36, 0, v7, s[52:53]
    v_cndmask_b32 v37, 0, v7, s[54:55]
    v_cndmask_b32 v38, 0, v7, s[56:57]
    v_cndmask_b32 v39, 0, v7, s[58:59]
    s_nop 13
    buffer_load_dwordx4 v[28:31], v4, s[4:7], s31 offen sc1
    buffer_load_dwordx4 v[32:35], v4, s[4:7], s31 offen offset:1024 sc1
    s_xor_b32 s19, s19, 262144
    s_mov_b32 m0, 133120
    s_add_u32 s26, s36, 4096
    s_branch CL1_waitA
CL1_pollA_retry:
    buffer_load_dwordx4 v[20:23], v4, s[4:7], s31 offen sc1
    buffer_load_dwordx4 v[24:27], v4, s[4:7], s31 offen offset:1024 sc1
    s_add_u32 s35, s35, 1
    s_waitcnt vmcnt(2)
    v_mfma_f32_16x16x32_bf16 v[40:43], v[36:39], v[28:31], 0
    v_max3_u32 v2, v28, v29, v30
    v_max3_u32 v3, v31, v32, v33
    v_mfma_f32_16x16x32_bf16 v[40:43], v[36:39], v[32:35], v[40:43]
    v_max3_u32 v2, v2, v34, v35
    v_max_u32 v2, v2, v3
    v_cmp_eq_u32 vcc, -1, v2
    s_cbranch_vccz CL1_goA
    buffer_load_dwordx4 v[28:31], v4, s[4:7], s31 offen sc1
    buffer_load_dwordx4 v[32:35], v4, s[4:7], s31 offen offset:1024 sc1
    s_cmp_gt_u32 s35, 262144
    s_cbranch_scc1 CL1_goA
CL1_waitA:
    s_waitcnt vmcnt(2)
    v_mfma_f32_16x16x32_bf16 v[40:43], v[36:39], v[20:23], 0
    v_max3_u32 v2, v20, v21, v22
    v_max3_u32 v3, v23, v24, v25
    v_mfma_f32_16x16x32_bf16 v[40:43], v[36:39], v[24:27], v[40:43]
    v_max3_u32 v2, v2, v26, v27
    v_max_u32 v2, v2, v3
    v_cmp_eq_u32 vcc, -1, v2
    s_nop 3
    s_cbranch_vccnz CL1_pollA_retry
CL1_goA_n:
    v_add_f32_dpp v40, v40, v40 row_ror:4 row_mask:0xf bank_mask:0xf
    v_add_f32_dpp v41, v41, v41 row_ror:4 row_mask:0xf bank_mask:0xf
    s_nop 0
    v_add_f32_dpp v40, v40, v40 row_ror:8 row_mask:0xf bank_mask:0xf
    v_add_f32_dpp v41, v41, v41 row_ror:8 row_mask:0xf bank_mask:0xf
    v_cvt_pk_bf16_f32 v40, v40, v41
    buffer_store_dword v40, v15, s[4:7], s20 offen
    ds_read_b128 v[108:111], v11 offset:0
    ds_read_b128 v[112:115], v12 offset:0
    ds_read_b128 v[116:119], v11 offset:1024
    ds_read_b128 v[120:123], v12 offset:1024
    ds_read_b128 v[76:79], v11 offset:2048
    ds_read_b128 v[80:83], v12 offset:2048
    ds_read_b128 v[84:87], v11 offset:3072
    ds_read_b128 v[88:91], v12 offset:3072
    s_nop 15
    s_nop 11
CL1_kvdone:
    buffer_load_dwordx4 v[36:39], v4, s[4:7], s36 offen offset:0 sc1
    buffer_load_dwordx4 v[40:43], v4, s[4:7], s36 offen offset:1024 sc1
    buffer_load_dwordx4 v4, s[4:7], s36 offen offset:0 sc1 lds
    buffer_load_dwordx4 v4, s[4:7], s36 offen offset:1024 sc1 lds
    ds_read_b128 v[92:95], v11 offset:4096
    ds_read_b128 v[96:99], v12 offset:4096
    s_nop 15
    s_nop 11
    buffer_load_dwordx4 v[44:47], v4, s[4:7], s36 offen offset:0 sc1
    buffer_load_dwordx4 v[48:51], v4, s[4:7], s36 offen offset:1024 sc1
    buffer_load_dwordx4 v4, s[4:7], s36 offen offset:0 sc1 lds
    buffer_load_dwordx4 v4, s[4:7], s36 offen offset:1024 sc1 lds
    ds_read_b128 v[100:103], v11 offset:5120
    ds_read_b128 v[104:107], v12 offset:5120
    s_waitcnt lgkmcnt(0)
    s_branch CL1_e0
CL1_goA:
    s_nop 3
    s_branch CL1_goA_n
CL1_done:
    s_add_u32 s22, s22, 4096
    buffer_store_dwordx4 v[60:63], v10, s[4:7], s22 offen sc1
    s_sub_u32 s22, s22, 4096
    s_cmp_lt_u32 s18, 63
    s_cbranch_scc1 CL1_resume
    s_branch CL_exit
CL0_entry:
    s_waitcnt lgkmcnt(0)
    ds_read_b128 v[108:111], v11 offset:0
    ds_read_b128 v[112:115], v12 offset:0
    ds_read_b128 v[116:119], v11 offset:1024
    ds_read_b128 v[120:123], v12 offset:1024
    ds_read_b128 v[76:79], v11 offset:2048
    ds_read_b128 v[80:83], v12 offset:2048
    ds_read_b128 v[84:87], v11 offset:3072
    ds_read_b128 v[88:91], v12 offset:3072
    ds_read_b128 v[92:95], v11 offset:4096
    ds_read_b128 v[96:99], v12 offset:4096
    ds_read_b128 v[100:103], v11 offset:5120
    ds_read_b128 v[104:107], v12 offset:5120
    v_mov_b64 v[52:53], 0
    v_mov_b64 v[54:55], 0
    v_mov_b64 v[56:57], 0
    v_mov_b64 v[58:59], 0
    v_mov_b64 v[60:61], 0
    v_mov_b64 v[62:63], 0
    v_mov_b64 v[64:65], 0
    v_mov_b64 v[66:67], 0
    v_mov_b64 v[68:69], 0
    v_mov_b64 v[70:71], 0
    v_mov_b64 v[72:73], 0
    v_mov_b64 v[74:75], 0
    s_cmp_le_u32 s38, 1
    s_cselect_b64 s[50:51], -1, 0
    s_lshl_b32 s34, s16, 8
    s_add_u32 s34, s34, 0
    s_waitcnt vmcnt(0) lgkmcnt(0)
    s_barrier
    s_branch CL0_b1
CL0_side:
    v_cmp_eq_u32 vcc, -1, v2
    s_cbranch_vccz CL0_side2
CL0_lateB:
    s_mov_b32 m0, 135168
    s_nop 0
    buffer_load_dwordx4 v10, s[4:7], s26 offen sc1 lds
    s_add_u32 s23, s23, 1
    s_cmp_gt_u32 s23, 262144
    s_waitcnt vmcnt(1)
    s_cbranch_scc1 CL0_lateB_ok
    ds_read_b128 v[36:39], v1 offset:4096
    ds_read_b128 v[40:43], v1 offset:5120
    ds_read_b128 v[44:47], v1 offset:6144
    ds_read_b128 v[48:51], v1 offset:7168
    s_waitcnt lgkmcnt(0)
    v_max3_u32 v2, v36, v37, v38
    v_max3_u32 v2, v2, v39, v40
    v_max3_u32 v2, v2, v41, v42
    v_max3_u32 v2, v2, v43, v44
    v_max3_u32 v2, v2, v45, v46
    v_max3_u32 v2, v2, v47, v48
    v_max3_u32 v2, v2, v49, v50
    v_max_u32 v2, v2, v51
    v_cmp_eq_u32 vcc, -1, v2
    s_cbranch_vccnz CL0_lateB
CL0_lateB_ok:
    s_waitcnt vmcnt(0)
CL0_side2:
    s_branch CL0_late_done
CL0_e1:
    buffer_load_dwordx4 v[36:39], v4, s[4:7], s36 offen offset:0 sc1
    buffer_load_dwordx4 v[40:43], v4, s[4:7], s36 offen offset:1024 sc1
    buffer_load_dwordx4 v4, s[4:7], s36 offen offset:0 sc1 lds
    buffer_load_dwordx4 v4, s[4:7], s36 offen offset:1024 sc1 lds
    s_waitcnt vmcnt(6)
    v_max3_u32 v2, v44, v45, v46
    v_max3_u32 v3, v47, v48, v49
    v_max3_u32 v2, v2, v50, v51
    v_max_u32 v2, v2, v3
    v_cmp_eq_u32 vcc, -1, v2
    s_waitcnt vmcnt(4)
    s_cbranch_vccz CL0_go
    buffer_load_dwordx4 v[44:47], v4, s[4:7], s36 offen offset:0 sc1
    buffer_load_dwordx4 v[48:51], v4, s[4:7], s36 offen offset:1024 sc1
    buffer_load_dwordx4 v4, s[4:7], s36 offen offset:0 sc1 lds
    buffer_load_dwordx4 v4, s[4:7], s36 offen offset:1024 sc1 lds
    s_add_u32 s23, s23, 1
    s_cmp_gt_u32 s23, 262144
    s_cbranch_scc1 CL0_go
CL0_e0:
    s_waitcnt vmcnt(6)
    v_max3_u32 v2, v36, v37, v38
    v_max3_u32 v3, v39, v40, v41
    v_max3_u32 v2, v2, v42, v43
    v_max_u32 v2, v2, v3
    v_cmp_eq_u32 vcc, -1, v2
    s_waitcnt vmcnt(4)
    s_cbranch_vccnz CL0_e1
CL0_go:
    s_mov_b32 m0, 135168
    s_barrier
    buffer_load_dwordx4 v10, s[4:7], s26 offen sc1 lds
CL0_b1:
    ds_read_b128 v[20:23], v1 offset:0
    ds_read_b128 v[24:27], v1 offset:1024
    ds_read_b128 v[28:31], v1 offset:2048
    ds_read_b128 v[32:35], v1 offset:3072
    s_waitcnt lgkmcnt(3)
    v_smfmac_f32_16x16x64_bf16 v[52:55], v[20:23], v[108:115], v0
    v_smfmac_f32_16x16x64_bf16 v[56:59], v[20:23], v[116:123], v0
    v_smfmac_f32_16x16x64_bf16 v[60:63], v[20:23], v[76:83], v0
    s_waitcnt lgkmcnt(0)
    v_smfmac_f32_16x16x64_bf16 v[64:67], v[20:23], v[84:91], v0
    v_mov_b64 v[120:121], -1
    v_smfmac_f32_16x16x64_bf16 v[52:55], v[24:27], v[92:99], v0
    v_mov_b64 v[122:123], -1
    v_smfmac_f32_16x16x64_bf16 v[56:59], v[24:27], v[100:107], v0
    ds_read_b128 v[108:111], v4 offset:8192
    v_smfmac_f32_16x16x64_bf16 v[60:63], v[24:27], a[96:103], v0
    ds_read_b128 v[112:115], v4 offset:9216
    v_smfmac_f32_16x16x64_bf16 v[64:67], v[24:27], a[152:159], v0
    ds_read_b128 v[76:79], v6 offset:0
    v_smfmac_f32_16x16x64_bf16 v[52:55], v[28:31], a[0:7], v0
    ds_read_b128 v[80:83], v6 offset:1024
    v_smfmac_f32_16x16x64_bf16 v[56:59], v[28:31], a[48:55], v0
    s_waitcnt vmcnt(0) lgkmcnt(2)
    s_barrier
    v_smfmac_f32_16x16x64_bf16 v[60:63], v[28:31], a[104:111], v0
    ds_read_b128 v[36:39], v1 offset:4096
    v_smfmac_f32_16x16x64_bf16 v[64:67], v[28:31], a[160:167], v0
    ds_read_b128 v[40:43], v1 offset:5120
    v_smfmac_f32_16x16x64_bf16 v[52:55], v[32:35], a[8:15], v0
    ds_read_b128 v[44:47], v1 offset:6144
    v_smfmac_f32_16x16x64_bf16 v[56:59], v[32:35], a[56:63], v0
    ds_read_b128 v[48:51], v1 offset:7168
    v_smfmac_f32_16x16x64_bf16 v[60:63], v[32:35], a[112:119], v0
    s_waitcnt lgkmcnt(2)
    v_max3_u32 v2, v36, v37, v38
    v_smfmac_f32_16x16x64_bf16 v[64:67], v[32:35], a[168:175], v0
    v_max3_u32 v2, v2, v39, v40
    v_smfmac_f32_16x16x64_bf16 v[68:71], v[20:23], a[208:215], v0
    v_max3_u32 v2, v2, v41, v42
    v_smfmac_f32_16x16x64_bf16 v[72:75], v[20:23], v[144:151], v0
    s_waitcnt lgkmcnt(0)
    v_max3_u32 v2, v2, v43, v44
    v_smfmac_f32_16x16x64_bf16 v[68:71], v[24:27], a[216:223], v0
    ds_read_b128 v[84:87], v6 offset:2048
    buffer_store_dwordx4 v[120:123], v4, s[4:7], s31 offen
    v_max3_u32 v2, v2, v45, v46
    v_smfmac_f32_16x16x64_bf16 v[72:75], v[24:27], v[152:159], v0
    ds_read_b128 v[88:91], v6 offset:3072
    v_max3_u32 v2, v2, v47, v48
    v_smfmac_f32_16x16x64_bf16 v[68:71], v[28:31], a[224:231], v0
    ds_read_b128 v[92:95], v6 offset:4096
    buffer_store_dwordx4 v[120:123], v4, s[4:7], s31 offen offset:1024
    v_max3_u32 v2, v2, v49, v50
    v_smfmac_f32_16x16x64_bf16 v[72:75], v[28:31], v[160:167], v0
    ds_read_b128 v[96:99], v6 offset:5120
    v_max_u32 v2, v2, v51
    v_smfmac_f32_16x16x64_bf16 v[68:71], v[32:35], a[232:239], v0
    ds_read_b128 v[100:103], v6 offset:6144
    v_cmp_eq_u32 vcc, -1, v2
    v_smfmac_f32_16x16x64_bf16 v[72:75], v[32:35], v[168:175], v0
    s_cbranch_vccnz CL0_side
CL0_late_done:
    v_smfmac_f32_16x16x64_bf16 v[52:55], v[36:39], a[16:23], v0
    ds_read_b128 v[104:107], v6 offset:7168
    v_smfmac_f32_16x16x64_bf16 v[52:55], v[40:43], a[24:31], v0
    v_smfmac_f32_16x16x64_bf16 v[52:55], v[44:47], a[32:39], v0
    v_smfmac_f32_16x16x64_bf16 v[52:55], v[48:51], a[40:47], v0
    v_smfmac_f32_16x16x64_bf16 v[56:59], v[36:39], a[64:71], v0
    s_nop 2
    v_smfmac_f32_16x16x64_bf16 v[56:59], v[40:43], a[72:79], v0
    s_nop 2
    v_smfmac_f32_16x16x64_bf16 v[56:59], v[44:47], a[80:87], v0
    buffer_store_dwordx4 v[124:127], v10, s[4:7], s22 offen sc1
    v_add_f32 v52, v52, v54
    v_smfmac_f32_16x16x64_bf16 v[56:59], v[48:51], a[88:95], v0
    v_add_f32 v53, v53, v55
    v_smfmac_f32_16x16x64_bf16 v[60:63], v[36:39], a[120:127], v0
    s_nop 0
    v_cvt_pk_bf16_f32 v52, v52, v53
    v_smfmac_f32_16x16x64_bf16 v[60:63], v[40:43], a[128:135], v0
    buffer_store_dword v120, v15, s[4:7], s32 offen
    v_smfmac_f32_16x16x64_bf16 v[60:63], v[44:47], a[136:143], v0
    s_nop 0
    v_add_f32 v56, v56, v58
    v_smfmac_f32_16x16x64_bf16 v[60:63], v[48:51], a[144:151], v0
    v_add_f32 v57, v57, v59
    v_smfmac_f32_16x16x64_bf16 v[64:67], v[36:39], a[176:183], v0
    s_nop 0
    v_cvt_pk_bf16_f32 v53, v56, v57
    v_smfmac_f32_16x16x64_bf16 v[64:67], v[40:43], a[184:191], v0
    ds_write2_b32 v8, v52, v53 offset0:0 offset1:128
    v_smfmac_f32_16x16x64_bf16 v[64:67], v[44:47], a[192:199], v0
    s_nop 0
    v_add_f32 v60, v60, v62
    v_smfmac_f32_16x16x64_bf16 v[64:67], v[48:51], a[200:207], v0
    v_add_f32 v61, v61, v63
    v_smfmac_f32_16x16x64_bf16 v[68:71], v[36:39], a[240:247], v0
    s_cmp_ge_u32 s18, 61
    v_cvt_pk_bf16_f32 v60, v60, v61
    v_smfmac_f32_16x16x64_bf16 v[72:75], v[36:39], v[176:183], v0
    s_nop 2
    v_smfmac_f32_16x16x64_bf16 v[68:71], v[40:43], a[248:255], v0
    s_waitcnt lgkmcnt(0)
    s_barrier
    v_add_f32 v64, v64, v66
    v_smfmac_f32_16x16x64_bf16 v[72:75], v[40:43], v[184:191], v0
    ds_read_b64_tr_b16 v[20:21], v9 offset:0
    ds_read_b64_tr_b16 v[22:23], v9 offset:512
    v_add_f32 v65, v65, v67
    v_smfmac_f32_16x16x64_bf16 v[68:71], v[44:47], v[128:135], v0
    ds_read_b64_tr_b16 v[24:25], v9 offset:1024
    ds_read_b64_tr_b16 v[26:27], v9 offset:1536
    v_cvt_pk_bf16_f32 v61, v64, v65
    v_smfmac_f32_16x16x64_bf16 v[72:75], v[44:47], v[192:199], v0
    ds_write2_b32 v8, v60, v61 offset0:1 offset1:129
    ds_read_b64_tr_b16 v[28:29], v9 offset:2048
    ds_read_b64_tr_b16 v[30:31], v9 offset:2560
    v_smfmac_f32_16x16x64_bf16 v[68:71], v[48:51], v[136:143], v0
    ds_read_b64_tr_b16 v[32:33], v9 offset:3072
    ds_read_b64_tr_b16 v[34:35], v9 offset:3584
    v_smfmac_f32_16x16x64_bf16 v[72:75], v[48:51], v[200:207], v0
    s_waitcnt lgkmcnt(7)
    v_mfma_f32_16x16x32_bf16 v[124:127], v[92:95], v[20:23], 0
    ds_read_b128 v[44:47], v11 offset:6144
    s_waitcnt lgkmcnt(6)
    v_mfma_f32_16x16x32_bf16 v[124:127], v[96:99], v[24:27], v[124:127]
    ds_read_b128 v[48:51], v12 offset:6144
    s_waitcnt lgkmcnt(4)
    v_mfma_f32_16x16x32_bf16 v[124:127], v[100:103], v[28:31], v[124:127]
    s_waitcnt lgkmcnt(2)
    s_waitcnt lgkmcnt(6)
    s_barrier
    v_mfma_f32_16x16x32_bf16 v[124:127], v[104:107], v[32:35], v[124:127]
    ds_read_b64_tr_b16 v[52:53], v9 offset:0
    ds_read_b64_tr_b16 v[54:55], v9 offset:512
    v_add_f32 v68, v68, v70
    v_mfma_f32_16x16x32_bf16 v[120:123], v[76:79], v[20:23], 0
    ds_read_b64_tr_b16 v[56:57], v9 offset:1024
    ds_read_b64_tr_b16 v[58:59], v9 offset:1536
    v_add_f32 v69, v69, v71
    v_mfma_f32_16x16x32_bf16 v[120:123], v[80:83], v[24:27], v[120:123]
    ds_read_b64_tr_b16 v[36:37], v9 offset:2048
    ds_read_b64_tr_b16 v[38:39], v9 offset:2560
    v_add_f32 v72, v72, v74
    v_mfma_f32_16x16x32_bf16 v[120:123], v[84:87], v[28:31], v[120:123]
    ds_read_b64_tr_b16 v[40:41], v9 offset:3072
    ds_read_b64_tr_b16 v[42:43], v9 offset:3584
    v_add_f32 v73, v73, v75
    v_mfma_f32_16x16x32_bf16 v[120:123], v[88:91], v[32:35], v[120:123]
    ds_read_b128 v[92:95], v11 offset:7168
    s_waitcnt lgkmcnt(7)
    v_cvt_pk_bf16_f32 v62, v68, v69
    v_mfma_f32_16x16x32_bf16 v[116:119], v[52:55], v[20:23], 0
    ds_read_b128 v[96:99], v12 offset:7168
    s_waitcnt lgkmcnt(6)
    v_cvt_pk_bf16_f32 v63, v72, v73
    v_mfma_f32_16x16x32_bf16 v[116:119], v[56:59], v[24:27], v[116:119]
    ds_read_b128 v[100:103], v11 offset:8192
    s_waitcnt lgkmcnt(5)
    v_mfma_f32_16x16x32_bf16 v[116:119], v[36:39], v[28:31], v[116:119]
    ds_read_b128 v[104:107], v12 offset:8192
    s_waitcnt lgkmcnt(4)
    v_max3_f32 v64, v124, v125, v126
    v_mfma_f32_16x16x32_bf16 v[116:119], v[40:43], v[32:35], v[116:119]
    ds_read_b128 v[76:79], v11 offset:9216
    v_max3_f32 v64, v64, v127, v120
    s_cbranch_scc1 CL0_done
CL0_resume:
    ds_read_b128 v[80:83], v12 offset:9216
    v_max3_f32 v64, v64, v121, v122
    v_max_f32 v64, v64, v123
    v_mov_b32 v66, s28
    v_xor_b32 v6, 8192, v6
    v_max3_f32 v65, v64, v118, v119
    v_max3_f32 v64, v64, v118, v119
    v_mov_b32 v68, 0x3f803f80
    v_mov_b32 v69, 0x3f803f80
    v_permlane32_swap_b32 v64, v65
    v_max_f32 v64, v64, v65
    v_mov_b32 v65, v64
    v_mov_b64 v[70:71], v[68:69]
    v_mov_b64 v[72:73], 0
    v_permlane16_swap_b32 v64, v65
    v_max_f32 v64, v64, v65
    v_mul_f32 v64, s28, v64
    v_pk_fma_f32 v[118:119], v[118:119], v[66:67], v[64:65] op_sel_hi:[1,0,0] neg_lo:[0,0,1] neg_hi:[0,0,1]
    v_pk_fma_f32 v[120:121], v[120:121], v[66:67], v[64:65] op_sel_hi:[1,0,0] neg_lo:[0,0,1] neg_hi:[0,0,1]
    v_pk_fma_f32 v[122:123], v[122:123], v[66:67], v[64:65] op_sel_hi:[1,0,0] neg_lo:[0,0,1] neg_hi:[0,0,1]
    v_pk_fma_f32 v[124:125], v[124:125], v[66:67], v[64:65] op_sel_hi:[1,0,0] neg_lo:[0,0,1] neg_hi:[0,0,1]
    v_pk_fma_f32 v[126:127], v[126:127], v[66:67], v[64:65] op_sel_hi:[1,0,0] neg_lo:[0,0,1] neg_hi:[0,0,1]
    v_exp_f32 v118, v118
    v_exp_f32 v119, v119
    v_exp_f32 v120, v120
    v_cvt_pk_bf16_f32 v16, v118, v119
    v_cvt_pk_bf16_f32 v19, v118, v119
    v_exp_f32 v121, v121
    v_mfma_f32_16x16x16_bf16 v[52:55], v[62:63], v[16:17], 0
    ds_read_b128 v[84:87], v11 offset:10240
    v_exp_f32 v122, v122
    v_exp_f32 v123, v123
    v_mfma_f32_16x16x16_bf16 v[56:59], v[62:63], v[18:19], 0
    ds_read_b128 v[88:91], v12 offset:10240
    v_exp_f32 v124, v124
    v_exp_f32 v125, v125
    v_mfma_f32_16x16x16_bf16 v[64:67], v[68:69], v[16:17], 0
    ds_read_b128 v[20:23], v11 offset:11264
    v_exp_f32 v126, v126
    v_exp_f32 v127, v127
    v_cvt_pk_bf16_f32 v120, v120, v121
    v_cvt_pk_bf16_f32 v121, v122, v123
    v_cvt_pk_bf16_f32 v122, v124, v125
    v_cvt_pk_bf16_f32 v123, v126, v127
    v_mov_b64 v[124:125], v[60:61]
    v_mov_b64 v[126:127], v[62:63]
    v_mfma_f32_16x16x32_bf16 v[64:67], v[68:71], v[120:123], v[64:67]
    ds_read_b128 v[24:27], v12 offset:11264
    v_mov_b64 v[60:61], 0
    v_mfma_f32_16x16x32_bf16 v[52:55], v[108:111], v[120:123], v[52:55]
    ds_read_b128 v[28:31], v11 offset:12288
    v_mov_b64 v[62:63], 0
    v_mfma_f32_16x16x32_bf16 v[56:59], v[112:115], v[120:123], v[56:59]
    ds_read_b128 v[32:35], v12 offset:12288
    v_mov_b64 v[68:69], 0
    v_mov_b64 v[70:71], 0
    v_mov_b64 v[74:75], 0
    v_rcp_f32 v64, v64
    s_nop 0
    v_pk_mul_f32 v[52:53], v[52:53], v[64:65] op_sel_hi:[1,0]
    v_pk_mul_f32 v[54:55], v[54:55], v[64:65] op_sel_hi:[1,0]
    v_pk_mul_f32 v[56:57], v[56:57], v[64:65] op_sel_hi:[1,0]
    v_pk_mul_f32 v[58:59], v[58:59], v[64:65] op_sel_hi:[1,0]
    v_cvt_pk_bf16_f32 v52, v52, v53
    v_cvt_pk_bf16_f32 v53, v54, v55
    v_cvt_pk_bf16_f32 v54, v56, v57
    v_cvt_pk_bf16_f32 v55, v58, v59
    ds_write_b128 v10, v[52:55] offset:4096
    v_mov_b32_dpp v52, v52 quad_perm:[0,1,0,1] row_mask:0xf bank_mask:0xf
    v_mov_b32_dpp v53, v53 quad_perm:[0,1,0,1] row_mask:0xf bank_mask:0xf
    v_mov_b32_dpp v54, v54 quad_perm:[0,1,0,1] row_mask:0xf bank_mask:0xf
    v_mov_b32_dpp v55, v55 quad_perm:[0,1,0,1] row_mask:0xf bank_mask:0xf
    v_mov_b64 v[64:65], 0
    v_mov_b64 v[66:67], 0
    v_smfmac_f32_16x16x64_bf16 v[68:71], v[52:55], v[208:215], v0
    ds_read_b128 v[36:39], v11 offset:13312
    s_add_u32 s25, s19, 4096
    v_smfmac_f32_16x16x64_bf16 v[72:75], v[52:55], v[232:239], v0
    ds_read_b128 v[40:43], v12 offset:13312
    s_mov_b32 s32, s20
    s_add_u32 s20, s20, 8192
    s_waitcnt lgkmcnt(2)
    s_barrier
    ds_read_b128 v[56:59], v5 offset:5120
    ds_read_b128 v[112:115], v5 offset:7168
    ds_read_b128 v[108:111], v5 offset:6144
    v_smfmac_f32_16x16x64_bf16 v[60:63], v[52:55], v[240:247], v0
    v_smfmac_f32_16x16x64_bf16 v[64:67], v[52:55], v[248:255], v0
    s_waitcnt lgkmcnt(2)
    v_smfmac_f32_16x16x64_bf16 v[68:71], v[56:59], v[216:223], v0
    s_waitcnt lgkmcnt(1)
    ds_read_b128 v[116:119], v11 offset:14336
    v_smfmac_f32_16x16x64_bf16 v[68:71], v[112:115], v[224:231], v0
    s_waitcnt lgkmcnt(1)
    ds_read_b128 v[120:123], v12 offset:14336
    v_smfmac_f32_16x16x64_bf16 v[68:71], v[108:111], v[44:51], v0
    s_and_b32 s20, s20, 0xffff7fff
    s_sub_u32 s36, s20, 131072
    s_add_u32 s31, s33, s19
    v_smfmac_f32_16x16x64_bf16 v[72:75], v[56:59], v[92:99], v0
    s_add_u32 s22, s22, 4096
    s_add_u32 s18, s18, 1
    s_nop 1
    v_cvt_pk_bf16_f32 v68, v68, v70
    v_cvt_pk_bf16_f32 v69, v69, v71
    v_smfmac_f32_16x16x64_bf16 v[72:75], v[112:115], v[100:107], v0
    buffer_store_dwordx2 v[68:69], v13, s[4:7], s19 offen offset:0
    v_smfmac_f32_16x16x64_bf16 v[72:75], v[108:111], v[76:83], v0
    ds_read_b128 v[44:47], v11 offset:15360
    s_nop 0
    v_smfmac_f32_16x16x64_bf16 v[60:63], v[56:59], v[84:91], v0
    ds_read_b128 v[48:51], v12 offset:15360
    s_nop 0
    v_smfmac_f32_16x16x64_bf16 v[60:63], v[112:115], v[20:27], v0
    s_nop 1
    v_cvt_pk_bf16_f32 v72, v72, v74
    v_cvt_pk_bf16_f32 v73, v73, v75
    v_smfmac_f32_16x16x64_bf16 v[60:63], v[108:111], v[28:35], v0
    buffer_store_dwordx2 v[72:73], v13, s[4:7], s19 offen offset:2048
    v_smfmac_f32_16x16x64_bf16 v[64:67], v[56:59], v[36:43], v0
    s_waitcnt lgkmcnt(0)
    s_nop 1
    v_smfmac_f32_16x16x64_bf16 v[64:67], v[112:115], v[116:123], v0
    s_nop 0
    s_nop 0
    v_cvt_pk_bf16_f32 v60, v60, v62
    v_cvt_pk_bf16_f32 v61, v61, v63
    v_smfmac_f32_16x16x64_bf16 v[64:67], v[108:111], v[44:51], v0
    buffer_store_dwordx2 v[60:61], v13, s[4:7], s25 offen offset:0
    s_nop 6
    v_cvt_pk_bf16_f32 v64, v64, v66
    v_cvt_pk_bf16_f32 v65, v65, v67
    buffer_store_dwordx2 v[64:65], v13, s[4:7], s25 offen offset:2048
    s_barrier
    s_nop 15
    s_nop 7
    buffer_load_dwordx4 v[20:23], v4, s[4:7], s31 offen sc1
    buffer_load_dwordx4 v[24:27], v4, s[4:7], s31 offen offset:1024 sc1
    v_mov_b64 v[52:53], 0
    v_mov_b64 v[54:55], 0
    v_mov_b64 v[56:57], 0
    v_mov_b64 v[58:59], 0
    v_mov_b64 v[60:61], 0
    v_mov_b64 v[62:63], 0
    v_mov_b64 v[64:65], 0
    v_mov_b64 v[66:67], 0
    v_mov_b64 v[68:69], 0
    v_mov_b64 v[70:71], 0
    v_mov_b64 v[72:73], 0
    v_mov_b64 v[74:75], 0
    v_cndmask_b32 v36, 0, v7, s[52:53]
    v_cndmask_b32 v37, 0, v7, s[54:55]
    v_cndmask_b32 v38, 0, v7, s[56:57]
    v_cndmask_b32 v39, 0, v7, s[58:59]
    s_nop 13
    buffer_load_dwordx4 v[28:31], v4, s[4:7], s31 offen sc1
    buffer_load_dwordx4 v[32:35], v4, s[4:7], s31 offen offset:1024 sc1
    s_xor_b32 s19, s19, 262144
    s_mov_b32 m0, 131072
    s_add_u32 s26, s36, 4096
    s_branch CL0_waitA
CL0_pollA_retry:
    buffer_load_dwordx4 v[20:23], v4, s[4:7], s31 offen sc1
    buffer_load_dwordx4 v[24:27], v4, s[4:7], s31 offen offset:1024 sc1
    s_add_u32 s35, s35, 1
    s_waitcnt vmcnt(2)
    v_mfma_f32_16x16x32_bf16 v[40:43], v[36:39], v[28:31], 0
    v_max3_u32 v2, v28, v29, v30
    v_max3_u32 v3, v31, v32, v33
    v_mfma_f32_16x16x32_bf16 v[40:43], v[36:39], v[32:35], v[40:43]
    v_max3_u32 v2, v2, v34, v35
    v_max_u32 v2, v2, v3
    v_cmp_eq_u32 vcc, -1, v2
    s_cbranch_vccz CL0_goA
    buffer_load_dwordx4 v[28:31], v4, s[4:7], s31 offen sc1
    buffer_load_dwordx4 v[32:35], v4, s[4:7], s31 offen offset:1024 sc1
    s_cmp_gt_u32 s35, 262144
    s_cbranch_scc1 CL0_goA
CL0_waitA:
    s_waitcnt vmcnt(2)
    v_mfma_f32_16x16x32_bf16 v[40:43], v[36:39], v[20:23], 0
    v_max3_u32 v2, v20, v21, v22
    v_max3_u32 v3, v23, v24, v25
    v_mfma_f32_16x16x32_bf16 v[40:43], v[36:39], v[24:27], v[40:43]
    v_max3_u32 v2, v2, v26, v27
    v_max_u32 v2, v2, v3
    v_cmp_eq_u32 vcc, -1, v2
    s_nop 3
    s_cbranch_vccnz CL0_pollA_retry
CL0_goA_n:
    v_add_f32_dpp v40, v40, v40 row_ror:4 row_mask:0xf bank_mask:0xf
    v_add_f32_dpp v41, v41, v41 row_ror:4 row_mask:0xf bank_mask:0xf
    s_nop 0
    v_add_f32_dpp v40, v40, v40 row_ror:8 row_mask:0xf bank_mask:0xf
    v_add_f32_dpp v41, v41, v41 row_ror:8 row_mask:0xf bank_mask:0xf
    v_cvt_pk_bf16_f32 v40, v40, v41
    buffer_store_dword v40, v15, s[4:7], s20 offen
    ds_read_b128 v[108:111], v11 offset:0
    ds_read_b128 v[112:115], v12 offset:0
    ds_read_b128 v[116:119], v11 offset:1024
    ds_read_b128 v[120:123], v12 offset:1024
    ds_read_b128 v[76:79], v11 offset:2048
    ds_read_b128 v[80:83], v12 offset:2048
    ds_read_b128 v[84:87], v11 offset:3072
    ds_read_b128 v[88:91], v12 offset:3072
    s_nop 15
    s_nop 11
CL0_kvdone:
    buffer_load_dwordx4 v[36:39], v4, s[4:7], s36 offen offset:0 sc1
    buffer_load_dwordx4 v[40:43], v4, s[4:7], s36 offen offset:1024 sc1
    buffer_load_dwordx4 v4, s[4:7], s36 offen offset:0 sc1 lds
    buffer_load_dwordx4 v4, s[4:7], s36 offen offset:1024 sc1 lds
    ds_read_b128 v[92:95], v11 offset:4096
    ds_read_b128 v[96:99], v12 offset:4096
    s_nop 15
    s_nop 11
    buffer_load_dwordx4 v[44:47], v4, s[4:7], s36 offen offset:0 sc1
    buffer_load_dwordx4 v[48:51], v4, s[4:7], s36 offen offset:1024 sc1
    buffer_load_dwordx4 v4, s[4:7], s36 offen offset:0 sc1 lds
    buffer_load_dwordx4 v4, s[4:7], s36 offen offset:1024 sc1 lds
    ds_read_b128 v[100:103], v11 offset:5120
    ds_read_b128 v[104:107], v12 offset:5120
    s_waitcnt lgkmcnt(0)
    s_branch CL0_e0
CL0_goA:
    s_nop 3
    s_branch CL0_goA_n
CL0_done:
    s_add_u32 s22, s22, 4096
    buffer_store_dwordx4 v[60:63], v10, s[4:7], s22 offen sc1
    s_sub_u32 s22, s22, 4096
    s_cmp_lt_u32 s18, 63
    s_cbranch_scc1 CL0_resume
CL_exit:
    s_branch L_chain_end
L_chain_global:
    s_cmp_eq_u32 s17, 0
    s_cbranch_scc1 CG0_entry
    s_cmp_eq_u32 s17, 1
    s_cbranch_scc1 CG1_entry
    s_cmp_eq_u32 s17, 2
    s_cbranch_scc1 CG2_entry
CG3_entry:
    s_waitcnt lgkmcnt(0)
    ds_read_b128 v[108:111], v11 offset:0
    ds_read_b128 v[112:115], v12 offset:0
    ds_read_b128 v[116:119], v11 offset:1024
    ds_read_b128 v[120:123], v12 offset:1024
    ds_read_b128 v[76:79], v11 offset:2048
    ds_read_b128 v[80:83], v12 offset:2048
    ds_read_b128 v[84:87], v11 offset:3072
    ds_read_b128 v[88:91], v12 offset:3072
    ds_read_b128 v[92:95], v11 offset:4096
    ds_read_b128 v[96:99], v12 offset:4096
    ds_read_b128 v[100:103], v11 offset:5120
    ds_read_b128 v[104:107], v12 offset:5120
    v_mov_b64 v[52:53], 0
    v_mov_b64 v[54:55], 0
    v_mov_b64 v[56:57], 0
    v_mov_b64 v[58:59], 0
    v_mov_b64 v[60:61], 0
    v_mov_b64 v[62:63], 0
    v_mov_b64 v[64:65], 0
    v_mov_b64 v[66:67], 0
    v_mov_b64 v[68:69], 0
    v_mov_b64 v[70:71], 0
    v_mov_b64 v[72:73], 0
    v_mov_b64 v[74:75], 0
    s_cmp_le_u32 s38, 1
    s_cselect_b64 s[50:51], -1, 0
    s_lshl_b32 s34, s16, 8
    s_add_u32 s34, s34, 0
    s_waitcnt vmcnt(0) lgkmcnt(0)
    s_branch CG3_e0
CG3_side:
    v_cmp_eq_u32 vcc, -1, v2
    s_cbranch_vccz CG3_side2
CG3_lateB:
    s_mov_b32 m0, 138240
    s_nop 0
    buffer_load_dwordx4 v10, s[4:7], s26 offen sc1 lds
    s_add_u32 s23, s23, 1
    s_cmp_gt_u32 s23, 262144
    s_waitcnt vmcnt(1)
    s_cbranch_scc1 CG3_lateB_ok
    ds_read_b128 v[36:39], v1 offset:4096
    ds_read_b128 v[40:43], v1 offset:5120
    ds_read_b128 v[44:47], v1 offset:6144
    ds_read_b128 v[48:51], v1 offset:7168
    s_waitcnt lgkmcnt(0)
    v_max3_u32 v2, v36, v37, v38
    v_max3_u32 v2, v2, v39, v40
    v_max3_u32 v2, v2, v41, v42
    v_max3_u32 v2, v2, v43, v44
    v_max3_u32 v2, v2, v45, v46
    v_max3_u32 v2, v2, v47, v48
    v_max3_u32 v2, v2, v49, v50
    v_max_u32 v2, v2, v51
    v_cmp_eq_u32 vcc, -1, v2
    s_cbranch_vccnz CG3_lateB
CG3_lateB_ok:
    s_waitcnt vmcnt(0)
CG3_side2:
    s_branch CG3_late_done
CG3_e1:
    buffer_load_dwordx4 v[36:39], v4, s[4:7], s36 offen offset:0 sc1
    buffer_load_dwordx4 v[40:43], v4, s[4:7], s36 offen offset:1024 sc1
    buffer_load_dwordx4 v4, s[4:7], s36 offen offset:0 sc1 lds
    buffer_load_dwordx4 v4, s[4:7], s36 offen offset:1024 sc1 lds
    s_waitcnt vmcnt(6)
    v_max3_u32 v2, v44, v45, v46
    v_max3_u32 v3, v47, v48, v49
    v_max3_u32 v2, v2, v50, v51
    v_max_u32 v2, v2, v3
    v_cmp_eq_u32 vcc, -1, v2
    s_waitcnt vmcnt(4)
    s_cbranch_vccz CG3_go
    buffer_load_dwordx4 v[44:47], v4, s[4:7], s36 offen offset:0 sc1
    buffer_load_dwordx4 v[48:51], v4, s[4:7], s36 offen offset:1024 sc1
    buffer_load_dwordx4 v4, s[4:7], s36 offen offset:0 sc1 lds
    buffer_load_dwordx4 v4, s[4:7], s36 offen offset:1024 sc1 lds
    s_add_u32 s23, s23, 1
    s_cmp_gt_u32 s23, 262144
    s_cbranch_scc1 CG3_go
CG3_e0:
    s_waitcnt vmcnt(0)
    s_cmp_eq_u32 s50, 0
    s_cbranch_scc1 CG3_kvgo
CG3_l_kvw:
    v_lshrrev_b32 v2, 2, v1
    s_lshl_b32 s27, s16, 8
    v_subrev_u32 v2, 32768, v2
    s_add_u32 s27, s27, 0
    buffer_load_dword v14, v2, s[4:7], s27 offen sc1
    s_add_u32 s23, s23, 1
    s_waitcnt vmcnt(0)
CG3_l_kve:
    v_cmp_ne_u32 vcc, 0, v14
    s_nop 0
    s_ff0_i32_b64 s38, vcc
    s_cmp_gt_u32 s23, 262144
    s_cbranch_scc1 CG3_l_kvw_done
    s_add_u32 s27, s18, 1
    s_cmp_ge_u32 s27, s38
    s_cbranch_scc1 CG3_l_kvw
CG3_l_kvw_done:
CG3_kvgo:
    s_cmp_eq_u32 s18, 0
    s_cbranch_scc0 CG3_go
    s_barrier
    s_branch CG3_b1
CG3_go:
    s_mov_b32 m0, 138240
    s_barrier
    buffer_load_dwordx4 v10, s[4:7], s26 offen sc1 lds
CG3_b1:
    ds_read_b128 v[20:23], v1 offset:0
    ds_read_b128 v[24:27], v1 offset:1024
    ds_read_b128 v[28:31], v1 offset:2048
    ds_read_b128 v[32:35], v1 offset:3072
    s_waitcnt lgkmcnt(3)
    v_smfmac_f32_16x16x64_bf16 v[52:55], v[20:23], v[108:115], v0
    s_add_u32 m0, s29, -2048
    s_add_u32 s27, s21, 4096
    v_smfmac_f32_16x16x64_bf16 v[56:59], v[20:23], v[116:123], v0
    v_smfmac_f32_16x16x64_bf16 v[60:63], v[20:23], v[76:83], v0
    s_waitcnt lgkmcnt(0)
    buffer_load_dwordx4 v1, s[4:7], s27 offen offset:0 sc1 lds
    v_smfmac_f32_16x16x64_bf16 v[64:67], v[20:23], v[84:91], v0
    v_mov_b64 v[120:121], -1
    v_smfmac_f32_16x16x64_bf16 v[52:55], v[24:27], v[92:99], v0
    buffer_load_dwordx4 v1, s[4:7], s27 offen offset:1024 sc1 lds
    v_mov_b64 v[122:123], -1
    v_smfmac_f32_16x16x64_bf16 v[56:59], v[24:27], v[100:107], v0
    ds_read_b128 v[108:111], v4 offset:8192
    v_smfmac_f32_16x16x64_bf16 v[60:63], v[24:27], a[96:103], v0
    ds_read_b128 v[112:115], v4 offset:9216
    buffer_load_dwordx4 v1, s[4:7], s27 offen offset:2048 sc1 lds
    v_smfmac_f32_16x16x64_bf16 v[64:67], v[24:27], a[152:159], v0
    ds_read_b128 v[76:79], v6 offset:0
    v_smfmac_f32_16x16x64_bf16 v[52:55], v[28:31], a[0:7], v0
    ds_read_b128 v[80:83], v6 offset:1024
    buffer_load_dwordx4 v1, s[4:7], s27 offen offset:3072 sc1 lds
    v_smfmac_f32_16x16x64_bf16 v[56:59], v[28:31], a[48:55], v0
    s_mov_b32 m0, 143360
    s_add_u32 s27, s21, 12288
    s_waitcnt vmcnt(4) lgkmcnt(2)
    s_barrier
    v_smfmac_f32_16x16x64_bf16 v[60:63], v[28:31], a[104:111], v0
    ds_read_b128 v[36:39], v1 offset:4096
    v_smfmac_f32_16x16x64_bf16 v[64:67], v[28:31], a[160:167], v0
    ds_read_b128 v[40:43], v1 offset:5120
    buffer_load_dwordx4 v1, s[4:7], s27 offen offset:0 sc1 lds
    v_smfmac_f32_16x16x64_bf16 v[52:55], v[32:35], a[8:15], v0
    ds_read_b128 v[44:47], v1 offset:6144
    v_smfmac_f32_16x16x64_bf16 v[56:59], v[32:35], a[56:63], v0
    ds_read_b128 v[48:51], v1 offset:7168
    buffer_load_dwordx4 v1, s[4:7], s27 offen offset:1024 sc1 lds
    v_smfmac_f32_16x16x64_bf16 v[60:63], v[32:35], a[112:119], v0
    s_waitcnt lgkmcnt(2)
    v_max3_u32 v2, v36, v37, v38
    v_smfmac_f32_16x16x64_bf16 v[64:67], v[32:35], a[168:175], v0
    buffer_load_dwordx4 v1, s[4:7], s27 offen offset:2048 sc1 lds
    v_max3_u32 v2, v2, v39, v40
    v_smfmac_f32_16x16x64_bf16 v[68:71], v[20:23], a[208:215], v0
    v_max3_u32 v2, v2, v41, v42
    v_smfmac_f32_16x16x64_bf16 v[72:75], v[20:23], v[144:151], v0
    s_waitcnt lgkmcnt(0)
    buffer_load_dwordx4 v1, s[4:7], s27 offen offset:3072 sc1 lds
    v_max3_u32 v2, v2, v43, v44
    v_smfmac_f32_16x16x64_bf16 v[68:71], v[24:27], a[216:223], v0
    ds_read_b128 v[84:87], v6 offset:2048
    v_max3_u32 v2, v2, v45, v46
    v_smfmac_f32_16x16x64_bf16 v[72:75], v[24:27], v[152:159], v0
    ds_read_b128 v[88:91], v6 offset:3072
    v_max3_u32 v2, v2, v47, v48
    v_smfmac_f32_16x16x64_bf16 v[68:71], v[28:31], a[224:231], v0
    ds_read_b128 v[92:95], v6 offset:4096
    v_max3_u32 v2, v2, v49, v50
    v_smfmac_f32_16x16x64_bf16 v[72:75], v[28:31], v[160:167], v0
    ds_read_b128 v[96:99], v6 offset:5120
    v_max_u32 v2, v2, v51
    v_smfmac_f32_16x16x64_bf16 v[68:71], v[32:35], a[232:239], v0
    ds_read_b128 v[100:103], v6 offset:6144
    v_cmp_eq_u32 vcc, -1, v2
    v_smfmac_f32_16x16x64_bf16 v[72:75], v[32:35], v[168:175], v0
    s_cbranch_vccnz CG3_side
CG3_late_done:
    v_smfmac_f32_16x16x64_bf16 v[52:55], v[36:39], a[16:23], v0
    ds_read_b128 v[104:107], v6 offset:7168
    v_lshrrev_b32 v2, 2, v1
    v_smfmac_f32_16x16x64_bf16 v[52:55], v[40:43], a[24:31], v0
    buffer_store_dwordx4 v[120:123], v4, s[4:7], s31 offen sc1
    v_subrev_u32 v2, 32768, v2
    v_smfmac_f32_16x16x64_bf16 v[52:55], v[44:47], a[32:39], v0
    v_smfmac_f32_16x16x64_bf16 v[52:55], v[48:51], a[40:47], v0
    buffer_store_dwordx4 v[120:123], v4, s[4:7], s31 offen offset:1024 sc1
    v_smfmac_f32_16x16x64_bf16 v[56:59], v[36:39], a[64:71], v0
    s_nop 2
    v_smfmac_f32_16x16x64_bf16 v[56:59], v[40:43], a[72:79], v0
    buffer_store_dwordx4 v[124:127], v10, s[4:7], s22 offen sc1
    v_smfmac_f32_16x16x64_bf16 v[56:59], v[44:47], a[80:87], v0
    v_add_f32 v52, v52, v54
    v_smfmac_f32_16x16x64_bf16 v[56:59], v[48:51], a[88:95], v0
    v_add_f32 v53, v53, v55
    v_smfmac_f32_16x16x64_bf16 v[60:63], v[36:39], a[120:127], v0
    s_nop 0
    v_cvt_pk_bf16_f32 v52, v52, v53
    v_smfmac_f32_16x16x64_bf16 v[60:63], v[40:43], a[128:135], v0
    s_nop 2
    v_smfmac_f32_16x16x64_bf16 v[60:63], v[44:47], a[136:143], v0
    v_add_f32 v56, v56, v58
    v_smfmac_f32_16x16x64_bf16 v[60:63], v[48:51], a[144:151], v0
    v_add_f32 v57, v57, v59
    v_smfmac_f32_16x16x64_bf16 v[64:67], v[36:39], a[176:183], v0
    buffer_store_dword v120, v15, s[4:7], s32 offen sc1
    v_cvt_pk_bf16_f32 v53, v56, v57
    v_smfmac_f32_16x16x64_bf16 v[64:67], v[40:43], a[184:191], v0
    ds_write2_b32 v8, v52, v53 offset0:0 offset1:128
    v_smfmac_f32_16x16x64_bf16 v[64:67], v[44:47], a[192:199], v0
    s_nop 0
    v_add_f32 v60, v60, v62
    v_smfmac_f32_16x16x64_bf16 v[64:67], v[48:51], a[200:207], v0
    buffer_load_dword v14, v2, s[4:7], s34 offen sc1
    v_add_f32 v61, v61, v63
    v_smfmac_f32_16x16x64_bf16 v[68:71], v[36:39], a[240:247], v0
    s_xor_b32 s29, s29, 8192
    s_add_u32 s21, s21, 524288
    s_cmp_ge_u32 s18, 61
    v_cvt_pk_bf16_f32 v60, v60, v61
    v_smfmac_f32_16x16x64_bf16 v[72:75], v[36:39], v[176:183], v0
    s_nop 2
    v_smfmac_f32_16x16x64_bf16 v[68:71], v[40:43], a[248:255], v0
    s_waitcnt lgkmcnt(0)
    s_barrier
    v_add_f32 v64, v64, v66
    v_smfmac_f32_16x16x64_bf16 v[72:75], v[40:43], v[184:191], v0
    ds_read_b64_tr_b16 v[20:21], v9 offset:0
    ds_read_b64_tr_b16 v[22:23], v9 offset:512
    v_add_f32 v65, v65, v67
    v_smfmac_f32_16x16x64_bf16 v[68:71], v[44:47], v[128:135], v0
    ds_read_b64_tr_b16 v[24:25], v9 offset:1024
    ds_read_b64_tr_b16 v[26:27], v9 offset:1536
    v_cvt_pk_bf16_f32 v61, v64, v65
    v_smfmac_f32_16x16x64_bf16 v[72:75], v[44:47], v[192:199], v0
    ds_write2_b32 v8, v60, v61 offset0:1 offset1:129
    ds_read_b64_tr_b16 v[28:29], v9 offset:2048
    ds_read_b64_tr_b16 v[30:31], v9 offset:2560
    v_smfmac_f32_16x16x64_bf16 v[68:71], v[48:51], v[136:143], v0
    ds_read_b64_tr_b16 v[32:33], v9 offset:3072
    ds_read_b64_tr_b16 v[34:35], v9 offset:3584
    v_smfmac_f32_16x16x64_bf16 v[72:75], v[48:51], v[200:207], v0
    s_waitcnt lgkmcnt(7)
    v_mfma_f32_16x16x32_bf16 v[124:127], v[92:95], v[20:23], 0
    ds_read_b128 v[44:47], v11 offset:6144
    s_waitcnt lgkmcnt(6)
    v_mfma_f32_16x16x32_bf16 v[124:127], v[96:99], v[24:27], v[124:127]
    ds_read_b128 v[48:51], v12 offset:6144
    s_waitcnt lgkmcnt(4)
    v_mfma_f32_16x16x32_bf16 v[124:127], v[100:103], v[28:31], v[124:127]
    s_waitcnt lgkmcnt(2)
    s_waitcnt lgkmcnt(6)
    s_barrier
    v_mfma_f32_16x16x32_bf16 v[124:127], v[104:107], v[32:35], v[124:127]
    ds_read_b64_tr_b16 v[52:53], v9 offset:0
    ds_read_b64_tr_b16 v[54:55], v9 offset:512
    v_add_f32 v68, v68, v70
    v_mfma_f32_16x16x32_bf16 v[120:123], v[76:79], v[20:23], 0
    ds_read_b64_tr_b16 v[56:57], v9 offset:1024
    ds_read_b64_tr_b16 v[58:59], v9 offset:1536
    v_add_f32 v69, v69, v71
    v_mfma_f32_16x16x32_bf16 v[120:123], v[80:83], v[24:27], v[120:123]
    ds_read_b64_tr_b16 v[36:37], v9 offset:2048
    ds_read_b64_tr_b16 v[38:39], v9 offset:2560
    v_add_f32 v72, v72, v74
    v_mfma_f32_16x16x32_bf16 v[120:123], v[84:87], v[28:31], v[120:123]
    ds_read_b64_tr_b16 v[40:41], v9 offset:3072
    ds_read_b64_tr_b16 v[42:43], v9 offset:3584
    v_add_f32 v73, v73, v75
    v_mfma_f32_16x16x32_bf16 v[120:123], v[88:91], v[32:35], v[120:123]
    ds_read_b128 v[92:95], v11 offset:7168
    s_waitcnt lgkmcnt(7)
    v_cvt_pk_bf16_f32 v62, v68, v69
    v_mfma_f32_16x16x32_bf16 v[116:119], v[52:55], v[20:23], 0
    ds_read_b128 v[96:99], v12 offset:7168
    s_waitcnt lgkmcnt(6)
    v_cvt_pk_bf16_f32 v63, v72, v73
    v_mfma_f32_16x16x32_bf16 v[116:119], v[56:59], v[24:27], v[116:119]
    ds_read_b128 v[100:103], v11 offset:8192
    s_waitcnt lgkmcnt(5)
    v_mfma_f32_16x16x32_bf16 v[116:119], v[36:39], v[28:31], v[116:119]
    ds_read_b128 v[104:107], v12 offset:8192
    s_waitcnt lgkmcnt(4)
    v_max3_f32 v64, v124, v125, v126
    v_mfma_f32_16x16x32_bf16 v[116:119], v[40:43], v[32:35], v[116:119]
    ds_read_b128 v[76:79], v11 offset:9216
    v_max3_f32 v64, v64, v127, v120
    s_cbranch_scc1 CG3_done
CG3_resume:
    ds_read_b128 v[80:83], v12 offset:9216
    v_max3_f32 v64, v64, v121, v122
    v_max_f32 v64, v64, v123
    v_mov_b32 v66, s28
    v_xor_b32 v6, 8192, v6
    v_max3_f32 v65, v64, v118, v119
    v_max3_f32 v64, v64, v118, v119
    v_mov_b32 v68, 0x3f803f80
    v_mov_b32 v69, 0x3f803f80
    v_permlane32_swap_b32 v64, v65
    v_max_f32 v64, v64, v65
    v_mov_b32 v65, v64
    v_mov_b64 v[70:71], v[68:69]
    v_mov_b64 v[72:73], 0
    v_permlane16_swap_b32 v64, v65
    v_max_f32 v64, v64, v65
    v_mul_f32 v64, s28, v64
    v_pk_fma_f32 v[118:119], v[118:119], v[66:67], v[64:65] op_sel_hi:[1,0,0] neg_lo:[0,0,1] neg_hi:[0,0,1]
    v_pk_fma_f32 v[120:121], v[120:121], v[66:67], v[64:65] op_sel_hi:[1,0,0] neg_lo:[0,0,1] neg_hi:[0,0,1]
    v_pk_fma_f32 v[122:123], v[122:123], v[66:67], v[64:65] op_sel_hi:[1,0,0] neg_lo:[0,0,1] neg_hi:[0,0,1]
    v_pk_fma_f32 v[124:125], v[124:125], v[66:67], v[64:65] op_sel_hi:[1,0,0] neg_lo:[0,0,1] neg_hi:[0,0,1]
    v_pk_fma_f32 v[126:127], v[126:127], v[66:67], v[64:65] op_sel_hi:[1,0,0] neg_lo:[0,0,1] neg_hi:[0,0,1]
    v_exp_f32 v118, v118
    v_exp_f32 v119, v119
    v_exp_f32 v120, v120
    v_cvt_pk_bf16_f32 v16, v118, v119
    v_cvt_pk_bf16_f32 v19, v118, v119
    v_exp_f32 v121, v121
    v_mfma_f32_16x16x16_bf16 v[52:55], v[62:63], v[16:17], 0
    ds_read_b128 v[84:87], v11 offset:10240
    v_exp_f32 v122, v122
    v_exp_f32 v123, v123
    v_mfma_f32_16x16x16_bf16 v[56:59], v[62:63], v[18:19], 0
    ds_read_b128 v[88:91], v12 offset:10240
    v_exp_f32 v124, v124
    v_exp_f32 v125, v125
    v_mfma_f32_16x16x16_bf16 v[64:67], v[68:69], v[16:17], 0
    ds_read_b128 v[20:23], v11 offset:11264
    v_exp_f32 v126, v126
    v_exp_f32 v127, v127
    v_cvt_pk_bf16_f32 v120, v120, v121
    v_cvt_pk_bf16_f32 v121, v122, v123
    v_cvt_pk_bf16_f32 v122, v124, v125
    v_cvt_pk_bf16_f32 v123, v126, v127
    v_mov_b64 v[124:125], v[60:61]
    v_mov_b64 v[126:127], v[62:63]
    v_mfma_f32_16x16x32_bf16 v[64:67], v[68:71], v[120:123], v[64:67]
    ds_read_b128 v[24:27], v12 offset:11264
    v_mov_b64 v[60:61], 0
    v_mfma_f32_16x16x32_bf16 v[52:55], v[108:111], v[120:123], v[52:55]
    ds_read_b128 v[28:31], v11 offset:12288
    v_mov_b64 v[62:63], 0
    v_mfma_f32_16x16x32_bf16 v[56:59], v[112:115], v[120:123], v[56:59]
    ds_read_b128 v[32:35], v12 offset:12288
    v_mov_b64 v[68:69], 0
    v_mov_b64 v[70:71], 0
    v_mov_b64 v[74:75], 0
    v_rcp_f32 v64, v64
    s_nop 0
    v_pk_mul_f32 v[52:53], v[52:53], v[64:65] op_sel_hi:[1,0]
    v_pk_mul_f32 v[54:55], v[54:55], v[64:65] op_sel_hi:[1,0]
    v_pk_mul_f32 v[56:57], v[56:57], v[64:65] op_sel_hi:[1,0]
    v_pk_mul_f32 v[58:59], v[58:59], v[64:65] op_sel_hi:[1,0]
    v_cvt_pk_bf16_f32 v52, v52, v53
    v_cvt_pk_bf16_f32 v53, v54, v55
    v_cvt_pk_bf16_f32 v54, v56, v57
    v_cvt_pk_bf16_f32 v55, v58, v59
    ds_write_b128 v10, v[52:55] offset:4096
    v_mov_b32_dpp v52, v52 quad_perm:[0,1,0,1] row_mask:0xf bank_mask:0xf
    v_mov_b32_dpp v53, v53 quad_perm:[0,1,0,1] row_mask:0xf bank_mask:0xf
    v_mov_b32_dpp v54, v54 quad_perm:[0,1,0,1] row_mask:0xf bank_mask:0xf
    v_mov_b32_dpp v55, v55 quad_perm:[0,1,0,1] row_mask:0xf bank_mask:0xf
    v_mov_b64 v[64:65], 0
    v_mov_b64 v[66:67], 0
    v_smfmac_f32_16x16x64_bf16 v[68:71], v[52:55], v[208:215], v0
    ds_read_b128 v[36:39], v11 offset:13312
    s_add_u32 s25, s19, 4096
    v_smfmac_f32_16x16x64_bf16 v[72:75], v[52:55], v[232:239], v0
    ds_read_b128 v[40:43], v12 offset:13312
    s_mov_b32 s32, s20
    s_add_u32 s20, s20, 8192
    s_waitcnt lgkmcnt(2)
    s_barrier
    ds_read_b128 v[56:59], v5 offset:6144
    ds_read_b128 v[112:115], v5 offset:4096
    ds_read_b128 v[108:111], v5 offset:5120
    v_smfmac_f32_16x16x64_bf16 v[60:63], v[52:55], v[240:247], v0
    v_smfmac_f32_16x16x64_bf16 v[64:67], v[52:55], v[248:255], v0
    s_waitcnt lgkmcnt(2)
    v_smfmac_f32_16x16x64_bf16 v[68:71], v[56:59], v[216:223], v0
    s_waitcnt lgkmcnt(1)
    ds_read_b128 v[116:119], v11 offset:14336
    v_smfmac_f32_16x16x64_bf16 v[68:71], v[112:115], v[224:231], v0
    s_waitcnt lgkmcnt(1)
    ds_read_b128 v[120:123], v12 offset:14336
    v_smfmac_f32_16x16x64_bf16 v[68:71], v[108:111], v[44:51], v0
    s_and_b32 s20, s20, 0xffff7fff
    s_sub_u32 s36, s20, 131072
    s_add_u32 s31, s33, s19
    v_smfmac_f32_16x16x64_bf16 v[72:75], v[56:59], v[92:99], v0
    s_add_u32 s22, s22, 4096
    s_add_u32 s18, s18, 1
    s_nop 1
    v_cvt_pk_bf16_f32 v68, v68, v70
    v_cvt_pk_bf16_f32 v69, v69, v71
    v_smfmac_f32_16x16x64_bf16 v[72:75], v[112:115], v[100:107], v0
    buffer_store_dwordx2 v[68:69], v13, s[4:7], s19 offen offset:0 sc1
    v_smfmac_f32_16x16x64_bf16 v[72:75], v[108:111], v[76:83], v0
    ds_read_b128 v[44:47], v11 offset:15360
    s_nop 0
    v_smfmac_f32_16x16x64_bf16 v[60:63], v[56:59], v[84:91], v0
    ds_read_b128 v[48:51], v12 offset:15360
    s_nop 0
    v_smfmac_f32_16x16x64_bf16 v[60:63], v[112:115], v[20:27], v0
    s_nop 1
    v_cvt_pk_bf16_f32 v72, v72, v74
    v_cvt_pk_bf16_f32 v73, v73, v75
    v_smfmac_f32_16x16x64_bf16 v[60:63], v[108:111], v[28:35], v0
    buffer_store_dwordx2 v[72:73], v13, s[4:7], s19 offen offset:2048 sc1
    v_smfmac_f32_16x16x64_bf16 v[64:67], v[56:59], v[36:43], v0
    s_waitcnt lgkmcnt(0)
    s_nop 1
    v_smfmac_f32_16x16x64_bf16 v[64:67], v[112:115], v[116:123], v0
    s_nop 0
    s_nop 0
    v_cvt_pk_bf16_f32 v60, v60, v62
    v_cvt_pk_bf16_f32 v61, v61, v63
    v_smfmac_f32_16x16x64_bf16 v[64:67], v[108:111], v[44:51], v0
    buffer_store_dwordx2 v[60:61], v13, s[4:7], s25 offen offset:0 sc1
    s_nop 6
    v_cvt_pk_bf16_f32 v64, v64, v66
    v_cvt_pk_bf16_f32 v65, v65, v67
    buffer_store_dwordx2 v[64:65], v13, s[4:7], s25 offen offset:2048 sc1
    s_barrier
    s_nop 15
    s_nop 15
    s_nop 15
    s_nop 11
    buffer_load_dwordx4 v[20:23], v4, s[4:7], s31 offen sc1
    buffer_load_dwordx4 v[24:27], v4, s[4:7], s31 offen offset:1024 sc1
    v_mov_b64 v[52:53], 0
    v_mov_b64 v[54:55], 0
    v_mov_b64 v[56:57], 0
    v_mov_b64 v[58:59], 0
    v_mov_b64 v[60:61], 0
    v_mov_b64 v[62:63], 0
    v_mov_b64 v[64:65], 0
    v_mov_b64 v[66:67], 0
    v_mov_b64 v[68:69], 0
    v_mov_b64 v[70:71], 0
    v_mov_b64 v[72:73], 0
    v_mov_b64 v[74:75], 0
    v_cndmask_b32 v36, 0, v7, s[52:53]
    v_cndmask_b32 v37, 0, v7, s[54:55]
    v_cndmask_b32 v38, 0, v7, s[56:57]
    v_cndmask_b32 v39, 0, v7, s[58:59]
    s_nop 13
    buffer_load_dwordx4 v[28:31], v4, s[4:7], s31 offen sc1
    buffer_load_dwordx4 v[32:35], v4, s[4:7], s31 offen offset:1024 sc1
    s_xor_b32 s19, s19, 262144
    s_mov_b32 m0, 137216
    s_add_u32 s26, s36, 4096
    s_branch CG3_waitA
CG3_pollA_retry:
    buffer_load_dwordx4 v[20:23], v4, s[4:7], s31 offen sc1
    buffer_load_dwordx4 v[24:27], v4, s[4:7], s31 offen offset:1024 sc1
    s_add_u32 s35, s35, 1
    s_waitcnt vmcnt(2)
    v_mfma_f32_16x16x32_bf16 v[40:43], v[36:39], v[28:31], 0
    v_max3_u32 v2, v28, v29, v30
    v_max3_u32 v3, v31, v32, v33
    v_mfma_f32_16x16x32_bf16 v[40:43], v[36:39], v[32:35], v[40:43]
    v_max3_u32 v2, v2, v34, v35
    v_max_u32 v2, v2, v3
    v_cmp_eq_u32 vcc, -1, v2
    s_cbranch_vccz CG3_goA
    buffer_load_dwordx4 v[28:31], v4, s[4:7], s31 offen sc1
    buffer_load_dwordx4 v[32:35], v4, s[4:7], s31 offen offset:1024 sc1
    s_cmp_gt_u32 s35, 262144
    s_cbranch_scc1 CG3_goA
CG3_waitA:
    s_waitcnt vmcnt(2)
    v_mfma_f32_16x16x32_bf16 v[40:43], v[36:39], v[20:23], 0
    v_max3_u32 v2, v20, v21, v22
    v_max3_u32 v3, v23, v24, v25
    v_mfma_f32_16x16x32_bf16 v[40:43], v[36:39], v[24:27], v[40:43]
    v_max3_u32 v2, v2, v26, v27
    v_max_u32 v2, v2, v3
    v_cmp_eq_u32 vcc, -1, v2
    s_nop 3
    s_cbranch_vccnz CG3_pollA_retry
CG3_goA_n:
    v_add_f32_dpp v40, v40, v40 row_ror:4 row_mask:0xf bank_mask:0xf
    v_add_f32_dpp v41, v41, v41 row_ror:4 row_mask:0xf bank_mask:0xf
    s_nop 0
    v_add_f32_dpp v40, v40, v40 row_ror:8 row_mask:0xf bank_mask:0xf
    v_add_f32_dpp v41, v41, v41 row_ror:8 row_mask:0xf bank_mask:0xf
    v_cvt_pk_bf16_f32 v40, v40, v41
    buffer_store_dword v40, v15, s[4:7], s20 offen sc1
    ds_read_b128 v[108:111], v11 offset:0
    ds_read_b128 v[112:115], v12 offset:0
    ds_read_b128 v[116:119], v11 offset:1024
    ds_read_b128 v[120:123], v12 offset:1024
    ds_read_b128 v[76:79], v11 offset:2048
    ds_read_b128 v[80:83], v12 offset:2048
    ds_read_b128 v[84:87], v11 offset:3072
    ds_read_b128 v[88:91], v12 offset:3072
    s_cmp_gt_u32 s38, 64
    s_cbranch_scc1 CG3_kvall
    v_cmp_ne_u32 vcc, 0, v14
    s_nop 0
    s_ff0_i32_b64 s38, vcc
    s_add_u32 s27, s18, 1
    s_cmp_ge_u32 s27, s38
    s_cselect_b64 s[50:51], -1, 0
    s_cmp_gt_u32 s38, 64
    s_cselect_b32 s34, 0x40000000, s34
    s_branch CG3_kvdone
CG3_kvall:
    s_mov_b64 s[50:51], 0
CG3_kvdone:
    ds_read_b128 v[92:95], v11 offset:4096
    ds_read_b128 v[96:99], v12 offset:4096
    ds_read_b128 v[100:103], v11 offset:5120
    ds_read_b128 v[104:107], v12 offset:5120
    s_waitcnt lgkmcnt(0)
    s_branch CG3_e0
CG3_goA:
    s_nop 3
    s_branch CG3_goA_n
CG3_done:
    s_add_u32 s22, s22, 4096
    buffer_store_dwordx4 v[60:63], v10, s[4:7], s22 offen sc1
    s_sub_u32 s22, s22, 4096
    s_cmp_lt_u32 s18, 63
    s_cbranch_scc1 CG3_resume
    s_branch CG_exit
CG2_entry:
    s_waitcnt lgkmcnt(0)
    ds_read_b128 v[108:111], v11 offset:0
    ds_read_b128 v[112:115], v12 offset:0
    ds_read_b128 v[116:119], v11 offset:1024
    ds_read_b128 v[120:123], v12 offset:1024
    ds_read_b128 v[76:79], v11 offset:2048
    ds_read_b128 v[80:83], v12 offset:2048
    ds_read_b128 v[84:87], v11 offset:3072
    ds_read_b128 v[88:91], v12 offset:3072
    ds_read_b128 v[92:95], v11 offset:4096
    ds_read_b128 v[96:99], v12 offset:4096
    ds_read_b128 v[100:103], v11 offset:5120
    ds_read_b128 v[104:107], v12 offset:5120
    v_mov_b64 v[52:53], 0
    v_mov_b64 v[54:55], 0
    v_mov_b64 v[56:57], 0
    v_mov_b64 v[58:59], 0
    v_mov_b64 v[60:61], 0
    v_mov_b64 v[62:63], 0
    v_mov_b64 v[64:65], 0
    v_mov_b64 v[66:67], 0
    v_mov_b64 v[68:69], 0
    v_mov_b64 v[70:71], 0
    v_mov_b64 v[72:73], 0
    v_mov_b64 v[74:75], 0
    s_cmp_le_u32 s38, 1
    s_cselect_b64 s[50:51], -1, 0
    s_lshl_b32 s34, s16, 8
    s_add_u32 s34, s34, 0
    s_waitcnt vmcnt(0) lgkmcnt(0)
    s_branch CG2_e0
CG2_side:
    v_cmp_eq_u32 vcc, -1, v2
    s_cbranch_vccz CG2_side2
CG2_lateB:
    s_mov_b32 m0, 137216
    s_nop 0
    buffer_load_dwordx4 v10, s[4:7], s26 offen sc1 lds
    s_add_u32 s23, s23, 1
    s_cmp_gt_u32 s23, 262144
    s_waitcnt vmcnt(1)
    s_cbranch_scc1 CG2_lateB_ok
    ds_read_b128 v[36:39], v1 offset:4096
    ds_read_b128 v[40:43], v1 offset:5120
    ds_read_b128 v[44:47], v1 offset:6144
    ds_read_b128 v[48:51], v1 offset:7168
    s_waitcnt lgkmcnt(0)
    v_max3_u32 v2, v36, v37, v38
    v_max3_u32 v2, v2, v39, v40
    v_max3_u32 v2, v2, v41, v42
    v_max3_u32 v2, v2, v43, v44
    v_max3_u32 v2, v2, v45, v46
    v_max3_u32 v2, v2, v47, v48
    v_max3_u32 v2, v2, v49, v50
    v_max_u32 v2, v2, v51
    v_cmp_eq_u32 vcc, -1, v2
    s_cbranch_vccnz CG2_lateB
CG2_lateB_ok:
    s_waitcnt vmcnt(0)
CG2_side2:
    s_branch CG2_late_done
CG2_e1:
    buffer_load_dwordx4 v[36:39], v4, s[4:7], s36 offen offset:0 sc1
    buffer_load_dwordx4 v[40:43], v4, s[4:7], s36 offen offset:1024 sc1
    buffer_load_dwordx4 v4, s[4:7], s36 offen offset:0 sc1 lds
    buffer_load_dwordx4 v4, s[4:7], s36 offen offset:1024 sc1 lds
    s_waitcnt vmcnt(6)
    v_max3_u32 v2, v44, v45, v46
    v_max3_u32 v3, v47, v48, v49
    v_max3_u32 v2, v2, v50, v51
    v_max_u32 v2, v2, v3
    v_cmp_eq_u32 vcc, -1, v2
    s_waitcnt vmcnt(4)
    s_cbranch_vccz CG2_go
    buffer_load_dwordx4 v[44:47], v4, s[4:7], s36 offen offset:0 sc1
    buffer_load_dwordx4 v[48:51], v4, s[4:7], s36 offen offset:1024 sc1
    buffer_load_dwordx4 v4, s[4:7], s36 offen offset:0 sc1 lds
    buffer_load_dwordx4 v4, s[4:7], s36 offen offset:1024 sc1 lds
    s_add_u32 s23, s23, 1
    s_cmp_gt_u32 s23, 262144
    s_cbranch_scc1 CG2_go
CG2_e0:
    s_waitcnt vmcnt(0)
    s_cmp_eq_u32 s50, 0
    s_cbranch_scc1 CG2_kvgo
CG2_l_kvw:
    v_lshrrev_b32 v2, 2, v1
    s_lshl_b32 s27, s16, 8
    v_subrev_u32 v2, 32768, v2
    s_add_u32 s27, s27, 0
    buffer_load_dword v14, v2, s[4:7], s27 offen sc1
    s_add_u32 s23, s23, 1
    s_waitcnt vmcnt(0)
CG2_l_kve:
    v_cmp_ne_u32 vcc, 0, v14
    s_nop 0
    s_ff0_i32_b64 s38, vcc
    s_cmp_gt_u32 s23, 262144
    s_cbranch_scc1 CG2_l_kvw_done
    s_add_u32 s27, s18, 1
    s_cmp_ge_u32 s27, s38
    s_cbranch_scc1 CG2_l_kvw
CG2_l_kvw_done:
CG2_kvgo:
    s_cmp_eq_u32 s18, 0
    s_cbranch_scc0 CG2_go
    s_barrier
    s_branch CG2_b1
CG2_go:
    s_mov_b32 m0, 137216
    s_barrier
    buffer_load_dwordx4 v10, s[4:7], s26 offen sc1 lds
CG2_b1:
    ds_read_b128 v[20:23], v1 offset:0
    ds_read_b128 v[24:27], v1 offset:1024
    ds_read_b128 v[28:31], v1 offset:2048
    ds_read_b128 v[32:35], v1 offset:3072
    s_waitcnt lgkmcnt(3)
    v_smfmac_f32_16x16x64_bf16 v[52:55], v[20:23], v[108:115], v0
    s_add_u32 m0, s29, -4096
    s_add_u32 s27, s21, 0
    v_smfmac_f32_16x16x64_bf16 v[56:59], v[20:23], v[116:123], v0
    buffer_load_dwordx4 v1, s[4:7], s27 offen offset:0 sc1 lds
    v_smfmac_f32_16x16x64_bf16 v[60:63], v[20:23], v[76:83], v0
    s_waitcnt lgkmcnt(0)
    v_smfmac_f32_16x16x64_bf16 v[64:67], v[20:23], v[84:91], v0
    buffer_load_dwordx4 v1, s[4:7], s27 offen offset:1024 sc1 lds
    v_mov_b64 v[120:121], -1
    v_smfmac_f32_16x16x64_bf16 v[52:55], v[24:27], v[92:99], v0
    v_mov_b64 v[122:123], -1
    v_smfmac_f32_16x16x64_bf16 v[56:59], v[24:27], v[100:107], v0
    ds_read_b128 v[108:111], v4 offset:8192
    buffer_load_dwordx4 v1, s[4:7], s27 offen offset:2048 sc1 lds
    v_smfmac_f32_16x16x64_bf16 v[60:63], v[24:27], a[96:103], v0
    ds_read_b128 v[112:115], v4 offset:9216
    v_smfmac_f32_16x16x64_bf16 v[64:67], v[24:27], a[152:159], v0
    ds_read_b128 v[76:79], v6 offset:0
    buffer_load_dwordx4 v1, s[4:7], s27 offen offset:3072 sc1 lds
    v_smfmac_f32_16x16x64_bf16 v[52:55], v[28:31], a[0:7], v0
    ds_read_b128 v[80:83], v6 offset:1024
    v_smfmac_f32_16x16x64_bf16 v[56:59], v[28:31], a[48:55], v0
    s_mov_b32 m0, 139264
    s_add_u32 s27, s21, 8192
    s_waitcnt vmcnt(4) lgkmcnt(2)
    s_barrier
    v_smfmac_f32_16x16x64_bf16 v[60:63], v[28:31], a[104:111], v0
    ds_read_b128 v[36:39], v1 offset:4096
    buffer_load_dwordx4 v1, s[4:7], s27 offen offset:0 sc1 lds
    v_smfmac_f32_16x16x64_bf16 v[64:67], v[28:31], a[160:167], v0
    ds_read_b128 v[40:43], v1 offset:5120
    v_smfmac_f32_16x16x64_bf16 v[52:55], v[32:35], a[8:15], v0
    ds_read_b128 v[44:47], v1 offset:6144
    buffer_load_dwordx4 v1, s[4:7], s27 offen offset:1024 sc1 lds
    v_smfmac_f32_16x16x64_bf16 v[56:59], v[32:35], a[56:63], v0
    ds_read_b128 v[48:51], v1 offset:7168
    v_smfmac_f32_16x16x64_bf16 v[60:63], v[32:35], a[112:119], v0
    s_waitcnt lgkmcnt(2)
    buffer_load_dwordx4 v1, s[4:7], s27 offen offset:2048 sc1 lds
    v_max3_u32 v2, v36, v37, v38
    v_smfmac_f32_16x16x64_bf16 v[64:67], v[32:35], a[168:175], v0
    v_max3_u32 v2, v2, v39, v40
    v_smfmac_f32_16x16x64_bf16 v[68:71], v[20:23], a[208:215], v0
    buffer_load_dwordx4 v1, s[4:7], s27 offen offset:3072 sc1 lds
    v_max3_u32 v2, v2, v41, v42
    v_smfmac_f32_16x16x64_bf16 v[72:75], v[20:23], v[144:151], v0
    s_waitcnt lgkmcnt(0)
    v_max3_u32 v2, v2, v43, v44
    v_smfmac_f32_16x16x64_bf16 v[68:71], v[24:27], a[216:223], v0
    ds_read_b128 v[84:87], v6 offset:2048
    v_max3_u32 v2, v2, v45, v46
    v_smfmac_f32_16x16x64_bf16 v[72:75], v[24:27], v[152:159], v0
    ds_read_b128 v[88:91], v6 offset:3072
    v_max3_u32 v2, v2, v47, v48
    v_smfmac_f32_16x16x64_bf16 v[68:71], v[28:31], a[224:231], v0
    ds_read_b128 v[92:95], v6 offset:4096
    v_max3_u32 v2, v2, v49, v50
    v_smfmac_f32_16x16x64_bf16 v[72:75], v[28:31], v[160:167], v0
    ds_read_b128 v[96:99], v6 offset:5120
    v_max_u32 v2, v2, v51
    v_smfmac_f32_16x16x64_bf16 v[68:71], v[32:35], a[232:239], v0
    ds_read_b128 v[100:103], v6 offset:6144
    v_cmp_eq_u32 vcc, -1, v2
    v_smfmac_f32_16x16x64_bf16 v[72:75], v[32:35], v[168:175], v0
    s_cbranch_vccnz CG2_side
CG2_late_done:
    v_smfmac_f32_16x16x64_bf16 v[52:55], v[36:39], a[16:23], v0
    buffer_store_dwordx4 v[120:123], v4, s[4:7], s31 offen sc1
    v_lshrrev_b32 v2, 2, v1
    v_smfmac_f32_16x16x64_bf16 v[52:55], v[40:43], a[24:31], v0
    ds_read_b128 v[104:107], v6 offset:7168
    v_subrev_u32 v2, 32768, v2
    v_smfmac_f32_16x16x64_bf16 v[52:55], v[44:47], a[32:39], v0
    buffer_store_dwordx4 v[120:123], v4, s[4:7], s31 offen offset:1024 sc1
    v_smfmac_f32_16x16x64_bf16 v[52:55], v[48:51], a[40:47], v0
    v_smfmac_f32_16x16x64_bf16 v[56:59], v[36:39], a[64:71], v0
    buffer_store_dwordx4 v[124:127], v10, s[4:7], s22 offen sc1
    v_smfmac_f32_16x16x64_bf16 v[56:59], v[40:43], a[72:79], v0
    s_nop 2
    v_smfmac_f32_16x16x64_bf16 v[56:59], v[44:47], a[80:87], v0
    s_nop 0
    v_add_f32 v52, v52, v54
    v_smfmac_f32_16x16x64_bf16 v[56:59], v[48:51], a[88:95], v0
    v_add_f32 v53, v53, v55
    v_smfmac_f32_16x16x64_bf16 v[60:63], v[36:39], a[120:127], v0
    s_nop 0
    v_cvt_pk_bf16_f32 v52, v52, v53
    v_smfmac_f32_16x16x64_bf16 v[60:63], v[40:43], a[128:135], v0
    s_nop 2
    v_smfmac_f32_16x16x64_bf16 v[60:63], v[44:47], a[136:143], v0
    v_add_f32 v56, v56, v58
    v_smfmac_f32_16x16x64_bf16 v[60:63], v[48:51], a[144:151], v0
    buffer_store_dword v120, v15, s[4:7], s32 offen sc1
    v_add_f32 v57, v57, v59
    v_smfmac_f32_16x16x64_bf16 v[64:67], v[36:39], a[176:183], v0
    s_nop 0
    v_cvt_pk_bf16_f32 v53, v56, v57
    v_smfmac_f32_16x16x64_bf16 v[64:67], v[40:43], a[184:191], v0
    ds_write2_b32 v8, v52, v53 offset0:0 offset1:128
    v_smfmac_f32_16x16x64_bf16 v[64:67], v[44:47], a[192:199], v0
    buffer_load_dword v14, v2, s[4:7], s34 offen sc1
    v_add_f32 v60, v60, v62
    v_smfmac_f32_16x16x64_bf16 v[64:67], v[48:51], a[200:207], v0
    v_add_f32 v61, v61, v63
    v_smfmac_f32_16x16x64_bf16 v[68:71], v[36:39], a[240:247], v0
    s_xor_b32 s29, s29, 8192
    s_add_u32 s21, s21, 524288
    s_cmp_ge_u32 s18, 61
    v_cvt_pk_bf16_f32 v60, v60, v61
    v_smfmac_f32_16x16x64_bf16 v[72:75], v[36:39], v[176:183], v0
    s_nop 2
    v_smfmac_f32_16x16x64_bf16 v[68:71], v[40:43], a[248:255], v0
    s_waitcnt lgkmcnt(0)
    s_barrier
    v_add_f32 v64, v64, v66
    v_smfmac_f32_16x16x64_bf16 v[72:75], v[40:43], v[184:191], v0
    ds_read_b64_tr_b16 v[20:21], v9 offset:0
    ds_read_b64_tr_b16 v[22:23], v9 offset:512
    v_add_f32 v65, v65, v67
    v_smfmac_f32_16x16x64_bf16 v[68:71], v[44:47], v[128:135], v0
    ds_read_b64_tr_b16 v[24:25], v9 offset:1024
    ds_read_b64_tr_b16 v[26:27], v9 offset:1536
    v_cvt_pk_bf16_f32 v61, v64, v65
    v_smfmac_f32_16x16x64_bf16 v[72:75], v[44:47], v[192:199], v0
    ds_write2_b32 v8, v60, v61 offset0:1 offset1:129
    ds_read_b64_tr_b16 v[28:29], v9 offset:2048
    ds_read_b64_tr_b16 v[30:31], v9 offset:2560
    v_smfmac_f32_16x16x64_bf16 v[68:71], v[48:51], v[136:143], v0
    ds_read_b64_tr_b16 v[32:33], v9 offset:3072
    ds_read_b64_tr_b16 v[34:35], v9 offset:3584
    v_smfmac_f32_16x16x64_bf16 v[72:75], v[48:51], v[200:207], v0
    s_waitcnt lgkmcnt(7)
    v_mfma_f32_16x16x32_bf16 v[124:127], v[92:95], v[20:23], 0
    ds_read_b128 v[44:47], v11 offset:6144
    s_waitcnt lgkmcnt(6)
    v_mfma_f32_16x16x32_bf16 v[124:127], v[96:99], v[24:27], v[124:127]
    ds_read_b128 v[48:51], v12 offset:6144
    s_waitcnt lgkmcnt(4)
    v_mfma_f32_16x16x32_bf16 v[124:127], v[100:103], v[28:31], v[124:127]
    s_waitcnt lgkmcnt(2)
    s_waitcnt lgkmcnt(6)
    s_barrier
    v_mfma_f32_16x16x32_bf16 v[124:127], v[104:107], v[32:35], v[124:127]
    ds_read_b64_tr_b16 v[52:53], v9 offset:0
    ds_read_b64_tr_b16 v[54:55], v9 offset:512
    v_add_f32 v68, v68, v70
    v_mfma_f32_16x16x32_bf16 v[120:123], v[76:79], v[20:23], 0
    ds_read_b64_tr_b16 v[56:57], v9 offset:1024
    ds_read_b64_tr_b16 v[58:59], v9 offset:1536
    v_add_f32 v69, v69, v71
    v_mfma_f32_16x16x32_bf16 v[120:123], v[80:83], v[24:27], v[120:123]
    ds_read_b64_tr_b16 v[36:37], v9 offset:2048
    ds_read_b64_tr_b16 v[38:39], v9 offset:2560
    v_add_f32 v72, v72, v74
    v_mfma_f32_16x16x32_bf16 v[120:123], v[84:87], v[28:31], v[120:123]
    ds_read_b64_tr_b16 v[40:41], v9 offset:3072
    ds_read_b64_tr_b16 v[42:43], v9 offset:3584
    v_add_f32 v73, v73, v75
    v_mfma_f32_16x16x32_bf16 v[120:123], v[88:91], v[32:35], v[120:123]
    ds_read_b128 v[92:95], v11 offset:7168
    s_waitcnt lgkmcnt(7)
    v_cvt_pk_bf16_f32 v62, v68, v69
    v_mfma_f32_16x16x32_bf16 v[116:119], v[52:55], v[20:23], 0
    ds_read_b128 v[96:99], v12 offset:7168
    s_waitcnt lgkmcnt(6)
    v_cvt_pk_bf16_f32 v63, v72, v73
    v_mfma_f32_16x16x32_bf16 v[116:119], v[56:59], v[24:27], v[116:119]
    ds_read_b128 v[100:103], v11 offset:8192
    s_waitcnt lgkmcnt(5)
    v_mfma_f32_16x16x32_bf16 v[116:119], v[36:39], v[28:31], v[116:119]
    ds_read_b128 v[104:107], v12 offset:8192
    s_waitcnt lgkmcnt(4)
    v_max3_f32 v64, v124, v125, v126
    v_mfma_f32_16x16x32_bf16 v[116:119], v[40:43], v[32:35], v[116:119]
    ds_read_b128 v[76:79], v11 offset:9216
    v_max3_f32 v64, v64, v127, v120
    s_cbranch_scc1 CG2_done
CG2_resume:
    ds_read_b128 v[80:83], v12 offset:9216
    v_max3_f32 v64, v64, v121, v122
    v_max_f32 v64, v64, v123
    v_mov_b32 v66, s28
    v_xor_b32 v6, 8192, v6
    v_max3_f32 v65, v64, v118, v119
    v_max3_f32 v64, v64, v118, v119
    v_mov_b32 v68, 0x3f803f80
    v_mov_b32 v69, 0x3f803f80
    v_permlane32_swap_b32 v64, v65
    v_max_f32 v64, v64, v65
    v_mov_b32 v65, v64
    v_mov_b64 v[70:71], v[68:69]
    v_mov_b64 v[72:73], 0
    v_permlane16_swap_b32 v64, v65
    v_max_f32 v64, v64, v65
    v_mul_f32 v64, s28, v64
    v_pk_fma_f32 v[118:119], v[118:119], v[66:67], v[64:65] op_sel_hi:[1,0,0] neg_lo:[0,0,1] neg_hi:[0,0,1]
    v_pk_fma_f32 v[120:121], v[120:121], v[66:67], v[64:65] op_sel_hi:[1,0,0] neg_lo:[0,0,1] neg_hi:[0,0,1]
    v_pk_fma_f32 v[122:123], v[122:123], v[66:67], v[64:65] op_sel_hi:[1,0,0] neg_lo:[0,0,1] neg_hi:[0,0,1]
    v_pk_fma_f32 v[124:125], v[124:125], v[66:67], v[64:65] op_sel_hi:[1,0,0] neg_lo:[0,0,1] neg_hi:[0,0,1]
    v_pk_fma_f32 v[126:127], v[126:127], v[66:67], v[64:65] op_sel_hi:[1,0,0] neg_lo:[0,0,1] neg_hi:[0,0,1]
    v_exp_f32 v118, v118
    v_exp_f32 v119, v119
    v_exp_f32 v120, v120
    v_cvt_pk_bf16_f32 v16, v118, v119
    v_cvt_pk_bf16_f32 v19, v118, v119
    v_exp_f32 v121, v121
    v_mfma_f32_16x16x16_bf16 v[52:55], v[62:63], v[16:17], 0
    ds_read_b128 v[84:87], v11 offset:10240
    v_exp_f32 v122, v122
    v_exp_f32 v123, v123
    v_mfma_f32_16x16x16_bf16 v[56:59], v[62:63], v[18:19], 0
    ds_read_b128 v[88:91], v12 offset:10240
    v_exp_f32 v124, v124
    v_exp_f32 v125, v125
    v_mfma_f32_16x16x16_bf16 v[64:67], v[68:69], v[16:17], 0
    ds_read_b128 v[20:23], v11 offset:11264
    v_exp_f32 v126, v126
    v_exp_f32 v127, v127
    v_cvt_pk_bf16_f32 v120, v120, v121
    v_cvt_pk_bf16_f32 v121, v122, v123
    v_cvt_pk_bf16_f32 v122, v124, v125
    v_cvt_pk_bf16_f32 v123, v126, v127
    v_mov_b64 v[124:125], v[60:61]
    v_mov_b64 v[126:127], v[62:63]
    v_mfma_f32_16x16x32_bf16 v[64:67], v[68:71], v[120:123], v[64:67]
    ds_read_b128 v[24:27], v12 offset:11264
    v_mov_b64 v[60:61], 0
    v_mfma_f32_16x16x32_bf16 v[52:55], v[108:111], v[120:123], v[52:55]
    ds_read_b128 v[28:31], v11 offset:12288
    v_mov_b64 v[62:63], 0
    v_mfma_f32_16x16x32_bf16 v[56:59], v[112:115], v[120:123], v[56:59]
    ds_read_b128 v[32:35], v12 offset:12288
    v_mov_b64 v[68:69], 0
    v_mov_b64 v[70:71], 0
    v_mov_b64 v[74:75], 0
    v_rcp_f32 v64, v64
    s_nop 0
    v_pk_mul_f32 v[52:53], v[52:53], v[64:65] op_sel_hi:[1,0]
    v_pk_mul_f32 v[54:55], v[54:55], v[64:65] op_sel_hi:[1,0]
    v_pk_mul_f32 v[56:57], v[56:57], v[64:65] op_sel_hi:[1,0]
    v_pk_mul_f32 v[58:59], v[58:59], v[64:65] op_sel_hi:[1,0]
    v_cvt_pk_bf16_f32 v52, v52, v53
    v_cvt_pk_bf16_f32 v53, v54, v55
    v_cvt_pk_bf16_f32 v54, v56, v57
    v_cvt_pk_bf16_f32 v55, v58, v59
    ds_write_b128 v10, v[52:55] offset:4096
    v_mov_b32_dpp v52, v52 quad_perm:[0,1,0,1] row_mask:0xf bank_mask:0xf
    v_mov_b32_dpp v53, v53 quad_perm:[0,1,0,1] row_mask:0xf bank_mask:0xf
    v_mov_b32_dpp v54, v54 quad_perm:[0,1,0,1] row_mask:0xf bank_mask:0xf
    v_mov_b32_dpp v55, v55 quad_perm:[0,1,0,1] row_mask:0xf bank_mask:0xf
    v_mov_b64 v[64:65], 0
    v_mov_b64 v[66:67], 0
    v_smfmac_f32_16x16x64_bf16 v[68:71], v[52:55], v[208:215], v0
    ds_read_b128 v[36:39], v11 offset:13312
    s_add_u32 s25, s19, 4096
    v_smfmac_f32_16x16x64_bf16 v[72:75], v[52:55], v[232:239], v0
    ds_read_b128 v[40:43], v12 offset:13312
    s_mov_b32 s32, s20
    s_add_u32 s20, s20, 8192
    s_waitcnt lgkmcnt(2)
    s_barrier
    ds_read_b128 v[56:59], v5 offset:7168
    ds_read_b128 v[112:115], v5 offset:5120
    ds_read_b128 v[108:111], v5 offset:4096
    v_smfmac_f32_16x16x64_bf16 v[60:63], v[52:55], v[240:247], v0
    v_smfmac_f32_16x16x64_bf16 v[64:67], v[52:55], v[248:255], v0
    s_waitcnt lgkmcnt(2)
    v_smfmac_f32_16x16x64_bf16 v[68:71], v[56:59], v[216:223], v0
    s_waitcnt lgkmcnt(1)
    ds_read_b128 v[116:119], v11 offset:14336
    v_smfmac_f32_16x16x64_bf16 v[68:71], v[112:115], v[224:231], v0
    s_waitcnt lgkmcnt(1)
    ds_read_b128 v[120:123], v12 offset:14336
    v_smfmac_f32_16x16x64_bf16 v[68:71], v[108:111], v[44:51], v0
    s_and_b32 s20, s20, 0xffff7fff
    s_sub_u32 s36, s20, 131072
    s_add_u32 s31, s33, s19
    v_smfmac_f32_16x16x64_bf16 v[72:75], v[56:59], v[92:99], v0
    s_add_u32 s22, s22, 4096
    s_add_u32 s18, s18, 1
    s_nop 1
    v_cvt_pk_bf16_f32 v68, v68, v70
    v_cvt_pk_bf16_f32 v69, v69, v71
    v_smfmac_f32_16x16x64_bf16 v[72:75], v[112:115], v[100:107], v0
    buffer_store_dwordx2 v[68:69], v13, s[4:7], s19 offen offset:0 sc1
    v_smfmac_f32_16x16x64_bf16 v[72:75], v[108:111], v[76:83], v0
    ds_read_b128 v[44:47], v11 offset:15360
    s_nop 0
    v_smfmac_f32_16x16x64_bf16 v[60:63], v[56:59], v[84:91], v0
    ds_read_b128 v[48:51], v12 offset:15360
    s_nop 0
    v_smfmac_f32_16x16x64_bf16 v[60:63], v[112:115], v[20:27], v0
    s_nop 1
    v_cvt_pk_bf16_f32 v72, v72, v74
    v_cvt_pk_bf16_f32 v73, v73, v75
    v_smfmac_f32_16x16x64_bf16 v[60:63], v[108:111], v[28:35], v0
    buffer_store_dwordx2 v[72:73], v13, s[4:7], s19 offen offset:2048 sc1
    v_smfmac_f32_16x16x64_bf16 v[64:67], v[56:59], v[36:43], v0
    s_waitcnt lgkmcnt(0)
    s_nop 1
    v_smfmac_f32_16x16x64_bf16 v[64:67], v[112:115], v[116:123], v0
    s_nop 0
    s_nop 0
    v_cvt_pk_bf16_f32 v60, v60, v62
    v_cvt_pk_bf16_f32 v61, v61, v63
    v_smfmac_f32_16x16x64_bf16 v[64:67], v[108:111], v[44:51], v0
    buffer_store_dwordx2 v[60:61], v13, s[4:7], s25 offen offset:0 sc1
    s_nop 6
    v_cvt_pk_bf16_f32 v64, v64, v66
    v_cvt_pk_bf16_f32 v65, v65, v67
    buffer_store_dwordx2 v[64:65], v13, s[4:7], s25 offen offset:2048 sc1
    s_barrier
    s_nop 15
    s_nop 15
    s_nop 15
    s_nop 1
    buffer_load_dwordx4 v[20:23], v4, s[4:7], s31 offen sc1
    buffer_load_dwordx4 v[24:27], v4, s[4:7], s31 offen offset:1024 sc1
    v_mov_b64 v[52:53], 0
    v_mov_b64 v[54:55], 0
    v_mov_b64 v[56:57], 0
    v_mov_b64 v[58:59], 0
    v_mov_b64 v[60:61], 0
    v_mov_b64 v[62:63], 0
    v_mov_b64 v[64:65], 0
    v_mov_b64 v[66:67], 0
    v_mov_b64 v[68:69], 0
    v_mov_b64 v[70:71], 0
    v_mov_b64 v[72:73], 0
    v_mov_b64 v[74:75], 0
    v_cndmask_b32 v36, 0, v7, s[52:53]
    v_cndmask_b32 v37, 0, v7, s[54:55]
    v_cndmask_b32 v38, 0, v7, s[56:57]
    v_cndmask_b32 v39, 0, v7, s[58:59]
    s_nop 13
    buffer_load_dwordx4 v[28:31], v4, s[4:7], s31 offen sc1
    buffer_load_dwordx4 v[32:35], v4, s[4:7], s31 offen offset:1024 sc1
    s_xor_b32 s19, s19, 262144
    s_mov_b32 m0, 135168
    s_add_u32 s26, s36, 4096
    s_branch CG2_waitA
CG2_pollA_retry:
    buffer_load_dwordx4 v[20:23], v4, s[4:7], s31 offen sc1
    buffer_load_dwordx4 v[24:27], v4, s[4:7], s31 offen offset:1024 sc1
    s_add_u32 s35, s35, 1
    s_waitcnt vmcnt(2)
    v_mfma_f32_16x16x32_bf16 v[40:43], v[36:39], v[28:31], 0
    v_max3_u32 v2, v28, v29, v30
    v_max3_u32 v3, v31, v32, v33
    v_mfma_f32_16x16x32_bf16 v[40:43], v[36:39], v[32:35], v[40:43]
    v_max3_u32 v2, v2, v34, v35
    v_max_u32 v2, v2, v3
    v_cmp_eq_u32 vcc, -1, v2
    s_cbranch_vccz CG2_goA
    buffer_load_dwordx4 v[28:31], v4, s[4:7], s31 offen sc1
    buffer_load_dwordx4 v[32:35], v4, s[4:7], s31 offen offset:1024 sc1
    s_cmp_gt_u32 s35, 262144
    s_cbranch_scc1 CG2_goA
CG2_waitA:
    s_waitcnt vmcnt(2)
    v_mfma_f32_16x16x32_bf16 v[40:43], v[36:39], v[20:23], 0
    v_max3_u32 v2, v20, v21, v22
    v_max3_u32 v3, v23, v24, v25
    v_mfma_f32_16x16x32_bf16 v[40:43], v[36:39], v[24:27], v[40:43]
    v_max3_u32 v2, v2, v26, v27
    v_max_u32 v2, v2, v3
    v_cmp_eq_u32 vcc, -1, v2
    s_nop 3
    s_cbranch_vccnz CG2_pollA_retry
CG2_goA_n:
    v_add_f32_dpp v40, v40, v40 row_ror:4 row_mask:0xf bank_mask:0xf
    v_add_f32_dpp v41, v41, v41 row_ror:4 row_mask:0xf bank_mask:0xf
    s_nop 0
    v_add_f32_dpp v40, v40, v40 row_ror:8 row_mask:0xf bank_mask:0xf
    v_add_f32_dpp v41, v41, v41 row_ror:8 row_mask:0xf bank_mask:0xf
    v_cvt_pk_bf16_f32 v40, v40, v41
    buffer_store_dword v40, v15, s[4:7], s20 offen sc1
    ds_read_b128 v[108:111], v11 offset:0
    ds_read_b128 v[112:115], v12 offset:0
    ds_read_b128 v[116:119], v11 offset:1024
    ds_read_b128 v[120:123], v12 offset:1024
    ds_read_b128 v[76:79], v11 offset:2048
    ds_read_b128 v[80:83], v12 offset:2048
    ds_read_b128 v[84:87], v11 offset:3072
    ds_read_b128 v[88:91], v12 offset:3072
    s_cmp_gt_u32 s38, 64
    s_cbranch_scc1 CG2_kvall
    v_cmp_ne_u32 vcc, 0, v14
    s_nop 0
    s_ff0_i32_b64 s38, vcc
    s_add_u32 s27, s18, 1
    s_cmp_ge_u32 s27, s38
    s_cselect_b64 s[50:51], -1, 0
    s_cmp_gt_u32 s38, 64
    s_cselect_b32 s34, 0x40000000, s34
    s_branch CG2_kvdone
CG2_kvall:
    s_mov_b64 s[50:51], 0
CG2_kvdone:
    ds_read_b128 v[92:95], v11 offset:4096
    ds_read_b128 v[96:99], v12 offset:4096
    ds_read_b128 v[100:103], v11 offset:5120
    ds_read_b128 v[104:107], v12 offset:5120
    s_waitcnt lgkmcnt(0)
    s_branch CG2_e0
CG2_goA:
    s_nop 3
    s_branch CG2_goA_n
CG2_done:
    s_add_u32 s22, s22, 4096
    buffer_store_dwordx4 v[60:63], v10, s[4:7], s22 offen sc1
    s_sub_u32 s22, s22, 4096
    s_cmp_lt_u32 s18, 63
    s_cbranch_scc1 CG2_resume
    s_branch CG_exit
CG1_entry:
    s_waitcnt lgkmcnt(0)
    ds_read_b128 v[108:111], v11 offset:0
    ds_read_b128 v[112:115], v12 offset:0
    ds_read_b128 v[116:119], v11 offset:1024
    ds_read_b128 v[120:123], v12 offset:1024
    ds_read_b128 v[76:79], v11 offset:2048
    ds_read_b128 v[80:83], v12 offset:2048
    ds_read_b128 v[84:87], v11 offset:3072
    ds_read_b128 v[88:91], v12 offset:3072
    ds_read_b128 v[92:95], v11 offset:4096
    ds_read_b128 v[96:99], v12 offset:4096
    ds_read_b128 v[100:103], v11 offset:5120
    ds_read_b128 v[104:107], v12 offset:5120
    v_mov_b64 v[52:53], 0
    v_mov_b64 v[54:55], 0
    v_mov_b64 v[56:57], 0
    v_mov_b64 v[58:59], 0
    v_mov_b64 v[60:61], 0
    v_mov_b64 v[62:63], 0
    v_mov_b64 v[64:65], 0
    v_mov_b64 v[66:67], 0
    v_mov_b64 v[68:69], 0
    v_mov_b64 v[70:71], 0
    v_mov_b64 v[72:73], 0
    v_mov_b64 v[74:75], 0
    s_cmp_le_u32 s38, 1
    s_cselect_b64 s[50:51], -1, 0
    s_lshl_b32 s34, s16, 8
    s_add_u32 s34, s34, 0
    s_waitcnt vmcnt(0) lgkmcnt(0)
    s_barrier
    s_branch CG1_b1
CG1_side:
    v_cmp_eq_u32 vcc, -1, v2
    s_cbranch_vccz CG1_side2
CG1_lateB:
    s_mov_b32 m0, 136192
    s_nop 0
    buffer_load_dwordx4 v10, s[4:7], s26 offen sc1 lds
    s_add_u32 s23, s23, 1
    s_cmp_gt_u32 s23, 262144
    s_waitcnt vmcnt(1)
    s_cbranch_scc1 CG1_lateB_ok
    ds_read_b128 v[36:39], v1 offset:4096
    ds_read_b128 v[40:43], v1 offset:5120
    ds_read_b128 v[44:47], v1 offset:6144
    ds_read_b128 v[48:51], v1 offset:7168
    s_waitcnt lgkmcnt(0)
    v_max3_u32 v2, v36, v37, v38
    v_max3_u32 v2, v2, v39, v40
    v_max3_u32 v2, v2, v41, v42
    v_max3_u32 v2, v2, v43, v44
    v_max3_u32 v2, v2, v45, v46
    v_max3_u32 v2, v2, v47, v48
    v_max3_u32 v2, v2, v49, v50
    v_max_u32 v2, v2, v51
    v_cmp_eq_u32 vcc, -1, v2
    s_cbranch_vccnz CG1_lateB
CG1_lateB_ok:
    s_waitcnt vmcnt(0)
CG1_side2:
    s_branch CG1_late_done
CG1_e1:
    buffer_load_dwordx4 v[36:39], v4, s[4:7], s36 offen offset:0 sc1
    buffer_load_dwordx4 v[40:43], v4, s[4:7], s36 offen offset:1024 sc1
    buffer_load_dwordx4 v4, s[4:7], s36 offen offset:0 sc1 lds
    buffer_load_dwordx4 v4, s[4:7], s36 offen offset:1024 sc1 lds
    s_waitcnt vmcnt(6)
    v_max3_u32 v2, v44, v45, v46
    v_max3_u32 v3, v47, v48, v49
    v_max3_u32 v2, v2, v50, v51
    v_max_u32 v2, v2, v3
    v_cmp_eq_u32 vcc, -1, v2
    s_waitcnt vmcnt(4)
    s_cbranch_vccz CG1_go
    buffer_load_dwordx4 v[44:47], v4, s[4:7], s36 offen offset:0 sc1
    buffer_load_dwordx4 v[48:51], v4, s[4:7], s36 offen offset:1024 sc1
    buffer_load_dwordx4 v4, s[4:7], s36 offen offset:0 sc1 lds
    buffer_load_dwordx4 v4, s[4:7], s36 offen offset:1024 sc1 lds
    s_add_u32 s23, s23, 1
    s_cmp_gt_u32 s23, 262144
    s_cbranch_scc1 CG1_go
CG1_e0:
    s_waitcnt vmcnt(6)
    v_max3_u32 v2, v36, v37, v38
    v_max3_u32 v3, v39, v40, v41
    v_max3_u32 v2, v2, v42, v43
    v_max_u32 v2, v2, v3
    v_cmp_eq_u32 vcc, -1, v2
    s_waitcnt vmcnt(4)
    s_cbranch_vccnz CG1_e1
CG1_go:
    s_mov_b32 m0, 136192
    s_barrier
    buffer_load_dwordx4 v10, s[4:7], s26 offen sc1 lds
CG1_b1:
    ds_read_b128 v[20:23], v1 offset:0
    ds_read_b128 v[24:27], v1 offset:1024
    ds_read_b128 v[28:31], v1 offset:2048
    ds_read_b128 v[32:35], v1 offset:3072
    s_waitcnt lgkmcnt(3)
    v_smfmac_f32_16x16x64_bf16 v[52:55], v[20:23], v[108:115], v0
    v_smfmac_f32_16x16x64_bf16 v[56:59], v[20:23], v[116:123], v0
    v_smfmac_f32_16x16x64_bf16 v[60:63], v[20:23], v[76:83], v0
    s_waitcnt lgkmcnt(0)
    v_smfmac_f32_16x16x64_bf16 v[64:67], v[20:23], v[84:91], v0
    v_mov_b64 v[120:121], -1
    v_smfmac_f32_16x16x64_bf16 v[52:55], v[24:27], v[92:99], v0
    v_mov_b64 v[122:123], -1
    v_smfmac_f32_16x16x64_bf16 v[56:59], v[24:27], v[100:107], v0
    ds_read_b128 v[108:111], v4 offset:8192
    v_smfmac_f32_16x16x64_bf16 v[60:63], v[24:27], a[96:103], v0
    ds_read_b128 v[112:115], v4 offset:9216
    v_smfmac_f32_16x16x64_bf16 v[64:67], v[24:27], a[152:159], v0
    ds_read_b128 v[76:79], v6 offset:0
    v_smfmac_f32_16x16x64_bf16 v[52:55], v[28:31], a[0:7], v0
    ds_read_b128 v[80:83], v6 offset:1024
    v_smfmac_f32_16x16x64_bf16 v[56:59], v[28:31], a[48:55], v0
    s_waitcnt vmcnt(0) lgkmcnt(2)
    s_barrier
    v_smfmac_f32_16x16x64_bf16 v[60:63], v[28:31], a[104:111], v0
    ds_read_b128 v[36:39], v1 offset:4096
    v_smfmac_f32_16x16x64_bf16 v[64:67], v[28:31], a[160:167], v0
    ds_read_b128 v[40:43], v1 offset:5120
    v_smfmac_f32_16x16x64_bf16 v[52:55], v[32:35], a[8:15], v0
    ds_read_b128 v[44:47], v1 offset:6144
    v_smfmac_f32_16x16x64_bf16 v[56:59], v[32:35], a[56:63], v0
    ds_read_b128 v[48:51], v1 offset:7168
    v_smfmac_f32_16x16x64_bf16 v[60:63], v[32:35], a[112:119], v0
    s_waitcnt lgkmcnt(2)
    v_max3_u32 v2, v36, v37, v38
    v_smfmac_f32_16x16x64_bf16 v[64:67], v[32:35], a[168:175], v0
    v_max3_u32 v2, v2, v39, v40
    v_smfmac_f32_16x16x64_bf16 v[68:71], v[20:23], a[208:215], v0
    v_max3_u32 v2, v2, v41, v42
    v_smfmac_f32_16x16x64_bf16 v[72:75], v[20:23], v[144:151], v0
    s_waitcnt lgkmcnt(0)
    v_max3_u32 v2, v2, v43, v44
    v_smfmac_f32_16x16x64_bf16 v[68:71], v[24:27], a[216:223], v0
    ds_read_b128 v[84:87], v6 offset:2048
    v_max3_u32 v2, v2, v45, v46
    v_smfmac_f32_16x16x64_bf16 v[72:75], v[24:27], v[152:159], v0
    ds_read_b128 v[88:91], v6 offset:3072
    buffer_store_dwordx4 v[120:123], v4, s[4:7], s31 offen sc1
    v_max3_u32 v2, v2, v47, v48
    v_smfmac_f32_16x16x64_bf16 v[68:71], v[28:31], a[224:231], v0
    ds_read_b128 v[92:95], v6 offset:4096
    v_max3_u32 v2, v2, v49, v50
    v_smfmac_f32_16x16x64_bf16 v[72:75], v[28:31], v[160:167], v0
    ds_read_b128 v[96:99], v6 offset:5120
    buffer_store_dwordx4 v[120:123], v4, s[4:7], s31 offen offset:1024 sc1
    v_max_u32 v2, v2, v51
    v_smfmac_f32_16x16x64_bf16 v[68:71], v[32:35], a[232:239], v0
    ds_read_b128 v[100:103], v6 offset:6144
    v_cmp_eq_u32 vcc, -1, v2
    v_smfmac_f32_16x16x64_bf16 v[72:75], v[32:35], v[168:175], v0
    s_cbranch_vccnz CG1_side
CG1_late_done:
    v_smfmac_f32_16x16x64_bf16 v[52:55], v[36:39], a[16:23], v0
    ds_read_b128 v[104:107], v6 offset:7168
    v_smfmac_f32_16x16x64_bf16 v[52:55], v[40:43], a[24:31], v0
    v_smfmac_f32_16x16x64_bf16 v[52:55], v[44:47], a[32:39], v0
    v_smfmac_f32_16x16x64_bf16 v[52:55], v[48:51], a[40:47], v0
    v_smfmac_f32_16x16x64_bf16 v[56:59], v[36:39], a[64:71], v0
    s_nop 2
    v_smfmac_f32_16x16x64_bf16 v[56:59], v[40:43], a[72:79], v0
    s_nop 2
    v_smfmac_f32_16x16x64_bf16 v[56:59], v[44:47], a[80:87], v0
    v_add_f32 v52, v52, v54
    v_smfmac_f32_16x16x64_bf16 v[56:59], v[48:51], a[88:95], v0
    buffer_store_dwordx4 v[124:127], v10, s[4:7], s22 offen sc1
    v_add_f32 v53, v53, v55
    v_smfmac_f32_16x16x64_bf16 v[60:63], v[36:39], a[120:127], v0
    s_nop 0
    v_cvt_pk_bf16_f32 v52, v52, v53
    v_smfmac_f32_16x16x64_bf16 v[60:63], v[40:43], a[128:135], v0
    s_nop 2
    v_smfmac_f32_16x16x64_bf16 v[60:63], v[44:47], a[136:143], v0
    buffer_store_dword v120, v15, s[4:7], s32 offen sc1
    v_add_f32 v56, v56, v58
    v_smfmac_f32_16x16x64_bf16 v[60:63], v[48:51], a[144:151], v0
    v_add_f32 v57, v57, v59
    v_smfmac_f32_16x16x64_bf16 v[64:67], v[36:39], a[176:183], v0
    s_nop 0
    v_cvt_pk_bf16_f32 v53, v56, v57
    v_smfmac_f32_16x16x64_bf16 v[64:67], v[40:43], a[184:191], v0
    ds_write2_b32 v8, v52, v53 offset0:0 offset1:128
    v_smfmac_f32_16x16x64_bf16 v[64:67], v[44:47], a[192:199], v0
    s_nop 0
    v_add_f32 v60, v60, v62
    v_smfmac_f32_16x16x64_bf16 v[64:67], v[48:51], a[200:207], v0
    v_add_f32 v61, v61, v63
    v_smfmac_f32_16x16x64_bf16 v[68:71], v[36:39], a[240:247], v0
    s_cmp_ge_u32 s18, 61
    v_cvt_pk_bf16_f32 v60, v60, v61
    v_smfmac_f32_16x16x64_bf16 v[72:75], v[36:39], v[176:183], v0
    s_nop 2
    v_smfmac_f32_16x16x64_bf16 v[68:71], v[40:43], a[248:255], v0
    s_waitcnt lgkmcnt(0)
    s_barrier
    v_add_f32 v64, v64, v66
    v_smfmac_f32_16x16x64_bf16 v[72:75], v[40:43], v[184:191], v0
    ds_read_b64_tr_b16 v[20:21], v9 offset:0
    ds_read_b64_tr_b16 v[22:23], v9 offset:512
    v_add_f32 v65, v65, v67
    v_smfmac_f32_16x16x64_bf16 v[68:71], v[44:47], v[128:135], v0
    ds_read_b64_tr_b16 v[24:25], v9 offset:1024
    ds_read_b64_tr_b16 v[26:27], v9 offset:1536
    v_cvt_pk_bf16_f32 v61, v64, v65
    v_smfmac_f32_16x16x64_bf16 v[72:75], v[44:47], v[192:199], v0
    ds_write2_b32 v8, v60, v61 offset0:1 offset1:129
    ds_read_b64_tr_b16 v[28:29], v9 offset:2048
    ds_read_b64_tr_b16 v[30:31], v9 offset:2560
    v_smfmac_f32_16x16x64_bf16 v[68:71], v[48:51], v[136:143], v0
    ds_read_b64_tr_b16 v[32:33], v9 offset:3072
    ds_read_b64_tr_b16 v[34:35], v9 offset:3584
    v_smfmac_f32_16x16x64_bf16 v[72:75], v[48:51], v[200:207], v0
    s_waitcnt lgkmcnt(7)
    v_mfma_f32_16x16x32_bf16 v[124:127], v[92:95], v[20:23], 0
    ds_read_b128 v[44:47], v11 offset:6144
    s_waitcnt lgkmcnt(6)
    v_mfma_f32_16x16x32_bf16 v[124:127], v[96:99], v[24:27], v[124:127]
    ds_read_b128 v[48:51], v12 offset:6144
    s_waitcnt lgkmcnt(4)
    v_mfma_f32_16x16x32_bf16 v[124:127], v[100:103], v[28:31], v[124:127]
    s_waitcnt lgkmcnt(2)
    s_waitcnt lgkmcnt(6)
    s_barrier
    v_mfma_f32_16x16x32_bf16 v[124:127], v[104:107], v[32:35], v[124:127]
    ds_read_b64_tr_b16 v[52:53], v9 offset:0
    ds_read_b64_tr_b16 v[54:55], v9 offset:512
    v_add_f32 v68, v68, v70
    v_mfma_f32_16x16x32_bf16 v[120:123], v[76:79], v[20:23], 0
    ds_read_b64_tr_b16 v[56:57], v9 offset:1024
    ds_read_b64_tr_b16 v[58:59], v9 offset:1536
    v_add_f32 v69, v69, v71
    v_mfma_f32_16x16x32_bf16 v[120:123], v[80:83], v[24:27], v[120:123]
    ds_read_b64_tr_b16 v[36:37], v9 offset:2048
    ds_read_b64_tr_b16 v[38:39], v9 offset:2560
    v_add_f32 v72, v72, v74
    v_mfma_f32_16x16x32_bf16 v[120:123], v[84:87], v[28:31], v[120:123]
    ds_read_b64_tr_b16 v[40:41], v9 offset:3072
    ds_read_b64_tr_b16 v[42:43], v9 offset:3584
    v_add_f32 v73, v73, v75
    v_mfma_f32_16x16x32_bf16 v[120:123], v[88:91], v[32:35], v[120:123]
    ds_read_b128 v[92:95], v11 offset:7168
    s_waitcnt lgkmcnt(7)
    v_cvt_pk_bf16_f32 v62, v68, v69
    v_mfma_f32_16x16x32_bf16 v[116:119], v[52:55], v[20:23], 0
    ds_read_b128 v[96:99], v12 offset:7168
    s_waitcnt lgkmcnt(6)
    v_cvt_pk_bf16_f32 v63, v72, v73
    v_mfma_f32_16x16x32_bf16 v[116:119], v[56:59], v[24:27], v[116:119]
    ds_read_b128 v[100:103], v11 offset:8192
    s_waitcnt lgkmcnt(5)
    v_mfma_f32_16x16x32_bf16 v[116:119], v[36:39], v[28:31], v[116:119]
    ds_read_b128 v[104:107], v12 offset:8192
    s_waitcnt lgkmcnt(4)
    v_max3_f32 v64, v124, v125, v126
    v_mfma_f32_16x16x32_bf16 v[116:119], v[40:43], v[32:35], v[116:119]
    ds_read_b128 v[76:79], v11 offset:9216
    v_max3_f32 v64, v64, v127, v120
    s_cbranch_scc1 CG1_done
CG1_resume:
    ds_read_b128 v[80:83], v12 offset:9216
    v_max3_f32 v64, v64, v121, v122
    v_max_f32 v64, v64, v123
    v_mov_b32 v66, s28
    v_xor_b32 v6, 8192, v6
    v_max3_f32 v65, v64, v118, v119
    v_max3_f32 v64, v64, v118, v119
    v_mov_b32 v68, 0x3f803f80
    v_mov_b32 v69, 0x3f803f80
    v_permlane32_swap_b32 v64, v65
    v_max_f32 v64, v64, v65
    v_mov_b32 v65, v64
    v_mov_b64 v[70:71], v[68:69]
    v_mov_b64 v[72:73], 0
    v_permlane16_swap_b32 v64, v65
    v_max_f32 v64, v64, v65
    v_mul_f32 v64, s28, v64
    v_pk_fma_f32 v[118:119], v[118:119], v[66:67], v[64:65] op_sel_hi:[1,0,0] neg_lo:[0,0,1] neg_hi:[0,0,1]
    v_pk_fma_f32 v[120:121], v[120:121], v[66:67], v[64:65] op_sel_hi:[1,0,0] neg_lo:[0,0,1] neg_hi:[0,0,1]
    v_pk_fma_f32 v[122:123], v[122:123], v[66:67], v[64:65] op_sel_hi:[1,0,0] neg_lo:[0,0,1] neg_hi:[0,0,1]
    v_pk_fma_f32 v[124:125], v[124:125], v[66:67], v[64:65] op_sel_hi:[1,0,0] neg_lo:[0,0,1] neg_hi:[0,0,1]
    v_pk_fma_f32 v[126:127], v[126:127], v[66:67], v[64:65] op_sel_hi:[1,0,0] neg_lo:[0,0,1] neg_hi:[0,0,1]
    v_exp_f32 v118, v118
    v_exp_f32 v119, v119
    v_exp_f32 v120, v120
    v_cvt_pk_bf16_f32 v16, v118, v119
    v_cvt_pk_bf16_f32 v19, v118, v119
    v_exp_f32 v121, v121
    v_mfma_f32_16x16x16_bf16 v[52:55], v[62:63], v[16:17], 0
    ds_read_b128 v[84:87], v11 offset:10240
    v_exp_f32 v122, v122
    v_exp_f32 v123, v123
    v_mfma_f32_16x16x16_bf16 v[56:59], v[62:63], v[18:19], 0
    ds_read_b128 v[88:91], v12 offset:10240
    v_exp_f32 v124, v124
    v_exp_f32 v125, v125
    v_mfma_f32_16x16x16_bf16 v[64:67], v[68:69], v[16:17], 0
    ds_read_b128 v[20:23], v11 offset:11264
    v_exp_f32 v126, v126
    v_exp_f32 v127, v127
    v_cvt_pk_bf16_f32 v120, v120, v121
    v_cvt_pk_bf16_f32 v121, v122, v123
    v_cvt_pk_bf16_f32 v122, v124, v125
    v_cvt_pk_bf16_f32 v123, v126, v127
    v_mov_b64 v[124:125], v[60:61]
    v_mov_b64 v[126:127], v[62:63]
    v_mfma_f32_16x16x32_bf16 v[64:67], v[68:71], v[120:123], v[64:67]
    ds_read_b128 v[24:27], v12 offset:11264
    v_mov_b64 v[60:61], 0
    v_mfma_f32_16x16x32_bf16 v[52:55], v[108:111], v[120:123], v[52:55]
    ds_read_b128 v[28:31], v11 offset:12288
    v_mov_b64 v[62:63], 0
    v_mfma_f32_16x16x32_bf16 v[56:59], v[112:115], v[120:123], v[56:59]
    ds_read_b128 v[32:35], v12 offset:12288
    v_mov_b64 v[68:69], 0
    v_mov_b64 v[70:71], 0
    v_mov_b64 v[74:75], 0
    v_rcp_f32 v64, v64
    s_nop 0
    v_pk_mul_f32 v[52:53], v[52:53], v[64:65] op_sel_hi:[1,0]
    v_pk_mul_f32 v[54:55], v[54:55], v[64:65] op_sel_hi:[1,0]
    v_pk_mul_f32 v[56:57], v[56:57], v[64:65] op_sel_hi:[1,0]
    v_pk_mul_f32 v[58:59], v[58:59], v[64:65] op_sel_hi:[1,0]
    v_cvt_pk_bf16_f32 v52, v52, v53
    v_cvt_pk_bf16_f32 v53, v54, v55
    v_cvt_pk_bf16_f32 v54, v56, v57
    v_cvt_pk_bf16_f32 v55, v58, v59
    ds_write_b128 v10, v[52:55] offset:4096
    v_mov_b32_dpp v52, v52 quad_perm:[0,1,0,1] row_mask:0xf bank_mask:0xf
    v_mov_b32_dpp v53, v53 quad_perm:[0,1,0,1] row_mask:0xf bank_mask:0xf
    v_mov_b32_dpp v54, v54 quad_perm:[0,1,0,1] row_mask:0xf bank_mask:0xf
    v_mov_b32_dpp v55, v55 quad_perm:[0,1,0,1] row_mask:0xf bank_mask:0xf
    v_mov_b64 v[64:65], 0
    v_mov_b64 v[66:67], 0
    v_smfmac_f32_16x16x64_bf16 v[68:71], v[52:55], v[208:215], v0
    ds_read_b128 v[36:39], v11 offset:13312
    s_add_u32 s25, s19, 4096
    v_smfmac_f32_16x16x64_bf16 v[72:75], v[52:55], v[232:239], v0
    ds_read_b128 v[40:43], v12 offset:13312
    s_mov_b32 s32, s20
    s_add_u32 s20, s20, 8192
    s_waitcnt lgkmcnt(2)
    s_barrier
    ds_read_b128 v[56:59], v5 offset:4096
    ds_read_b128 v[112:115], v5 offset:6144
    ds_read_b128 v[108:111], v5 offset:7168
    v_smfmac_f32_16x16x64_bf16 v[60:63], v[52:55], v[240:247], v0
    v_smfmac_f32_16x16x64_bf16 v[64:67], v[52:55], v[248:255], v0
    s_waitcnt lgkmcnt(2)
    v_smfmac_f32_16x16x64_bf16 v[68:71], v[56:59], v[216:223], v0
    s_waitcnt lgkmcnt(1)
    ds_read_b128 v[116:119], v11 offset:14336
    v_smfmac_f32_16x16x64_bf16 v[68:71], v[112:115], v[224:231], v0
    s_waitcnt lgkmcnt(1)
    ds_read_b128 v[120:123], v12 offset:14336
    v_smfmac_f32_16x16x64_bf16 v[68:71], v[108:111], v[44:51], v0
    s_and_b32 s20, s20, 0xffff7fff
    s_sub_u32 s36, s20, 131072
    s_add_u32 s31, s33, s19
    v_smfmac_f32_16x16x64_bf16 v[72:75], v[56:59], v[92:99], v0
    s_add_u32 s22, s22, 4096
    s_add_u32 s18, s18, 1
    s_nop 1
    v_cvt_pk_bf16_f32 v68, v68, v70
    v_cvt_pk_bf16_f32 v69, v69, v71
    v_smfmac_f32_16x16x64_bf16 v[72:75], v[112:115], v[100:107], v0
    buffer_store_dwordx2 v[68:69], v13, s[4:7], s19 offen offset:0 sc1
    v_smfmac_f32_16x16x64_bf16 v[72:75], v[108:111], v[76:83], v0
    ds_read_b128 v[44:47], v11 offset:15360
    s_nop 0
    v_smfmac_f32_16x16x64_bf16 v[60:63], v[56:59], v[84:91], v0
    ds_read_b128 v[48:51], v12 offset:15360
    s_nop 0
    v_smfmac_f32_16x16x64_bf16 v[60:63], v[112:115], v[20:27], v0
    s_nop 1
    v_cvt_pk_bf16_f32 v72, v72, v74
    v_cvt_pk_bf16_f32 v73, v73, v75
    v_smfmac_f32_16x16x64_bf16 v[60:63], v[108:111], v[28:35], v0
    buffer_store_dwordx2 v[72:73], v13, s[4:7], s19 offen offset:2048 sc1
    v_smfmac_f32_16x16x64_bf16 v[64:67], v[56:59], v[36:43], v0
    s_waitcnt lgkmcnt(0)
    s_nop 1
    v_smfmac_f32_16x16x64_bf16 v[64:67], v[112:115], v[116:123], v0
    s_nop 0
    s_nop 0
    v_cvt_pk_bf16_f32 v60, v60, v62
    v_cvt_pk_bf16_f32 v61, v61, v63
    v_smfmac_f32_16x16x64_bf16 v[64:67], v[108:111], v[44:51], v0
    buffer_store_dwordx2 v[60:61], v13, s[4:7], s25 offen offset:0 sc1
    s_nop 6
    v_cvt_pk_bf16_f32 v64, v64, v66
    v_cvt_pk_bf16_f32 v65, v65, v67
    buffer_store_dwordx2 v[64:65], v13, s[4:7], s25 offen offset:2048 sc1
    s_barrier
    s_nop 15
    s_nop 15
    s_nop 3
    buffer_load_dwordx4 v[20:23], v4, s[4:7], s31 offen sc1
    buffer_load_dwordx4 v[24:27], v4, s[4:7], s31 offen offset:1024 sc1
    v_mov_b64 v[52:53], 0
    v_mov_b64 v[54:55], 0
    v_mov_b64 v[56:57], 0
    v_mov_b64 v[58:59], 0
    v_mov_b64 v[60:61], 0
    v_mov_b64 v[62:63], 0
    v_mov_b64 v[64:65], 0
    v_mov_b64 v[66:67], 0
    v_mov_b64 v[68:69], 0
    v_mov_b64 v[70:71], 0
    v_mov_b64 v[72:73], 0
    v_mov_b64 v[74:75], 0
    v_cndmask_b32 v36, 0, v7, s[52:53]
    v_cndmask_b32 v37, 0, v7, s[54:55]
    v_cndmask_b32 v38, 0, v7, s[56:57]
    v_cndmask_b32 v39, 0, v7, s[58:59]
    s_nop 13
    buffer_load_dwordx4 v[28:31], v4, s[4:7], s31 offen sc1
    buffer_load_dwordx4 v[32:35], v4, s[4:7], s31 offen offset:1024 sc1
    s_xor_b32 s19, s19, 262144
    s_mov_b32 m0, 133120
    s_add_u32 s26, s36, 4096
    s_branch CG1_waitA
CG1_pollA_retry:
    buffer_load_dwordx4 v[20:23], v4, s[4:7], s31 offen sc1
    buffer_load_dwordx4 v[24:27], v4, s[4:7], s31 offen offset:1024 sc1
    s_add_u32 s35, s35, 1
    s_waitcnt vmcnt(2)
    v_mfma_f32_16x16x32_bf16 v[40:43], v[36:39], v[28:31], 0
    v_max3_u32 v2, v28, v29, v30
    v_max3_u32 v3, v31, v32, v33
    v_mfma_f32_16x16x32_bf16 v[40:43], v[36:39], v[32:35], v[40:43]
    v_max3_u32 v2, v2, v34, v35
    v_max_u32 v2, v2, v3
    v_cmp_eq_u32 vcc, -1, v2
    s_cbranch_vccz CG1_goA
    buffer_load_dwordx4 v[28:31], v4, s[4:7], s31 offen sc1
    buffer_load_dwordx4 v[32:35], v4, s[4:7], s31 offen offset:1024 sc1
    s_cmp_gt_u32 s35, 262144
    s_cbranch_scc1 CG1_goA
CG1_waitA:
    s_waitcnt vmcnt(2)
    v_mfma_f32_16x16x32_bf16 v[40:43], v[36:39], v[20:23], 0
    v_max3_u32 v2, v20, v21, v22
    v_max3_u32 v3, v23, v24, v25
    v_mfma_f32_16x16x32_bf16 v[40:43], v[36:39], v[24:27], v[40:43]
    v_max3_u32 v2, v2, v26, v27
    v_max_u32 v2, v2, v3
    v_cmp_eq_u32 vcc, -1, v2
    s_nop 3
    s_cbranch_vccnz CG1_pollA_retry
CG1_goA_n:
    v_add_f32_dpp v40, v40, v40 row_ror:4 row_mask:0xf bank_mask:0xf
    v_add_f32_dpp v41, v41, v41 row_ror:4 row_mask:0xf bank_mask:0xf
    s_nop 0
    v_add_f32_dpp v40, v40, v40 row_ror:8 row_mask:0xf bank_mask:0xf
    v_add_f32_dpp v41, v41, v41 row_ror:8 row_mask:0xf bank_mask:0xf
    v_cvt_pk_bf16_f32 v40, v40, v41
    buffer_store_dword v40, v15, s[4:7], s20 offen sc1
    ds_read_b128 v[108:111], v11 offset:0
    ds_read_b128 v[112:115], v12 offset:0
    ds_read_b128 v[116:119], v11 offset:1024
    ds_read_b128 v[120:123], v12 offset:1024
    ds_read_b128 v[76:79], v11 offset:2048
    ds_read_b128 v[80:83], v12 offset:2048
    ds_read_b128 v[84:87], v11 offset:3072
    ds_read_b128 v[88:91], v12 offset:3072
    s_nop 15
    s_nop 11
CG1_kvdone:
    buffer_load_dwordx4 v[36:39], v4, s[4:7], s36 offen offset:0 sc1
    buffer_load_dwordx4 v[40:43], v4, s[4:7], s36 offen offset:1024 sc1
    buffer_load_dwordx4 v4, s[4:7], s36 offen offset:0 sc1 lds
    buffer_load_dwordx4 v4, s[4:7], s36 offen offset:1024 sc1 lds
    ds_read_b128 v[92:95], v11 offset:4096
    ds_read_b128 v[96:99], v12 offset:4096
    s_nop 15
    s_nop 11
    buffer_load_dwordx4 v[44:47], v4, s[4:7], s36 offen offset:0 sc1
    buffer_load_dwordx4 v[48:51], v4, s[4:7], s36 offen offset:1024 sc1
    buffer_load_dwordx4 v4, s[4:7], s36 offen offset:0 sc1 lds
    buffer_load_dwordx4 v4, s[4:7], s36 offen offset:1024 sc1 lds
    ds_read_b128 v[100:103], v11 offset:5120
    ds_read_b128 v[104:107], v12 offset:5120
    s_waitcnt lgkmcnt(0)
    s_branch CG1_e0
CG1_goA:
    s_nop 3
    s_branch CG1_goA_n
CG1_done:
    s_add_u32 s22, s22, 4096
    buffer_store_dwordx4 v[60:63], v10, s[4:7], s22 offen sc1
    s_sub_u32 s22, s22, 4096
    s_cmp_lt_u32 s18, 63
    s_cbranch_scc1 CG1_resume
    s_branch CG_exit
CG0_entry:
    s_waitcnt lgkmcnt(0)
    ds_read_b128 v[108:111], v11 offset:0
    ds_read_b128 v[112:115], v12 offset:0
    ds_read_b128 v[116:119], v11 offset:1024
    ds_read_b128 v[120:123], v12 offset:1024
    ds_read_b128 v[76:79], v11 offset:2048
    ds_read_b128 v[80:83], v12 offset:2048
    ds_read_b128 v[84:87], v11 offset:3072
    ds_read_b128 v[88:91], v12 offset:3072
    ds_read_b128 v[92:95], v11 offset:4096
    ds_read_b128 v[96:99], v12 offset:4096
    ds_read_b128 v[100:103], v11 offset:5120
    ds_read_b128 v[104:107], v12 offset:5120
    v_mov_b64 v[52:53], 0
    v_mov_b64 v[54:55], 0
    v_mov_b64 v[56:57], 0
    v_mov_b64 v[58:59], 0
    v_mov_b64 v[60:61], 0
    v_mov_b64 v[62:63], 0
    v_mov_b64 v[64:65], 0
    v_mov_b64 v[66:67], 0
    v_mov_b64 v[68:69], 0
    v_mov_b64 v[70:71], 0
    v_mov_b64 v[72:73], 0
    v_mov_b64 v[74:75], 0
    s_cmp_le_u32 s38, 1
    s_cselect_b64 s[50:51], -1, 0
    s_lshl_b32 s34, s16, 8
    s_add_u32 s34, s34, 0
    s_waitcnt vmcnt(0) lgkmcnt(0)
    s_barrier
    s_branch CG0_b1
CG0_side:
    v_cmp_eq_u32 vcc, -1, v2
    s_cbranch_vccz CG0_side2
CG0_lateB:
    s_mov_b32 m0, 135168
    s_nop 0
    buffer_load_dwordx4 v10, s[4:7], s26 offen sc1 lds
    s_add_u32 s23, s23, 1
    s_cmp_gt_u32 s23, 262144
    s_waitcnt vmcnt(1)
    s_cbranch_scc1 CG0_lateB_ok
    ds_read_b128 v[36:39], v1 offset:4096
    ds_read_b128 v[40:43], v1 offset:5120
    ds_read_b128 v[44:47], v1 offset:6144
    ds_read_b128 v[48:51], v1 offset:7168
    s_waitcnt lgkmcnt(0)
    v_max3_u32 v2, v36, v37, v38
    v_max3_u32 v2, v2, v39, v40
    v_max3_u32 v2, v2, v41, v42
    v_max3_u32 v2, v2, v43, v44
    v_max3_u32 v2, v2, v45, v46
    v_max3_u32 v2, v2, v47, v48
    v_max3_u32 v2, v2, v49, v50
    v_max_u32 v2, v2, v51
    v_cmp_eq_u32 vcc, -1, v2
    s_cbranch_vccnz CG0_lateB
CG0_lateB_ok:
    s_waitcnt vmcnt(0)
CG0_side2:
    s_branch CG0_late_done
CG0_e1:
    buffer_load_dwordx4 v[36:39], v4, s[4:7], s36 offen offset:0 sc1
    buffer_load_dwordx4 v[40:43], v4, s[4:7], s36 offen offset:1024 sc1
    buffer_load_dwordx4 v4, s[4:7], s36 offen offset:0 sc1 lds
    buffer_load_dwordx4 v4, s[4:7], s36 offen offset:1024 sc1 lds
    s_waitcnt vmcnt(6)
    v_max3_u32 v2, v44, v45, v46
    v_max3_u32 v3, v47, v48, v49
    v_max3_u32 v2, v2, v50, v51
    v_max_u32 v2, v2, v3
    v_cmp_eq_u32 vcc, -1, v2
    s_waitcnt vmcnt(4)
    s_cbranch_vccz CG0_go
    buffer_load_dwordx4 v[44:47], v4, s[4:7], s36 offen offset:0 sc1
    buffer_load_dwordx4 v[48:51], v4, s[4:7], s36 offen offset:1024 sc1
    buffer_load_dwordx4 v4, s[4:7], s36 offen offset:0 sc1 lds
    buffer_load_dwordx4 v4, s[4:7], s36 offen offset:1024 sc1 lds
    s_add_u32 s23, s23, 1
    s_cmp_gt_u32 s23, 262144
    s_cbranch_scc1 CG0_go
CG0_e0:
    s_waitcnt vmcnt(6)
    v_max3_u32 v2, v36, v37, v38
    v_max3_u32 v3, v39, v40, v41
    v_max3_u32 v2, v2, v42, v43
    v_max_u32 v2, v2, v3
    v_cmp_eq_u32 vcc, -1, v2
    s_waitcnt vmcnt(4)
    s_cbranch_vccnz CG0_e1
CG0_go:
    s_mov_b32 m0, 135168
    s_barrier
    buffer_load_dwordx4 v10, s[4:7], s26 offen sc1 lds
CG0_b1:
    ds_read_b128 v[20:23], v1 offset:0
    ds_read_b128 v[24:27], v1 offset:1024
    ds_read_b128 v[28:31], v1 offset:2048
    ds_read_b128 v[32:35], v1 offset:3072
    s_waitcnt lgkmcnt(3)
    v_smfmac_f32_16x16x64_bf16 v[52:55], v[20:23], v[108:115], v0
    v_smfmac_f32_16x16x64_bf16 v[56:59], v[20:23], v[116:123], v0
    v_smfmac_f32_16x16x64_bf16 v[60:63], v[20:23], v[76:83], v0
    s_waitcnt lgkmcnt(0)
    v_smfmac_f32_16x16x64_bf16 v[64:67], v[20:23], v[84:91], v0
    v_mov_b64 v[120:121], -1
    v_smfmac_f32_16x16x64_bf16 v[52:55], v[24:27], v[92:99], v0
    v_mov_b64 v[122:123], -1
    v_smfmac_f32_16x16x64_bf16 v[56:59], v[24:27], v[100:107], v0
    ds_read_b128 v[108:111], v4 offset:8192
    v_smfmac_f32_16x16x64_bf16 v[60:63], v[24:27], a[96:103], v0
    ds_read_b128 v[112:115], v4 offset:9216
    v_smfmac_f32_16x16x64_bf16 v[64:67], v[24:27], a[152:159], v0
    ds_read_b128 v[76:79], v6 offset:0
    v_smfmac_f32_16x16x64_bf16 v[52:55], v[28:31], a[0:7], v0
    ds_read_b128 v[80:83], v6 offset:1024
    v_smfmac_f32_16x16x64_bf16 v[56:59], v[28:31], a[48:55], v0
    s_waitcnt vmcnt(0) lgkmcnt(2)
    s_barrier
    v_smfmac_f32_16x16x64_bf16 v[60:63], v[28:31], a[104:111], v0
    ds_read_b128 v[36:39], v1 offset:4096
    v_smfmac_f32_16x16x64_bf16 v[64:67], v[28:31], a[160:167], v0
    ds_read_b128 v[40:43], v1 offset:5120
    v_smfmac_f32_16x16x64_bf16 v[52:55], v[32:35], a[8:15], v0
    ds_read_b128 v[44:47], v1 offset:6144
    v_smfmac_f32_16x16x64_bf16 v[56:59], v[32:35], a[56:63], v0
    ds_read_b128 v[48:51], v1 offset:7168
    v_smfmac_f32_16x16x64_bf16 v[60:63], v[32:35], a[112:119], v0
    s_waitcnt lgkmcnt(2)
    v_max3_u32 v2, v36, v37, v38
    v_smfmac_f32_16x16x64_bf16 v[64:67], v[32:35], a[168:175], v0
    v_max3_u32 v2, v2, v39, v40
    v_smfmac_f32_16x16x64_bf16 v[68:71], v[20:23], a[208:215], v0
    v_max3_u32 v2, v2, v41, v42
    v_smfmac_f32_16x16x64_bf16 v[72:75], v[20:23], v[144:151], v0
    s_waitcnt lgkmcnt(0)
    v_max3_u32 v2, v2, v43, v44
    v_smfmac_f32_16x16x64_bf16 v[68:71], v[24:27], a[216:223], v0
    ds_read_b128 v[84:87], v6 offset:2048
    buffer_store_dwordx4 v[120:123], v4, s[4:7], s31 offen sc1
    v_max3_u32 v2, v2, v45, v46
    v_smfmac_f32_16x16x64_bf16 v[72:75], v[24:27], v[152:159], v0
    ds_read_b128 v[88:91], v6 offset:3072
    v_max3_u32 v2, v2, v47, v48
    v_smfmac_f32_16x16x64_bf16 v[68:71], v[28:31], a[224:231], v0
    ds_read_b128 v[92:95], v6 offset:4096
    buffer_store_dwordx4 v[120:123], v4, s[4:7], s31 offen offset:1024 sc1
    v_max3_u32 v2, v2, v49, v50
    v_smfmac_f32_16x16x64_bf16 v[72:75], v[28:31], v[160:167], v0
    ds_read_b128 v[96:99], v6 offset:5120
    v_max_u32 v2, v2, v51
    v_smfmac_f32_16x16x64_bf16 v[68:71], v[32:35], a[232:239], v0
    ds_read_b128 v[100:103], v6 offset:6144
    v_cmp_eq_u32 vcc, -1, v2
    v_smfmac_f32_16x16x64_bf16 v[72:75], v[32:35], v[168:175], v0
    s_cbranch_vccnz CG0_side
CG0_late_done:
    v_smfmac_f32_16x16x64_bf16 v[52:55], v[36:39], a[16:23], v0
    ds_read_b128 v[104:107], v6 offset:7168
    v_smfmac_f32_16x16x64_bf16 v[52:55], v[40:43], a[24:31], v0
    v_smfmac_f32_16x16x64_bf16 v[52:55], v[44:47], a[32:39], v0
    v_smfmac_f32_16x16x64_bf16 v[52:55], v[48:51], a[40:47], v0
    v_smfmac_f32_16x16x64_bf16 v[56:59], v[36:39], a[64:71], v0
    s_nop 2
    v_smfmac_f32_16x16x64_bf16 v[56:59], v[40:43], a[72:79], v0
    s_nop 2
    v_smfmac_f32_16x16x64_bf16 v[56:59], v[44:47], a[80:87], v0
    buffer_store_dwordx4 v[124:127], v10, s[4:7], s22 offen sc1
    v_add_f32 v52, v52, v54
    v_smfmac_f32_16x16x64_bf16 v[56:59], v[48:51], a[88:95], v0
    v_add_f32 v53, v53, v55
    v_smfmac_f32_16x16x64_bf16 v[60:63], v[36:39], a[120:127], v0
    s_nop 0
    v_cvt_pk_bf16_f32 v52, v52, v53
    v_smfmac_f32_16x16x64_bf16 v[60:63], v[40:43], a[128:135], v0
    buffer_store_dword v120, v15, s[4:7], s32 offen sc1
    v_smfmac_f32_16x16x64_bf16 v[60:63], v[44:47], a[136:143], v0
    s_nop 0
    v_add_f32 v56, v56, v58
    v_smfmac_f32_16x16x64_bf16 v[60:63], v[48:51], a[144:151], v0
    v_add_f32 v57, v57, v59
    v_smfmac_f32_16x16x64_bf16 v[64:67], v[36:39], a[176:183], v0
    s_nop 0
    v_cvt_pk_bf16_f32 v53, v56, v57
    v_smfmac_f32_16x16x64_bf16 v[64:67], v[40:43], a[184:191], v0
    ds_write2_b32 v8, v52, v53 offset0:0 offset1:128
    v_smfmac_f32_16x16x64_bf16 v[64:67], v[44:47], a[192:199], v0
    s_nop 0
    v_add_f32 v60, v60, v62
    v_smfmac_f32_16x16x64_bf16 v[64:67], v[48:51], a[200:207], v0
    v_add_f32 v61, v61, v63
    v_smfmac_f32_16x16x64_bf16 v[68:71], v[36:39], a[240:247], v0
    s_cmp_ge_u32 s18, 61
    v_cvt_pk_bf16_f32 v60, v60, v61
    v_smfmac_f32_16x16x64_bf16 v[72:75], v[36:39], v[176:183], v0
    s_nop 2
    v_smfmac_f32_16x16x64_bf16 v[68:71], v[40:43], a[248:255], v0
    s_waitcnt lgkmcnt(0)
    s_barrier
    v_add_f32 v64, v64, v66
    v_smfmac_f32_16x16x64_bf16 v[72:75], v[40:43], v[184:191], v0
    ds_read_b64_tr_b16 v[20:21], v9 offset:0
    ds_read_b64_tr_b16 v[22:23], v9 offset:512
    v_add_f32 v65, v65, v67
    v_smfmac_f32_16x16x64_bf16 v[68:71], v[44:47], v[128:135], v0
    ds_read_b64_tr_b16 v[24:25], v9 offset:1024
    ds_read_b64_tr_b16 v[26:27], v9 offset:1536
    v_cvt_pk_bf16_f32 v61, v64, v65
    v_smfmac_f32_16x16x64_bf16 v[72:75], v[44:47], v[192:199], v0
    ds_write2_b32 v8, v60, v61 offset0:1 offset1:129
    ds_read_b64_tr_b16 v[28:29], v9 offset:2048
    ds_read_b64_tr_b16 v[30:31], v9 offset:2560
    v_smfmac_f32_16x16x64_bf16 v[68:71], v[48:51], v[136:143], v0
    ds_read_b64_tr_b16 v[32:33], v9 offset:3072
    ds_read_b64_tr_b16 v[34:35], v9 offset:3584
    v_smfmac_f32_16x16x64_bf16 v[72:75], v[48:51], v[200:207], v0
    s_waitcnt lgkmcnt(7)
    v_mfma_f32_16x16x32_bf16 v[124:127], v[92:95], v[20:23], 0
    ds_read_b128 v[44:47], v11 offset:6144
    s_waitcnt lgkmcnt(6)
    v_mfma_f32_16x16x32_bf16 v[124:127], v[96:99], v[24:27], v[124:127]
    ds_read_b128 v[48:51], v12 offset:6144
    s_waitcnt lgkmcnt(4)
    v_mfma_f32_16x16x32_bf16 v[124:127], v[100:103], v[28:31], v[124:127]
    s_waitcnt lgkmcnt(2)
    s_waitcnt lgkmcnt(6)
    s_barrier
    v_mfma_f32_16x16x32_bf16 v[124:127], v[104:107], v[32:35], v[124:127]
    ds_read_b64_tr_b16 v[52:53], v9 offset:0
    ds_read_b64_tr_b16 v[54:55], v9 offset:512
    v_add_f32 v68, v68, v70
    v_mfma_f32_16x16x32_bf16 v[120:123], v[76:79], v[20:23], 0
    ds_read_b64_tr_b16 v[56:57], v9 offset:1024
    ds_read_b64_tr_b16 v[58:59], v9 offset:1536
    v_add_f32 v69, v69, v71
    v_mfma_f32_16x16x32_bf16 v[120:123], v[80:83], v[24:27], v[120:123]
    ds_read_b64_tr_b16 v[36:37], v9 offset:2048
    ds_read_b64_tr_b16 v[38:39], v9 offset:2560
    v_add_f32 v72, v72, v74
    v_mfma_f32_16x16x32_bf16 v[120:123], v[84:87], v[28:31], v[120:123]
    ds_read_b64_tr_b16 v[40:41], v9 offset:3072
    ds_read_b64_tr_b16 v[42:43], v9 offset:3584
    v_add_f32 v73, v73, v75
    v_mfma_f32_16x16x32_bf16 v[120:123], v[88:91], v[32:35], v[120:123]
    ds_read_b128 v[92:95], v11 offset:7168
    s_waitcnt lgkmcnt(7)
    v_cvt_pk_bf16_f32 v62, v68, v69
    v_mfma_f32_16x16x32_bf16 v[116:119], v[52:55], v[20:23], 0
    ds_read_b128 v[96:99], v12 offset:7168
    s_waitcnt lgkmcnt(6)
    v_cvt_pk_bf16_f32 v63, v72, v73
    v_mfma_f32_16x16x32_bf16 v[116:119], v[56:59], v[24:27], v[116:119]
    ds_read_b128 v[100:103], v11 offset:8192
    s_waitcnt lgkmcnt(5)
    v_mfma_f32_16x16x32_bf16 v[116:119], v[36:39], v[28:31], v[116:119]
    ds_read_b128 v[104:107], v12 offset:8192
    s_waitcnt lgkmcnt(4)
    v_max3_f32 v64, v124, v125, v126
    v_mfma_f32_16x16x32_bf16 v[116:119], v[40:43], v[32:35], v[116:119]
    ds_read_b128 v[76:79], v11 offset:9216
    v_max3_f32 v64, v64, v127, v120
    s_cbranch_scc1 CG0_done
CG0_resume:
    ds_read_b128 v[80:83], v12 offset:9216
    v_max3_f32 v64, v64, v121, v122
    v_max_f32 v64, v64, v123
    v_mov_b32 v66, s28
    v_xor_b32 v6, 8192, v6
    v_max3_f32 v65, v64, v118, v119
    v_max3_f32 v64, v64, v118, v119
    v_mov_b32 v68, 0x3f803f80
    v_mov_b32 v69, 0x3f803f80
    v_permlane32_swap_b32 v64, v65
    v_max_f32 v64, v64, v65
    v_mov_b32 v65, v64
    v_mov_b64 v[70:71], v[68:69]
    v_mov_b64 v[72:73], 0
    v_permlane16_swap_b32 v64, v65
    v_max_f32 v64, v64, v65
    v_mul_f32 v64, s28, v64
    v_pk_fma_f32 v[118:119], v[118:119], v[66:67], v[64:65] op_sel_hi:[1,0,0] neg_lo:[0,0,1] neg_hi:[0,0,1]
    v_pk_fma_f32 v[120:121], v[120:121], v[66:67], v[64:65] op_sel_hi:[1,0,0] neg_lo:[0,0,1] neg_hi:[0,0,1]
    v_pk_fma_f32 v[122:123], v[122:123], v[66:67], v[64:65] op_sel_hi:[1,0,0] neg_lo:[0,0,1] neg_hi:[0,0,1]
    v_pk_fma_f32 v[124:125], v[124:125], v[66:67], v[64:65] op_sel_hi:[1,0,0] neg_lo:[0,0,1] neg_hi:[0,0,1]
    v_pk_fma_f32 v[126:127], v[126:127], v[66:67], v[64:65] op_sel_hi:[1,0,0] neg_lo:[0,0,1] neg_hi:[0,0,1]
    v_exp_f32 v118, v118
    v_exp_f32 v119, v119
    v_exp_f32 v120, v120
    v_cvt_pk_bf16_f32 v16, v118, v119
    v_cvt_pk_bf16_f32 v19, v118, v119
    v_exp_f32 v121, v121
    v_mfma_f32_16x16x16_bf16 v[52:55], v[62:63], v[16:17], 0
    ds_read_b128 v[84:87], v11 offset:10240
    v_exp_f32 v122, v122
    v_exp_f32 v123, v123
    v_mfma_f32_16x16x16_bf16 v[56:59], v[62:63], v[18:19], 0
    ds_read_b128 v[88:91], v12 offset:10240
    v_exp_f32 v124, v124
    v_exp_f32 v125, v125
    v_mfma_f32_16x16x16_bf16 v[64:67], v[68:69], v[16:17], 0
    ds_read_b128 v[20:23], v11 offset:11264
    v_exp_f32 v126, v126
    v_exp_f32 v127, v127
    v_cvt_pk_bf16_f32 v120, v120, v121
    v_cvt_pk_bf16_f32 v121, v122, v123
    v_cvt_pk_bf16_f32 v122, v124, v125
    v_cvt_pk_bf16_f32 v123, v126, v127
    v_mov_b64 v[124:125], v[60:61]
    v_mov_b64 v[126:127], v[62:63]
    v_mfma_f32_16x16x32_bf16 v[64:67], v[68:71], v[120:123], v[64:67]
    ds_read_b128 v[24:27], v12 offset:11264
    v_mov_b64 v[60:61], 0
    v_mfma_f32_16x16x32_bf16 v[52:55], v[108:111], v[120:123], v[52:55]
    ds_read_b128 v[28:31], v11 offset:12288
    v_mov_b64 v[62:63], 0
    v_mfma_f32_16x16x32_bf16 v[56:59], v[112:115], v[120:123], v[56:59]
    ds_read_b128 v[32:35], v12 offset:12288
    v_mov_b64 v[68:69], 0
    v_mov_b64 v[70:71], 0
    v_mov_b64 v[74:75], 0
    v_rcp_f32 v64, v64
    s_nop 0
    v_pk_mul_f32 v[52:53], v[52:53], v[64:65] op_sel_hi:[1,0]
    v_pk_mul_f32 v[54:55], v[54:55], v[64:65] op_sel_hi:[1,0]
    v_pk_mul_f32 v[56:57], v[56:57], v[64:65] op_sel_hi:[1,0]
    v_pk_mul_f32 v[58:59], v[58:59], v[64:65] op_sel_hi:[1,0]
    v_cvt_pk_bf16_f32 v52, v52, v53
    v_cvt_pk_bf16_f32 v53, v54, v55
    v_cvt_pk_bf16_f32 v54, v56, v57
    v_cvt_pk_bf16_f32 v55, v58, v59
    ds_write_b128 v10, v[52:55] offset:4096
    v_mov_b32_dpp v52, v52 quad_perm:[0,1,0,1] row_mask:0xf bank_mask:0xf
    v_mov_b32_dpp v53, v53 quad_perm:[0,1,0,1] row_mask:0xf bank_mask:0xf
    v_mov_b32_dpp v54, v54 quad_perm:[0,1,0,1] row_mask:0xf bank_mask:0xf
    v_mov_b32_dpp v55, v55 quad_perm:[0,1,0,1] row_mask:0xf bank_mask:0xf
    v_mov_b64 v[64:65], 0
    v_mov_b64 v[66:67], 0
    v_smfmac_f32_16x16x64_bf16 v[68:71], v[52:55], v[208:215], v0
    ds_read_b128 v[36:39], v11 offset:13312
    s_add_u32 s25, s19, 4096
    v_smfmac_f32_16x16x64_bf16 v[72:75], v[52:55], v[232:239], v0
    ds_read_b128 v[40:43], v12 offset:13312
    s_mov_b32 s32, s20
    s_add_u32 s20, s20, 8192
    s_waitcnt lgkmcnt(2)
    s_barrier
    ds_read_b128 v[56:59], v5 offset:5120
    ds_read_b128 v[112:115], v5 offset:7168
    ds_read_b128 v[108:111], v5 offset:6144
    v_smfmac_f32_16x16x64_bf16 v[60:63], v[52:55], v[240:247], v0
    v_smfmac_f32_16x16x64_bf16 v[64:67], v[52:55], v[248:255], v0
    s_waitcnt lgkmcnt(2)
    v_smfmac_f32_16x16x64_bf16 v[68:71], v[56:59], v[216:223], v0
    s_waitcnt lgkmcnt(1)
    ds_read_b128 v[116:119], v11 offset:14336
    v_smfmac_f32_16x16x64_bf16 v[68:71], v[112:115], v[224:231], v0
    s_waitcnt lgkmcnt(1)
    ds_read_b128 v[120:123], v12 offset:14336
    v_smfmac_f32_16x16x64_bf16 v[68:71], v[108:111], v[44:51], v0
    s_and_b32 s20, s20, 0xffff7fff
    s_sub_u32 s36, s20, 131072
    s_add_u32 s31, s33, s19
    v_smfmac_f32_16x16x64_bf16 v[72:75], v[56:59], v[92:99], v0
    s_add_u32 s22, s22, 4096
    s_add_u32 s18, s18, 1
    s_nop 1
    v_cvt_pk_bf16_f32 v68, v68, v70
    v_cvt_pk_bf16_f32 v69, v69, v71
    v_smfmac_f32_16x16x64_bf16 v[72:75], v[112:115], v[100:107], v0
    buffer_store_dwordx2 v[68:69], v13, s[4:7], s19 offen offset:0 sc1
    v_smfmac_f32_16x16x64_bf16 v[72:75], v[108:111], v[76:83], v0
    ds_read_b128 v[44:47], v11 offset:15360
    s_nop 0
    v_smfmac_f32_16x16x64_bf16 v[60:63], v[56:59], v[84:91], v0
    ds_read_b128 v[48:51], v12 offset:15360
    s_nop 0
    v_smfmac_f32_16x16x64_bf16 v[60:63], v[112:115], v[20:27], v0
    s_nop 1
    v_cvt_pk_bf16_f32 v72, v72, v74
    v_cvt_pk_bf16_f32 v73, v73, v75
    v_smfmac_f32_16x16x64_bf16 v[60:63], v[108:111], v[28:35], v0
    buffer_store_dwordx2 v[72:73], v13, s[4:7], s19 offen offset:2048 sc1
    v_smfmac_f32_16x16x64_bf16 v[64:67], v[56:59], v[36:43], v0
    s_waitcnt lgkmcnt(0)
    s_nop 1
    v_smfmac_f32_16x16x64_bf16 v[64:67], v[112:115], v[116:123], v0
    s_nop 0
    s_nop 0
    v_cvt_pk_bf16_f32 v60, v60, v62
    v_cvt_pk_bf16_f32 v61, v61, v63
    v_smfmac_f32_16x16x64_bf16 v[64:67], v[108:111], v[44:51], v0
    buffer_store_dwordx2 v[60:61], v13, s[4:7], s25 offen offset:0 sc1
    s_nop 6
    v_cvt_pk_bf16_f32 v64, v64, v66
    v_cvt_pk_bf16_f32 v65, v65, v67
    buffer_store_dwordx2 v[64:65], v13, s[4:7], s25 offen offset:2048 sc1
    s_barrier
    s_nop 15
    s_nop 7
    buffer_load_dwordx4 v[20:23], v4, s[4:7], s31 offen sc1
    buffer_load_dwordx4 v[24:27], v4, s[4:7], s31 offen offset:1024 sc1
    v_mov_b64 v[52:53], 0
    v_mov_b64 v[54:55], 0
    v_mov_b64 v[56:57], 0
    v_mov_b64 v[58:59], 0
    v_mov_b64 v[60:61], 0
    v_mov_b64 v[62:63], 0
    v_mov_b64 v[64:65], 0
    v_mov_b64 v[66:67], 0
    v_mov_b64 v[68:69], 0
    v_mov_b64 v[70:71], 0
    v_mov_b64 v[72:73], 0
    v_mov_b64 v[74:75], 0
    v_cndmask_b32 v36, 0, v7, s[52:53]
    v_cndmask_b32 v37, 0, v7, s[54:55]
    v_cndmask_b32 v38, 0, v7, s[56:57]
    v_cndmask_b32 v39, 0, v7, s[58:59]
    s_nop 13
    buffer_load_dwordx4 v[28:31], v4, s[4:7], s31 offen sc1
    buffer_load_dwordx4 v[32:35], v4, s[4:7], s31 offen offset:1024 sc1
    s_xor_b32 s19, s19, 262144
    s_mov_b32 m0, 131072
    s_add_u32 s26, s36, 4096
    s_branch CG0_waitA
CG0_pollA_retry:
    buffer_load_dwordx4 v[20:23], v4, s[4:7], s31 offen sc1
    buffer_load_dwordx4 v[24:27], v4, s[4:7], s31 offen offset:1024 sc1
    s_add_u32 s35, s35, 1
    s_waitcnt vmcnt(2)
    v_mfma_f32_16x16x32_bf16 v[40:43], v[36:39], v[28:31], 0
    v_max3_u32 v2, v28, v29, v30
    v_max3_u32 v3, v31, v32, v33
    v_mfma_f32_16x16x32_bf16 v[40:43], v[36:39], v[32:35], v[40:43]
    v_max3_u32 v2, v2, v34, v35
    v_max_u32 v2, v2, v3
    v_cmp_eq_u32 vcc, -1, v2
    s_cbranch_vccz CG0_goA
    buffer_load_dwordx4 v[28:31], v4, s[4:7], s31 offen sc1
    buffer_load_dwordx4 v[32:35], v4, s[4:7], s31 offen offset:1024 sc1
    s_cmp_gt_u32 s35, 262144
    s_cbranch_scc1 CG0_goA
CG0_waitA:
    s_waitcnt vmcnt(2)
    v_mfma_f32_16x16x32_bf16 v[40:43], v[36:39], v[20:23], 0
    v_max3_u32 v2, v20, v21, v22
    v_max3_u32 v3, v23, v24, v25
    v_mfma_f32_16x16x32_bf16 v[40:43], v[36:39], v[24:27], v[40:43]
    v_max3_u32 v2, v2, v26, v27
    v_max_u32 v2, v2, v3
    v_cmp_eq_u32 vcc, -1, v2
    s_nop 3
    s_cbranch_vccnz CG0_pollA_retry
CG0_goA_n:
    v_add_f32_dpp v40, v40, v40 row_ror:4 row_mask:0xf bank_mask:0xf
    v_add_f32_dpp v41, v41, v41 row_ror:4 row_mask:0xf bank_mask:0xf
    s_nop 0
    v_add_f32_dpp v40, v40, v40 row_ror:8 row_mask:0xf bank_mask:0xf
    v_add_f32_dpp v41, v41, v41 row_ror:8 row_mask:0xf bank_mask:0xf
    v_cvt_pk_bf16_f32 v40, v40, v41
    buffer_store_dword v40, v15, s[4:7], s20 offen sc1
    ds_read_b128 v[108:111], v11 offset:0
    ds_read_b128 v[112:115], v12 offset:0
    ds_read_b128 v[116:119], v11 offset:1024
    ds_read_b128 v[120:123], v12 offset:1024
    ds_read_b128 v[76:79], v11 offset:2048
    ds_read_b128 v[80:83], v12 offset:2048
    ds_read_b128 v[84:87], v11 offset:3072
    ds_read_b128 v[88:91], v12 offset:3072
    s_nop 15
    s_nop 11
CG0_kvdone:
    buffer_load_dwordx4 v[36:39], v4, s[4:7], s36 offen offset:0 sc1
    buffer_load_dwordx4 v[40:43], v4, s[4:7], s36 offen offset:1024 sc1
    buffer_load_dwordx4 v4, s[4:7], s36 offen offset:0 sc1 lds
    buffer_load_dwordx4 v4, s[4:7], s36 offen offset:1024 sc1 lds
    ds_read_b128 v[92:95], v11 offset:4096
    ds_read_b128 v[96:99], v12 offset:4096
    s_nop 15
    s_nop 11
    buffer_load_dwordx4 v[44:47], v4, s[4:7], s36 offen offset:0 sc1
    buffer_load_dwordx4 v[48:51], v4, s[4:7], s36 offen offset:1024 sc1
    buffer_load_dwordx4 v4, s[4:7], s36 offen offset:0 sc1 lds
    buffer_load_dwordx4 v4, s[4:7], s36 offen offset:1024 sc1 lds
    ds_read_b128 v[100:103], v11 offset:5120
    ds_read_b128 v[104:107], v12 offset:5120
    s_waitcnt lgkmcnt(0)
    s_branch CG0_e0
CG0_goA:
    s_nop 3
    s_branch CG0_goA_n
CG0_done:
    s_add_u32 s22, s22, 4096
    buffer_store_dwordx4 v[60:63], v10, s[4:7], s22 offen sc1
    s_sub_u32 s22, s22, 4096
    s_cmp_lt_u32 s18, 63
    s_cbranch_scc1 CG0_resume
CG_exit:
L_chain_end:
    v_mov_b32 v3, 208
wt_6:
    buffer_load_dword v2, v3, s[12:15], 0 offen sc1
    s_add_u32 s23, s23, 1
    s_waitcnt vmcnt(0)
    v_readfirstlane_b32 s24, v2
    s_cmp_gt_u32 s23, 262144
    s_cbranch_scc1 wte_7
    s_cmp_ge_u32 s24, 64
    s_cbranch_scc1 wte_7
    s_sleep 4
    s_branch wt_6
wte_7:
    s_mov_b32 s38, 0
    s_branch L_helper
L_notchain:
    v_and_b32 v1, 63, v0
    v_and_b32 v2, 15, v1
    v_lshrrev_b32 v3, 4, v1
    v_lshrrev_b32 v4, 2, v2
    v_and_b32 v5, 3, v2
    v_lshlrev_b32 v6, 4, v1
    s_mov_b32 s23, 0
    s_cmp_eq_u32 s39, 5
    s_cbranch_scc1 L_post
    s_lshl_b32 s26, s39, 5
    s_add_u32 s26, s26, s16
    s_sub_u32 s26, s26, 32
    s_mul_i32 s26, s26, 18944
    v_lshlrev_b32 v7, 4, v0
    s_mov_b32 s46, 4194304
    s_mov_b32 s47, 0x20000
    s_mov_b32 s44, s50
    s_mov_b32 s45, s51
    s_mov_b32 s27, s26
    buffer_load_dwordx4 v[128:131], v7, s[44:47], s27 offen
    s_add_u32 s27, s27, 4096
    buffer_load_dwordx4 v[132:135], v7, s[44:47], s27 offen
    s_add_u32 s27, s27, 4096
    buffer_load_dwordx4 v[136:139], v7, s[44:47], s27 offen
    s_add_u32 s27, s27, 4096
    buffer_load_dwordx4 v[140:143], v7, s[44:47], s27 offen
    s_add_u32 s27, s27, 4096
    buffer_load_dwordx4 v[144:147], v7, s[44:47], s27 offen
    s_add_u32 s27, s27, 4096
    s_lshl_b32 s24, s17, 2
    v_add_u32 v8, s24, v3
    v_lshlrev_b32 v8, 13, v8
    s_lshr_b32 s24, s17, 1
    s_lshl_b32 s24, s24, 3
    v_lshlrev_b32 v10, 1, v3
    v_or_b32 v10, s24, v10
    v_xor_b32 v10, v2, v10
    v_lshl_add_u32 v8, v10, 4, v8
    s_lshl_b32 s24, s16, 8
    v_add_u32 v8, s24, v8
    v_and_b32 v10, 1, v3
    v_lshl_add_u32 v10, v10, 2, v4
    s_lshl_b32 s24, s17, 1
    v_xor_b32 v10, s24, v10
    v_lshlrev_b32 v10, 5, v10
    v_lshl_add_u32 v10, v5, 3, v10
    v_lshl_add_u32 v11, v3, 3, v4
    v_lshl_add_u32 v10, v11, 8, v10
    v_xor_b32 v11, 32, v10
    s_load_dwordx2 s[8:9], s[0:1], 24
    s_mov_b32 s10, 4194304
    s_mov_b32 s11, 0x20000
    s_waitcnt lgkmcnt(0)
    s_lshl_b32 s24, s17, 10
    s_add_u32 m0, s24, 0
    s_mov_b32 s25, 0
    s_waitcnt vmcnt(3)
    buffer_load_dwordx4 v8, s[8:11], s25 offen lds
    s_add_u32 m0, s24, 4096
    s_mov_b32 s25, 131072
    s_waitcnt vmcnt(3)
    buffer_load_dwordx4 v8, s[8:11], s25 offen lds
    s_add_u32 m0, s24, 8192
    s_mov_b32 s25, 262144
    s_waitcnt vmcnt(3)
    buffer_load_dwordx4 v8, s[8:11], s25 offen lds
    s_add_u32 m0, s24, 12288
    s_mov_b32 s25, 393216
    s_waitcnt vmcnt(3)
    buffer_load_dwordx4 v8, s[8:11], s25 offen lds
    s_add_u32 m0, s24, 16384
    s_mov_b32 s25, 524288
    s_waitcnt vmcnt(3)
    buffer_load_dwordx4 v8, s[8:11], s25 offen lds
    s_add_u32 m0, s24, 20480
    s_mov_b32 s25, 655360
    s_waitcnt vmcnt(3)
    buffer_load_dwordx4 v8, s[8:11], s25 offen lds
    s_add_u32 m0, s24, 24576
    s_mov_b32 s25, 786432
    s_waitcnt vmcnt(3)
    buffer_load_dwordx4 v8, s[8:11], s25 offen lds
    s_add_u32 m0, s24, 28672
    s_mov_b32 s25, 917504
    s_waitcnt vmcnt(3)
    buffer_load_dwordx4 v8, s[8:11], s25 offen lds
    s_add_u32 m0, s24, 32768
    s_mov_b32 s25, 1048576
    s_waitcnt vmcnt(3)
    buffer_load_dwordx4 v8, s[8:11], s25 offen lds
    s_add_u32 m0, s24, 36864
    s_mov_b32 s25, 1179648
    s_waitcnt vmcnt(3)
    buffer_load_dwordx4 v8, s[8:11], s25 offen lds
    s_add_u32 m0, s24, 40960
    s_mov_b32 s25, 1310720
    s_waitcnt vmcnt(3)
    buffer_load_dwordx4 v8, s[8:11], s25 offen lds
    s_add_u32 m0, s24, 45056
    s_mov_b32 s25, 1441792
    s_waitcnt vmcnt(3)
    buffer_load_dwordx4 v8, s[8:11], s25 offen lds
    s_add_u32 m0, s24, 49152
    s_mov_b32 s25, 1572864
    s_waitcnt vmcnt(3)
    buffer_load_dwordx4 v8, s[8:11], s25 offen lds
    s_add_u32 m0, s24, 53248
    s_mov_b32 s25, 1703936
    s_waitcnt vmcnt(3)
    buffer_load_dwordx4 v8, s[8:11], s25 offen lds
    s_add_u32 m0, s24, 57344
    s_mov_b32 s25, 1835008
    s_waitcnt vmcnt(3)
    buffer_load_dwordx4 v8, s[8:11], s25 offen lds
    s_add_u32 m0, s24, 61440
    s_mov_b32 s25, 1966080
    s_waitcnt vmcnt(3)
    buffer_load_dwordx4 v8, s[8:11], s25 offen lds
    s_lshl_b32 s26, s39, 5
    s_add_u32 s26, s26, s16
    s_sub_u32 s26, s26, 32
    s_mul_i32 s26, s26, 18944
    v_lshlrev_b32 v7, 4, v0
    s_mov_b32 s46, 4194304
    s_mov_b32 s47, 0x20000
    s_mov_b32 s44, s52
    s_mov_b32 s45, s53
    s_mov_b32 s27, s26
    buffer_load_dwordx4 v[128:131], v7, s[44:47], s27 offen
    s_add_u32 s27, s27, 4096
    buffer_load_dwordx4 v[132:135], v7, s[44:47], s27 offen
    s_add_u32 s27, s27, 4096
    buffer_load_dwordx4 v[136:139], v7, s[44:47], s27 offen
    s_add_u32 s27, s27, 4096
    buffer_load_dwordx4 v[140:143], v7, s[44:47], s27 offen
    s_add_u32 s27, s27, 4096
    buffer_load_dwordx4 v[144:147], v7, s[44:47], s27 offen
    s_add_u32 s27, s27, 4096
    s_lshl_b32 s24, s17, 10
    s_add_u32 m0, s24, 65536
    s_mov_b32 s25, 2097152
    s_waitcnt vmcnt(3)
    buffer_load_dwordx4 v8, s[8:11], s25 offen lds
    s_add_u32 m0, s24, 69632
    s_mov_b32 s25, 2228224
    s_waitcnt vmcnt(3)
    buffer_load_dwordx4 v8, s[8:11], s25 offen lds
    s_add_u32 m0, s24, 73728
    s_mov_b32 s25, 2359296
    s_waitcnt vmcnt(3)
    buffer_load_dwordx4 v8, s[8:11], s25 offen lds
    s_add_u32 m0, s24, 77824
    s_mov_b32 s25, 2490368
    s_waitcnt vmcnt(3)
    buffer_load_dwordx4 v8, s[8:11], s25 offen lds
    s_add_u32 m0, s24, 81920
    s_mov_b32 s25, 2621440
    s_waitcnt vmcnt(3)
    buffer_load_dwordx4 v8, s[8:11], s25 offen lds
    s_add_u32 m0, s24, 86016
    s_mov_b32 s25, 2752512
    s_waitcnt vmcnt(3)
    buffer_load_dwordx4 v8, s[8:11], s25 offen lds
    s_add_u32 m0, s24, 90112
    s_mov_b32 s25, 2883584
    s_waitcnt vmcnt(3)
    buffer_load_dwordx4 v8, s[8:11], s25 offen lds
    s_add_u32 m0, s24, 94208
    s_mov_b32 s25, 3014656
    s_waitcnt vmcnt(3)
    buffer_load_dwordx4 v8, s[8:11], s25 offen lds
    s_add_u32 m0, s24, 98304
    s_mov_b32 s25, 3145728
    s_waitcnt vmcnt(3)
    buffer_load_dwordx4 v8, s[8:11], s25 offen lds
    s_add_u32 m0, s24, 102400
    s_mov_b32 s25, 3276800
    s_waitcnt vmcnt(3)
    buffer_load_dwordx4 v8, s[8:11], s25 offen lds
    s_add_u32 m0, s24, 106496
    s_mov_b32 s25, 3407872
    s_waitcnt vmcnt(3)
    buffer_load_dwordx4 v8, s[8:11], s25 offen lds
    s_add_u32 m0, s24, 110592
    s_mov_b32 s25, 3538944
    s_waitcnt vmcnt(3)
    buffer_load_dwordx4 v8, s[8:11], s25 offen lds
    s_add_u32 m0, s24, 114688
    s_mov_b32 s25, 3670016
    s_waitcnt vmcnt(3)
    buffer_load_dwordx4 v8, s[8:11], s25 offen lds
    s_add_u32 m0, s24, 118784
    s_mov_b32 s25, 3801088
    s_waitcnt vmcnt(3)
    buffer_load_dwordx4 v8, s[8:11], s25 offen lds
    s_add_u32 m0, s24, 122880
    s_mov_b32 s25, 3932160
    s_waitcnt vmcnt(3)
    buffer_load_dwordx4 v8, s[8:11], s25 offen lds
    s_add_u32 m0, s24, 126976
    s_mov_b32 s25, 4063232
    s_waitcnt vmcnt(3)
    buffer_load_dwordx4 v8, s[8:11], s25 offen lds
    v_xor_b32 v12, v3, v2
    v_lshlrev_b32 v12, 4, v12
    v_lshl_add_u32 v12, v2, 10, v12
    v_xor_b32 v13, 64, v12
    v_xor_b32 v14, 128, v12
    v_xor_b32 v15, 192, v12
    s_cmp_ge_u32 s39, 6
    s_cselect_b32 s24, 2, 1
    s_cselect_b32 s56, 2, 8
    s_cselect_b32 s59, 4, 0
    s_sub_u32 s33, s39, s24
    s_lshl_b32 s24, s16, 7
    s_add_u32 s24, s24, 32768
    v_mov_b32 v22, s24
    v_mov_b32 v19, 163824
    s_waitcnt vmcnt(16)
    s_barrier
    ds_read_b64_tr_b16 a[0:1], v10 offset:0
    ds_read_b64_tr_b16 a[2:3], v10 offset:1024
    ds_read_b64_tr_b16 a[4:5], v10 offset:8192
    ds_read_b64_tr_b16 a[6:7], v10 offset:9216
    ds_read_b64_tr_b16 a[8:9], v10 offset:16384
    ds_read_b64_tr_b16 a[10:11], v10 offset:17408
    ds_read_b64_tr_b16 a[12:13], v10 offset:24576
    ds_read_b64_tr_b16 a[14:15], v10 offset:25600
    ds_read_b64_tr_b16 a[16:17], v10 offset:32768
    ds_read_b64_tr_b16 a[18:19], v10 offset:33792
    ds_read_b64_tr_b16 a[20:21], v10 offset:40960
    ds_read_b64_tr_b16 a[22:23], v10 offset:41984
    ds_read_b64_tr_b16 a[24:25], v10 offset:49152
    ds_read_b64_tr_b16 a[26:27], v10 offset:50176
    ds_read_b64_tr_b16 a[28:29], v10 offset:57344
    ds_read_b64_tr_b16 a[30:31], v10 offset:58368
    ds_read_b64_tr_b16 a[64:65], v11 offset:0
    ds_read_b64_tr_b16 a[66:67], v11 offset:1024
    ds_read_b64_tr_b16 a[68:69], v11 offset:8192
    ds_read_b64_tr_b16 a[70:71], v11 offset:9216
    ds_read_b64_tr_b16 a[72:73], v11 offset:16384
    ds_read_b64_tr_b16 a[74:75], v11 offset:17408
    ds_read_b64_tr_b16 a[76:77], v11 offset:24576
    ds_read_b64_tr_b16 a[78:79], v11 offset:25600
    ds_read_b64_tr_b16 a[80:81], v11 offset:32768
    ds_read_b64_tr_b16 a[82:83], v11 offset:33792
    ds_read_b64_tr_b16 a[84:85], v11 offset:40960
    ds_read_b64_tr_b16 a[86:87], v11 offset:41984
    ds_read_b64_tr_b16 a[88:89], v11 offset:49152
    ds_read_b64_tr_b16 a[90:91], v11 offset:50176
    ds_read_b64_tr_b16 a[92:93], v11 offset:57344
    ds_read_b64_tr_b16 a[94:95], v11 offset:58368
    s_waitcnt lgkmcnt(0)
    v_xor_b32 v10, 0x10000, v10
    v_xor_b32 v11, 0x10000, v11
    s_barrier
    s_load_dwordx2 s[8:9], s[0:1], 32
    s_mov_b32 s10, 4194304
    s_mov_b32 s11, 0x20000
    s_waitcnt lgkmcnt(0)
    s_lshl_b32 s26, s39, 5
    s_add_u32 s26, s26, s16
    s_sub_u32 s26, s26, 32
    s_mul_i32 s26, s26, 18944
    v_lshlrev_b32 v7, 4, v0
    s_mov_b32 s46, 4194304
    s_mov_b32 s47, 0x20000
    s_mov_b32 s44, s48
    s_mov_b32 s45, s49
    s_mov_b32 s27, s26
    buffer_load_dwordx4 v[128:131], v7, s[44:47], s27 offen
    s_add_u32 s27, s27, 4096
    buffer_load_dwordx4 v[132:135], v7, s[44:47], s27 offen
    s_add_u32 s27, s27, 4096
    buffer_load_dwordx4 v[136:139], v7, s[44:47], s27 offen
    s_add_u32 s27, s27, 4096
    buffer_load_dwordx4 v[140:143], v7, s[44:47], s27 offen
    s_add_u32 s27, s27, 4096
    buffer_load_dwordx4 v[144:147], v7, s[44:47], s27 offen
    s_add_u32 s27, s27, 4096
    s_mov_b32 s44, s54
    s_mov_b32 s45, s55
    s_mov_b32 s27, s26
    buffer_load_dwordx4 v[148:151], v7, s[44:47], s27 offen
    s_add_u32 s27, s27, 4096
    buffer_load_dwordx4 v[152:155], v7, s[44:47], s27 offen
    s_add_u32 s27, s27, 4096
    buffer_load_dwordx4 v[156:159], v7, s[44:47], s27 offen
    s_add_u32 s27, s27, 4096
    buffer_load_dwordx4 v[160:163], v7, s[44:47], s27 offen
    s_add_u32 s27, s27, 4096
    buffer_load_dwordx4 v[164:167], v7, s[44:47], s27 offen
    s_add_u32 s27, s27, 4096
    s_lshl_b32 s24, s17, 10
    s_add_u32 m0, s24, 0
    s_mov_b32 s25, 0
    s_waitcnt vmcnt(3)
    buffer_load_dwordx4 v8, s[8:11], s25 offen lds
    s_add_u32 m0, s24, 4096
    s_mov_b32 s25, 131072
    s_waitcnt vmcnt(3)
    buffer_load_dwordx4 v8, s[8:11], s25 offen lds
    s_add_u32 m0, s24, 8192
    s_mov_b32 s25, 262144
    s_waitcnt vmcnt(3)
    buffer_load_dwordx4 v8, s[8:11], s25 offen lds
    s_add_u32 m0, s24, 12288
    s_mov_b32 s25, 393216
    s_waitcnt vmcnt(3)
    buffer_load_dwordx4 v8, s[8:11], s25 offen lds
    s_add_u32 m0, s24, 16384
    s_mov_b32 s25, 524288
    s_waitcnt vmcnt(3)
    buffer_load_dwordx4 v8, s[8:11], s25 offen lds
    s_add_u32 m0, s24, 20480
    s_mov_b32 s25, 655360
    s_waitcnt vmcnt(3)
    buffer_load_dwordx4 v8, s[8:11], s25 offen lds
    s_add_u32 m0, s24, 24576
    s_mov_b32 s25, 786432
    s_waitcnt vmcnt(3)
    buffer_load_dwordx4 v8, s[8:11], s25 offen lds
    s_add_u32 m0, s24, 28672
    s_mov_b32 s25, 917504
    s_waitcnt vmcnt(3)
    buffer_load_dwordx4 v8, s[8:11], s25 offen lds
    s_add_u32 m0, s24, 32768
    s_mov_b32 s25, 1048576
    s_waitcnt vmcnt(3)
    buffer_load_dwordx4 v8, s[8:11], s25 offen lds
    s_add_u32 m0, s24, 36864
    s_mov_b32 s25, 1179648
    s_waitcnt vmcnt(3)
    buffer_load_dwordx4 v8, s[8:11], s25 offen lds
    s_add_u32 m0, s24, 40960
    s_mov_b32 s25, 1310720
    s_waitcnt vmcnt(3)
    buffer_load_dwordx4 v8, s[8:11], s25 offen lds
    s_add_u32 m0, s24, 45056
    s_mov_b32 s25, 1441792
    s_waitcnt vmcnt(3)
    buffer_load_dwordx4 v8, s[8:11], s25 offen lds
    s_add_u32 m0, s24, 49152
    s_mov_b32 s25, 1572864
    s_waitcnt vmcnt(3)
    buffer_load_dwordx4 v8, s[8:11], s25 offen lds
    s_add_u32 m0, s24, 53248
    s_mov_b32 s25, 1703936
    s_waitcnt vmcnt(3)
    buffer_load_dwordx4 v8, s[8:11], s25 offen lds
    s_add_u32 m0, s24, 57344
    s_mov_b32 s25, 1835008
    s_waitcnt vmcnt(3)
    buffer_load_dwordx4 v8, s[8:11], s25 offen lds
    s_add_u32 m0, s24, 61440
    s_mov_b32 s25, 1966080
    s_waitcnt vmcnt(3)
    buffer_load_dwordx4 v8, s[8:11], s25 offen lds
    s_waitcnt vmcnt(16)
    s_barrier
    ds_read_b64_tr_b16 a[32:33], v10 offset:0
    ds_read_b64_tr_b16 a[34:35], v10 offset:1024
    ds_read_b64_tr_b16 a[36:37], v10 offset:8192
    ds_read_b64_tr_b16 a[38:39], v10 offset:9216
    ds_read_b64_tr_b16 a[40:41], v10 offset:16384
    ds_read_b64_tr_b16 a[42:43], v10 offset:17408
    ds_read_b64_tr_b16 a[44:45], v10 offset:24576
    ds_read_b64_tr_b16 a[46:47], v10 offset:25600
    ds_read_b64_tr_b16 a[48:49], v10 offset:32768
    ds_read_b64_tr_b16 a[50:51], v10 offset:33792
    ds_read_b64_tr_b16 a[52:53], v10 offset:40960
    ds_read_b64_tr_b16 a[54:55], v10 offset:41984
    ds_read_b64_tr_b16 a[56:57], v10 offset:49152
    ds_read_b64_tr_b16 a[58:59], v10 offset:50176
    ds_read_b64_tr_b16 a[60:61], v10 offset:57344
    ds_read_b64_tr_b16 a[62:63], v10 offset:58368
    ds_read_b64_tr_b16 a[96:97], v11 offset:0
    ds_read_b64_tr_b16 a[98:99], v11 offset:1024
    ds_read_b64_tr_b16 a[100:101], v11 offset:8192
    ds_read_b64_tr_b16 a[102:103], v11 offset:9216
    ds_read_b64_tr_b16 a[104:105], v11 offset:16384
    ds_read_b64_tr_b16 a[106:107], v11 offset:17408
    ds_read_b64_tr_b16 a[108:109], v11 offset:24576
    ds_read_b64_tr_b16 a[110:111], v11 offset:25600
    ds_read_b64_tr_b16 a[112:113], v11 offset:32768
    ds_read_b64_tr_b16 a[114:115], v11 offset:33792
    ds_read_b64_tr_b16 a[116:117], v11 offset:40960
    ds_read_b64_tr_b16 a[118:119], v11 offset:41984
    ds_read_b64_tr_b16 a[120:121], v11 offset:49152
    ds_read_b64_tr_b16 a[122:123], v11 offset:50176
    ds_read_b64_tr_b16 a[124:125], v11 offset:57344
    ds_read_b64_tr_b16 a[126:127], v11 offset:58368
    s_waitcnt lgkmcnt(0)
    v_xor_b32 v10, 0x10000, v10
    v_xor_b32 v11, 0x10000, v11
    s_barrier
    s_cmp_lg_u32 s17, 0
    s_cbranch_scc1 wte_9
    v_mov_b32 v21, 200
wt_8:
    buffer_load_dword v20, v21, s[12:15], 0 offen sc1
    s_add_u32 s23, s23, 1
    s_waitcnt vmcnt(0)
    v_readfirstlane_b32 s24, v20
    s_cmp_gt_u32 s23, 262144
    s_cbranch_scc1 wte_9
    s_cmp_ge_u32 s24, 64
    s_cbranch_scc1 wte_9
    s_sleep 2
    s_branch wt_8
wte_9:
    s_cmp_lg_u32 s17, 0
    s_cbranch_scc1 tk_10
    v_mov_b32 v23, 1
    s_mov_b64 exec, 1
    buffer_atomic_add v23, v22, s[4:7], 0 offen sc0
    s_mov_b64 exec, -1
tk_10:
    s_lshl_b32 s26, s39, 5
    s_add_u32 s26, s26, s16
    s_sub_u32 s26, s26, 32
    s_mul_i32 s26, s26, 18944
    v_lshlrev_b32 v7, 4, v0
    s_mov_b32 s46, 4194304
    s_mov_b32 s47, 0x20000
    s_load_dwordx2 s[44:45], s[0:1], 64
    s_mov_b32 s46, 1409024
    s_lshl_b32 s27, s39, 5
    s_add_u32 s27, s27, s16
    s_sub_u32 s27, s27, 32
    s_mul_i32 s27, s27, 6400
    s_add_u32 s26, s27, 4096
    s_waitcnt lgkmcnt(0)
    buffer_load_dwordx4 v[128:131], v7, s[44:47], s27 offen
    buffer_load_dwordx4 v[128:131], v7, s[44:47], s26 offen
    s_lshl_b32 s24, s17, 10
    s_add_u32 m0, s24, 65536
    s_mov_b32 s25, 2097152
    s_waitcnt vmcnt(3)
    buffer_load_dwordx4 v8, s[8:11], s25 offen lds
    s_add_u32 m0, s24, 69632
    s_mov_b32 s25, 2228224
    s_waitcnt vmcnt(3)
    buffer_load_dwordx4 v8, s[8:11], s25 offen lds
    s_add_u32 m0, s24, 73728
    s_mov_b32 s25, 2359296
    s_waitcnt vmcnt(3)
    buffer_load_dwordx4 v8, s[8:11], s25 offen lds
    s_add_u32 m0, s24, 77824
    s_mov_b32 s25, 2490368
    s_waitcnt vmcnt(3)
    buffer_load_dwordx4 v8, s[8:11], s25 offen lds
    s_add_u32 m0, s24, 81920
    s_mov_b32 s25, 2621440
    s_waitcnt vmcnt(3)
    buffer_load_dwordx4 v8, s[8:11], s25 offen lds
    s_add_u32 m0, s24, 86016
    s_mov_b32 s25, 2752512
    s_waitcnt vmcnt(3)
    buffer_load_dwordx4 v8, s[8:11], s25 offen lds
    s_add_u32 m0, s24, 90112
    s_mov_b32 s25, 2883584
    s_waitcnt vmcnt(3)
    buffer_load_dwordx4 v8, s[8:11], s25 offen lds
    s_add_u32 m0, s24, 94208
    s_mov_b32 s25, 3014656
    s_waitcnt vmcnt(3)
    buffer_load_dwordx4 v8, s[8:11], s25 offen lds
    s_add_u32 m0, s24, 98304
    s_mov_b32 s25, 3145728
    s_waitcnt vmcnt(3)
    buffer_load_dwordx4 v8, s[8:11], s25 offen lds
    s_add_u32 m0, s24, 102400
    s_mov_b32 s25, 3276800
    s_waitcnt vmcnt(3)
    buffer_load_dwordx4 v8, s[8:11], s25 offen lds
    s_add_u32 m0, s24, 106496
    s_mov_b32 s25, 3407872
    s_waitcnt vmcnt(3)
    buffer_load_dwordx4 v8, s[8:11], s25 offen lds
    s_add_u32 m0, s24, 110592
    s_mov_b32 s25, 3538944
    s_waitcnt vmcnt(3)
    buffer_load_dwordx4 v8, s[8:11], s25 offen lds
    s_add_u32 m0, s24, 114688
    s_mov_b32 s25, 3670016
    s_waitcnt vmcnt(3)
    buffer_load_dwordx4 v8, s[8:11], s25 offen lds
    s_add_u32 m0, s24, 118784
    s_mov_b32 s25, 3801088
    s_waitcnt vmcnt(3)
    buffer_load_dwordx4 v8, s[8:11], s25 offen lds
    s_add_u32 m0, s24, 122880
    s_mov_b32 s25, 3932160
    s_waitcnt vmcnt(3)
    buffer_load_dwordx4 v8, s[8:11], s25 offen lds
    s_add_u32 m0, s24, 126976
    s_mov_b32 s25, 4063232
    s_waitcnt vmcnt(3)
    buffer_load_dwordx4 v8, s[8:11], s25 offen lds
    s_waitcnt vmcnt(16)
    s_cmp_lg_u32 s17, 0
    s_cbranch_scc1 tk_11
    s_mov_b64 exec, 1
    ds_write_b32 v19, v23
    s_mov_b64 exec, -1
    s_waitcnt lgkmcnt(0)
tk_11:
    s_barrier
    ds_read_b32 v20, v19
    v_xor_b32 v19, 8, v19
    s_waitcnt lgkmcnt(0)
    v_readfirstlane_b32 s18, v20
    ds_read_b64_tr_b16 a[128:129], v10 offset:0
    ds_read_b64_tr_b16 a[130:131], v10 offset:1024
    ds_read_b64_tr_b16 a[132:133], v10 offset:8192
    ds_read_b64_tr_b16 a[134:135], v10 offset:9216
    ds_read_b64_tr_b16 a[136:137], v10 offset:16384
    ds_read_b64_tr_b16 a[138:139], v10 offset:17408
    ds_read_b64_tr_b16 a[140:141], v10 offset:24576
    ds_read_b64_tr_b16 a[142:143], v10 offset:25600
    ds_read_b64_tr_b16 a[144:145], v10 offset:32768
    ds_read_b64_tr_b16 a[146:147], v10 offset:33792
    ds_read_b64_tr_b16 a[148:149], v10 offset:40960
    ds_read_b64_tr_b16 a[150:151], v10 offset:41984
    ds_read_b64_tr_b16 a[152:153], v10 offset:49152
    ds_read_b64_tr_b16 a[154:155], v10 offset:50176
    ds_read_b64_tr_b16 a[156:157], v10 offset:57344
    ds_read_b64_tr_b16 a[158:159], v10 offset:58368
    ds_read_b64_tr_b16 a[192:193], v11 offset:0
    ds_read_b64_tr_b16 a[194:195], v11 offset:1024
    ds_read_b64_tr_b16 a[196:197], v11 offset:8192
    ds_read_b64_tr_b16 a[198:199], v11 offset:9216
    ds_read_b64_tr_b16 a[200:201], v11 offset:16384
    ds_read_b64_tr_b16 a[202:203], v11 offset:17408
    ds_read_b64_tr_b16 a[204:205], v11 offset:24576
    ds_read_b64_tr_b16 a[206:207], v11 offset:25600
    ds_read_b64_tr_b16 a[208:209], v11 offset:32768
    ds_read_b64_tr_b16 a[210:211], v11 offset:33792
    ds_read_b64_tr_b16 a[212:213], v11 offset:40960
    ds_read_b64_tr_b16 a[214:215], v11 offset:41984
    ds_read_b64_tr_b16 a[216:217], v11 offset:49152
    ds_read_b64_tr_b16 a[218:219], v11 offset:50176
    ds_read_b64_tr_b16 a[220:221], v11 offset:57344
    ds_read_b64_tr_b16 a[222:223], v11 offset:58368
    s_waitcnt lgkmcnt(0)
    v_xor_b32 v10, 0x10000, v10
    v_xor_b32 v11, 0x10000, v11
    s_barrier
    s_lshl_b32 s21, s18, 15
    s_add_u32 s21, s21, 52428800
    s_cmp_ge_u32 s18, 64
    s_cselect_b32 s21, 1073741824, s21
    s_mov_b32 s19, 0
    s_lshl_b32 s24, s17, 13
    s_add_u32 s25, s24, s21
    s_and_b32 s26, s17, 1
    s_lshl_b32 s26, s26, 7
    s_add_u32 s27, s26, 0
    v_xor_b32 v16, s27, v6
    s_add_u32 m0, s24, 0
    s_nop 0
    buffer_load_dwordx4 v16, s[4:7], s25 offen sc1 lds
    s_add_u32 s25, s25, 1024
    s_add_u32 s27, s26, 16
    v_xor_b32 v16, s27, v6
    s_add_u32 m0, s24, 1024
    s_nop 0
    buffer_load_dwordx4 v16, s[4:7], s25 offen sc1 lds
    s_add_u32 s25, s25, 1024
    s_add_u32 s27, s26, 32
    v_xor_b32 v16, s27, v6
    s_add_u32 m0, s24, 2048
    s_nop 0
    buffer_load_dwordx4 v16, s[4:7], s25 offen sc1 lds
    s_add_u32 s25, s25, 1024
    s_add_u32 s27, s26, 48
    v_xor_b32 v16, s27, v6
    s_add_u32 m0, s24, 3072
    s_nop 0
    buffer_load_dwordx4 v16, s[4:7], s25 offen sc1 lds
    s_add_u32 s25, s25, 1024
    s_add_u32 s27, s26, 64
    v_xor_b32 v16, s27, v6
    s_add_u32 m0, s24, 4096
    s_nop 0
    buffer_load_dwordx4 v16, s[4:7], s25 offen sc1 lds
    s_add_u32 s25, s25, 1024
    s_add_u32 s27, s26, 80
    v_xor_b32 v16, s27, v6
    s_add_u32 m0, s24, 5120
    s_nop 0
    buffer_load_dwordx4 v16, s[4:7], s25 offen sc1 lds
    s_add_u32 s25, s25, 1024
    s_add_u32 s27, s26, 96
    v_xor_b32 v16, s27, v6
    s_add_u32 m0, s24, 6144
    s_nop 0
    buffer_load_dwordx4 v16, s[4:7], s25 offen sc1 lds
    s_add_u32 s25, s25, 1024
    s_add_u32 s27, s26, 112
    v_xor_b32 v16, s27, v6
    s_add_u32 m0, s24, 7168
    s_nop 0
    buffer_load_dwordx4 v16, s[4:7], s25 offen sc1 lds
    s_add_u32 s25, s25, 1024
    s_waitcnt vmcnt(0)
    s_barrier
    ds_read_b64_tr_b16 a[160:161], v10 offset:0
    ds_read_b64_tr_b16 a[162:163], v10 offset:1024
    ds_read_b64_tr_b16 a[164:165], v10 offset:8192
    ds_read_b64_tr_b16 a[166:167], v10 offset:9216
    ds_read_b64_tr_b16 a[168:169], v10 offset:16384
    ds_read_b64_tr_b16 a[170:171], v10 offset:17408
    ds_read_b64_tr_b16 a[172:173], v10 offset:24576
    ds_read_b64_tr_b16 a[174:175], v10 offset:25600
    ds_read_b64_tr_b16 a[176:177], v10 offset:32768
    ds_read_b64_tr_b16 a[178:179], v10 offset:33792
    ds_read_b64_tr_b16 a[180:181], v10 offset:40960
    ds_read_b64_tr_b16 a[182:183], v10 offset:41984
    ds_read_b64_tr_b16 a[184:185], v10 offset:49152
    ds_read_b64_tr_b16 a[186:187], v10 offset:50176
    ds_read_b64_tr_b16 a[188:189], v10 offset:57344
    ds_read_b64_tr_b16 a[190:191], v10 offset:58368
    ds_read_b64_tr_b16 a[224:225], v11 offset:0
    ds_read_b64_tr_b16 a[226:227], v11 offset:1024
    ds_read_b64_tr_b16 a[228:229], v11 offset:8192
    ds_read_b64_tr_b16 a[230:231], v11 offset:9216
    ds_read_b64_tr_b16 a[232:233], v11 offset:16384
    ds_read_b64_tr_b16 a[234:235], v11 offset:17408
    ds_read_b64_tr_b16 a[236:237], v11 offset:24576
    ds_read_b64_tr_b16 a[238:239], v11 offset:25600
    ds_read_b64_tr_b16 a[240:241], v11 offset:32768
    ds_read_b64_tr_b16 a[242:243], v11 offset:33792
    ds_read_b64_tr_b16 a[244:245], v11 offset:40960
    ds_read_b64_tr_b16 a[246:247], v11 offset:41984
    ds_read_b64_tr_b16 a[248:249], v11 offset:49152
    ds_read_b64_tr_b16 a[250:251], v11 offset:50176
    ds_read_b64_tr_b16 a[252:253], v11 offset:57344
    ds_read_b64_tr_b16 a[254:255], v11 offset:58368
    s_waitcnt lgkmcnt(0)
    v_xor_b32 v10, 0x10000, v10
    v_xor_b32 v11, 0x10000, v11
    s_barrier
    s_mov_b32 s20, 0
    v_mov_b32 v104, -1
    v_mov_b32 v105, -1
    v_mov_b32 v106, -1
    v_mov_b32 v107, -1
    s_mov_b32 s57, 64
    s_mov_b32 s58, 64
    s_lshl_b32 s28, s16, 17
    s_lshl_b32 s24, s17, 6
    v_xor_b32 v18, s24, v6
    s_lshl_b32 s24, s17, 10
    s_add_u32 s24, s24, s28
    v_add_u32 v18, s24, v18
    v_lshl_add_u32 v108, v3, 2, v4
    v_lshlrev_b32 v108, 10, v108
    v_lshl_add_u32 v108, v4, 6, v108
    v_lshl_add_u32 v108, v5, 4, v108
    s_lshl_b32 s24, s17, 8
    v_add_u32 v108, s24, v108
    v_xor_b32 v109, 64, v108
    v_xor_b32 v110, 128, v108
    v_xor_b32 v111, 192, v108
    s_mov_b32 s40, s48
    s_mov_b32 s41, s49
    s_mov_b32 s42, 4194304
    s_mov_b32 s43, 0x20000
    s_mov_b64 vcc, 0
    v_mov_b32 v17, v8
    s_mov_b32 s32, 131072
    s_mov_b32 s31, 0
    s_mov_b32 s30, 65536
    v_xor_b32 v10, 0x10000, v10
    v_xor_b32 v11, 0x10000, v11
H1_loop:
    s_cmp_gt_u32 s20, 1
    s_cbranch_scc1 H1_lag
    s_waitcnt vmcnt(0)
    s_mov_b32 s58, s57
H1_lag:
    s_waitcnt vmcnt(5)
    s_barrier
    s_add_u32 s33, s33, s56
    s_xor_b32 s56, s56, s59
    s_cmp_ge_u32 s58, 64
    s_cbranch_scc1 fl_12
    s_lshl_b32 s28, s16, 6
    s_add_u32 s28, s28, s58
    s_lshl_b32 s28, s28, 2
    s_cmp_lg_u32 s17, 0
    s_cbranch_scc1 sig_13
    v_mov_b32 v20, 1
    v_mov_b32 v21, s28
    s_mov_b64 exec, 1
    buffer_store_dword v20, v21, s[4:7], 0 offen sc1
    s_mov_b64 exec, -1
sig_13:
fl_12:
    s_cmp_eq_u32 s20, 1
    s_cbranch_scc0 H1_np2
    v_mov_b32 v21, 212
wt_14:
    buffer_load_dword v20, v21, s[12:15], 0 offen sc1
    s_add_u32 s23, s23, 1
    s_waitcnt vmcnt(0)
    v_readfirstlane_b32 s24, v20
    s_cmp_gt_u32 s23, 262144
    s_cbranch_scc1 wte_15
    s_cmp_ge_u32 s24, 64
    s_cbranch_scc1 wte_15
    s_sleep 2
    s_branch wt_14
wte_15:
H1_np2:
    s_cmp_lt_u32 s39, 6
    s_cbranch_scc1 H1_bgh
    s_cmp_eq_u32 s20, 10
    s_cbranch_scc1 H1_bge
    s_cmp_lg_u32 s20, 6
    s_cbranch_scc1 H1_bga2
    s_load_dwordx2 s[40:41], s[0:1], 72
    s_mov_b32 s42, 8388608
    v_lshlrev_b32 v17, 4, v0
    s_mov_b32 s32, 4096
    s_lshl_b32 s31, s39, 5
    s_add_u32 s31, s31, s16
    s_sub_u32 s31, s31, 192
    s_lshl_b32 s31, s31, 17
    s_waitcnt lgkmcnt(0)
    s_mov_b64 vcc, -1
    s_branch H1_bga2
H1_bgh:
    s_cmp_eq_u32 s20, 1
    s_cbranch_scc1 H1_bga
    s_cmp_eq_u32 s20, 3
    s_cbranch_scc1 H1_bgb
    s_cmp_eq_u32 s20, 5
    s_cbranch_scc1 H1_bgc
    s_cmp_eq_u32 s20, 8
    s_cbranch_scc1 H1_bge
    s_branch H1_bgd
H1_bge:
    s_mov_b64 vcc, 0
    s_branch H1_bgd
H1_bgc:
    ds_read_b64_tr_b16 v[160:161], v10 offset:0
    ds_read_b64_tr_b16 v[162:163], v10 offset:1024
    ds_read_b64_tr_b16 v[164:165], v10 offset:8192
    ds_read_b64_tr_b16 v[166:167], v10 offset:9216
    ds_read_b64_tr_b16 v[168:169], v10 offset:16384
    ds_read_b64_tr_b16 v[170:171], v10 offset:17408
    ds_read_b64_tr_b16 v[172:173], v10 offset:24576
    ds_read_b64_tr_b16 v[174:175], v10 offset:25600
    ds_read_b64_tr_b16 v[176:177], v10 offset:32768
    ds_read_b64_tr_b16 v[178:179], v10 offset:33792
    ds_read_b64_tr_b16 v[180:181], v10 offset:40960
    ds_read_b64_tr_b16 v[182:183], v10 offset:41984
    ds_read_b64_tr_b16 v[184:185], v10 offset:49152
    ds_read_b64_tr_b16 v[186:187], v10 offset:50176
    ds_read_b64_tr_b16 v[188:189], v10 offset:57344
    ds_read_b64_tr_b16 v[190:191], v10 offset:58368
    ds_read_b64_tr_b16 v[224:225], v11 offset:0
    ds_read_b64_tr_b16 v[226:227], v11 offset:1024
    ds_read_b64_tr_b16 v[228:229], v11 offset:8192
    ds_read_b64_tr_b16 v[230:231], v11 offset:9216
    ds_read_b64_tr_b16 v[232:233], v11 offset:16384
    ds_read_b64_tr_b16 v[234:235], v11 offset:17408
    ds_read_b64_tr_b16 v[236:237], v11 offset:24576
    ds_read_b64_tr_b16 v[238:239], v11 offset:25600
    ds_read_b64_tr_b16 v[240:241], v11 offset:32768
    ds_read_b64_tr_b16 v[242:243], v11 offset:33792
    ds_read_b64_tr_b16 v[244:245], v11 offset:40960
    ds_read_b64_tr_b16 v[246:247], v11 offset:41984
    ds_read_b64_tr_b16 v[248:249], v11 offset:49152
    ds_read_b64_tr_b16 v[250:251], v11 offset:50176
    ds_read_b64_tr_b16 v[252:253], v11 offset:57344
    ds_read_b64_tr_b16 v[254:255], v11 offset:58368
    s_waitcnt lgkmcnt(0)
    s_barrier
    s_mov_b32 s40, s54
    s_mov_b32 s41, s55
    v_mov_b32 v17, v18
    s_mov_b32 s32, 4096
    s_mov_b32 s31, 0
    s_branch H1_bga2
H1_bgb:
    ds_read_b64_tr_b16 v[128:129], v10 offset:0
    ds_read_b64_tr_b16 v[130:131], v10 offset:1024
    ds_read_b64_tr_b16 v[132:133], v10 offset:8192
    ds_read_b64_tr_b16 v[134:135], v10 offset:9216
    ds_read_b64_tr_b16 v[136:137], v10 offset:16384
    ds_read_b64_tr_b16 v[138:139], v10 offset:17408
    ds_read_b64_tr_b16 v[140:141], v10 offset:24576
    ds_read_b64_tr_b16 v[142:143], v10 offset:25600
    ds_read_b64_tr_b16 v[144:145], v10 offset:32768
    ds_read_b64_tr_b16 v[146:147], v10 offset:33792
    ds_read_b64_tr_b16 v[148:149], v10 offset:40960
    ds_read_b64_tr_b16 v[150:151], v10 offset:41984
    ds_read_b64_tr_b16 v[152:153], v10 offset:49152
    ds_read_b64_tr_b16 v[154:155], v10 offset:50176
    ds_read_b64_tr_b16 v[156:157], v10 offset:57344
    ds_read_b64_tr_b16 v[158:159], v10 offset:58368
    ds_read_b64_tr_b16 v[192:193], v11 offset:0
    ds_read_b64_tr_b16 v[194:195], v11 offset:1024
    ds_read_b64_tr_b16 v[196:197], v11 offset:8192
    ds_read_b64_tr_b16 v[198:199], v11 offset:9216
    ds_read_b64_tr_b16 v[200:201], v11 offset:16384
    ds_read_b64_tr_b16 v[202:203], v11 offset:17408
    ds_read_b64_tr_b16 v[204:205], v11 offset:24576
    ds_read_b64_tr_b16 v[206:207], v11 offset:25600
    ds_read_b64_tr_b16 v[208:209], v11 offset:32768
    ds_read_b64_tr_b16 v[210:211], v11 offset:33792
    ds_read_b64_tr_b16 v[212:213], v11 offset:40960
    ds_read_b64_tr_b16 v[214:215], v11 offset:41984
    ds_read_b64_tr_b16 v[216:217], v11 offset:49152
    ds_read_b64_tr_b16 v[218:219], v11 offset:50176
    ds_read_b64_tr_b16 v[220:221], v11 offset:57344
    ds_read_b64_tr_b16 v[222:223], v11 offset:58368
    s_waitcnt lgkmcnt(0)
    s_barrier
    s_branch H1_bga2
H1_bga:
    s_mov_b64 vcc, -1
    s_mov_b32 s31, 0
H1_bga2:
    s_lshl_b32 s30, s17, 10
    s_add_u32 s30, s30, 65536
H1_bgd:
    s_lshl_b32 s21, s33, 15
    s_add_u32 s21, s21, 52428800
    s_xor_b32 s19, s19, 32768
    s_cmp_ge_u32 s33, 64
    s_cselect_b32 s21, 1073741824, s21
    s_lshl_b32 s34, s17, 13
    s_add_u32 s35, s34, s21
    s_add_u32 s34, s34, s19
    s_and_b32 s36, s17, 1
    s_lshl_b32 s36, s36, 7
    ds_read_b128 v[24:27], v12 offset:0
    ds_read_b128 v[28:31], v12 offset:16384
    ds_read_b128 v[32:35], v13 offset:0
    ds_read_b128 v[36:39], v13 offset:16384
    ds_read_b128 v[40:43], v14 offset:0
    ds_read_b128 v[44:47], v14 offset:16384
    s_waitcnt lgkmcnt(4)
    v_mfma_f32_16x16x32_bf16 v[56:59], a[0:3], v[24:27], 0
    ds_read_b128 v[48:51], v15 offset:0
    v_mfma_f32_16x16x32_bf16 v[72:75], v[24:27], a[128:131], 0
    ds_read_b128 v[52:55], v15 offset:16384
    v_mfma_f32_16x16x32_bf16 v[64:67], a[0:3], v[28:31], 0
    s_mov_b32 m0, s34
    s_add_u32 s34, s34, 1024
    v_xor_b32 v16, s36, v6
    v_mfma_f32_16x16x32_bf16 v[76:79], v[28:31], a[128:131], 0
    buffer_load_dwordx4 v16, s[4:7], s35 offen sc1 lds
    s_add_u32 s35, s35, 1024
    s_add_u32 s36, s36, 16
    v_mfma_f32_16x16x32_bf16 v[60:63], a[64:67], v[24:27], 0
    v_mfma_f32_16x16x32_bf16 v[80:83], v[24:27], a[192:195], 0
    v_mfma_f32_16x16x32_bf16 v[68:71], a[64:67], v[28:31], 0
    s_mov_b32 m0, s30
    s_add_u32 s30, s30, 4096
    v_mfma_f32_16x16x32_bf16 v[84:87], v[28:31], a[192:195], 0
    s_cbranch_vccz H1_nb0
    buffer_load_dwordx4 v17, s[40:43], s31 offen lds
H1_nb0:
    s_add_u32 s31, s31, s32
    s_waitcnt lgkmcnt(4)
    v_mfma_f32_16x16x32_bf16 v[56:59], a[4:7], v[32:35], v[56:59]
    ds_read_b128 v[24:27], v12 offset:256
    v_mfma_f32_16x16x32_bf16 v[72:75], v[32:35], a[132:135], v[72:75]
    ds_read_b128 v[28:31], v12 offset:16640
    v_mfma_f32_16x16x32_bf16 v[64:67], a[4:7], v[36:39], v[64:67]
    s_mov_b32 m0, s34
    s_add_u32 s34, s34, 1024
    v_xor_b32 v16, s36, v6
    v_mfma_f32_16x16x32_bf16 v[76:79], v[36:39], a[132:135], v[76:79]
    buffer_load_dwordx4 v16, s[4:7], s35 offen sc1 lds
    s_add_u32 s35, s35, 1024
    s_add_u32 s36, s36, 16
    v_mfma_f32_16x16x32_bf16 v[60:63], a[68:71], v[32:35], v[60:63]
    v_mfma_f32_16x16x32_bf16 v[80:83], v[32:35], a[196:199], v[80:83]
    v_mfma_f32_16x16x32_bf16 v[68:71], a[68:71], v[36:39], v[68:71]
    s_mov_b32 m0, s30
    s_add_u32 s30, s30, 4096
    v_mfma_f32_16x16x32_bf16 v[84:87], v[36:39], a[196:199], v[84:87]
    s_cbranch_vccz H1_nb1
    buffer_load_dwordx4 v17, s[40:43], s31 offen lds
H1_nb1:
    s_add_u32 s31, s31, s32
    s_waitcnt lgkmcnt(4)
    v_mfma_f32_16x16x32_bf16 v[56:59], a[8:11], v[40:43], v[56:59]
    ds_read_b128 v[32:35], v13 offset:256
    v_mfma_f32_16x16x32_bf16 v[72:75], v[40:43], a[136:139], v[72:75]
    ds_read_b128 v[36:39], v13 offset:16640
    v_mfma_f32_16x16x32_bf16 v[64:67], a[8:11], v[44:47], v[64:67]
    s_mov_b32 m0, s34
    s_add_u32 s34, s34, 1024
    v_xor_b32 v16, s36, v6
    v_mfma_f32_16x16x32_bf16 v[76:79], v[44:47], a[136:139], v[76:79]
    buffer_load_dwordx4 v16, s[4:7], s35 offen sc1 lds
    s_add_u32 s35, s35, 1024
    s_add_u32 s36, s36, 16
    v_mfma_f32_16x16x32_bf16 v[60:63], a[72:75], v[40:43], v[60:63]
    v_mfma_f32_16x16x32_bf16 v[80:83], v[40:43], a[200:203], v[80:83]
    v_mfma_f32_16x16x32_bf16 v[68:71], a[72:75], v[44:47], v[68:71]
    s_mov_b32 m0, s30
    s_add_u32 s30, s30, 4096
    v_mfma_f32_16x16x32_bf16 v[84:87], v[44:47], a[200:203], v[84:87]
    s_cbranch_vccz H1_nb2
    buffer_load_dwordx4 v17, s[40:43], s31 offen lds
H1_nb2:
    s_add_u32 s31, s31, s32
    s_waitcnt lgkmcnt(4)
    v_mfma_f32_16x16x32_bf16 v[56:59], a[12:15], v[48:51], v[56:59]
    ds_read_b128 v[40:43], v14 offset:256
    v_mfma_f32_16x16x32_bf16 v[72:75], v[48:51], a[140:143], v[72:75]
    ds_read_b128 v[44:47], v14 offset:16640
    v_mfma_f32_16x16x32_bf16 v[64:67], a[12:15], v[52:55], v[64:67]
    s_mov_b32 m0, s34
    s_add_u32 s34, s34, 1024
    v_xor_b32 v16, s36, v6
    v_mfma_f32_16x16x32_bf16 v[76:79], v[52:55], a[140:143], v[76:79]
    buffer_load_dwordx4 v16, s[4:7], s35 offen sc1 lds
    s_add_u32 s35, s35, 1024
    s_add_u32 s36, s36, 16
    v_mfma_f32_16x16x32_bf16 v[60:63], a[76:79], v[48:51], v[60:63]
    v_mfma_f32_16x16x32_bf16 v[80:83], v[48:51], a[204:207], v[80:83]
    v_mfma_f32_16x16x32_bf16 v[68:71], a[76:79], v[52:55], v[68:71]
    s_mov_b32 m0, s30
    s_add_u32 s30, s30, 4096
    v_mfma_f32_16x16x32_bf16 v[84:87], v[52:55], a[204:207], v[84:87]
    s_cbranch_vccz H1_nb3
    buffer_load_dwordx4 v17, s[40:43], s31 offen lds
H1_nb3:
    s_add_u32 s31, s31, s32
    s_waitcnt lgkmcnt(4)
    v_mfma_f32_16x16x32_bf16 v[56:59], a[16:19], v[24:27], v[56:59]
    ds_read_b128 v[48:51], v15 offset:256
    v_mfma_f32_16x16x32_bf16 v[72:75], v[24:27], a[144:147], v[72:75]
    ds_read_b128 v[52:55], v15 offset:16640
    v_mfma_f32_16x16x32_bf16 v[64:67], a[16:19], v[28:31], v[64:67]
    s_mov_b32 m0, s34
    s_add_u32 s34, s34, 1024
    v_xor_b32 v16, s36, v6
    v_mfma_f32_16x16x32_bf16 v[76:79], v[28:31], a[144:147], v[76:79]
    buffer_load_dwordx4 v16, s[4:7], s35 offen sc1 lds
    s_add_u32 s35, s35, 1024
    s_add_u32 s36, s36, 16
    v_mfma_f32_16x16x32_bf16 v[60:63], a[80:83], v[24:27], v[60:63]
    v_mfma_f32_16x16x32_bf16 v[80:83], v[24:27], a[208:211], v[80:83]
    v_mfma_f32_16x16x32_bf16 v[68:71], a[80:83], v[28:31], v[68:71]
    s_mov_b32 m0, s30
    s_add_u32 s30, s30, 4096
    v_mfma_f32_16x16x32_bf16 v[84:87], v[28:31], a[208:211], v[84:87]
    s_cbranch_vccz H1_nb4
    buffer_load_dwordx4 v17, s[40:43], s31 offen lds
H1_nb4:
    s_add_u32 s31, s31, s32
    s_waitcnt lgkmcnt(4)
    v_mfma_f32_16x16x32_bf16 v[56:59], a[20:23], v[32:35], v[56:59]
    ds_read_b128 v[24:27], v12 offset:512
    v_mfma_f32_16x16x32_bf16 v[72:75], v[32:35], a[148:151], v[72:75]
    ds_read_b128 v[28:31], v12 offset:16896
    v_mfma_f32_16x16x32_bf16 v[64:67], a[20:23], v[36:39], v[64:67]
    s_mov_b32 m0, s34
    s_add_u32 s34, s34, 1024
    v_xor_b32 v16, s36, v6
    v_mfma_f32_16x16x32_bf16 v[76:79], v[36:39], a[148:151], v[76:79]
    buffer_load_dwordx4 v16, s[4:7], s35 offen sc1 lds
    s_add_u32 s35, s35, 1024
    s_add_u32 s36, s36, 16
    v_mfma_f32_16x16x32_bf16 v[60:63], a[84:87], v[32:35], v[60:63]
    v_mfma_f32_16x16x32_bf16 v[80:83], v[32:35], a[212:215], v[80:83]
    v_mfma_f32_16x16x32_bf16 v[68:71], a[84:87], v[36:39], v[68:71]
    s_mov_b32 m0, s30
    s_add_u32 s30, s30, 4096
    v_mfma_f32_16x16x32_bf16 v[84:87], v[36:39], a[212:215], v[84:87]
    s_cbranch_vccz H1_nb5
    buffer_load_dwordx4 v17, s[40:43], s31 offen lds
H1_nb5:
    s_add_u32 s31, s31, s32
    s_waitcnt lgkmcnt(4)
    v_mfma_f32_16x16x32_bf16 v[56:59], a[24:27], v[40:43], v[56:59]
    ds_read_b128 v[32:35], v13 offset:512
    v_mfma_f32_16x16x32_bf16 v[72:75], v[40:43], a[152:155], v[72:75]
    ds_read_b128 v[36:39], v13 offset:16896
    v_mfma_f32_16x16x32_bf16 v[64:67], a[24:27], v[44:47], v[64:67]
    s_mov_b32 m0, s34
    s_add_u32 s34, s34, 1024
    v_xor_b32 v16, s36, v6
    v_mfma_f32_16x16x32_bf16 v[76:79], v[44:47], a[152:155], v[76:79]
    buffer_load_dwordx4 v16, s[4:7], s35 offen sc1 lds
    s_add_u32 s35, s35, 1024
    s_add_u32 s36, s36, 16
    v_mfma_f32_16x16x32_bf16 v[60:63], a[88:91], v[40:43], v[60:63]
    v_mfma_f32_16x16x32_bf16 v[80:83], v[40:43], a[216:219], v[80:83]
    v_mfma_f32_16x16x32_bf16 v[68:71], a[88:91], v[44:47], v[68:71]
    s_mov_b32 m0, s30
    s_add_u32 s30, s30, 4096
    v_mfma_f32_16x16x32_bf16 v[84:87], v[44:47], a[216:219], v[84:87]
    s_cbranch_vccz H1_nb6
    buffer_load_dwordx4 v17, s[40:43], s31 offen lds
H1_nb6:
    s_add_u32 s31, s31, s32
    s_waitcnt lgkmcnt(4)
    v_mfma_f32_16x16x32_bf16 v[56:59], a[28:31], v[48:51], v[56:59]
    ds_read_b128 v[40:43], v14 offset:512
    v_mfma_f32_16x16x32_bf16 v[72:75], v[48:51], a[156:159], v[72:75]
    ds_read_b128 v[44:47], v14 offset:16896
    v_mfma_f32_16x16x32_bf16 v[64:67], a[28:31], v[52:55], v[64:67]
    s_mov_b32 m0, s34
    s_add_u32 s34, s34, 1024
    v_xor_b32 v16, s36, v6
    v_mfma_f32_16x16x32_bf16 v[76:79], v[52:55], a[156:159], v[76:79]
    buffer_load_dwordx4 v16, s[4:7], s35 offen sc1 lds
    s_add_u32 s35, s35, 1024
    s_add_u32 s36, s36, 16
    v_mfma_f32_16x16x32_bf16 v[60:63], a[92:95], v[48:51], v[60:63]
    v_mfma_f32_16x16x32_bf16 v[80:83], v[48:51], a[220:223], v[80:83]
    v_mfma_f32_16x16x32_bf16 v[68:71], a[92:95], v[52:55], v[68:71]
    s_mov_b32 m0, s30
    s_add_u32 s30, s30, 4096
    v_mfma_f32_16x16x32_bf16 v[84:87], v[52:55], a[220:223], v[84:87]
    s_cbranch_vccz H1_nb7
    buffer_load_dwordx4 v17, s[40:43], s31 offen lds
H1_nb7:
    s_add_u32 s31, s31, s32
    s_waitcnt lgkmcnt(4)
    v_mfma_f32_16x16x32_bf16 v[56:59], a[32:35], v[24:27], v[56:59]
    ds_read_b128 v[48:51], v15 offset:512
    v_mfma_f32_16x16x32_bf16 v[72:75], v[24:27], a[160:163], v[72:75]
    ds_read_b128 v[52:55], v15 offset:16896
    v_mfma_f32_16x16x32_bf16 v[64:67], a[32:35], v[28:31], v[64:67]
    v_mfma_f32_16x16x32_bf16 v[76:79], v[28:31], a[160:163], v[76:79]
    v_mfma_f32_16x16x32_bf16 v[60:63], a[96:99], v[24:27], v[60:63]
    v_mfma_f32_16x16x32_bf16 v[80:83], v[24:27], a[224:227], v[80:83]
    v_mfma_f32_16x16x32_bf16 v[68:71], a[96:99], v[28:31], v[68:71]
    v_mfma_f32_16x16x32_bf16 v[84:87], v[28:31], a[224:227], v[84:87]
    s_waitcnt lgkmcnt(4)
    v_mfma_f32_16x16x32_bf16 v[56:59], a[36:39], v[32:35], v[56:59]
    ds_read_b128 v[24:27], v12 offset:768
    v_mfma_f32_16x16x32_bf16 v[72:75], v[32:35], a[164:167], v[72:75]
    ds_read_b128 v[28:31], v12 offset:17152
    v_mfma_f32_16x16x32_bf16 v[64:67], a[36:39], v[36:39], v[64:67]
    v_mfma_f32_16x16x32_bf16 v[76:79], v[36:39], a[164:167], v[76:79]
    v_mfma_f32_16x16x32_bf16 v[60:63], a[100:103], v[32:35], v[60:63]
    v_mfma_f32_16x16x32_bf16 v[80:83], v[32:35], a[228:231], v[80:83]
    v_mfma_f32_16x16x32_bf16 v[68:71], a[100:103], v[36:39], v[68:71]
    v_mfma_f32_16x16x32_bf16 v[84:87], v[36:39], a[228:231], v[84:87]
    s_waitcnt lgkmcnt(4)
    v_mfma_f32_16x16x32_bf16 v[56:59], a[40:43], v[40:43], v[56:59]
    ds_read_b128 v[32:35], v13 offset:768
    v_mfma_f32_16x16x32_bf16 v[72:75], v[40:43], a[168:171], v[72:75]
    ds_read_b128 v[36:39], v13 offset:17152
    v_mfma_f32_16x16x32_bf16 v[64:67], a[40:43], v[44:47], v[64:67]
    v_mfma_f32_16x16x32_bf16 v[76:79], v[44:47], a[168:171], v[76:79]
    v_mfma_f32_16x16x32_bf16 v[60:63], a[104:107], v[40:43], v[60:63]
    v_mfma_f32_16x16x32_bf16 v[80:83], v[40:43], a[232:235], v[80:83]
    v_mfma_f32_16x16x32_bf16 v[68:71], a[104:107], v[44:47], v[68:71]
    v_mfma_f32_16x16x32_bf16 v[84:87], v[44:47], a[232:235], v[84:87]
    s_waitcnt lgkmcnt(4)
    v_mfma_f32_16x16x32_bf16 v[56:59], a[44:47], v[48:51], v[56:59]
    ds_read_b128 v[40:43], v14 offset:768
    v_mfma_f32_16x16x32_bf16 v[72:75], v[48:51], a[172:175], v[72:75]
    ds_read_b128 v[44:47], v14 offset:17152
    v_mfma_f32_16x16x32_bf16 v[64:67], a[44:47], v[52:55], v[64:67]
    v_mfma_f32_16x16x32_bf16 v[76:79], v[52:55], a[172:175], v[76:79]
    v_mfma_f32_16x16x32_bf16 v[60:63], a[108:111], v[48:51], v[60:63]
    v_mfma_f32_16x16x32_bf16 v[80:83], v[48:51], a[236:239], v[80:83]
    v_mfma_f32_16x16x32_bf16 v[68:71], a[108:111], v[52:55], v[68:71]
    v_mfma_f32_16x16x32_bf16 v[84:87], v[52:55], a[236:239], v[84:87]
    s_waitcnt lgkmcnt(4)
    v_mfma_f32_16x16x32_bf16 v[56:59], a[48:51], v[24:27], v[56:59]
    ds_read_b128 v[48:51], v15 offset:768
    v_mfma_f32_16x16x32_bf16 v[72:75], v[24:27], a[176:179], v[72:75]
    ds_read_b128 v[52:55], v15 offset:17152
    v_mfma_f32_16x16x32_bf16 v[64:67], a[48:51], v[28:31], v[64:67]
    v_mfma_f32_16x16x32_bf16 v[76:79], v[28:31], a[176:179], v[76:79]
    v_mfma_f32_16x16x32_bf16 v[60:63], a[112:115], v[24:27], v[60:63]
    v_mfma_f32_16x16x32_bf16 v[80:83], v[24:27], a[240:243], v[80:83]
    v_mfma_f32_16x16x32_bf16 v[68:71], a[112:115], v[28:31], v[68:71]
    v_mfma_f32_16x16x32_bf16 v[84:87], v[28:31], a[240:243], v[84:87]
    s_waitcnt lgkmcnt(4)
    v_mfma_f32_16x16x32_bf16 v[56:59], a[52:55], v[32:35], v[56:59]
    v_mfma_f32_16x16x32_bf16 v[72:75], v[32:35], a[180:183], v[72:75]
    v_mfma_f32_16x16x32_bf16 v[64:67], a[52:55], v[36:39], v[64:67]
    v_mfma_f32_16x16x32_bf16 v[76:79], v[36:39], a[180:183], v[76:79]
    v_mfma_f32_16x16x32_bf16 v[60:63], a[116:119], v[32:35], v[60:63]
    v_mfma_f32_16x16x32_bf16 v[80:83], v[32:35], a[244:247], v[80:83]
    v_mfma_f32_16x16x32_bf16 v[68:71], a[116:119], v[36:39], v[68:71]
    v_mfma_f32_16x16x32_bf16 v[84:87], v[36:39], a[244:247], v[84:87]
    s_waitcnt lgkmcnt(2)
    v_mfma_f32_16x16x32_bf16 v[56:59], a[56:59], v[40:43], v[56:59]
    v_mfma_f32_16x16x32_bf16 v[72:75], v[40:43], a[184:187], v[72:75]
    v_mfma_f32_16x16x32_bf16 v[64:67], a[56:59], v[44:47], v[64:67]
    v_mfma_f32_16x16x32_bf16 v[76:79], v[44:47], a[184:187], v[76:79]
    v_mfma_f32_16x16x32_bf16 v[60:63], a[120:123], v[40:43], v[60:63]
    v_mfma_f32_16x16x32_bf16 v[80:83], v[40:43], a[248:251], v[80:83]
    v_mfma_f32_16x16x32_bf16 v[68:71], a[120:123], v[44:47], v[68:71]
    v_mfma_f32_16x16x32_bf16 v[84:87], v[44:47], a[248:251], v[84:87]
    s_waitcnt lgkmcnt(0)
    v_mfma_f32_16x16x32_bf16 v[56:59], a[60:63], v[48:51], v[56:59]
    v_mfma_f32_16x16x32_bf16 v[72:75], v[48:51], a[188:191], v[72:75]
    v_mfma_f32_16x16x32_bf16 v[64:67], a[60:63], v[52:55], v[64:67]
    v_mfma_f32_16x16x32_bf16 v[76:79], v[52:55], a[188:191], v[76:79]
    v_mfma_f32_16x16x32_bf16 v[60:63], a[124:127], v[48:51], v[60:63]
    v_mfma_f32_16x16x32_bf16 v[80:83], v[48:51], a[252:255], v[80:83]
    v_mfma_f32_16x16x32_bf16 v[68:71], a[124:127], v[52:55], v[68:71]
    v_mfma_f32_16x16x32_bf16 v[84:87], v[52:55], a[252:255], v[84:87]
    v_xor_b32 v12, 0x8000, v12
    v_xor_b32 v13, 0x8000, v13
    v_xor_b32 v14, 0x8000, v14
    v_xor_b32 v15, 0x8000, v15
    s_lshl_b32 s24, s18, 19
    s_lshl_b32 s25, s16, 14
    s_add_u32 s24, s24, s25
    s_add_u32 s24, s24, 2097152
    s_mul_i32 s37, s16, 65
    s_add_u32 s37, s37, s18
    s_lshl_b32 s37, s37, 12
    s_add_u32 s37, s37, 37752832
    s_cmp_ge_u32 s18, 64
    s_cselect_b32 s24, 1073741824, s24
    s_cselect_b32 s37, 1073741824, s37
    s_lshl_b32 s25, s17, 10
    s_add_u32 s37, s37, s25
    s_add_u32 s26, s24, s25
    s_add_u32 s27, s26, 4096
    s_add_u32 s25, s25, s26
    s_add_u32 s25, s25, 8192
    v_cvt_pk_bf16_f32 v88, v56, v57
    v_cvt_pk_bf16_f32 v89, v58, v59
    v_cvt_pk_bf16_f32 v90, v60, v61
    v_cvt_pk_bf16_f32 v91, v62, v63
    v_cvt_pk_bf16_f32 v92, v64, v65
    v_cvt_pk_bf16_f32 v93, v66, v67
    v_cvt_pk_bf16_f32 v94, v68, v69
    v_cvt_pk_bf16_f32 v95, v70, v71
    v_cvt_pk_bf16_f32 v96, v72, v73
    v_cvt_pk_bf16_f32 v97, v74, v75
    v_cvt_pk_bf16_f32 v98, v76, v77
    v_cvt_pk_bf16_f32 v99, v78, v79
    v_cvt_pk_bf16_f32 v100, v80, v81
    v_cvt_pk_bf16_f32 v101, v82, v83
    v_cvt_pk_bf16_f32 v102, v84, v85
    v_cvt_pk_bf16_f32 v103, v86, v87
    buffer_store_dwordx4 v[88:91], v6, s[4:7], s26 offen sc1
    buffer_store_dwordx4 v[92:95], v6, s[4:7], s27 offen sc1
    buffer_store_dwordx4 v[96:99], v6, s[4:7], s25 offen sc1
    buffer_store_dwordx4 v[100:103], v6, s[4:7], s25 offen offset:1024 sc1
    buffer_store_dwordx4 v[104:107], v6, s[4:7], s37 offen sc1
    s_add_u32 s20, s20, 1
    s_mov_b32 s58, s57
    s_mov_b32 s57, s18
    s_mov_b32 s18, s33
    s_cmp_lt_u32 s18, 64
    s_cbranch_scc1 H1_loop
    s_waitcnt vmcnt(0)
    s_barrier
    s_cmp_ge_u32 s58, 64
    s_cbranch_scc1 fl_16
    s_lshl_b32 s28, s16, 6
    s_add_u32 s28, s28, s58
    s_lshl_b32 s28, s28, 2
    s_cmp_lg_u32 s17, 0
    s_cbranch_scc1 sig_17
    v_mov_b32 v20, 1
    v_mov_b32 v21, s28
    s_mov_b64 exec, 1
    buffer_store_dword v20, v21, s[4:7], 0 offen sc1
    s_mov_b64 exec, -1
sig_17:
fl_16:
    s_cmp_ge_u32 s57, 64
    s_cbranch_scc1 fl_18
    s_lshl_b32 s28, s16, 6
    s_add_u32 s28, s28, s57
    s_lshl_b32 s28, s28, 2
    s_cmp_lg_u32 s17, 0
    s_cbranch_scc1 sig_19
    v_mov_b32 v20, 1
    v_mov_b32 v21, s28
    s_mov_b64 exec, 1
    buffer_store_dword v20, v21, s[4:7], 0 offen sc1
    s_mov_b64 exec, -1
sig_19:
fl_18:
    s_cmp_ge_u32 s39, 6
    s_cbranch_scc1 L_post2
    s_load_dwordx2 s[8:9], s[0:1], 40
    s_mov_b32 s10, 4194304
    s_mov_b32 s11, 0x20000
    s_waitcnt lgkmcnt(0)
    s_lshl_b32 s24, s17, 10
    s_add_u32 m0, s24, 0
    s_mov_b32 s25, 98304
    buffer_load_dwordx4 v18, s[8:11], s25 offen lds
    s_add_u32 m0, s24, 4096
    s_mov_b32 s25, 102400
    buffer_load_dwordx4 v18, s[8:11], s25 offen lds
    s_add_u32 m0, s24, 8192
    s_mov_b32 s25, 106496
    buffer_load_dwordx4 v18, s[8:11], s25 offen lds
    s_add_u32 m0, s24, 12288
    s_mov_b32 s25, 110592
    buffer_load_dwordx4 v18, s[8:11], s25 offen lds
    s_add_u32 m0, s24, 16384
    s_mov_b32 s25, 114688
    buffer_load_dwordx4 v18, s[8:11], s25 offen lds
    s_add_u32 m0, s24, 20480
    s_mov_b32 s25, 118784
    buffer_load_dwordx4 v18, s[8:11], s25 offen lds
    s_add_u32 m0, s24, 24576
    s_mov_b32 s25, 122880
    buffer_load_dwordx4 v18, s[8:11], s25 offen lds
    s_add_u32 m0, s24, 28672
    s_mov_b32 s25, 126976
    buffer_load_dwordx4 v18, s[8:11], s25 offen lds
    v_accvgpr_write_b32 a0, v128
    v_accvgpr_write_b32 a1, v129
    v_accvgpr_write_b32 a2, v130
    v_accvgpr_write_b32 a3, v131
    v_accvgpr_write_b32 a4, v132
    v_accvgpr_write_b32 a5, v133
    v_accvgpr_write_b32 a6, v134
    v_accvgpr_write_b32 a7, v135
    v_accvgpr_write_b32 a8, v136
    v_accvgpr_write_b32 a9, v137
    v_accvgpr_write_b32 a10, v138
    v_accvgpr_write_b32 a11, v139
    v_accvgpr_write_b32 a12, v140
    v_accvgpr_write_b32 a13, v141
    v_accvgpr_write_b32 a14, v142
    v_accvgpr_write_b32 a15, v143
    v_accvgpr_write_b32 a16, v144
    v_accvgpr_write_b32 a17, v145
    v_accvgpr_write_b32 a18, v146
    v_accvgpr_write_b32 a19, v147
    v_accvgpr_write_b32 a20, v148
    v_accvgpr_write_b32 a21, v149
    v_accvgpr_write_b32 a22, v150
    v_accvgpr_write_b32 a23, v151
    v_accvgpr_write_b32 a24, v152
    v_accvgpr_write_b32 a25, v153
    v_accvgpr_write_b32 a26, v154
    v_accvgpr_write_b32 a27, v155
    v_accvgpr_write_b32 a28, v156
    v_accvgpr_write_b32 a29, v157
    v_accvgpr_write_b32 a30, v158
    v_accvgpr_write_b32 a31, v159
    v_accvgpr_write_b32 a32, v160
    v_accvgpr_write_b32 a33, v161
    v_accvgpr_write_b32 a34, v162
    v_accvgpr_write_b32 a35, v163
    v_accvgpr_write_b32 a36, v164
    v_accvgpr_write_b32 a37, v165
    v_accvgpr_write_b32 a38, v166
    v_accvgpr_write_b32 a39, v167
    v_accvgpr_write_b32 a40, v168
    v_accvgpr_write_b32 a41, v169
    v_accvgpr_write_b32 a42, v170
    v_accvgpr_write_b32 a43, v171
    v_accvgpr_write_b32 a44, v172
    v_accvgpr_write_b32 a45, v173
    v_accvgpr_write_b32 a46, v174
    v_accvgpr_write_b32 a47, v175
    v_accvgpr_write_b32 a48, v176
    v_accvgpr_write_b32 a49, v177
    v_accvgpr_write_b32 a50, v178
    v_accvgpr_write_b32 a51, v179
    v_accvgpr_write_b32 a52, v180
    v_accvgpr_write_b32 a53, v181
    v_accvgpr_write_b32 a54, v182
    v_accvgpr_write_b32 a55, v183
    v_accvgpr_write_b32 a56, v184
    v_accvgpr_write_b32 a57, v185
    v_accvgpr_write_b32 a58, v186
    v_accvgpr_write_b32 a59, v187
    v_accvgpr_write_b32 a60, v188
    v_accvgpr_write_b32 a61, v189
    v_accvgpr_write_b32 a62, v190
    v_accvgpr_write_b32 a63, v191
    v_accvgpr_write_b32 a64, v192
    v_accvgpr_write_b32 a65, v193
    v_accvgpr_write_b32 a66, v194
    v_accvgpr_write_b32 a67, v195
    v_accvgpr_write_b32 a68, v196
    v_accvgpr_write_b32 a69, v197
    v_accvgpr_write_b32 a70, v198
    v_accvgpr_write_b32 a71, v199
    v_accvgpr_write_b32 a72, v200
    v_accvgpr_write_b32 a73, v201
    v_accvgpr_write_b32 a74, v202
    v_accvgpr_write_b32 a75, v203
    v_accvgpr_write_b32 a76, v204
    v_accvgpr_write_b32 a77, v205
    v_accvgpr_write_b32 a78, v206
    v_accvgpr_write_b32 a79, v207
    v_accvgpr_write_b32 a80, v208
    v_accvgpr_write_b32 a81, v209
    v_accvgpr_write_b32 a82, v210
    v_accvgpr_write_b32 a83, v211
    v_accvgpr_write_b32 a84, v212
    v_accvgpr_write_b32 a85, v213
    v_accvgpr_write_b32 a86, v214
    v_accvgpr_write_b32 a87, v215
    v_accvgpr_write_b32 a88, v216
    v_accvgpr_write_b32 a89, v217
    v_accvgpr_write_b32 a90, v218
    v_accvgpr_write_b32 a91, v219
    v_accvgpr_write_b32 a92, v220
    v_accvgpr_write_b32 a93, v221
    v_accvgpr_write_b32 a94, v222
    v_accvgpr_write_b32 a95, v223
    v_accvgpr_write_b32 a96, v224
    v_accvgpr_write_b32 a97, v225
    v_accvgpr_write_b32 a98, v226
    v_accvgpr_write_b32 a99, v227
    v_accvgpr_write_b32 a100, v228
    v_accvgpr_write_b32 a101, v229
    v_accvgpr_write_b32 a102, v230
    v_accvgpr_write_b32 a103, v231
    v_accvgpr_write_b32 a104, v232
    v_accvgpr_write_b32 a105, v233
    v_accvgpr_write_b32 a106, v234
    v_accvgpr_write_b32 a107, v235
    v_accvgpr_write_b32 a108, v236
    v_accvgpr_write_b32 a109, v237
    v_accvgpr_write_b32 a110, v238
    v_accvgpr_write_b32 a111, v239
    v_accvgpr_write_b32 a112, v240
    v_accvgpr_write_b32 a113, v241
    v_accvgpr_write_b32 a114, v242
    v_accvgpr_write_b32 a115, v243
    v_accvgpr_write_b32 a116, v244
    v_accvgpr_write_b32 a117, v245
    v_accvgpr_write_b32 a118, v246
    v_accvgpr_write_b32 a119, v247
    v_accvgpr_write_b32 a120, v248
    v_accvgpr_write_b32 a121, v249
    v_accvgpr_write_b32 a122, v250
    v_accvgpr_write_b32 a123, v251
    v_accvgpr_write_b32 a124, v252
    v_accvgpr_write_b32 a125, v253
    v_accvgpr_write_b32 a126, v254
    v_accvgpr_write_b32 a127, v255
    v_add_u32 v44, 0x10000, v108
    v_add_u32 v45, 0x10000, v109
    v_add_u32 v46, 0x10000, v110
    v_add_u32 v47, 0x10000, v111
    ds_read_b64_tr_b16 a[128:129], v44 offset:0
    ds_read_b64_tr_b16 a[130:131], v44 offset:16384
    ds_read_b64_tr_b16 a[144:145], v44 offset:8
    ds_read_b64_tr_b16 a[146:147], v44 offset:16392
    ds_read_b64_tr_b16 a[160:161], v45 offset:0
    ds_read_b64_tr_b16 a[162:163], v45 offset:16384
    ds_read_b64_tr_b16 a[176:177], v45 offset:8
    ds_read_b64_tr_b16 a[178:179], v45 offset:16392
    ds_read_b64_tr_b16 a[192:193], v46 offset:0
    ds_read_b64_tr_b16 a[194:195], v46 offset:16384
    ds_read_b64_tr_b16 a[208:209], v46 offset:8
    ds_read_b64_tr_b16 a[210:211], v46 offset:16392
    ds_read_b64_tr_b16 a[224:225], v47 offset:0
    ds_read_b64_tr_b16 a[226:227], v47 offset:16384
    ds_read_b64_tr_b16 a[240:241], v47 offset:8
    ds_read_b64_tr_b16 a[242:243], v47 offset:16392
    ds_read_b64_tr_b16 a[132:133], v44 offset:32768
    ds_read_b64_tr_b16 a[134:135], v44 offset:49152
    ds_read_b64_tr_b16 a[148:149], v44 offset:32776
    ds_read_b64_tr_b16 a[150:151], v44 offset:49160
    ds_read_b64_tr_b16 a[164:165], v45 offset:32768
    ds_read_b64_tr_b16 a[166:167], v45 offset:49152
    ds_read_b64_tr_b16 a[180:181], v45 offset:32776
    ds_read_b64_tr_b16 a[182:183], v45 offset:49160
    ds_read_b64_tr_b16 a[196:197], v46 offset:32768
    ds_read_b64_tr_b16 a[198:199], v46 offset:49152
    ds_read_b64_tr_b16 a[212:213], v46 offset:32776
    ds_read_b64_tr_b16 a[214:215], v46 offset:49160
    ds_read_b64_tr_b16 a[228:229], v47 offset:32768
    ds_read_b64_tr_b16 a[230:231], v47 offset:49152
    ds_read_b64_tr_b16 a[244:245], v47 offset:32776
    ds_read_b64_tr_b16 a[246:247], v47 offset:49160
    v_add_u32 v44, 0x20000, v108
    v_add_u32 v45, 0x20000, v109
    v_add_u32 v46, 0x20000, v110
    v_add_u32 v47, 0x20000, v111
    ds_read_b64_tr_b16 a[136:137], v44 offset:0
    ds_read_b64_tr_b16 a[138:139], v44 offset:16384
    ds_read_b64_tr_b16 a[152:153], v44 offset:8
    ds_read_b64_tr_b16 a[154:155], v44 offset:16392
    ds_read_b64_tr_b16 a[168:169], v45 offset:0
    ds_read_b64_tr_b16 a[170:171], v45 offset:16384
    ds_read_b64_tr_b16 a[184:185], v45 offset:8
    ds_read_b64_tr_b16 a[186:187], v45 offset:16392
    ds_read_b64_tr_b16 a[200:201], v46 offset:0
    ds_read_b64_tr_b16 a[202:203], v46 offset:16384
    ds_read_b64_tr_b16 a[216:217], v46 offset:8
    ds_read_b64_tr_b16 a[218:219], v46 offset:16392
    ds_read_b64_tr_b16 a[232:233], v47 offset:0
    ds_read_b64_tr_b16 a[234:235], v47 offset:16384
    ds_read_b64_tr_b16 a[248:249], v47 offset:8
    ds_read_b64_tr_b16 a[250:251], v47 offset:16392
    s_waitcnt lgkmcnt(0)
    s_barrier
    s_load_dwordx2 s[8:9], s[0:1], 64
    s_mov_b32 s10, 1409024
    s_mov_b32 s11, 0x20000
    s_waitcnt lgkmcnt(0)
    s_lshl_b32 s30, s17, 5
    s_add_u32 s30, s30, s16
    s_cmp_ge_u32 s30, 86
    s_cbranch_scc1 H2_nowin
    v_lshrrev_b32 v40, 1, v1
    v_mul_u32_u24 v40, 2752, v40
    v_and_b32 v41, 1, v1
    v_lshl_add_u32 v40, v41, 4, v40
    s_lshl_b32 s25, s30, 5
    s_lshl_b32 s24, s17, 14
    s_add_u32 s24, s24, 65536
    s_add_u32 m0, s24, 0
    s_nop 0
    buffer_load_dwordx4 v40, s[8:11], s25 offen lds
    s_add_u32 s25, s25, 88064
    s_add_u32 m0, s24, 1024
    s_nop 0
    buffer_load_dwordx4 v40, s[8:11], s25 offen lds
    s_add_u32 s25, s25, 88064
    s_add_u32 m0, s24, 2048
    s_nop 0
    buffer_load_dwordx4 v40, s[8:11], s25 offen lds
    s_add_u32 s25, s25, 88064
    s_add_u32 m0, s24, 3072
    s_nop 0
    buffer_load_dwordx4 v40, s[8:11], s25 offen lds
    s_add_u32 s25, s25, 88064
    s_add_u32 m0, s24, 4096
    s_nop 0
    buffer_load_dwordx4 v40, s[8:11], s25 offen lds
    s_add_u32 s25, s25, 88064
    s_add_u32 m0, s24, 5120
    s_nop 0
    buffer_load_dwordx4 v40, s[8:11], s25 offen lds
    s_add_u32 s25, s25, 88064
    s_add_u32 m0, s24, 6144
    s_nop 0
    buffer_load_dwordx4 v40, s[8:11], s25 offen lds
    s_add_u32 s25, s25, 88064
    s_add_u32 m0, s24, 7168
    s_nop 0
    buffer_load_dwordx4 v40, s[8:11], s25 offen lds
    s_add_u32 s25, s25, 88064
    s_add_u32 m0, s24, 8192
    s_nop 0
    buffer_load_dwordx4 v40, s[8:11], s25 offen lds
    s_add_u32 s25, s25, 88064
    s_add_u32 m0, s24, 9216
    s_nop 0
    buffer_load_dwordx4 v40, s[8:11], s25 offen lds
    s_add_u32 s25, s25, 88064
    s_add_u32 m0, s24, 10240
    s_nop 0
    buffer_load_dwordx4 v40, s[8:11], s25 offen lds
    s_add_u32 s25, s25, 88064
    s_add_u32 m0, s24, 11264
    s_nop 0
    buffer_load_dwordx4 v40, s[8:11], s25 offen lds
    s_add_u32 s25, s25, 88064
    s_add_u32 m0, s24, 12288
    s_nop 0
    buffer_load_dwordx4 v40, s[8:11], s25 offen lds
    s_add_u32 s25, s25, 88064
    s_add_u32 m0, s24, 13312
    s_nop 0
    buffer_load_dwordx4 v40, s[8:11], s25 offen lds
    s_add_u32 s25, s25, 88064
    s_add_u32 m0, s24, 14336
    s_nop 0
    buffer_load_dwordx4 v40, s[8:11], s25 offen lds
    s_add_u32 s25, s25, 88064
    s_add_u32 m0, s24, 15360
    s_nop 0
    buffer_load_dwordx4 v40, s[8:11], s25 offen lds
    s_add_u32 s25, s25, 88064
    v_lshl_add_u32 v41, v3, 3, v4
    v_lshlrev_b32 v41, 5, v41
    v_lshl_add_u32 v41, v5, 3, v41
    v_add_u32 v41, s24, v41
    s_waitcnt vmcnt(0)
    ds_read_b64_tr_b16 v[192:193], v41 offset:0
    ds_read_b64_tr_b16 v[194:195], v41 offset:128
    ds_read_b64_tr_b16 v[196:197], v41 offset:1024
    ds_read_b64_tr_b16 v[198:199], v41 offset:1152
    ds_read_b64_tr_b16 v[200:201], v41 offset:2048
    ds_read_b64_tr_b16 v[202:203], v41 offset:2176
    ds_read_b64_tr_b16 v[204:205], v41 offset:3072
    ds_read_b64_tr_b16 v[206:207], v41 offset:3200
    ds_read_b64_tr_b16 v[208:209], v41 offset:4096
    ds_read_b64_tr_b16 v[210:211], v41 offset:4224
    ds_read_b64_tr_b16 v[212:213], v41 offset:5120
    ds_read_b64_tr_b16 v[214:215], v41 offset:5248
    ds_read_b64_tr_b16 v[216:217], v41 offset:6144
    ds_read_b64_tr_b16 v[218:219], v41 offset:6272
    ds_read_b64_tr_b16 v[220:221], v41 offset:7168
    ds_read_b64_tr_b16 v[222:223], v41 offset:7296
    ds_read_b64_tr_b16 v[224:225], v41 offset:8192
    ds_read_b64_tr_b16 v[226:227], v41 offset:8320
    ds_read_b64_tr_b16 v[228:229], v41 offset:9216
    ds_read_b64_tr_b16 v[230:231], v41 offset:9344
    ds_read_b64_tr_b16 v[232:233], v41 offset:10240
    ds_read_b64_tr_b16 v[234:235], v41 offset:10368
    ds_read_b64_tr_b16 v[236:237], v41 offset:11264
    ds_read_b64_tr_b16 v[238:239], v41 offset:11392
    ds_read_b64_tr_b16 v[240:241], v41 offset:12288
    ds_read_b64_tr_b16 v[242:243], v41 offset:12416
    ds_read_b64_tr_b16 v[244:245], v41 offset:13312
    ds_read_b64_tr_b16 v[246:247], v41 offset:13440
    ds_read_b64_tr_b16 v[248:249], v41 offset:14336
    ds_read_b64_tr_b16 v[250:251], v41 offset:14464
    ds_read_b64_tr_b16 v[252:253], v41 offset:15360
    ds_read_b64_tr_b16 v[254:255], v41 offset:15488
    s_waitcnt lgkmcnt(0)
H2_nowin:
    s_waitcnt vmcnt(0)
    s_barrier
    ds_read_b64_tr_b16 a[140:141], v108 offset:0
    ds_read_b64_tr_b16 a[142:143], v108 offset:16384
    ds_read_b64_tr_b16 a[156:157], v108 offset:8
    ds_read_b64_tr_b16 a[158:159], v108 offset:16392
    ds_read_b64_tr_b16 a[172:173], v109 offset:0
    ds_read_b64_tr_b16 a[174:175], v109 offset:16384
    ds_read_b64_tr_b16 a[188:189], v109 offset:8
    ds_read_b64_tr_b16 a[190:191], v109 offset:16392
    ds_read_b64_tr_b16 a[204:205], v110 offset:0
    ds_read_b64_tr_b16 a[206:207], v110 offset:16384
    ds_read_b64_tr_b16 a[220:221], v110 offset:8
    ds_read_b64_tr_b16 a[222:223], v110 offset:16392
    ds_read_b64_tr_b16 a[236:237], v111 offset:0
    ds_read_b64_tr_b16 a[238:239], v111 offset:16384
    ds_read_b64_tr_b16 a[252:253], v111 offset:8
    ds_read_b64_tr_b16 a[254:255], v111 offset:16392
    s_waitcnt lgkmcnt(0)
    s_load_dwordx2 s[8:9], s[0:1], 0
    s_mov_b32 s10, 2097152
    s_mov_b32 s11, 0x20000
    s_waitcnt lgkmcnt(0)
    s_and_b32 s24, s39, 1
    s_lshl_b32 s24, s24, 6
    s_lshr_b32 s25, s39, 1
    s_lshl_b32 s25, s25, 2
    s_add_u32 s24, s24, s25
    v_mov_b32 v41, s24
    buffer_load_dword v40, v41, s[12:15], 0 offen sc1
    s_waitcnt vmcnt(0)
    v_readfirstlane_b32 s24, v40
    s_nop 0
    s_cmp_ge_u32 s24, 32
    s_cselect_b32 s31, 1, 0
    v_xor_b32 v12, v3, v2
    v_lshlrev_b32 v12, 4, v12
    v_lshl_add_u32 v12, v2, 10, v12
    v_xor_b32 v13, 64, v12
    v_xor_b32 v14, 128, v12
    v_xor_b32 v15, 192, v12
    v_lshl_add_u32 v40, v4, 3, v5
    s_cmp_lt_u32 s30, 43
    s_cselect_b64 vcc, -1, 0
    s_cselect_b32 s24, 16, 4
    v_cndmask_b32 v40, v40, v2, vcc
    v_and_b32 v41, 15, v40
    v_xor_b32 v41, v41, v3
    v_lshlrev_b32 v41, 4, v41
    v_lshl_add_u32 v41, v40, 10, v41
    v_add_u32 v16, 32768, v41
    v_xor_b32 v17, 64, v16
    v_xor_b32 v18, 128, v16
    v_xor_b32 v19, 192, v16
    v_add_u32 v40, s24, v40
    v_and_b32 v41, 15, v40
    v_xor_b32 v41, v41, v3
    v_lshlrev_b32 v41, 4, v41
    v_lshl_add_u32 v41, v40, 10, v41
    v_add_u32 v20, 32768, v41
    v_xor_b32 v21, 64, v20
    v_xor_b32 v22, 128, v20
    v_xor_b32 v23, 192, v20
    v_lshlrev_b32 v25, 5, v2
    v_lshl_add_u32 v25, v3, 3, v25
    s_lshl_b32 s24, s17, 10
    s_add_u32 s24, s24, 118784
    v_add_u32 v25, s24, v25
    v_lshlrev_b32 v26, 3, v1
    v_add_u32 v26, 118784, v26
    s_mul_i32 s24, s17, 8704
    s_add_u32 s24, s24, 65536
    v_mul_u32_u24 v27, 272, v2
    v_lshl_add_u32 v27, v3, 4, v27
    v_add_u32 v27, s24, v27
    v_mul_u32_u24 v28, 272, v3
    v_lshl_add_u32 v28, v2, 4, v28
    v_add_u32 v28, s24, v28
    s_lshl_b32 s24, s17, 8
    v_lshlrev_b32 v40, 4, v2
    v_add_u32 v40, s24, v40
    v_lshl_add_u32 v29, v3, 15, v40
    v_lshl_add_u32 v38, v3, 10, v40
    v_lshl_add_u32 v39, v3, 2, v40
    v_add_u32 v9, 131072, v6
    s_lshr_b32 s24, s17, 1
    s_lshl_b32 s24, s24, 12
    v_add_u32 v8, s24, v9
    v_and_b32 v40, 1, v2
    v_lshlrev_b32 v40, 4, v40
    v_mov_b32 v41, 0x3f80
    v_lshlrev_b32 v41, v40, v41
    v_cmp_eq_u32 vcc, 0, v4
    s_nop 1
    v_cndmask_b32 v184, 0, v41, vcc
    v_cmp_eq_u32 vcc, 1, v4
    s_nop 1
    v_cndmask_b32 v185, 0, v41, vcc
    v_cmp_eq_u32 vcc, 2, v4
    s_nop 1
    v_cndmask_b32 v186, 0, v41, vcc
    v_cmp_eq_u32 vcc, 3, v4
    s_nop 1
    v_cndmask_b32 v187, 0, v41, vcc
    v_add_u32 v37, 65536, v6
    s_lshl_b32 s24, s17, 10
    v_add_u32 v34, s24, v37
    s_and_b32 s24, s17, 1
    s_lshl_b32 s24, s24, 12
    v_add_u32 v35, s24, v37
    s_lshr_b32 s25, s17, 1
    s_lshl_b32 s25, s25, 11
    v_add_u32 v36, s25, v35
    s_and_b32 s24, s17, 1
    s_lshl_b32 s24, s24, 4
    v_add_u32 v40, s24, v2
    v_lshlrev_b32 v41, 2, v3
    v_sub_u32 v40, v40, v41
    v_cmp_le_i32 s[44:45], 0, v40
    v_cmp_le_i32 s[46:47], 1, v40
    v_cmp_le_i32 s[48:49], 2, v40
    v_cmp_le_i32 s[50:51], 3, v40
    v_cmp_le_i32 s[52:53], 16, v40
    v_cmp_le_i32 s[54:55], 17, v40
    v_cmp_le_i32 s[56:57], 18, v40
    v_cmp_le_i32 s[58:59], 19, v40
    v_mov_b32 v30, 0
    v_mov_b32 v31, 0
    v_mov_b32 v32, 0
    v_mov_b32 v33, 0
    s_sub_u32 s18, s39, 1
    s_mov_b32 s38, 0
    s_mov_b32 s32, 0
    s_lshl_b32 s33, s39, 5
    s_add_u32 s33, s33, s16
    s_barrier
    s_add_u32 s25, s18, 0
    s_min_u32 s25, s25, 63
    s_cmp_gt_u32 s32, s25
    s_cbranch_scc1 H2_kvda
    v_lshlrev_b32 v11, 2, v1
    s_lshl_b32 s28, s16, 8
H2_kvwa:
    buffer_load_dword v7, v11, s[4:7], s28 offen sc1
    s_add_u32 s23, s23, 1
    s_cmp_gt_u32 s23, 262144
    s_waitcnt vmcnt(0)
    s_cbranch_scc1 H2_kvda
    v_cmp_ne_u32 vcc, 0, v7
    s_nop 0
    s_ff0_i32_b64 s32, vcc
    s_cmp_gt_u32 s32, s25
    s_cbranch_scc0 H2_kvwa
H2_kvda:
    s_lshl_b32 s21, s18, 15
    s_add_u32 s21, s21, 52428800
    s_lshl_b32 s24, s17, 13
    s_add_u32 s25, s24, s21
    s_and_b32 s26, s17, 1
    s_lshl_b32 s26, s26, 7
    s_add_u32 s27, s26, 0
    v_xor_b32 v24, s27, v6
    s_add_u32 m0, s24, 0
    s_nop 0
    buffer_load_dwordx4 v24, s[4:7], s25 offen sc1 lds
    s_add_u32 s25, s25, 1024
    s_add_u32 s27, s26, 16
    v_xor_b32 v24, s27, v6
    s_add_u32 m0, s24, 1024
    s_nop 0
    buffer_load_dwordx4 v24, s[4:7], s25 offen sc1 lds
    s_add_u32 s25, s25, 1024
    s_add_u32 s27, s26, 32
    v_xor_b32 v24, s27, v6
    s_add_u32 m0, s24, 2048
    s_nop 0
    buffer_load_dwordx4 v24, s[4:7], s25 offen sc1 lds
    s_add_u32 s25, s25, 1024
    s_add_u32 s27, s26, 48
    v_xor_b32 v24, s27, v6
    s_add_u32 m0, s24, 3072
    s_nop 0
    buffer_load_dwordx4 v24, s[4:7], s25 offen sc1 lds
    s_add_u32 s25, s25, 1024
    s_add_u32 s27, s26, 64
    v_xor_b32 v24, s27, v6
    s_add_u32 m0, s24, 4096
    s_nop 0
    buffer_load_dwordx4 v24, s[4:7], s25 offen sc1 lds
    s_add_u32 s25, s25, 1024
    s_add_u32 s27, s26, 80
    v_xor_b32 v24, s27, v6
    s_add_u32 m0, s24, 5120
    s_nop 0
    buffer_load_dwordx4 v24, s[4:7], s25 offen sc1 lds
    s_add_u32 s25, s25, 1024
    s_add_u32 s27, s26, 96
    v_xor_b32 v24, s27, v6
    s_add_u32 m0, s24, 6144
    s_nop 0
    buffer_load_dwordx4 v24, s[4:7], s25 offen sc1 lds
    s_add_u32 s25, s25, 1024
    s_add_u32 s27, s26, 112
    v_xor_b32 v24, s27, v6
    s_add_u32 m0, s24, 7168
    s_nop 0
    buffer_load_dwordx4 v24, s[4:7], s25 offen sc1 lds
    s_add_u32 s25, s25, 1024
    s_lshl_b32 s27, s18, 19
    s_lshl_b32 s25, s16, 14
    s_add_u32 s27, s27, s25
    s_lshl_b32 s25, s17, 12
    s_add_u32 s27, s27, s25
    s_add_u32 s27, s27, 2097152
    s_add_u32 m0, s25, 131072
    s_nop 0
    buffer_load_dwordx4 v6, s[4:7], s27 offen offset:0 sc1 lds
    buffer_load_dwordx4 v6, s[4:7], s27 offen offset:1024 sc1 lds
    buffer_load_dwordx4 v6, s[4:7], s27 offen offset:2048 sc1 lds
    buffer_load_dwordx4 v6, s[4:7], s27 offen offset:3072 sc1 lds
    s_lshl_b32 s24, s33, 10
    s_add_u32 s24, s24, 56623104
    buffer_load_dword v183, v39, s[4:7], s24 offen sc1
    s_lshl_b32 s24, s33, 15
    s_add_u32 s24, s24, 67108864
    buffer_load_dword v183, v39, s[4:7], s24 offen sc1
    s_lshl_b32 s24, s39, 7
    v_lshlrev_b32 v165, 11, v3
    s_add_u32 s24, s24, 8192
    buffer_load_dword v183, v165, s[4:7], s24 offen sc1
    s_waitcnt vmcnt(3)
    s_barrier
    s_mul_i32 s26, s16, 65
    s_add_u32 s26, s26, s18
    s_lshl_b32 s26, s26, 12
    s_add_u32 s26, s26, 37752832
    s_lshl_b32 s27, s17, 10
    s_add_u32 s27, s27, s26
    s_lshr_b32 s24, s17, 1
    s_lshl_b32 s24, s24, 11
    s_add_u32 s26, s26, s24
    buffer_load_dwordx2 v[164:165], v6, s[4:7], s27 offen sc1
    buffer_load_dwordx2 v[168:169], v6, s[4:7], s26 offen offset:8 sc1
    buffer_load_dwordx2 v[170:171], v6, s[4:7], s26 offen offset:1032 sc1
    ds_read_b128 v[40:43], v12 offset:0
    ds_read_b128 v[44:47], v12 offset:16384
    ds_read_b128 v[48:51], v13 offset:0
    ds_read_b128 v[52:55], v13 offset:16384
    ds_read_b128 v[56:59], v14 offset:0
    ds_read_b128 v[60:63], v14 offset:16384
    s_waitcnt lgkmcnt(4)
    v_mfma_f32_16x16x32_bf16 v[148:151], a[0:3], v[40:43], 0
    ds_read_b128 v[64:67], v15 offset:0
    v_mfma_f32_16x16x32_bf16 v[156:159], a[0:3], v[44:47], 0
    ds_read_b128 v[68:71], v15 offset:16384
    v_mfma_f32_16x16x32_bf16 v[152:155], a[64:67], v[40:43], 0
    v_mfma_f32_16x16x32_bf16 v[160:163], a[64:67], v[44:47], 0
    s_waitcnt lgkmcnt(4)
    v_mfma_f32_16x16x32_bf16 v[148:151], a[4:7], v[48:51], v[148:151]
    ds_read_b128 v[40:43], v12 offset:256
    v_mfma_f32_16x16x32_bf16 v[156:159], a[4:7], v[52:55], v[156:159]
    ds_read_b128 v[44:47], v12 offset:16640
    v_mfma_f32_16x16x32_bf16 v[152:155], a[68:71], v[48:51], v[152:155]
    v_mfma_f32_16x16x32_bf16 v[160:163], a[68:71], v[52:55], v[160:163]
    s_waitcnt lgkmcnt(4)
    v_mfma_f32_16x16x32_bf16 v[148:151], a[8:11], v[56:59], v[148:151]
    ds_read_b128 v[48:51], v13 offset:256
    v_mfma_f32_16x16x32_bf16 v[156:159], a[8:11], v[60:63], v[156:159]
    ds_read_b128 v[52:55], v13 offset:16640
    v_mfma_f32_16x16x32_bf16 v[152:155], a[72:75], v[56:59], v[152:155]
    v_mfma_f32_16x16x32_bf16 v[160:163], a[72:75], v[60:63], v[160:163]
    s_waitcnt lgkmcnt(4)
    v_mfma_f32_16x16x32_bf16 v[148:151], a[12:15], v[64:67], v[148:151]
    ds_read_b128 v[56:59], v14 offset:256
    v_mfma_f32_16x16x32_bf16 v[156:159], a[12:15], v[68:71], v[156:159]
    ds_read_b128 v[60:63], v14 offset:16640
    v_mfma_f32_16x16x32_bf16 v[152:155], a[76:79], v[64:67], v[152:155]
    v_mfma_f32_16x16x32_bf16 v[160:163], a[76:79], v[68:71], v[160:163]
    s_waitcnt lgkmcnt(4)
    v_mfma_f32_16x16x32_bf16 v[148:151], a[16:19], v[40:43], v[148:151]
    ds_read_b128 v[64:67], v15 offset:256
    v_mfma_f32_16x16x32_bf16 v[156:159], a[16:19], v[44:47], v[156:159]
    ds_read_b128 v[68:71], v15 offset:16640
    v_mfma_f32_16x16x32_bf16 v[152:155], a[80:83], v[40:43], v[152:155]
    v_mfma_f32_16x16x32_bf16 v[160:163], a[80:83], v[44:47], v[160:163]
    s_waitcnt lgkmcnt(4)
    v_mfma_f32_16x16x32_bf16 v[148:151], a[20:23], v[48:51], v[148:151]
    ds_read_b128 v[40:43], v12 offset:512
    v_mfma_f32_16x16x32_bf16 v[156:159], a[20:23], v[52:55], v[156:159]
    ds_read_b128 v[44:47], v12 offset:16896
    v_mfma_f32_16x16x32_bf16 v[152:155], a[84:87], v[48:51], v[152:155]
    v_mfma_f32_16x16x32_bf16 v[160:163], a[84:87], v[52:55], v[160:163]
    s_waitcnt lgkmcnt(4)
    v_mfma_f32_16x16x32_bf16 v[148:151], a[24:27], v[56:59], v[148:151]
    ds_read_b128 v[48:51], v13 offset:512
    v_mfma_f32_16x16x32_bf16 v[156:159], a[24:27], v[60:63], v[156:159]
    ds_read_b128 v[52:55], v13 offset:16896
    v_mfma_f32_16x16x32_bf16 v[152:155], a[88:91], v[56:59], v[152:155]
    v_mfma_f32_16x16x32_bf16 v[160:163], a[88:91], v[60:63], v[160:163]
    s_waitcnt lgkmcnt(4)
    v_mfma_f32_16x16x32_bf16 v[148:151], a[28:31], v[64:67], v[148:151]
    ds_read_b128 v[56:59], v14 offset:512
    v_mfma_f32_16x16x32_bf16 v[156:159], a[28:31], v[68:71], v[156:159]
    ds_read_b128 v[60:63], v14 offset:16896
    v_mfma_f32_16x16x32_bf16 v[152:155], a[92:95], v[64:67], v[152:155]
    v_mfma_f32_16x16x32_bf16 v[160:163], a[92:95], v[68:71], v[160:163]
    s_waitcnt lgkmcnt(4)
    v_mfma_f32_16x16x32_bf16 v[148:151], a[32:35], v[40:43], v[148:151]
    ds_read_b128 v[64:67], v15 offset:512
    v_mfma_f32_16x16x32_bf16 v[156:159], a[32:35], v[44:47], v[156:159]
    ds_read_b128 v[68:71], v15 offset:16896
    v_mfma_f32_16x16x32_bf16 v[152:155], a[96:99], v[40:43], v[152:155]
    v_mfma_f32_16x16x32_bf16 v[160:163], a[96:99], v[44:47], v[160:163]
    s_waitcnt lgkmcnt(4)
    v_mfma_f32_16x16x32_bf16 v[148:151], a[36:39], v[48:51], v[148:151]
    ds_read_b128 v[40:43], v12 offset:768
    v_mfma_f32_16x16x32_bf16 v[156:159], a[36:39], v[52:55], v[156:159]
    ds_read_b128 v[44:47], v12 offset:17152
    v_mfma_f32_16x16x32_bf16 v[152:155], a[100:103], v[48:51], v[152:155]
    v_mfma_f32_16x16x32_bf16 v[160:163], a[100:103], v[52:55], v[160:163]
    s_waitcnt lgkmcnt(4)
    v_mfma_f32_16x16x32_bf16 v[148:151], a[40:43], v[56:59], v[148:151]
    ds_read_b128 v[48:51], v13 offset:768
    v_mfma_f32_16x16x32_bf16 v[156:159], a[40:43], v[60:63], v[156:159]
    ds_read_b128 v[52:55], v13 offset:17152
    v_mfma_f32_16x16x32_bf16 v[152:155], a[104:107], v[56:59], v[152:155]
    v_mfma_f32_16x16x32_bf16 v[160:163], a[104:107], v[60:63], v[160:163]
    s_waitcnt lgkmcnt(4)
    v_mfma_f32_16x16x32_bf16 v[148:151], a[44:47], v[64:67], v[148:151]
    ds_read_b128 v[56:59], v14 offset:768
    v_mfma_f32_16x16x32_bf16 v[156:159], a[44:47], v[68:71], v[156:159]
    ds_read_b128 v[60:63], v14 offset:17152
    v_mfma_f32_16x16x32_bf16 v[152:155], a[108:111], v[64:67], v[152:155]
    v_mfma_f32_16x16x32_bf16 v[160:163], a[108:111], v[68:71], v[160:163]
    s_waitcnt lgkmcnt(4)
    v_mfma_f32_16x16x32_bf16 v[148:151], a[48:51], v[40:43], v[148:151]
    ds_read_b128 v[64:67], v15 offset:768
    v_mfma_f32_16x16x32_bf16 v[156:159], a[48:51], v[44:47], v[156:159]
    ds_read_b128 v[68:71], v15 offset:17152
    v_mfma_f32_16x16x32_bf16 v[152:155], a[112:115], v[40:43], v[152:155]
    v_mfma_f32_16x16x32_bf16 v[160:163], a[112:115], v[44:47], v[160:163]
    s_waitcnt lgkmcnt(4)
    v_mfma_f32_16x16x32_bf16 v[148:151], a[52:55], v[48:51], v[148:151]
    v_mfma_f32_16x16x32_bf16 v[156:159], a[52:55], v[52:55], v[156:159]
    v_mfma_f32_16x16x32_bf16 v[152:155], a[116:119], v[48:51], v[152:155]
    v_mfma_f32_16x16x32_bf16 v[160:163], a[116:119], v[52:55], v[160:163]
    s_waitcnt lgkmcnt(2)
    v_mfma_f32_16x16x32_bf16 v[148:151], a[56:59], v[56:59], v[148:151]
    v_mfma_f32_16x16x32_bf16 v[156:159], a[56:59], v[60:63], v[156:159]
    v_mfma_f32_16x16x32_bf16 v[152:155], a[120:123], v[56:59], v[152:155]
    v_mfma_f32_16x16x32_bf16 v[160:163], a[120:123], v[60:63], v[160:163]
    s_waitcnt lgkmcnt(0)
    v_mfma_f32_16x16x32_bf16 v[148:151], a[60:63], v[64:67], v[148:151]
    v_mfma_f32_16x16x32_bf16 v[156:159], a[60:63], v[68:71], v[156:159]
    v_mfma_f32_16x16x32_bf16 v[152:155], a[124:127], v[64:67], v[152:155]
    v_mfma_f32_16x16x32_bf16 v[160:163], a[124:127], v[68:71], v[160:163]
    s_nop 4
    v_cvt_pk_bf16_f32 v40, v148, v149
    v_cvt_pk_bf16_f32 v41, v150, v151
    v_cvt_pk_bf16_f32 v42, v152, v153
    v_cvt_pk_bf16_f32 v43, v154, v155
    ds_write_b128 v34, v[40:43] offset:36864
    v_cvt_pk_bf16_f32 v44, v156, v157
    v_cvt_pk_bf16_f32 v45, v158, v159
    v_cvt_pk_bf16_f32 v46, v160, v161
    v_cvt_pk_bf16_f32 v47, v162, v163
    ds_write_b128 v34, v[44:47] offset:40960
    s_waitcnt lgkmcnt(0)
    s_barrier
    ds_read_b128 v[120:123], v35 offset:36864
    ds_read_b128 v[124:127], v35 offset:37888
    ds_read_b128 v[128:131], v35 offset:38912
    ds_read_b128 v[132:135], v35 offset:39936
    ds_read_b128 v[72:75], v9 offset:0
    ds_read_b128 v[76:79], v9 offset:1024
    ds_read_b128 v[80:83], v9 offset:2048
    ds_read_b128 v[84:87], v9 offset:3072
    ds_read_b128 v[88:91], v9 offset:4096
    ds_read_b128 v[92:95], v9 offset:5120
    ds_read_b128 v[96:99], v9 offset:6144
    ds_read_b128 v[100:103], v9 offset:7168
    v_mov_b32 v173, 0xce6e6b28
    s_waitcnt lgkmcnt(4)
    v_mfma_f32_16x16x32_bf16 v[140:143], v[72:75], v[120:123], 0
    ds_read_b128 v[104:107], v8 offset:8192
    v_mfma_f32_16x16x32_bf16 v[140:143], v[76:79], v[124:127], v[140:143]
    ds_read_b128 v[108:111], v8 offset:9216
    v_mfma_f32_16x16x32_bf16 v[140:143], v[80:83], v[128:131], v[140:143]
    ds_read_b128 v[112:115], v8 offset:10240
    v_mfma_f32_16x16x32_bf16 v[140:143], v[84:87], v[132:135], v[140:143]
    ds_read_b128 v[116:119], v8 offset:11264
    s_waitcnt lgkmcnt(4)
    v_mfma_f32_16x16x32_bf16 v[144:147], v[88:91], v[120:123], 0
    v_mfma_f32_16x16x32_bf16 v[144:147], v[92:95], v[124:127], v[144:147]
    v_mfma_f32_16x16x32_bf16 v[144:147], v[96:99], v[128:131], v[144:147]
    v_mfma_f32_16x16x32_bf16 v[144:147], v[100:103], v[132:135], v[144:147]
    s_nop 1
    v_cvt_pk_bf16_f32 v174, v140, v141
    v_lshlrev_b32 v140, 16, v174
    v_and_b32 v141, 0xffff0000, v174
    v_mul_f32 v140, 0x3db504f3, v140
    v_mul_f32 v141, 0x3db504f3, v141
    v_cvt_pk_bf16_f32 v174, v140, v141
    v_lshlrev_b32 v140, 16, v174
    v_and_b32 v141, 0xffff0000, v174
    v_cvt_pk_bf16_f32 v174, v142, v143
    v_lshlrev_b32 v142, 16, v174
    v_and_b32 v143, 0xffff0000, v174
    v_mul_f32 v142, 0x3db504f3, v142
    v_mul_f32 v143, 0x3db504f3, v143
    v_cvt_pk_bf16_f32 v174, v142, v143
    v_lshlrev_b32 v142, 16, v174
    v_and_b32 v143, 0xffff0000, v174
    v_cvt_pk_bf16_f32 v174, v144, v145
    v_lshlrev_b32 v144, 16, v174
    v_and_b32 v145, 0xffff0000, v174
    v_mul_f32 v144, 0x3db504f3, v144
    v_mul_f32 v145, 0x3db504f3, v145
    v_cvt_pk_bf16_f32 v174, v144, v145
    v_lshlrev_b32 v144, 16, v174
    v_and_b32 v145, 0xffff0000, v174
    v_cvt_pk_bf16_f32 v174, v146, v147
    v_lshlrev_b32 v146, 16, v174
    v_and_b32 v147, 0xffff0000, v174
    v_mul_f32 v146, 0x3db504f3, v146
    v_mul_f32 v147, 0x3db504f3, v147
    v_cvt_pk_bf16_f32 v174, v146, v147
    v_lshlrev_b32 v146, 16, v174
    v_and_b32 v147, 0xffff0000, v174
    v_cndmask_b32 v140, v173, v140, s[44:45]
    v_cndmask_b32 v141, v173, v141, s[46:47]
    v_cndmask_b32 v142, v173, v142, s[48:49]
    v_cndmask_b32 v143, v173, v143, s[50:51]
    v_cndmask_b32 v144, v173, v144, s[52:53]
    v_cndmask_b32 v145, v173, v145, s[54:55]
    v_cndmask_b32 v146, v173, v146, s[56:57]
    v_cndmask_b32 v147, v173, v147, s[58:59]
    v_max3_f32 v172, v140, v141, v142
    v_max3_f32 v172, v172, v143, v144
    v_max3_f32 v172, v172, v145, v146
    v_max_f32 v172, v172, v147
    s_waitcnt lgkmcnt(0)
    s_waitcnt vmcnt(0)
    s_lshl_b32 s29, s39, 7
H2_loop:
    s_lshl_b32 s22, s18, 5
    s_add_u32 s22, s22, s16
    s_add_u32 s25, s18, 4
    s_min_u32 s25, s25, 63
    s_cmp_gt_u32 s32, s25
    s_cbranch_scc1 H2_kvdb
    v_lshlrev_b32 v11, 2, v1
    s_lshl_b32 s28, s16, 8
H2_kvwb:
    buffer_load_dword v7, v11, s[4:7], s28 offen sc1
    s_add_u32 s23, s23, 1
    s_cmp_gt_u32 s23, 262144
    s_waitcnt vmcnt(0)
    s_cbranch_scc1 H2_kvdb
    v_cmp_ne_u32 vcc, 0, v7
    s_nop 0
    s_ff0_i32_b64 s32, vcc
    s_cmp_gt_u32 s32, s25
    s_cbranch_scc0 H2_kvwb
H2_kvdb:
    s_mul_i32 s26, s16, 65
    s_add_u32 s26, s26, s18
    s_lshl_b32 s26, s26, 12
    s_add_u32 s26, s26, 37752832
    s_lshl_b32 s27, s17, 10
    s_add_u32 s27, s27, s26
    s_lshr_b32 s24, s17, 1
    s_lshl_b32 s24, s24, 11
    s_add_u32 s26, s26, s24
    s_branch H2_kme
H2_kmr:
    s_cmp_ge_u32 s18, 61
    s_cbranch_scc1 H2_kmp
    v_mov_b32 v167, 0
H2_kmc:
    s_sleep 8
    buffer_load_dword v166, v167, s[4:7], s27 offen sc1
    s_add_u32 s23, s23, 1
    s_cmp_gt_u32 s23, 262144
    s_waitcnt vmcnt(0)
    s_cbranch_scc1 H2_kmp
    v_cmp_eq_u32 vcc, -1, v166
    s_cbranch_vccnz H2_kmc
H2_kmp:
    buffer_load_dwordx2 v[164:165], v6, s[4:7], s27 offen sc1
    buffer_load_dwordx2 v[168:169], v6, s[4:7], s26 offen offset:8 sc1
    buffer_load_dwordx2 v[170:171], v6, s[4:7], s26 offen offset:1032 sc1
    s_add_u32 s23, s23, 1
    s_cmp_gt_u32 s23, 262144
    s_waitcnt vmcnt(0)
    s_cbranch_scc1 H2_kmd
H2_kme:
    v_max3_u32 v166, v164, v165, v168
    v_max3_u32 v166, v166, v169, v170
    v_max_u32 v166, v166, v171
    v_cmp_eq_u32 vcc, -1, v166
    s_cbranch_vccnz H2_kmr
H2_kmd:
    ds_write2st64_b32 v25, v164, v165 offset0:0 offset1:2
    s_lshl_b32 s24, s22, 10
    buffer_load_dword v10, v39, s[8:11], s24 offen
    s_waitcnt lgkmcnt(0)
    s_barrier
    ds_read_b64_tr_b16 v[148:149], v26 offset:0
    ds_read_b64_tr_b16 v[150:151], v26 offset:512
    ds_read_b64_tr_b16 v[152:153], v26 offset:1024
    ds_read_b64_tr_b16 v[154:155], v26 offset:1536
    ds_read_b64_tr_b16 v[156:157], v26 offset:2048
    ds_read_b64_tr_b16 v[158:159], v26 offset:2560
    ds_read_b64_tr_b16 v[160:161], v26 offset:3072
    ds_read_b64_tr_b16 v[162:163], v26 offset:3584
    s_add_u32 s26, s18, 4
    s_lshl_b32 s21, s26, 15
    s_add_u32 s21, s21, 52428800
    s_lshl_b32 s27, s26, 19
    s_lshl_b32 s25, s16, 14
    s_add_u32 s27, s27, s25
    s_lshl_b32 s25, s17, 12
    s_add_u32 s27, s27, s25
    s_add_u32 s27, s27, 2097152
    s_add_u32 m0, s25, 131072
    s_cmp_ge_u32 s26, 64
    s_cselect_b32 s21, 1073741824, s21
    s_cselect_b32 s27, 1073741824, s27
    s_waitcnt lgkmcnt(6)
    v_mfma_f32_16x16x32_bf16 v[136:139], v[148:151], v[120:123], 0
    s_waitcnt lgkmcnt(4)
    v_mfma_f32_16x16x32_bf16 v[136:139], v[152:155], v[124:127], v[136:139]
    s_waitcnt lgkmcnt(2)
    v_mfma_f32_16x16x32_bf16 v[136:139], v[156:159], v[128:131], v[136:139]
    s_waitcnt lgkmcnt(0)
    v_mfma_f32_16x16x32_bf16 v[136:139], v[160:163], v[132:135], v[136:139]
    buffer_load_dwordx4 v6, s[4:7], s27 offen offset:0 sc1 lds
    s_nop 6
    v_cvt_pk_bf16_f32 v174, v136, v137
    v_lshlrev_b32 v136, 16, v174
    v_and_b32 v137, 0xffff0000, v174
    v_mul_f32 v136, 0x3db504f3, v136
    v_mul_f32 v137, 0x3db504f3, v137
    v_cvt_pk_bf16_f32 v174, v136, v137
    v_lshlrev_b32 v136, 16, v174
    v_and_b32 v137, 0xffff0000, v174
    v_max3_f32 v172, v172, v136, v137
    v_mov_b32 v174, v172
    s_nop 1
    v_permlane16_swap_b32 v172, v174
    v_max_f32 v172, v172, v174
    v_mov_b32 v174, v172
    s_nop 1
    v_permlane32_swap_b32 v172, v174
    v_max_f32 v172, v172, v174
    v_mov_b32 v174, 0x3fb8aa3b
    v_pk_add_f32 v[140:141], v[140:141], v[172:173] op_sel_hi:[1,0] neg_lo:[0,1] neg_hi:[0,1]
    v_pk_add_f32 v[142:143], v[142:143], v[172:173] op_sel_hi:[1,0] neg_lo:[0,1] neg_hi:[0,1]
    v_pk_add_f32 v[144:145], v[144:145], v[172:173] op_sel_hi:[1,0] neg_lo:[0,1] neg_hi:[0,1]
    v_pk_add_f32 v[146:147], v[146:147], v[172:173] op_sel_hi:[1,0] neg_lo:[0,1] neg_hi:[0,1]
    v_pk_add_f32 v[136:137], v[136:137], v[172:173] op_sel_hi:[1,0] neg_lo:[0,1] neg_hi:[0,1]
    v_pk_mul_f32 v[140:141], v[140:141], v[174:175] op_sel_hi:[1,0]
    v_pk_mul_f32 v[142:143], v[142:143], v[174:175] op_sel_hi:[1,0]
    v_pk_mul_f32 v[144:145], v[144:145], v[174:175] op_sel_hi:[1,0]
    v_pk_mul_f32 v[146:147], v[146:147], v[174:175] op_sel_hi:[1,0]
    v_pk_mul_f32 v[136:137], v[136:137], v[174:175] op_sel_hi:[1,0]
    v_exp_f32 v140, v140
    v_exp_f32 v141, v141
    v_exp_f32 v142, v142
    v_exp_f32 v143, v143
    v_exp_f32 v144, v144
    v_exp_f32 v145, v145
    v_exp_f32 v146, v146
    v_exp_f32 v147, v147
    v_exp_f32 v136, v136
    v_exp_f32 v137, v137
    v_pk_add_f32 v[172:173], v[140:141], v[142:143]
    v_pk_add_f32 v[172:173], v[172:173], v[144:145]
    v_pk_add_f32 v[172:173], v[172:173], v[146:147]
    v_pk_add_f32 v[172:173], v[172:173], v[136:137]
    v_add_f32 v172, v172, v173
    v_mov_b32 v174, v172
    s_nop 1
    v_permlane16_swap_b32 v172, v174
    v_add_f32 v172, v172, v174
    v_mov_b32 v174, v172
    s_nop 1
    v_permlane32_swap_b32 v172, v174
    v_add_f32 v172, v172, v174
    v_rcp_f32 v172, v172
    s_nop 0
    v_pk_mul_f32 v[140:141], v[140:141], v[172:173] op_sel_hi:[1,0]
    v_pk_mul_f32 v[142:143], v[142:143], v[172:173] op_sel_hi:[1,0]
    v_pk_mul_f32 v[144:145], v[144:145], v[172:173] op_sel_hi:[1,0]
    v_pk_mul_f32 v[146:147], v[146:147], v[172:173] op_sel_hi:[1,0]
    v_pk_mul_f32 v[136:137], v[136:137], v[172:173] op_sel_hi:[1,0]
    v_cvt_pk_bf16_f32 v140, v140, v141
    v_cvt_pk_bf16_f32 v141, v142, v143
    v_cvt_pk_bf16_f32 v142, v144, v145
    v_cvt_pk_bf16_f32 v143, v146, v147
    v_cvt_pk_bf16_f32 v30, v136, v137
    v_cvt_pk_bf16_f32 v33, v136, v137
    v_mfma_f32_16x16x32_bf16 v[40:43], v[104:107], v[140:143], 0
    buffer_load_dwordx4 v6, s[4:7], s27 offen offset:1024 sc1 lds
    v_mfma_f32_16x16x32_bf16 v[44:47], v[108:111], v[140:143], 0
    v_mfma_f32_16x16x32_bf16 v[48:51], v[112:115], v[140:143], 0
    v_mfma_f32_16x16x32_bf16 v[52:55], v[116:119], v[140:143], 0
    s_nop 1
    v_mfma_f32_16x16x16_bf16 v[40:43], v[168:169], v[30:31], v[40:43]
    s_nop 0
    v_mfma_f32_16x16x16_bf16 v[44:47], v[168:169], v[32:33], v[44:47]
    v_mfma_f32_16x16x16_bf16 v[48:51], v[170:171], v[30:31], v[48:51]
    v_mfma_f32_16x16x16_bf16 v[52:55], v[170:171], v[32:33], v[52:55]
    buffer_load_dwordx4 v6, s[4:7], s27 offen offset:2048 sc1 lds
    s_nop 2
    v_cvt_pk_bf16_f32 v120, v40, v41
    v_cvt_pk_bf16_f32 v121, v42, v43
    v_cvt_pk_bf16_f32 v122, v44, v45
    v_cvt_pk_bf16_f32 v123, v46, v47
    ds_write_b128 v36, v[120:123] offset:45056
    v_cvt_pk_bf16_f32 v124, v48, v49
    v_cvt_pk_bf16_f32 v125, v50, v51
    v_cvt_pk_bf16_f32 v126, v52, v53
    v_cvt_pk_bf16_f32 v127, v54, v55
    ds_write_b128 v36, v[124:127] offset:46080
    s_lshl_b32 s24, s39, 20
    s_lshl_b32 s25, s16, 10
    s_add_u32 s24, s24, s25
    s_add_u32 s24, s24, 67108864
    s_waitcnt lgkmcnt(0)
    s_barrier
    ds_read_b128 v[40:43], v37 offset:45056
    ds_read_b128 v[44:47], v37 offset:46080
    ds_read_b128 v[48:51], v37 offset:47104
    ds_read_b128 v[52:55], v37 offset:48128
    ds_read_b128 v[56:59], v37 offset:49152
    ds_read_b128 v[60:63], v37 offset:50176
    ds_read_b128 v[64:67], v37 offset:51200
    ds_read_b128 v[68:71], v37 offset:52224
    buffer_load_dwordx4 v6, s[4:7], s27 offen offset:3072 sc1 lds
    s_lshl_b32 s34, s17, 13
    s_add_u32 s35, s34, s21
    s_add_u32 s34, s34, 0
    s_and_b32 s36, s17, 1
    s_lshl_b32 s36, s36, 7
    s_cmp_eq_u32 s31, 0
    s_cbranch_scc1 dg_20
    s_waitcnt lgkmcnt(4)
    v_mfma_f32_16x16x32_bf16 v[72:75], a[128:131], v[40:43], 0
    v_mfma_f32_16x16x32_bf16 v[72:75], a[132:135], v[44:47], v[72:75]
    s_mov_b32 m0, s34
    s_add_u32 s34, s34, 1024
    v_xor_b32 v24, s36, v6
    v_mfma_f32_16x16x32_bf16 v[72:75], a[136:139], v[48:51], v[72:75]
    buffer_load_dwordx4 v24, s[4:7], s35 offen sc1 lds
    s_add_u32 s35, s35, 1024
    s_add_u32 s36, s36, 16
    v_mfma_f32_16x16x32_bf16 v[72:75], a[140:143], v[52:55], v[72:75]
    v_mfma_f32_16x16x32_bf16 v[76:79], a[144:147], v[40:43], 0
    v_mfma_f32_16x16x32_bf16 v[76:79], a[148:151], v[44:47], v[76:79]
    s_mov_b32 m0, s34
    s_add_u32 s34, s34, 1024
    v_xor_b32 v24, s36, v6
    v_mfma_f32_16x16x32_bf16 v[76:79], a[152:155], v[48:51], v[76:79]
    buffer_load_dwordx4 v24, s[4:7], s35 offen sc1 lds
    s_add_u32 s35, s35, 1024
    s_add_u32 s36, s36, 16
    v_mfma_f32_16x16x32_bf16 v[76:79], a[156:159], v[52:55], v[76:79]
    v_mfma_f32_16x16x32_bf16 v[80:83], a[160:163], v[40:43], 0
    v_mfma_f32_16x16x32_bf16 v[80:83], a[164:167], v[44:47], v[80:83]
    s_mov_b32 m0, s34
    s_add_u32 s34, s34, 1024
    v_xor_b32 v24, s36, v6
    v_mfma_f32_16x16x32_bf16 v[80:83], a[168:171], v[48:51], v[80:83]
    buffer_load_dwordx4 v24, s[4:7], s35 offen sc1 lds
    s_add_u32 s35, s35, 1024
    s_add_u32 s36, s36, 16
    v_mfma_f32_16x16x32_bf16 v[80:83], a[172:175], v[52:55], v[80:83]
    v_cvt_pk_bf16_f32 v72, v72, v73
    v_cvt_pk_bf16_f32 v73, v74, v75
    v_mfma_f32_16x16x32_bf16 v[84:87], a[176:179], v[40:43], 0
    v_cvt_pk_bf16_f32 v74, v76, v77
    v_cvt_pk_bf16_f32 v75, v78, v79
    v_mfma_f32_16x16x32_bf16 v[84:87], a[180:183], v[44:47], v[84:87]
    ds_write_b128 v27, v[72:75] offset:0
    v_mfma_f32_16x16x32_bf16 v[84:87], a[184:187], v[48:51], v[84:87]
    v_mfma_f32_16x16x32_bf16 v[84:87], a[188:191], v[52:55], v[84:87]
    s_mov_b32 m0, s34
    s_add_u32 s34, s34, 1024
    v_xor_b32 v24, s36, v6
    v_mfma_f32_16x16x32_bf16 v[88:91], a[192:195], v[40:43], 0
    buffer_load_dwordx4 v24, s[4:7], s35 offen sc1 lds
    s_add_u32 s35, s35, 1024
    s_add_u32 s36, s36, 16
    v_mfma_f32_16x16x32_bf16 v[88:91], a[196:199], v[44:47], v[88:91]
    v_mfma_f32_16x16x32_bf16 v[88:91], a[200:203], v[48:51], v[88:91]
    v_mfma_f32_16x16x32_bf16 v[88:91], a[204:207], v[52:55], v[88:91]
    v_cvt_pk_bf16_f32 v80, v80, v81
    v_cvt_pk_bf16_f32 v81, v82, v83
    v_mfma_f32_16x16x32_bf16 v[92:95], a[208:211], v[40:43], 0
    v_cvt_pk_bf16_f32 v82, v84, v85
    v_cvt_pk_bf16_f32 v83, v86, v87
    v_mfma_f32_16x16x32_bf16 v[92:95], a[212:215], v[44:47], v[92:95]
    ds_write_b128 v27, v[80:83] offset:64
    v_mfma_f32_16x16x32_bf16 v[92:95], a[216:219], v[48:51], v[92:95]
    s_mov_b32 m0, s34
    s_add_u32 s34, s34, 1024
    v_xor_b32 v24, s36, v6
    v_mfma_f32_16x16x32_bf16 v[92:95], a[220:223], v[52:55], v[92:95]
    buffer_load_dwordx4 v24, s[4:7], s35 offen sc1 lds
    s_add_u32 s35, s35, 1024
    s_add_u32 s36, s36, 16
    v_mfma_f32_16x16x32_bf16 v[96:99], a[224:227], v[40:43], 0
    v_mfma_f32_16x16x32_bf16 v[96:99], a[228:231], v[44:47], v[96:99]
    s_mov_b32 m0, s34
    s_add_u32 s34, s34, 1024
    v_xor_b32 v24, s36, v6
    v_mfma_f32_16x16x32_bf16 v[96:99], a[232:235], v[48:51], v[96:99]
    buffer_load_dwordx4 v24, s[4:7], s35 offen sc1 lds
    s_add_u32 s35, s35, 1024
    s_add_u32 s36, s36, 16
    v_mfma_f32_16x16x32_bf16 v[96:99], a[236:239], v[52:55], v[96:99]
    v_cvt_pk_bf16_f32 v88, v88, v89
    v_cvt_pk_bf16_f32 v89, v90, v91
    v_mfma_f32_16x16x32_bf16 v[100:103], a[240:243], v[40:43], 0
    v_cvt_pk_bf16_f32 v90, v92, v93
    v_cvt_pk_bf16_f32 v91, v94, v95
    v_mfma_f32_16x16x32_bf16 v[100:103], a[244:247], v[44:47], v[100:103]
    ds_write_b128 v27, v[88:91] offset:128
    v_mfma_f32_16x16x32_bf16 v[100:103], a[248:251], v[48:51], v[100:103]
    s_waitcnt lgkmcnt(3)
    v_mfma_f32_16x16x32_bf16 v[100:103], a[252:255], v[52:55], v[100:103]
    s_mov_b32 m0, s34
    s_add_u32 s34, s34, 1024
    v_xor_b32 v24, s36, v6
    v_mfma_f32_16x16x32_bf16 v[104:107], a[128:131], v[56:59], 0
    buffer_load_dwordx4 v24, s[4:7], s35 offen sc1 lds
    s_add_u32 s35, s35, 1024
    s_add_u32 s36, s36, 16
    v_mfma_f32_16x16x32_bf16 v[104:107], a[132:135], v[60:63], v[104:107]
    v_mfma_f32_16x16x32_bf16 v[104:107], a[136:139], v[64:67], v[104:107]
    v_mfma_f32_16x16x32_bf16 v[104:107], a[140:143], v[68:71], v[104:107]
    v_cvt_pk_bf16_f32 v96, v96, v97
    v_cvt_pk_bf16_f32 v97, v98, v99
    v_mfma_f32_16x16x32_bf16 v[108:111], a[144:147], v[56:59], 0
    v_cvt_pk_bf16_f32 v98, v100, v101
    v_cvt_pk_bf16_f32 v99, v102, v103
    v_mfma_f32_16x16x32_bf16 v[108:111], a[148:151], v[60:63], v[108:111]
    ds_write_b128 v27, v[96:99] offset:192
    v_mfma_f32_16x16x32_bf16 v[108:111], a[152:155], v[64:67], v[108:111]
    s_mov_b32 m0, s34
    s_add_u32 s34, s34, 1024
    v_xor_b32 v24, s36, v6
    v_mfma_f32_16x16x32_bf16 v[108:111], a[156:159], v[68:71], v[108:111]
    buffer_load_dwordx4 v24, s[4:7], s35 offen sc1 lds
    s_add_u32 s35, s35, 1024
    s_add_u32 s36, s36, 16
    v_mfma_f32_16x16x32_bf16 v[112:115], a[160:163], v[56:59], 0
    s_waitcnt lgkmcnt(0)
    ds_read_b128 v[136:139], v28 offset:0
    ds_read_b128 v[140:143], v28 offset:1088
    v_mfma_f32_16x16x32_bf16 v[112:115], a[164:167], v[60:63], v[112:115]
    ds_read_b128 v[144:147], v28 offset:2176
    ds_read_b128 v[148:151], v28 offset:3264
    v_mfma_f32_16x16x32_bf16 v[112:115], a[168:171], v[64:67], v[112:115]
    v_mfma_f32_16x16x32_bf16 v[112:115], a[172:175], v[68:71], v[112:115]
    v_cvt_pk_bf16_f32 v104, v104, v105
    v_cvt_pk_bf16_f32 v105, v106, v107
    v_mfma_f32_16x16x32_bf16 v[116:119], a[176:179], v[56:59], 0
    v_cvt_pk_bf16_f32 v106, v108, v109
    v_cvt_pk_bf16_f32 v107, v110, v111
    v_mfma_f32_16x16x32_bf16 v[116:119], a[180:183], v[60:63], v[116:119]
    ds_write_b128 v27, v[104:107] offset:4352
    v_mfma_f32_16x16x32_bf16 v[116:119], a[184:187], v[64:67], v[116:119]
    v_mfma_f32_16x16x32_bf16 v[116:119], a[188:191], v[68:71], v[116:119]
    s_waitcnt lgkmcnt(1)
    buffer_store_dwordx4 v[136:139], v29, s[4:7], s24 offen
    s_add_u32 s24, s24, 131072
    v_mfma_f32_16x16x32_bf16 v[120:123], a[192:195], v[56:59], 0
    v_mfma_f32_16x16x32_bf16 v[120:123], a[196:199], v[60:63], v[120:123]
    v_mfma_f32_16x16x32_bf16 v[120:123], a[200:203], v[64:67], v[120:123]
    v_mfma_f32_16x16x32_bf16 v[120:123], a[204:207], v[68:71], v[120:123]
    buffer_store_dwordx4 v[140:143], v29, s[4:7], s24 offen
    s_add_u32 s24, s24, 131072
    v_cvt_pk_bf16_f32 v112, v112, v113
    v_cvt_pk_bf16_f32 v113, v114, v115
    v_mfma_f32_16x16x32_bf16 v[124:127], a[208:211], v[56:59], 0
    v_cvt_pk_bf16_f32 v114, v116, v117
    v_cvt_pk_bf16_f32 v115, v118, v119
    v_mfma_f32_16x16x32_bf16 v[124:127], a[212:215], v[60:63], v[124:127]
    ds_write_b128 v27, v[112:115] offset:4416
    v_mfma_f32_16x16x32_bf16 v[124:127], a[216:219], v[64:67], v[124:127]
    v_mfma_f32_16x16x32_bf16 v[124:127], a[220:223], v[68:71], v[124:127]
    buffer_store_dwordx4 v[144:147], v29, s[4:7], s24 offen
    s_add_u32 s24, s24, 131072
    v_mfma_f32_16x16x32_bf16 v[128:131], a[224:227], v[56:59], 0
    v_mfma_f32_16x16x32_bf16 v[128:131], a[228:231], v[60:63], v[128:131]
    v_mfma_f32_16x16x32_bf16 v[128:131], a[232:235], v[64:67], v[128:131]
    v_mfma_f32_16x16x32_bf16 v[128:131], a[236:239], v[68:71], v[128:131]
    buffer_store_dwordx4 v[148:151], v29, s[4:7], s24 offen
    s_add_u32 s24, s24, 131072
    v_cvt_pk_bf16_f32 v120, v120, v121
    v_cvt_pk_bf16_f32 v121, v122, v123
    v_mfma_f32_16x16x32_bf16 v[132:135], a[240:243], v[56:59], 0
    v_cvt_pk_bf16_f32 v122, v124, v125
    v_cvt_pk_bf16_f32 v123, v126, v127
    v_mfma_f32_16x16x32_bf16 v[132:135], a[244:247], v[60:63], v[132:135]
    ds_write_b128 v27, v[120:123] offset:4480
    v_mfma_f32_16x16x32_bf16 v[132:135], a[248:251], v[64:67], v[132:135]
    v_mfma_f32_16x16x32_bf16 v[132:135], a[252:255], v[68:71], v[132:135]
    v_cvt_pk_bf16_f32 v128, v128, v129
    v_cvt_pk_bf16_f32 v129, v130, v131
    s_nop 5
    v_cvt_pk_bf16_f32 v130, v132, v133
    v_cvt_pk_bf16_f32 v131, v134, v135
    ds_write_b128 v27, v[128:131] offset:4544
    s_waitcnt lgkmcnt(0)
    ds_read_b128 v[136:139], v28 offset:4352
    ds_read_b128 v[140:143], v28 offset:5440
    ds_read_b128 v[144:147], v28 offset:6528
    ds_read_b128 v[148:151], v28 offset:7616
    s_waitcnt lgkmcnt(3)
    buffer_store_dwordx4 v[136:139], v29, s[4:7], s24 offen
    s_add_u32 s24, s24, 131072
    s_waitcnt lgkmcnt(2)
    buffer_store_dwordx4 v[140:143], v29, s[4:7], s24 offen
    s_add_u32 s24, s24, 131072
    s_waitcnt lgkmcnt(1)
    buffer_store_dwordx4 v[144:147], v29, s[4:7], s24 offen
    s_add_u32 s24, s24, 131072
    s_waitcnt lgkmcnt(0)
    buffer_store_dwordx4 v[148:151], v29, s[4:7], s24 offen
    s_add_u32 s24, s24, 131072
    s_branch de_21
dg_20:
    s_waitcnt lgkmcnt(4)
    v_mfma_f32_16x16x32_bf16 v[72:75], a[128:131], v[40:43], 0
    v_mfma_f32_16x16x32_bf16 v[72:75], a[132:135], v[44:47], v[72:75]
    s_mov_b32 m0, s34
    s_add_u32 s34, s34, 1024
    v_xor_b32 v24, s36, v6
    v_mfma_f32_16x16x32_bf16 v[72:75], a[136:139], v[48:51], v[72:75]
    buffer_load_dwordx4 v24, s[4:7], s35 offen sc1 lds
    s_add_u32 s35, s35, 1024
    s_add_u32 s36, s36, 16
    v_mfma_f32_16x16x32_bf16 v[72:75], a[140:143], v[52:55], v[72:75]
    v_mfma_f32_16x16x32_bf16 v[76:79], a[144:147], v[40:43], 0
    v_mfma_f32_16x16x32_bf16 v[76:79], a[148:151], v[44:47], v[76:79]
    s_mov_b32 m0, s34
    s_add_u32 s34, s34, 1024
    v_xor_b32 v24, s36, v6
    v_mfma_f32_16x16x32_bf16 v[76:79], a[152:155], v[48:51], v[76:79]
    buffer_load_dwordx4 v24, s[4:7], s35 offen sc1 lds
    s_add_u32 s35, s35, 1024
    s_add_u32 s36, s36, 16
    v_mfma_f32_16x16x32_bf16 v[76:79], a[156:159], v[52:55], v[76:79]
    v_mfma_f32_16x16x32_bf16 v[80:83], a[160:163], v[40:43], 0
    v_mfma_f32_16x16x32_bf16 v[80:83], a[164:167], v[44:47], v[80:83]
    s_mov_b32 m0, s34
    s_add_u32 s34, s34, 1024
    v_xor_b32 v24, s36, v6
    v_mfma_f32_16x16x32_bf16 v[80:83], a[168:171], v[48:51], v[80:83]
    buffer_load_dwordx4 v24, s[4:7], s35 offen sc1 lds
    s_add_u32 s35, s35, 1024
    s_add_u32 s36, s36, 16
    v_mfma_f32_16x16x32_bf16 v[80:83], a[172:175], v[52:55], v[80:83]
    v_cvt_pk_bf16_f32 v72, v72, v73
    v_cvt_pk_bf16_f32 v73, v74, v75
    v_mfma_f32_16x16x32_bf16 v[84:87], a[176:179], v[40:43], 0
    v_cvt_pk_bf16_f32 v74, v76, v77
    v_cvt_pk_bf16_f32 v75, v78, v79
    v_mfma_f32_16x16x32_bf16 v[84:87], a[180:183], v[44:47], v[84:87]
    ds_write_b128 v27, v[72:75] offset:0
    v_mfma_f32_16x16x32_bf16 v[84:87], a[184:187], v[48:51], v[84:87]
    v_mfma_f32_16x16x32_bf16 v[84:87], a[188:191], v[52:55], v[84:87]
    s_mov_b32 m0, s34
    s_add_u32 s34, s34, 1024
    v_xor_b32 v24, s36, v6
    v_mfma_f32_16x16x32_bf16 v[88:91], a[192:195], v[40:43], 0
    buffer_load_dwordx4 v24, s[4:7], s35 offen sc1 lds
    s_add_u32 s35, s35, 1024
    s_add_u32 s36, s36, 16
    v_mfma_f32_16x16x32_bf16 v[88:91], a[196:199], v[44:47], v[88:91]
    v_mfma_f32_16x16x32_bf16 v[88:91], a[200:203], v[48:51], v[88:91]
    v_mfma_f32_16x16x32_bf16 v[88:91], a[204:207], v[52:55], v[88:91]
    v_cvt_pk_bf16_f32 v80, v80, v81
    v_cvt_pk_bf16_f32 v81, v82, v83
    v_mfma_f32_16x16x32_bf16 v[92:95], a[208:211], v[40:43], 0
    v_cvt_pk_bf16_f32 v82, v84, v85
    v_cvt_pk_bf16_f32 v83, v86, v87
    v_mfma_f32_16x16x32_bf16 v[92:95], a[212:215], v[44:47], v[92:95]
    ds_write_b128 v27, v[80:83] offset:64
    v_mfma_f32_16x16x32_bf16 v[92:95], a[216:219], v[48:51], v[92:95]
    s_mov_b32 m0, s34
    s_add_u32 s34, s34, 1024
    v_xor_b32 v24, s36, v6
    v_mfma_f32_16x16x32_bf16 v[92:95], a[220:223], v[52:55], v[92:95]
    buffer_load_dwordx4 v24, s[4:7], s35 offen sc1 lds
    s_add_u32 s35, s35, 1024
    s_add_u32 s36, s36, 16
    v_mfma_f32_16x16x32_bf16 v[96:99], a[224:227], v[40:43], 0
    v_mfma_f32_16x16x32_bf16 v[96:99], a[228:231], v[44:47], v[96:99]
    s_mov_b32 m0, s34
    s_add_u32 s34, s34, 1024
    v_xor_b32 v24, s36, v6
    v_mfma_f32_16x16x32_bf16 v[96:99], a[232:235], v[48:51], v[96:99]
    buffer_load_dwordx4 v24, s[4:7], s35 offen sc1 lds
    s_add_u32 s35, s35, 1024
    s_add_u32 s36, s36, 16
    v_mfma_f32_16x16x32_bf16 v[96:99], a[236:239], v[52:55], v[96:99]
    v_cvt_pk_bf16_f32 v88, v88, v89
    v_cvt_pk_bf16_f32 v89, v90, v91
    v_mfma_f32_16x16x32_bf16 v[100:103], a[240:243], v[40:43], 0
    v_cvt_pk_bf16_f32 v90, v92, v93
    v_cvt_pk_bf16_f32 v91, v94, v95
    v_mfma_f32_16x16x32_bf16 v[100:103], a[244:247], v[44:47], v[100:103]
    ds_write_b128 v27, v[88:91] offset:128
    v_mfma_f32_16x16x32_bf16 v[100:103], a[248:251], v[48:51], v[100:103]
    s_waitcnt lgkmcnt(3)
    v_mfma_f32_16x16x32_bf16 v[100:103], a[252:255], v[52:55], v[100:103]
    s_mov_b32 m0, s34
    s_add_u32 s34, s34, 1024
    v_xor_b32 v24, s36, v6
    v_mfma_f32_16x16x32_bf16 v[104:107], a[128:131], v[56:59], 0
    buffer_load_dwordx4 v24, s[4:7], s35 offen sc1 lds
    s_add_u32 s35, s35, 1024
    s_add_u32 s36, s36, 16
    v_mfma_f32_16x16x32_bf16 v[104:107], a[132:135], v[60:63], v[104:107]
    v_mfma_f32_16x16x32_bf16 v[104:107], a[136:139], v[64:67], v[104:107]
    v_mfma_f32_16x16x32_bf16 v[104:107], a[140:143], v[68:71], v[104:107]
    v_cvt_pk_bf16_f32 v96, v96, v97
    v_cvt_pk_bf16_f32 v97, v98, v99
    v_mfma_f32_16x16x32_bf16 v[108:111], a[144:147], v[56:59], 0
    v_cvt_pk_bf16_f32 v98, v100, v101
    v_cvt_pk_bf16_f32 v99, v102, v103
    v_mfma_f32_16x16x32_bf16 v[108:111], a[148:151], v[60:63], v[108:111]
    ds_write_b128 v27, v[96:99] offset:192
    v_mfma_f32_16x16x32_bf16 v[108:111], a[152:155], v[64:67], v[108:111]
    s_mov_b32 m0, s34
    s_add_u32 s34, s34, 1024
    v_xor_b32 v24, s36, v6
    v_mfma_f32_16x16x32_bf16 v[108:111], a[156:159], v[68:71], v[108:111]
    buffer_load_dwordx4 v24, s[4:7], s35 offen sc1 lds
    s_add_u32 s35, s35, 1024
    s_add_u32 s36, s36, 16
    v_mfma_f32_16x16x32_bf16 v[112:115], a[160:163], v[56:59], 0
    s_waitcnt lgkmcnt(0)
    ds_read_b128 v[136:139], v28 offset:0
    ds_read_b128 v[140:143], v28 offset:1088
    v_mfma_f32_16x16x32_bf16 v[112:115], a[164:167], v[60:63], v[112:115]
    ds_read_b128 v[144:147], v28 offset:2176
    ds_read_b128 v[148:151], v28 offset:3264
    v_mfma_f32_16x16x32_bf16 v[112:115], a[168:171], v[64:67], v[112:115]
    v_mfma_f32_16x16x32_bf16 v[112:115], a[172:175], v[68:71], v[112:115]
    v_cvt_pk_bf16_f32 v104, v104, v105
    v_cvt_pk_bf16_f32 v105, v106, v107
    v_mfma_f32_16x16x32_bf16 v[116:119], a[176:179], v[56:59], 0
    v_cvt_pk_bf16_f32 v106, v108, v109
    v_cvt_pk_bf16_f32 v107, v110, v111
    v_mfma_f32_16x16x32_bf16 v[116:119], a[180:183], v[60:63], v[116:119]
    ds_write_b128 v27, v[104:107] offset:4352
    v_mfma_f32_16x16x32_bf16 v[116:119], a[184:187], v[64:67], v[116:119]
    v_mfma_f32_16x16x32_bf16 v[116:119], a[188:191], v[68:71], v[116:119]
    s_waitcnt lgkmcnt(1)
    buffer_store_dwordx4 v[136:139], v29, s[4:7], s24 offen sc1
    s_add_u32 s24, s24, 131072
    v_mfma_f32_16x16x32_bf16 v[120:123], a[192:195], v[56:59], 0
    v_mfma_f32_16x16x32_bf16 v[120:123], a[196:199], v[60:63], v[120:123]
    v_mfma_f32_16x16x32_bf16 v[120:123], a[200:203], v[64:67], v[120:123]
    v_mfma_f32_16x16x32_bf16 v[120:123], a[204:207], v[68:71], v[120:123]
    buffer_store_dwordx4 v[140:143], v29, s[4:7], s24 offen sc1
    s_add_u32 s24, s24, 131072
    v_cvt_pk_bf16_f32 v112, v112, v113
    v_cvt_pk_bf16_f32 v113, v114, v115
    v_mfma_f32_16x16x32_bf16 v[124:127], a[208:211], v[56:59], 0
    v_cvt_pk_bf16_f32 v114, v116, v117
    v_cvt_pk_bf16_f32 v115, v118, v119
    v_mfma_f32_16x16x32_bf16 v[124:127], a[212:215], v[60:63], v[124:127]
    ds_write_b128 v27, v[112:115] offset:4416
    v_mfma_f32_16x16x32_bf16 v[124:127], a[216:219], v[64:67], v[124:127]
    v_mfma_f32_16x16x32_bf16 v[124:127], a[220:223], v[68:71], v[124:127]
    buffer_store_dwordx4 v[144:147], v29, s[4:7], s24 offen sc1
    s_add_u32 s24, s24, 131072
    v_mfma_f32_16x16x32_bf16 v[128:131], a[224:227], v[56:59], 0
    v_mfma_f32_16x16x32_bf16 v[128:131], a[228:231], v[60:63], v[128:131]
    v_mfma_f32_16x16x32_bf16 v[128:131], a[232:235], v[64:67], v[128:131]
    v_mfma_f32_16x16x32_bf16 v[128:131], a[236:239], v[68:71], v[128:131]
    buffer_store_dwordx4 v[148:151], v29, s[4:7], s24 offen sc1
    s_add_u32 s24, s24, 131072
    v_cvt_pk_bf16_f32 v120, v120, v121
    v_cvt_pk_bf16_f32 v121, v122, v123
    v_mfma_f32_16x16x32_bf16 v[132:135], a[240:243], v[56:59], 0
    v_cvt_pk_bf16_f32 v122, v124, v125
    v_cvt_pk_bf16_f32 v123, v126, v127
    v_mfma_f32_16x16x32_bf16 v[132:135], a[244:247], v[60:63], v[132:135]
    ds_write_b128 v27, v[120:123] offset:4480
    v_mfma_f32_16x16x32_bf16 v[132:135], a[248:251], v[64:67], v[132:135]
    v_mfma_f32_16x16x32_bf16 v[132:135], a[252:255], v[68:71], v[132:135]
    v_cvt_pk_bf16_f32 v128, v128, v129
    v_cvt_pk_bf16_f32 v129, v130, v131
    s_nop 5
    v_cvt_pk_bf16_f32 v130, v132, v133
    v_cvt_pk_bf16_f32 v131, v134, v135
    ds_write_b128 v27, v[128:131] offset:4544
    s_waitcnt lgkmcnt(0)
    ds_read_b128 v[136:139], v28 offset:4352
    ds_read_b128 v[140:143], v28 offset:5440
    ds_read_b128 v[144:147], v28 offset:6528
    ds_read_b128 v[148:151], v28 offset:7616
    s_waitcnt lgkmcnt(3)
    buffer_store_dwordx4 v[136:139], v29, s[4:7], s24 offen sc1
    s_add_u32 s24, s24, 131072
    s_waitcnt lgkmcnt(2)
    buffer_store_dwordx4 v[140:143], v29, s[4:7], s24 offen sc1
    s_add_u32 s24, s24, 131072
    s_waitcnt lgkmcnt(1)
    buffer_store_dwordx4 v[144:147], v29, s[4:7], s24 offen sc1
    s_add_u32 s24, s24, 131072
    s_waitcnt lgkmcnt(0)
    buffer_store_dwordx4 v[148:151], v29, s[4:7], s24 offen sc1
    s_add_u32 s24, s24, 131072
de_21:
    s_add_u32 s28, s29, 8192
    s_cmp_lt_u32 s18, 60
    s_cbranch_scc1 H2_pre1
    s_waitcnt vmcnt(0)
    s_barrier
    s_cmp_lg_u32 s17, 0
    s_cbranch_scc1 gs_22
    s_lshl_b32 s24, s16, 2
    s_add_u32 s25, s18, 1
    v_mov_b32 v7, s25
    v_mov_b32 v11, s24
    s_mov_b64 exec, 1
    s_cmp_eq_u32 s31, 0
    s_cbranch_scc1 dg_23
    buffer_store_dword v7, v11, s[4:7], s28 offen
    s_branch de_24
dg_23:
    buffer_store_dword v7, v11, s[4:7], s28 offen sc1
de_24:
    s_mov_b64 exec, -1
gs_22:
    s_branch H2_pre1d
H2_pre1:
    s_waitcnt vmcnt(8)
    s_barrier
    ds_read_b128 v[40:43], v12 offset:0
    ds_read_b128 v[44:47], v12 offset:16384
    ds_read_b128 v[48:51], v13 offset:0
    ds_read_b128 v[52:55], v13 offset:16384
    ds_read_b128 v[56:59], v14 offset:0
    ds_read_b128 v[60:63], v14 offset:16384
    s_waitcnt lgkmcnt(4)
    v_mfma_f32_16x16x32_bf16 v[148:151], a[0:3], v[40:43], 0
    ds_read_b128 v[64:67], v15 offset:0
    v_mfma_f32_16x16x32_bf16 v[156:159], a[0:3], v[44:47], 0
    ds_read_b128 v[68:71], v15 offset:16384
    v_mfma_f32_16x16x32_bf16 v[152:155], a[64:67], v[40:43], 0
    v_mfma_f32_16x16x32_bf16 v[160:163], a[64:67], v[44:47], 0
    s_waitcnt lgkmcnt(4)
    v_mfma_f32_16x16x32_bf16 v[148:151], a[4:7], v[48:51], v[148:151]
    ds_read_b128 v[40:43], v12 offset:256
    v_mfma_f32_16x16x32_bf16 v[156:159], a[4:7], v[52:55], v[156:159]
    ds_read_b128 v[44:47], v12 offset:16640
    v_mfma_f32_16x16x32_bf16 v[152:155], a[68:71], v[48:51], v[152:155]
    v_mfma_f32_16x16x32_bf16 v[160:163], a[68:71], v[52:55], v[160:163]
    s_waitcnt lgkmcnt(4)
    v_mfma_f32_16x16x32_bf16 v[148:151], a[8:11], v[56:59], v[148:151]
    ds_read_b128 v[48:51], v13 offset:256
    v_mfma_f32_16x16x32_bf16 v[156:159], a[8:11], v[60:63], v[156:159]
    ds_read_b128 v[52:55], v13 offset:16640
    v_mfma_f32_16x16x32_bf16 v[152:155], a[72:75], v[56:59], v[152:155]
    v_mfma_f32_16x16x32_bf16 v[160:163], a[72:75], v[60:63], v[160:163]
    s_waitcnt lgkmcnt(4)
    v_mfma_f32_16x16x32_bf16 v[148:151], a[12:15], v[64:67], v[148:151]
    ds_read_b128 v[56:59], v14 offset:256
    v_mfma_f32_16x16x32_bf16 v[156:159], a[12:15], v[68:71], v[156:159]
    ds_read_b128 v[60:63], v14 offset:16640
    v_mfma_f32_16x16x32_bf16 v[152:155], a[76:79], v[64:67], v[152:155]
    v_mfma_f32_16x16x32_bf16 v[160:163], a[76:79], v[68:71], v[160:163]
    s_waitcnt lgkmcnt(4)
    v_mfma_f32_16x16x32_bf16 v[148:151], a[16:19], v[40:43], v[148:151]
    ds_read_b128 v[64:67], v15 offset:256
    v_mfma_f32_16x16x32_bf16 v[156:159], a[16:19], v[44:47], v[156:159]
    ds_read_b128 v[68:71], v15 offset:16640
    v_mfma_f32_16x16x32_bf16 v[152:155], a[80:83], v[40:43], v[152:155]
    v_mfma_f32_16x16x32_bf16 v[160:163], a[80:83], v[44:47], v[160:163]
    s_waitcnt lgkmcnt(4)
    v_mfma_f32_16x16x32_bf16 v[148:151], a[20:23], v[48:51], v[148:151]
    ds_read_b128 v[40:43], v12 offset:512
    v_mfma_f32_16x16x32_bf16 v[156:159], a[20:23], v[52:55], v[156:159]
    ds_read_b128 v[44:47], v12 offset:16896
    v_mfma_f32_16x16x32_bf16 v[152:155], a[84:87], v[48:51], v[152:155]
    v_mfma_f32_16x16x32_bf16 v[160:163], a[84:87], v[52:55], v[160:163]
    s_waitcnt vmcnt(0)
    s_barrier
    s_cmp_lg_u32 s17, 0
    s_cbranch_scc1 gs_25
    s_lshl_b32 s24, s16, 2
    s_add_u32 s25, s18, 1
    v_mov_b32 v7, s25
    v_mov_b32 v11, s24
    s_mov_b64 exec, 1
    s_cmp_eq_u32 s31, 0
    s_cbranch_scc1 dg_26
    buffer_store_dword v7, v11, s[4:7], s28 offen
    s_branch de_27
dg_26:
    buffer_store_dword v7, v11, s[4:7], s28 offen sc1
de_27:
    s_mov_b64 exec, -1
gs_25:
    s_waitcnt lgkmcnt(4)
    v_mfma_f32_16x16x32_bf16 v[148:151], a[24:27], v[56:59], v[148:151]
    ds_read_b128 v[48:51], v13 offset:512
    v_mfma_f32_16x16x32_bf16 v[156:159], a[24:27], v[60:63], v[156:159]
    ds_read_b128 v[52:55], v13 offset:16896
    v_mfma_f32_16x16x32_bf16 v[152:155], a[88:91], v[56:59], v[152:155]
    v_mfma_f32_16x16x32_bf16 v[160:163], a[88:91], v[60:63], v[160:163]
    s_waitcnt lgkmcnt(4)
    v_mfma_f32_16x16x32_bf16 v[148:151], a[28:31], v[64:67], v[148:151]
    ds_read_b128 v[56:59], v14 offset:512
    v_mfma_f32_16x16x32_bf16 v[156:159], a[28:31], v[68:71], v[156:159]
    ds_read_b128 v[60:63], v14 offset:16896
    v_mfma_f32_16x16x32_bf16 v[152:155], a[92:95], v[64:67], v[152:155]
    v_mfma_f32_16x16x32_bf16 v[160:163], a[92:95], v[68:71], v[160:163]
    s_waitcnt lgkmcnt(4)
    v_mfma_f32_16x16x32_bf16 v[148:151], a[32:35], v[40:43], v[148:151]
    ds_read_b128 v[64:67], v15 offset:512
    v_mfma_f32_16x16x32_bf16 v[156:159], a[32:35], v[44:47], v[156:159]
    ds_read_b128 v[68:71], v15 offset:16896
    v_mfma_f32_16x16x32_bf16 v[152:155], a[96:99], v[40:43], v[152:155]
    v_mfma_f32_16x16x32_bf16 v[160:163], a[96:99], v[44:47], v[160:163]
    s_waitcnt lgkmcnt(4)
    v_mfma_f32_16x16x32_bf16 v[148:151], a[36:39], v[48:51], v[148:151]
    ds_read_b128 v[40:43], v12 offset:768
    v_mfma_f32_16x16x32_bf16 v[156:159], a[36:39], v[52:55], v[156:159]
    ds_read_b128 v[44:47], v12 offset:17152
    v_mfma_f32_16x16x32_bf16 v[152:155], a[100:103], v[48:51], v[152:155]
    v_mfma_f32_16x16x32_bf16 v[160:163], a[100:103], v[52:55], v[160:163]
    s_waitcnt lgkmcnt(4)
    v_mfma_f32_16x16x32_bf16 v[148:151], a[40:43], v[56:59], v[148:151]
    ds_read_b128 v[48:51], v13 offset:768
    v_mfma_f32_16x16x32_bf16 v[156:159], a[40:43], v[60:63], v[156:159]
    ds_read_b128 v[52:55], v13 offset:17152
    v_mfma_f32_16x16x32_bf16 v[152:155], a[104:107], v[56:59], v[152:155]
    v_mfma_f32_16x16x32_bf16 v[160:163], a[104:107], v[60:63], v[160:163]
    s_waitcnt lgkmcnt(4)
    v_mfma_f32_16x16x32_bf16 v[148:151], a[44:47], v[64:67], v[148:151]
    ds_read_b128 v[56:59], v14 offset:768
    v_mfma_f32_16x16x32_bf16 v[156:159], a[44:47], v[68:71], v[156:159]
    ds_read_b128 v[60:63], v14 offset:17152
    v_mfma_f32_16x16x32_bf16 v[152:155], a[108:111], v[64:67], v[152:155]
    v_mfma_f32_16x16x32_bf16 v[160:163], a[108:111], v[68:71], v[160:163]
    s_waitcnt lgkmcnt(4)
    v_mfma_f32_16x16x32_bf16 v[148:151], a[48:51], v[40:43], v[148:151]
    ds_read_b128 v[64:67], v15 offset:768
    v_mfma_f32_16x16x32_bf16 v[156:159], a[48:51], v[44:47], v[156:159]
    ds_read_b128 v[68:71], v15 offset:17152
    v_mfma_f32_16x16x32_bf16 v[152:155], a[112:115], v[40:43], v[152:155]
    v_mfma_f32_16x16x32_bf16 v[160:163], a[112:115], v[44:47], v[160:163]
    s_waitcnt lgkmcnt(4)
    v_mfma_f32_16x16x32_bf16 v[148:151], a[52:55], v[48:51], v[148:151]
    v_mfma_f32_16x16x32_bf16 v[156:159], a[52:55], v[52:55], v[156:159]
    v_mfma_f32_16x16x32_bf16 v[152:155], a[116:119], v[48:51], v[152:155]
    v_mfma_f32_16x16x32_bf16 v[160:163], a[116:119], v[52:55], v[160:163]
    s_waitcnt lgkmcnt(2)
    v_mfma_f32_16x16x32_bf16 v[148:151], a[56:59], v[56:59], v[148:151]
    v_mfma_f32_16x16x32_bf16 v[156:159], a[56:59], v[60:63], v[156:159]
    v_mfma_f32_16x16x32_bf16 v[152:155], a[120:123], v[56:59], v[152:155]
    v_mfma_f32_16x16x32_bf16 v[160:163], a[120:123], v[60:63], v[160:163]
    s_waitcnt lgkmcnt(0)
    v_mfma_f32_16x16x32_bf16 v[148:151], a[60:63], v[64:67], v[148:151]
    v_mfma_f32_16x16x32_bf16 v[156:159], a[60:63], v[68:71], v[156:159]
    v_mfma_f32_16x16x32_bf16 v[152:155], a[124:127], v[64:67], v[152:155]
    v_mfma_f32_16x16x32_bf16 v[160:163], a[124:127], v[68:71], v[160:163]
    s_nop 4
    v_cvt_pk_bf16_f32 v40, v148, v149
    v_cvt_pk_bf16_f32 v41, v150, v151
    v_cvt_pk_bf16_f32 v42, v152, v153
    v_cvt_pk_bf16_f32 v43, v154, v155
    ds_write_b128 v34, v[40:43] offset:36864
    v_cvt_pk_bf16_f32 v44, v156, v157
    v_cvt_pk_bf16_f32 v45, v158, v159
    v_cvt_pk_bf16_f32 v46, v160, v161
    v_cvt_pk_bf16_f32 v47, v162, v163
    ds_write_b128 v34, v[44:47] offset:40960
    s_waitcnt lgkmcnt(0)
H2_pre1d:
    s_lshl_b32 s26, s33, 15
    s_add_u32 s26, s26, 67108864
    s_cmp_lg_u32 s17, 0
    s_cbranch_scc1 gwe_29
    v_and_b32 v11, 31, v1
    v_lshlrev_b32 v11, 2, v11
gw_28:
    buffer_load_dword v7, v11, s[4:7], s28 offen sc1
    s_add_u32 s23, s23, 1
    s_cmp_gt_u32 s23, 262144
    s_cbranch_scc1 gwe_29
    s_waitcnt vmcnt(0)
    v_cmp_ge_u32 vcc, s18, v7
    s_cbranch_vccnz gw_28
gwe_29:
    s_barrier
    buffer_load_dwordx4 v[40:43], v38, s[4:7], s26 offen sc1
    s_add_u32 s26, s26, 4096
    buffer_load_dwordx4 v[44:47], v38, s[4:7], s26 offen sc1
    s_add_u32 s26, s26, 4096
    buffer_load_dwordx4 v[48:51], v38, s[4:7], s26 offen sc1
    s_add_u32 s26, s26, 4096
    buffer_load_dwordx4 v[52:55], v38, s[4:7], s26 offen sc1
    s_add_u32 s26, s26, 4096
    buffer_load_dwordx4 v[56:59], v38, s[4:7], s26 offen sc1
    s_add_u32 s26, s26, 4096
    buffer_load_dwordx4 v[60:63], v38, s[4:7], s26 offen sc1
    s_add_u32 s26, s26, 4096
    buffer_load_dwordx4 v[64:67], v38, s[4:7], s26 offen sc1
    s_add_u32 s26, s26, 4096
    buffer_load_dwordx4 v[68:71], v38, s[4:7], s26 offen sc1
    s_add_u32 s26, s26, 4096
    v_lshlrev_b32 v76, 16, v10
    v_and_b32 v77, 0xffff0000, v10
    s_waitcnt vmcnt(7)
    v_mfma_f32_16x16x32_bf16 v[72:75], v[184:187], v[40:43], 0
    s_waitcnt vmcnt(6)
    v_mfma_f32_16x16x32_bf16 v[72:75], v[184:187], v[44:47], v[72:75]
    s_waitcnt vmcnt(5)
    v_mfma_f32_16x16x32_bf16 v[72:75], v[184:187], v[48:51], v[72:75]
    s_waitcnt vmcnt(4)
    v_mfma_f32_16x16x32_bf16 v[72:75], v[184:187], v[52:55], v[72:75]
    s_waitcnt vmcnt(3)
    v_mfma_f32_16x16x32_bf16 v[72:75], v[184:187], v[56:59], v[72:75]
    s_waitcnt vmcnt(2)
    v_mfma_f32_16x16x32_bf16 v[72:75], v[184:187], v[60:63], v[72:75]
    s_waitcnt vmcnt(1)
    v_mfma_f32_16x16x32_bf16 v[72:75], v[184:187], v[64:67], v[72:75]
    s_waitcnt vmcnt(0)
    v_mfma_f32_16x16x32_bf16 v[72:75], v[184:187], v[68:71], v[72:75]
    s_nop 7
    v_cvt_pk_bf16_f32 v74, v72, v73
    v_lshlrev_b32 v72, 16, v74
    v_and_b32 v73, 0xffff0000, v74
    v_add_f32 v72, v72, v76
    v_add_f32 v73, v73, v77
    v_cvt_pk_bf16_f32 v10, v72, v73
    v_lshlrev_b32 v72, 16, v10
    v_and_b32 v73, 0xffff0000, v10
    v_add_f32 v76, v72, v73
    v_mul_f32 v77, v72, v72
    v_fmac_f32 v77, v73, v73
    v_add_f32_dpp v76, v76, v76 row_ror:8 row_mask:0xf bank_mask:0xf
    s_nop 0
    v_add_f32_dpp v77, v77, v77 row_ror:8 row_mask:0xf bank_mask:0xf
    v_add_f32_dpp v76, v76, v76 row_ror:4 row_mask:0xf bank_mask:0xf
    s_nop 0
    v_add_f32_dpp v77, v77, v77 row_ror:4 row_mask:0xf bank_mask:0xf
    v_add_f32_dpp v76, v76, v76 row_ror:2 row_mask:0xf bank_mask:0xf
    s_nop 0
    v_add_f32_dpp v77, v77, v77 row_ror:2 row_mask:0xf bank_mask:0xf
    v_add_f32_dpp v76, v76, v76 row_ror:1 row_mask:0xf bank_mask:0xf
    s_nop 0
    v_add_f32_dpp v77, v77, v77 row_ror:1 row_mask:0xf bank_mask:0xf
    v_mov_b32 v78, v76
    s_nop 1
    v_permlane16_swap_b32 v76, v78
    v_add_f32 v76, v76, v78
    v_mov_b32 v78, v77
    s_nop 1
    v_permlane16_swap_b32 v77, v78
    v_add_f32 v77, v77, v78
    v_mov_b32 v78, v76
    s_nop 1
    v_permlane32_swap_b32 v76, v78
    v_add_f32 v76, v76, v78
    v_mov_b32 v78, v77
    s_nop 1
    v_permlane32_swap_b32 v77, v78
    v_add_f32 v77, v77, v78
    s_lshl_b32 s24, s17, 3
    s_add_u32 s24, s24, 122880
    v_mov_b32 v78, s24
    v_mov_b32 v79, 122880
    ds_write_b64 v78, v[76:77]
    s_lshl_b32 s24, s33, 10
    s_add_u32 s26, s24, 56623104
    s_waitcnt lgkmcnt(0)
    s_barrier
    ds_read_b128 v[80:83], v79
    ds_read_b128 v[84:87], v79 offset:16
    s_waitcnt lgkmcnt(0)
    v_pk_add_f32 v[80:81], v[80:81], v[82:83]
    v_pk_add_f32 v[84:85], v[84:85], v[86:87]
    v_pk_add_f32 v[76:77], v[80:81], v[84:85]
    v_mul_f32 v76, 0x3b000000, v76
    v_mul_f32 v77, 0x3b000000, v77
    v_fma_f32 v77, -v76, v76, v77
    v_max_f32 v77, 0, v77
    v_cvt_pk_bf16_f32 v76, v76, v76
    v_and_b32 v76, 0xffff0000, v76
    v_cvt_pk_bf16_f32 v77, v77, v77
    v_and_b32 v77, 0xffff0000, v77
    v_add_f32 v77, 0x3727c5ac, v77
    v_cvt_pk_bf16_f32 v77, v77, v77
    v_and_b32 v77, 0xffff0000, v77
    v_sqrt_f32 v77, v77
    s_nop 0
    v_cvt_pk_bf16_f32 v77, v77, v77
    v_and_b32 v77, 0xffff0000, v77
    v_rcp_f32 v77, v77
    v_sub_f32 v72, v72, v76
    v_sub_f32 v73, v73, v76
    v_cvt_pk_bf16_f32 v74, v72, v73
    v_lshlrev_b32 v72, 16, v74
    v_and_b32 v73, 0xffff0000, v74
    v_mul_f32 v72, v72, v77
    v_mul_f32 v73, v73, v77
    v_cvt_pk_bf16_f32 v74, v72, v73
    s_cmp_eq_u32 s31, 0
    s_cbranch_scc1 dg_30
    buffer_store_dword v74, v39, s[4:7], s26 offen
    s_branch de_31
dg_30:
    buffer_store_dword v74, v39, s[4:7], s26 offen sc1
de_31:
    s_waitcnt vmcnt(0)
    s_barrier
    s_add_u32 s28, s29, 10240
    s_cmp_lg_u32 s17, 0
    s_cbranch_scc1 gs_32
    s_lshl_b32 s24, s16, 2
    s_add_u32 s25, s18, 1
    v_mov_b32 v7, s25
    v_mov_b32 v11, s24
    s_mov_b64 exec, 1
    s_cmp_eq_u32 s31, 0
    s_cbranch_scc1 dg_33
    buffer_store_dword v7, v11, s[4:7], s28 offen
    s_branch de_34
dg_33:
    buffer_store_dword v7, v11, s[4:7], s28 offen sc1
de_34:
    s_mov_b64 exec, -1
gs_32:
    s_cmp_ge_u32 s18, 60
    s_cbranch_scc1 H2_pre2d
    ds_read_b128 v[120:123], v35 offset:36864
    ds_read_b128 v[124:127], v35 offset:37888
    ds_read_b128 v[128:131], v35 offset:38912
    ds_read_b128 v[132:135], v35 offset:39936
    ds_read_b128 v[72:75], v9 offset:0
    ds_read_b128 v[76:79], v9 offset:1024
    ds_read_b128 v[80:83], v9 offset:2048
    ds_read_b128 v[84:87], v9 offset:3072
    ds_read_b128 v[88:91], v9 offset:4096
    ds_read_b128 v[92:95], v9 offset:5120
    ds_read_b128 v[96:99], v9 offset:6144
    ds_read_b128 v[100:103], v9 offset:7168
    v_mov_b32 v173, 0xce6e6b28
    s_waitcnt lgkmcnt(4)
    v_mfma_f32_16x16x32_bf16 v[140:143], v[72:75], v[120:123], 0
    ds_read_b128 v[104:107], v8 offset:8192
    v_mfma_f32_16x16x32_bf16 v[140:143], v[76:79], v[124:127], v[140:143]
    ds_read_b128 v[108:111], v8 offset:9216
    v_mfma_f32_16x16x32_bf16 v[140:143], v[80:83], v[128:131], v[140:143]
    ds_read_b128 v[112:115], v8 offset:10240
    v_mfma_f32_16x16x32_bf16 v[140:143], v[84:87], v[132:135], v[140:143]
    ds_read_b128 v[116:119], v8 offset:11264
    s_waitcnt lgkmcnt(4)
    v_mfma_f32_16x16x32_bf16 v[144:147], v[88:91], v[120:123], 0
    v_mfma_f32_16x16x32_bf16 v[144:147], v[92:95], v[124:127], v[144:147]
    v_mfma_f32_16x16x32_bf16 v[144:147], v[96:99], v[128:131], v[144:147]
    v_mfma_f32_16x16x32_bf16 v[144:147], v[100:103], v[132:135], v[144:147]
    s_nop 1
    v_cvt_pk_bf16_f32 v174, v140, v141
    v_lshlrev_b32 v140, 16, v174
    v_and_b32 v141, 0xffff0000, v174
    v_mul_f32 v140, 0x3db504f3, v140
    v_mul_f32 v141, 0x3db504f3, v141
    v_cvt_pk_bf16_f32 v174, v140, v141
    v_lshlrev_b32 v140, 16, v174
    v_and_b32 v141, 0xffff0000, v174
    v_cvt_pk_bf16_f32 v174, v142, v143
    v_lshlrev_b32 v142, 16, v174
    v_and_b32 v143, 0xffff0000, v174
    v_mul_f32 v142, 0x3db504f3, v142
    v_mul_f32 v143, 0x3db504f3, v143
    v_cvt_pk_bf16_f32 v174, v142, v143
    v_lshlrev_b32 v142, 16, v174
    v_and_b32 v143, 0xffff0000, v174
    v_cvt_pk_bf16_f32 v174, v144, v145
    v_lshlrev_b32 v144, 16, v174
    v_and_b32 v145, 0xffff0000, v174
    v_mul_f32 v144, 0x3db504f3, v144
    v_mul_f32 v145, 0x3db504f3, v145
    v_cvt_pk_bf16_f32 v174, v144, v145
    v_lshlrev_b32 v144, 16, v174
    v_and_b32 v145, 0xffff0000, v174
    v_cvt_pk_bf16_f32 v174, v146, v147
    v_lshlrev_b32 v146, 16, v174
    v_and_b32 v147, 0xffff0000, v174
    v_mul_f32 v146, 0x3db504f3, v146
    v_mul_f32 v147, 0x3db504f3, v147
    v_cvt_pk_bf16_f32 v174, v146, v147
    v_lshlrev_b32 v146, 16, v174
    v_and_b32 v147, 0xffff0000, v174
    v_cndmask_b32 v140, v173, v140, s[44:45]
    v_cndmask_b32 v141, v173, v141, s[46:47]
    v_cndmask_b32 v142, v173, v142, s[48:49]
    v_cndmask_b32 v143, v173, v143, s[50:51]
    v_cndmask_b32 v144, v173, v144, s[52:53]
    v_cndmask_b32 v145, v173, v145, s[54:55]
    v_cndmask_b32 v146, v173, v146, s[56:57]
    v_cndmask_b32 v147, v173, v147, s[58:59]
    v_max3_f32 v172, v140, v141, v142
    v_max3_f32 v172, v172, v143, v144
    v_max3_f32 v172, v172, v145, v146
    v_max_f32 v172, v172, v147
    s_waitcnt lgkmcnt(0)
H2_pre2d:
    s_cmp_lg_u32 s17, 0
    s_cbranch_scc1 gwe_36
    v_and_b32 v11, 31, v1
    v_lshlrev_b32 v11, 2, v11
gw_35:
    buffer_load_dword v7, v11, s[4:7], s28 offen sc1
    s_add_u32 s23, s23, 1
    s_cmp_gt_u32 s23, 262144
    s_cbranch_scc1 gwe_36
    s_waitcnt vmcnt(0)
    v_cmp_ge_u32 vcc, s18, v7
    s_cbranch_vccnz gw_35
gwe_36:
    s_barrier
    s_cmp_ge_u32 s18, 4
    s_cbranch_scc1 H2_sent
    v_mov_b32 v11, 208
wt_37:
    buffer_load_dword v7, v11, s[12:15], 0 offen sc1
    s_add_u32 s23, s23, 1
    s_waitcnt vmcnt(0)
    v_readfirstlane_b32 s24, v7
    s_cmp_gt_u32 s23, 262144
    s_cbranch_scc1 wte_38
    s_cmp_ge_u32 s24, 64
    s_cbranch_scc1 wte_38
    s_sleep 4
    s_branch wt_37
wte_38:
H2_sent:
    s_lshl_b32 s21, s39, 15
    s_add_u32 s21, s21, 56623104
    s_lshl_b32 s24, s17, 13
    s_add_u32 s25, s24, s21
    s_and_b32 s26, s17, 1
    s_lshl_b32 s26, s26, 7
    s_add_u32 s27, s26, 0
    v_xor_b32 v24, s27, v6
    s_add_u32 m0, s24, 32768
    s_nop 0
    buffer_load_dwordx4 v24, s[4:7], s25 offen sc1 lds
    s_add_u32 s25, s25, 1024
    s_add_u32 s27, s26, 16
    v_xor_b32 v24, s27, v6
    s_add_u32 m0, s24, 33792
    s_nop 0
    buffer_load_dwordx4 v24, s[4:7], s25 offen sc1 lds
    s_add_u32 s25, s25, 1024
    s_add_u32 s27, s26, 32
    v_xor_b32 v24, s27, v6
    s_add_u32 m0, s24, 34816
    s_nop 0
    buffer_load_dwordx4 v24, s[4:7], s25 offen sc1 lds
    s_add_u32 s25, s25, 1024
    s_add_u32 s27, s26, 48
    v_xor_b32 v24, s27, v6
    s_add_u32 m0, s24, 35840
    s_nop 0
    buffer_load_dwordx4 v24, s[4:7], s25 offen sc1 lds
    s_add_u32 s25, s25, 1024
    s_add_u32 s27, s26, 64
    v_xor_b32 v24, s27, v6
    s_add_u32 m0, s24, 36864
    s_nop 0
    buffer_load_dwordx4 v24, s[4:7], s25 offen sc1 lds
    s_add_u32 s25, s25, 1024
    s_add_u32 s27, s26, 80
    v_xor_b32 v24, s27, v6
    s_add_u32 m0, s24, 37888
    s_nop 0
    buffer_load_dwordx4 v24, s[4:7], s25 offen sc1 lds
    s_add_u32 s25, s25, 1024
    s_add_u32 s27, s26, 96
    v_xor_b32 v24, s27, v6
    s_add_u32 m0, s24, 38912
    s_nop 0
    buffer_load_dwordx4 v24, s[4:7], s25 offen sc1 lds
    s_add_u32 s25, s25, 1024
    s_add_u32 s27, s26, 112
    v_xor_b32 v24, s27, v6
    s_add_u32 m0, s24, 39936
    s_nop 0
    buffer_load_dwordx4 v24, s[4:7], s25 offen sc1 lds
    s_add_u32 s25, s25, 1024
    s_mul_i32 s26, s16, 65
    s_add_u32 s26, s26, s18
    s_lshl_b32 s26, s26, 12
    s_add_u32 s26, s26, 37769216
    s_lshl_b32 s27, s17, 10
    s_add_u32 s27, s27, s26
    s_lshr_b32 s24, s17, 1
    s_lshl_b32 s24, s24, 11
    s_add_u32 s26, s26, s24
    buffer_load_dwordx2 v[164:165], v6, s[4:7], s27 offen sc1
    buffer_load_dwordx2 v[168:169], v6, s[4:7], s26 offen offset:8 sc1
    buffer_load_dwordx2 v[170:171], v6, s[4:7], s26 offen offset:1032 sc1
    s_lshl_b32 s25, s22, 10
    s_add_u32 s25, s25, 54525952
    buffer_store_dword v10, v39, s[4:7], s25 offen sc1
    s_waitcnt vmcnt(4)
    s_barrier
    s_cmp_lg_u32 s16, 31
    s_cbranch_scc1 H2_nolead
    s_cmp_lt_u32 s18, 4
    s_cbranch_scc1 H2_nolead
    s_lshl_b32 s28, s18, 7
    s_add_u32 s28, s28, 15872
    s_cmp_lg_u32 s17, 0
    s_cbranch_scc1 sig_39
    v_mov_b32 v7, 1
    v_mov_b32 v11, s28
    s_mov_b64 exec, 1
    buffer_store_dword v7, v11, s[4:7], 0 offen sc1
    s_mov_b64 exec, -1
sig_39:
H2_nolead:
    s_cmp_ge_u32 s30, 86
    s_cbranch_scc1 H2_skipz
    ds_read_b128 v[40:43], v16 offset:0
    ds_read_b128 v[44:47], v20 offset:0
    ds_read_b128 v[48:51], v17 offset:0
    ds_read_b128 v[52:55], v21 offset:0
    ds_read_b128 v[56:59], v18 offset:0
    ds_read_b128 v[60:63], v22 offset:0
    ds_read_b128 v[64:67], v19 offset:0
    ds_read_b128 v[68:71], v23 offset:0
    s_cmp_lt_u32 s30, 43
    s_cbranch_scc1 H2_z1
    s_waitcnt lgkmcnt(6)
    v_mfma_f32_16x16x32_bf16 v[148:151], v[40:43], v[192:195], 0
    ds_read_b128 v[72:75], v16 offset:256
    v_mfma_f32_16x16x32_bf16 v[152:155], v[44:47], v[192:195], 0
    ds_read_b128 v[76:79], v20 offset:256
    s_waitcnt lgkmcnt(6)
    v_mfma_f32_16x16x32_bf16 v[148:151], v[48:51], v[196:199], v[148:151]
    ds_read_b128 v[80:83], v17 offset:256
    v_mfma_f32_16x16x32_bf16 v[152:155], v[52:55], v[196:199], v[152:155]
    ds_read_b128 v[84:87], v21 offset:256
    s_waitcnt lgkmcnt(6)
    v_mfma_f32_16x16x32_bf16 v[148:151], v[56:59], v[200:203], v[148:151]
    ds_read_b128 v[88:91], v18 offset:256
    v_mfma_f32_16x16x32_bf16 v[152:155], v[60:63], v[200:203], v[152:155]
    ds_read_b128 v[92:95], v22 offset:256
    s_waitcnt lgkmcnt(6)
    v_mfma_f32_16x16x32_bf16 v[148:151], v[64:67], v[204:207], v[148:151]
    ds_read_b128 v[96:99], v19 offset:256
    v_mfma_f32_16x16x32_bf16 v[152:155], v[68:71], v[204:207], v[152:155]
    ds_read_b128 v[100:103], v23 offset:256
    s_waitcnt lgkmcnt(6)
    v_mfma_f32_16x16x32_bf16 v[148:151], v[72:75], v[208:211], v[148:151]
    ds_read_b128 v[40:43], v16 offset:512
    v_mfma_f32_16x16x32_bf16 v[152:155], v[76:79], v[208:211], v[152:155]
    ds_read_b128 v[44:47], v20 offset:512
    s_waitcnt lgkmcnt(6)
    v_mfma_f32_16x16x32_bf16 v[148:151], v[80:83], v[212:215], v[148:151]
    ds_read_b128 v[48:51], v17 offset:512
    v_mfma_f32_16x16x32_bf16 v[152:155], v[84:87], v[212:215], v[152:155]
    ds_read_b128 v[52:55], v21 offset:512
    s_waitcnt lgkmcnt(6)
    v_mfma_f32_16x16x32_bf16 v[148:151], v[88:91], v[216:219], v[148:151]
    ds_read_b128 v[56:59], v18 offset:512
    v_mfma_f32_16x16x32_bf16 v[152:155], v[92:95], v[216:219], v[152:155]
    ds_read_b128 v[60:63], v22 offset:512
    s_waitcnt lgkmcnt(6)
    v_mfma_f32_16x16x32_bf16 v[148:151], v[96:99], v[220:223], v[148:151]
    ds_read_b128 v[64:67], v19 offset:512
    v_mfma_f32_16x16x32_bf16 v[152:155], v[100:103], v[220:223], v[152:155]
    ds_read_b128 v[68:71], v23 offset:512
    s_waitcnt lgkmcnt(6)
    v_mfma_f32_16x16x32_bf16 v[148:151], v[40:43], v[224:227], v[148:151]
    ds_read_b128 v[72:75], v16 offset:768
    v_mfma_f32_16x16x32_bf16 v[152:155], v[44:47], v[224:227], v[152:155]
    ds_read_b128 v[76:79], v20 offset:768
    s_waitcnt lgkmcnt(6)
    v_mfma_f32_16x16x32_bf16 v[148:151], v[48:51], v[228:231], v[148:151]
    ds_read_b128 v[80:83], v17 offset:768
    v_mfma_f32_16x16x32_bf16 v[152:155], v[52:55], v[228:231], v[152:155]
    ds_read_b128 v[84:87], v21 offset:768
    s_waitcnt lgkmcnt(6)
    v_mfma_f32_16x16x32_bf16 v[148:151], v[56:59], v[232:235], v[148:151]
    ds_read_b128 v[88:91], v18 offset:768
    v_mfma_f32_16x16x32_bf16 v[152:155], v[60:63], v[232:235], v[152:155]
    ds_read_b128 v[92:95], v22 offset:768
    s_waitcnt lgkmcnt(6)
    v_mfma_f32_16x16x32_bf16 v[148:151], v[64:67], v[236:239], v[148:151]
    ds_read_b128 v[96:99], v19 offset:768
    v_mfma_f32_16x16x32_bf16 v[152:155], v[68:71], v[236:239], v[152:155]
    ds_read_b128 v[100:103], v23 offset:768
    s_waitcnt lgkmcnt(6)
    v_mfma_f32_16x16x32_bf16 v[148:151], v[72:75], v[240:243], v[148:151]
    v_mfma_f32_16x16x32_bf16 v[152:155], v[76:79], v[240:243], v[152:155]
    s_waitcnt lgkmcnt(4)
    v_mfma_f32_16x16x32_bf16 v[148:151], v[80:83], v[244:247], v[148:151]
    v_mfma_f32_16x16x32_bf16 v[152:155], v[84:87], v[244:247], v[152:155]
    s_waitcnt lgkmcnt(2)
    v_mfma_f32_16x16x32_bf16 v[148:151], v[88:91], v[248:251], v[148:151]
    v_mfma_f32_16x16x32_bf16 v[152:155], v[92:95], v[248:251], v[152:155]
    s_waitcnt lgkmcnt(0)
    v_mfma_f32_16x16x32_bf16 v[148:151], v[96:99], v[252:255], v[148:151]
    v_mfma_f32_16x16x32_bf16 v[152:155], v[100:103], v[252:255], v[152:155]
    s_branch H2_zc
H2_z1:
    s_waitcnt lgkmcnt(6)
    s_nop 4
    v_mfma_f32_16x16x32_bf16 v[148:151], v[192:195], v[40:43], 0
    ds_read_b128 v[72:75], v16 offset:256
    v_mfma_f32_16x16x32_bf16 v[152:155], v[192:195], v[44:47], 0
    ds_read_b128 v[76:79], v20 offset:256
    s_waitcnt lgkmcnt(6)
    v_mfma_f32_16x16x32_bf16 v[148:151], v[196:199], v[48:51], v[148:151]
    ds_read_b128 v[80:83], v17 offset:256
    v_mfma_f32_16x16x32_bf16 v[152:155], v[196:199], v[52:55], v[152:155]
    ds_read_b128 v[84:87], v21 offset:256
    s_waitcnt lgkmcnt(6)
    v_mfma_f32_16x16x32_bf16 v[148:151], v[200:203], v[56:59], v[148:151]
    ds_read_b128 v[88:91], v18 offset:256
    v_mfma_f32_16x16x32_bf16 v[152:155], v[200:203], v[60:63], v[152:155]
    ds_read_b128 v[92:95], v22 offset:256
    s_waitcnt lgkmcnt(6)
    v_mfma_f32_16x16x32_bf16 v[148:151], v[204:207], v[64:67], v[148:151]
    ds_read_b128 v[96:99], v19 offset:256
    v_mfma_f32_16x16x32_bf16 v[152:155], v[204:207], v[68:71], v[152:155]
    ds_read_b128 v[100:103], v23 offset:256
    s_waitcnt lgkmcnt(6)
    v_mfma_f32_16x16x32_bf16 v[148:151], v[208:211], v[72:75], v[148:151]
    ds_read_b128 v[40:43], v16 offset:512
    v_mfma_f32_16x16x32_bf16 v[152:155], v[208:211], v[76:79], v[152:155]
    ds_read_b128 v[44:47], v20 offset:512
    s_waitcnt lgkmcnt(6)
    v_mfma_f32_16x16x32_bf16 v[148:151], v[212:215], v[80:83], v[148:151]
    ds_read_b128 v[48:51], v17 offset:512
    v_mfma_f32_16x16x32_bf16 v[152:155], v[212:215], v[84:87], v[152:155]
    ds_read_b128 v[52:55], v21 offset:512
    s_waitcnt lgkmcnt(6)
    v_mfma_f32_16x16x32_bf16 v[148:151], v[216:219], v[88:91], v[148:151]
    ds_read_b128 v[56:59], v18 offset:512
    v_mfma_f32_16x16x32_bf16 v[152:155], v[216:219], v[92:95], v[152:155]
    ds_read_b128 v[60:63], v22 offset:512
    s_waitcnt lgkmcnt(6)
    v_mfma_f32_16x16x32_bf16 v[148:151], v[220:223], v[96:99], v[148:151]
    ds_read_b128 v[64:67], v19 offset:512
    v_mfma_f32_16x16x32_bf16 v[152:155], v[220:223], v[100:103], v[152:155]
    ds_read_b128 v[68:71], v23 offset:512
    s_waitcnt lgkmcnt(6)
    v_mfma_f32_16x16x32_bf16 v[148:151], v[224:227], v[40:43], v[148:151]
    ds_read_b128 v[72:75], v16 offset:768
    v_mfma_f32_16x16x32_bf16 v[152:155], v[224:227], v[44:47], v[152:155]
    ds_read_b128 v[76:79], v20 offset:768
    s_waitcnt lgkmcnt(6)
    v_mfma_f32_16x16x32_bf16 v[148:151], v[228:231], v[48:51], v[148:151]
    ds_read_b128 v[80:83], v17 offset:768
    v_mfma_f32_16x16x32_bf16 v[152:155], v[228:231], v[52:55], v[152:155]
    ds_read_b128 v[84:87], v21 offset:768
    s_waitcnt lgkmcnt(6)
    v_mfma_f32_16x16x32_bf16 v[148:151], v[232:235], v[56:59], v[148:151]
    ds_read_b128 v[88:91], v18 offset:768
    v_mfma_f32_16x16x32_bf16 v[152:155], v[232:235], v[60:63], v[152:155]
    ds_read_b128 v[92:95], v22 offset:768
    s_waitcnt lgkmcnt(6)
    v_mfma_f32_16x16x32_bf16 v[148:151], v[236:239], v[64:67], v[148:151]
    ds_read_b128 v[96:99], v19 offset:768
    v_mfma_f32_16x16x32_bf16 v[152:155], v[236:239], v[68:71], v[152:155]
    ds_read_b128 v[100:103], v23 offset:768
    s_waitcnt lgkmcnt(6)
    v_mfma_f32_16x16x32_bf16 v[148:151], v[240:243], v[72:75], v[148:151]
    v_mfma_f32_16x16x32_bf16 v[152:155], v[240:243], v[76:79], v[152:155]
    s_waitcnt lgkmcnt(4)
    v_mfma_f32_16x16x32_bf16 v[148:151], v[244:247], v[80:83], v[148:151]
    v_mfma_f32_16x16x32_bf16 v[152:155], v[244:247], v[84:87], v[152:155]
    s_waitcnt lgkmcnt(2)
    v_mfma_f32_16x16x32_bf16 v[148:151], v[248:251], v[88:91], v[148:151]
    v_mfma_f32_16x16x32_bf16 v[152:155], v[248:251], v[92:95], v[152:155]
    s_waitcnt lgkmcnt(0)
    v_mfma_f32_16x16x32_bf16 v[148:151], v[252:255], v[96:99], v[148:151]
    v_mfma_f32_16x16x32_bf16 v[152:155], v[252:255], v[100:103], v[152:155]
H2_zc:
    s_nop 7
    v_mov_b32 v40, 0xbdd2d3e8
    v_mov_b32 v42, 0xc0135761
    v_cvt_pk_bf16_f32 v176, v148, v149
    v_lshlrev_b32 v148, 16, v176
    v_and_b32 v149, 0xffff0000, v176
    v_cvt_pk_bf16_f32 v176, v150, v151
    v_lshlrev_b32 v150, 16, v176
    v_and_b32 v151, 0xffff0000, v176
    v_cvt_pk_bf16_f32 v176, v152, v153
    v_lshlrev_b32 v152, 16, v176
    v_and_b32 v153, 0xffff0000, v176
    v_cvt_pk_bf16_f32 v176, v154, v155
    v_lshlrev_b32 v154, 16, v176
    v_and_b32 v155, 0xffff0000, v176
    v_pk_mul_f32 v[176:177], v[148:149], v[148:149]
    v_pk_fma_f32 v[176:177], v[176:177], v[40:41], v[42:43] op_sel_hi:[1,0,0]
    v_pk_mul_f32 v[176:177], v[176:177], v[148:149]
    v_pk_mul_f32 v[178:179], v[150:151], v[150:151]
    v_pk_fma_f32 v[178:179], v[178:179], v[40:41], v[42:43] op_sel_hi:[1,0,0]
    v_pk_mul_f32 v[178:179], v[178:179], v[150:151]
    v_pk_mul_f32 v[180:181], v[152:153], v[152:153]
    v_pk_fma_f32 v[180:181], v[180:181], v[40:41], v[42:43] op_sel_hi:[1,0,0]
    v_pk_mul_f32 v[180:181], v[180:181], v[152:153]
    v_pk_mul_f32 v[182:183], v[154:155], v[154:155]
    v_pk_fma_f32 v[182:183], v[182:183], v[40:41], v[42:43] op_sel_hi:[1,0,0]
    v_pk_mul_f32 v[182:183], v[182:183], v[154:155]
    v_exp_f32 v176, v176
    v_exp_f32 v177, v177
    v_exp_f32 v178, v178
    v_exp_f32 v179, v179
    v_exp_f32 v180, v180
    v_exp_f32 v181, v181
    v_exp_f32 v182, v182
    v_exp_f32 v183, v183
    v_pk_add_f32 v[176:177], v[176:177], 1.0 op_sel_hi:[1,0]
    v_pk_add_f32 v[178:179], v[178:179], 1.0 op_sel_hi:[1,0]
    v_pk_add_f32 v[180:181], v[180:181], 1.0 op_sel_hi:[1,0]
    v_pk_add_f32 v[182:183], v[182:183], 1.0 op_sel_hi:[1,0]
    v_rcp_f32 v176, v176
    v_rcp_f32 v177, v177
    v_rcp_f32 v178, v178
    v_rcp_f32 v179, v179
    v_rcp_f32 v180, v180
    v_rcp_f32 v181, v181
    v_rcp_f32 v182, v182
    v_rcp_f32 v183, v183
    v_pk_mul_f32 v[148:149], v[148:149], v[176:177]
    v_pk_mul_f32 v[150:151], v[150:151], v[178:179]
    v_pk_mul_f32 v[152:153], v[152:153], v[180:181]
    v_pk_mul_f32 v[154:155], v[154:155], v[182:183]
    v_cvt_pk_bf16_f32 v176, v148, v149
    v_cvt_pk_bf16_f32 v177, v150, v151
    v_cvt_pk_bf16_f32 v178, v152, v153
    v_cvt_pk_bf16_f32 v179, v154, v155
    s_mul_i32 s24, s18, 86
    s_add_u32 s24, s24, s30
    s_lshl_b32 s24, s24, 10
    s_add_u32 s24, s24, 58720256
    s_waitcnt vmcnt(2)
    s_cmp_eq_u32 s16, 31
    s_cbranch_scc1 H2_kw
    s_waitcnt vmcnt(1)
H2_kw:
    s_cmp_eq_u32 s17, 0
    s_cbranch_scc1 H2_kw2
    s_waitcnt vmcnt(1)
H2_kw2:
    s_cmp_ge_u32 s18, 4
    s_cbranch_scc1 H2_kw3
    s_waitcnt vmcnt(1)
H2_kw3:
    buffer_store_dwordx4 v[176:179], v6, s[4:7], s24 offen sc1
    s_cmp_lt_u32 s30, 43
    s_cbranch_scc1 H2_nostat
    v_lshlrev_b32 v40, 16, v176
    v_and_b32 v42, 0xffff0000, v176
    v_lshlrev_b32 v44, 16, v177
    v_and_b32 v46, 0xffff0000, v177
    v_lshlrev_b32 v48, 16, v178
    v_and_b32 v50, 0xffff0000, v178
    v_lshlrev_b32 v52, 16, v179
    v_and_b32 v54, 0xffff0000, v179
    v_mul_f32 v41, v40, v40
    v_mul_f32 v43, v42, v42
    v_mul_f32 v45, v44, v44
    v_mul_f32 v47, v46, v46
    v_mul_f32 v49, v48, v48
    v_mul_f32 v51, v50, v50
    v_mul_f32 v53, v52, v52
    v_mul_f32 v55, v54, v54
    v_add_f32_dpp v40, v40, v40 row_ror:8 row_mask:0xf bank_mask:0xf
    v_add_f32_dpp v41, v41, v41 row_ror:8 row_mask:0xf bank_mask:0xf
    v_add_f32_dpp v42, v42, v42 row_ror:8 row_mask:0xf bank_mask:0xf
    v_add_f32_dpp v43, v43, v43 row_ror:8 row_mask:0xf bank_mask:0xf
    v_add_f32_dpp v44, v44, v44 row_ror:8 row_mask:0xf bank_mask:0xf
    v_add_f32_dpp v45, v45, v45 row_ror:8 row_mask:0xf bank_mask:0xf
    v_add_f32_dpp v46, v46, v46 row_ror:8 row_mask:0xf bank_mask:0xf
    v_add_f32_dpp v47, v47, v47 row_ror:8 row_mask:0xf bank_mask:0xf
    v_add_f32_dpp v48, v48, v48 row_ror:8 row_mask:0xf bank_mask:0xf
    v_add_f32_dpp v49, v49, v49 row_ror:8 row_mask:0xf bank_mask:0xf
    v_add_f32_dpp v50, v50, v50 row_ror:8 row_mask:0xf bank_mask:0xf
    v_add_f32_dpp v51, v51, v51 row_ror:8 row_mask:0xf bank_mask:0xf
    v_add_f32_dpp v52, v52, v52 row_ror:8 row_mask:0xf bank_mask:0xf
    v_add_f32_dpp v53, v53, v53 row_ror:8 row_mask:0xf bank_mask:0xf
    v_add_f32_dpp v54, v54, v54 row_ror:8 row_mask:0xf bank_mask:0xf
    v_add_f32_dpp v55, v55, v55 row_ror:8 row_mask:0xf bank_mask:0xf
    v_mov_b32_dpp v40, v48 quad_perm:[0,1,2,3] row_mask:0xf bank_mask:0xc
    v_mov_b32_dpp v41, v49 quad_perm:[0,1,2,3] row_mask:0xf bank_mask:0xc
    v_mov_b32_dpp v42, v50 quad_perm:[0,1,2,3] row_mask:0xf bank_mask:0xc
    v_mov_b32_dpp v43, v51 quad_perm:[0,1,2,3] row_mask:0xf bank_mask:0xc
    v_mov_b32_dpp v44, v52 quad_perm:[0,1,2,3] row_mask:0xf bank_mask:0xc
    v_mov_b32_dpp v45, v53 quad_perm:[0,1,2,3] row_mask:0xf bank_mask:0xc
    v_mov_b32_dpp v46, v54 quad_perm:[0,1,2,3] row_mask:0xf bank_mask:0xc
    v_mov_b32_dpp v47, v55 quad_perm:[0,1,2,3] row_mask:0xf bank_mask:0xc
    v_add_f32_dpp v40, v40, v40 row_half_mirror row_mask:0xf bank_mask:0xf
    v_add_f32_dpp v41, v41, v41 row_half_mirror row_mask:0xf bank_mask:0xf
    v_add_f32_dpp v42, v42, v42 row_half_mirror row_mask:0xf bank_mask:0xf
    v_add_f32_dpp v43, v43, v43 row_half_mirror row_mask:0xf bank_mask:0xf
    v_add_f32_dpp v44, v44, v44 row_half_mirror row_mask:0xf bank_mask:0xf
    v_add_f32_dpp v45, v45, v45 row_half_mirror row_mask:0xf bank_mask:0xf
    v_add_f32_dpp v46, v46, v46 row_half_mirror row_mask:0xf bank_mask:0xf
    v_add_f32_dpp v47, v47, v47 row_half_mirror row_mask:0xf bank_mask:0xf
    v_mov_b32_dpp v40, v44 quad_perm:[0,1,2,3] row_mask:0xf bank_mask:0xa
    v_mov_b32_dpp v41, v45 quad_perm:[0,1,2,3] row_mask:0xf bank_mask:0xa
    v_mov_b32_dpp v42, v46 quad_perm:[0,1,2,3] row_mask:0xf bank_mask:0xa
    v_mov_b32_dpp v43, v47 quad_perm:[0,1,2,3] row_mask:0xf bank_mask:0xa
    v_add_f32_dpp v40, v40, v40 quad_perm:[1,0,3,2] row_mask:0xf bank_mask:0xf
    v_add_f32_dpp v41, v41, v41 quad_perm:[1,0,3,2] row_mask:0xf bank_mask:0xf
    v_add_f32_dpp v42, v42, v42 quad_perm:[1,0,3,2] row_mask:0xf bank_mask:0xf
    v_add_f32_dpp v43, v43, v43 quad_perm:[1,0,3,2] row_mask:0xf bank_mask:0xf
    v_add_f32_dpp v40, v40, v40 quad_perm:[2,3,0,1] row_mask:0xf bank_mask:0xf
    v_add_f32_dpp v41, v41, v41 quad_perm:[2,3,0,1] row_mask:0xf bank_mask:0xf
    v_add_f32_dpp v42, v42, v42 quad_perm:[2,3,0,1] row_mask:0xf bank_mask:0xf
    v_add_f32_dpp v43, v43, v43 quad_perm:[2,3,0,1] row_mask:0xf bank_mask:0xf
    v_lshlrev_b32 v44, 2, v1
    v_mov_b32 v45, 1073741824
    v_cmp_eq_u32 vcc, 0, v5
    s_nop 1
    v_cndmask_b32 v44, v45, v44, vcc
    s_lshl_b32 s24, s18, 6
    s_add_u32 s24, s24, s30
    s_lshl_b32 s24, s24, 8
    s_add_u32 s24, s24, 65000704
    buffer_store_dwordx4 v[40:43], v44, s[4:7], s24 offen sc1
    s_branch H2_nostat
H2_skipz:
    s_waitcnt vmcnt(1)
H2_nostat:
    s_add_u32 s18, s18, 4
    s_cmp_lt_u32 s18, 64
    s_cbranch_scc1 H2_loop
    s_sub_u32 s18, s18, 4
    s_waitcnt vmcnt(0)
    s_barrier
    s_add_u32 s28, s29, 12288
    s_cmp_lg_u32 s17, 0
    s_cbranch_scc1 gs_40
    s_lshl_b32 s24, s16, 2
    s_add_u32 s25, s18, 1
    v_mov_b32 v7, s25
    v_mov_b32 v11, s24
    s_mov_b64 exec, 1
    s_cmp_eq_u32 s31, 0
    s_cbranch_scc1 dg_41
    buffer_store_dword v7, v11, s[4:7], s28 offen
    s_branch de_42
dg_41:
    buffer_store_dword v7, v11, s[4:7], s28 offen sc1
de_42:
    s_mov_b64 exec, -1
gs_40:
    s_cmp_lg_u32 s16, 31
    s_cbranch_scc1 H2_nosig
    s_cmp_lg_u32 s17, 0
    s_cbranch_scc1 gwe_44
    v_and_b32 v11, 31, v1
    v_lshlrev_b32 v11, 2, v11
gw_43:
    buffer_load_dword v7, v11, s[4:7], s28 offen sc1
    s_add_u32 s23, s23, 1
    s_cmp_gt_u32 s23, 262144
    s_cbranch_scc1 gwe_44
    s_waitcnt vmcnt(0)
    v_cmp_ge_u32 vcc, s18, v7
    s_cbranch_vccnz gw_43
gwe_44:
    s_lshl_b32 s28, s18, 7
    s_add_u32 s28, s28, 16384
    s_cmp_lg_u32 s17, 0
    s_cbranch_scc1 sig_45
    v_mov_b32 v7, 1
    v_mov_b32 v11, s28
    s_mov_b64 exec, 1
    buffer_store_dword v7, v11, s[4:7], 0 offen sc1
    s_mov_b64 exec, -1
sig_45:
H2_nosig:
L_helper:
    v_mbcnt_lo_u32_b32 v0, -1, 0
    v_mbcnt_hi_u32_b32 v0, -1, v0
    v_and_b32 v1, 63, v0
    v_and_b32 v2, 15, v1
    v_lshrrev_b32 v3, 4, v1
    v_lshrrev_b32 v4, 2, v2
    v_and_b32 v5, 3, v2
    v_lshlrev_b32 v6, 4, v1
    s_mov_b32 s23, 0
    s_lshl_b32 s24, s39, 5
    s_add_u32 s24, s24, s16
    s_mul_i32 s18, s24, 171
    s_lshr_b32 s18, s18, 9
    s_mul_i32 s25, s18, 3
    s_sub_u32 s19, s24, s25
    s_add_u32 s19, s19, 1
    s_waitcnt vmcnt(0) lgkmcnt(0)
    s_barrier
    s_cmp_eq_u32 s38, 1
    s_cbranch_scc1 T6_rest
    s_load_dwordx2 s[40:41], s[0:1], 88
    s_mov_b32 s42, 704512
    s_mov_b32 s43, 0x20000
    v_lshrrev_b32 v8, 6, v6
    v_lshlrev_b32 v8, 10, v8
    v_and_b32 v9, 48, v6
    v_add_u32 v8, v8, v9
    s_lshl_b32 s24, s19, 8
    s_lshl_b32 s25, s17, 6
    s_add_u32 s25, s25, s24
    s_add_u32 s25, s25, 0
    s_mul_i32 s24, s17, 24576
    v_add_u32 v9, s24, v6
    s_waitcnt lgkmcnt(0)
    s_add_u32 m0, s24, 0
    s_nop 0
    buffer_load_dwordx4 v8, s[40:43], s25 offen lds
    s_add_u32 s25, s25, 16384
    s_add_u32 m0, s24, 1024
    s_nop 0
    buffer_load_dwordx4 v8, s[40:43], s25 offen lds
    s_add_u32 s25, s25, 16384
    s_add_u32 m0, s24, 2048
    s_nop 0
    buffer_load_dwordx4 v8, s[40:43], s25 offen lds
    s_add_u32 s25, s25, 16384
    s_add_u32 m0, s24, 3072
    s_nop 0
    buffer_load_dwordx4 v8, s[40:43], s25 offen lds
    s_add_u32 s25, s25, 16384
    s_add_u32 m0, s24, 4096
    s_nop 0
    buffer_load_dwordx4 v8, s[40:43], s25 offen lds
    s_add_u32 s25, s25, 16384
    s_add_u32 m0, s24, 5120
    s_nop 0
    buffer_load_dwordx4 v8, s[40:43], s25 offen lds
    s_add_u32 s25, s25, 16384
    s_add_u32 m0, s24, 6144
    s_nop 0
    buffer_load_dwordx4 v8, s[40:43], s25 offen lds
    s_add_u32 s25, s25, 16384
    s_add_u32 m0, s24, 7168
    s_nop 0
    buffer_load_dwordx4 v8, s[40:43], s25 offen lds
    s_add_u32 s25, s25, 16384
    s_add_u32 m0, s24, 8192
    s_nop 0
    buffer_load_dwordx4 v8, s[40:43], s25 offen lds
    s_add_u32 s25, s25, 16384
    s_add_u32 m0, s24, 9216
    s_nop 0
    buffer_load_dwordx4 v8, s[40:43], s25 offen lds
    s_add_u32 s25, s25, 16384
    s_add_u32 m0, s24, 10240
    s_nop 0
    buffer_load_dwordx4 v8, s[40:43], s25 offen lds
    s_add_u32 s25, s25, 16384
    s_add_u32 m0, s24, 11264
    s_nop 0
    buffer_load_dwordx4 v8, s[40:43], s25 offen lds
    s_add_u32 s25, s25, 16384
    s_add_u32 m0, s24, 12288
    s_nop 0
    buffer_load_dwordx4 v8, s[40:43], s25 offen lds
    s_add_u32 s25, s25, 16384
    s_add_u32 m0, s24, 13312
    s_nop 0
    buffer_load_dwordx4 v8, s[40:43], s25 offen lds
    s_add_u32 s25, s25, 16384
    s_add_u32 m0, s24, 14336
    s_nop 0
    buffer_load_dwordx4 v8, s[40:43], s25 offen lds
    s_add_u32 s25, s25, 16384
    s_add_u32 m0, s24, 15360
    s_nop 0
    buffer_load_dwordx4 v8, s[40:43], s25 offen lds
    s_add_u32 s25, s25, 16384
    s_add_u32 m0, s24, 16384
    s_nop 0
    buffer_load_dwordx4 v8, s[40:43], s25 offen lds
    s_add_u32 s25, s25, 16384
    s_add_u32 m0, s24, 17408
    s_nop 0
    buffer_load_dwordx4 v8, s[40:43], s25 offen lds
    s_add_u32 s25, s25, 16384
    s_add_u32 m0, s24, 18432
    s_nop 0
    buffer_load_dwordx4 v8, s[40:43], s25 offen lds
    s_add_u32 s25, s25, 16384
    s_add_u32 m0, s24, 19456
    s_nop 0
    buffer_load_dwordx4 v8, s[40:43], s25 offen lds
    s_add_u32 s25, s25, 16384
    s_add_u32 m0, s24, 20480
    s_nop 0
    buffer_load_dwordx4 v8, s[40:43], s25 offen lds
    s_add_u32 s25, s25, 16384
    s_add_u32 m0, s24, 21504
    s_nop 0
    buffer_load_dwordx4 v8, s[40:43], s25 offen lds
    s_add_u32 s25, s25, 16384
    s_waitcnt vmcnt(20) lgkmcnt(0)
    ds_read_b64_tr_b16 a[0:1], v9 offset:0
    ds_read_b64_tr_b16 a[2:3], v9 offset:1024
    ds_read_b64_tr_b16 a[4:5], v9 offset:8
    ds_read_b64_tr_b16 a[6:7], v9 offset:1032
    s_add_u32 m0, s24, 22528
    s_nop 0
    buffer_load_dwordx4 v8, s[40:43], s25 offen lds
    s_add_u32 s25, s25, 16384
    s_add_u32 m0, s24, 23552
    s_nop 0
    buffer_load_dwordx4 v8, s[40:43], s25 offen lds
    s_add_u32 s25, s25, 16384
    s_waitcnt vmcnt(20) lgkmcnt(0)
    ds_read_b64_tr_b16 a[8:9], v9 offset:2048
    ds_read_b64_tr_b16 a[10:11], v9 offset:3072
    ds_read_b64_tr_b16 a[12:13], v9 offset:2056
    ds_read_b64_tr_b16 a[14:15], v9 offset:3080
    s_add_u32 m0, s24, 0
    s_nop 0
    buffer_load_dwordx4 v8, s[40:43], s25 offen lds
    s_add_u32 s25, s25, 16384
    s_add_u32 m0, s24, 1024
    s_nop 0
    buffer_load_dwordx4 v8, s[40:43], s25 offen lds
    s_add_u32 s25, s25, 16384
    s_waitcnt vmcnt(20) lgkmcnt(0)
    ds_read_b64_tr_b16 a[16:17], v9 offset:4096
    ds_read_b64_tr_b16 a[18:19], v9 offset:5120
    ds_read_b64_tr_b16 a[20:21], v9 offset:4104
    ds_read_b64_tr_b16 a[22:23], v9 offset:5128
    s_add_u32 m0, s24, 2048
    s_nop 0
    buffer_load_dwordx4 v8, s[40:43], s25 offen lds
    s_add_u32 s25, s25, 16384
    s_add_u32 m0, s24, 3072
    s_nop 0
    buffer_load_dwordx4 v8, s[40:43], s25 offen lds
    s_add_u32 s25, s25, 16384
    s_waitcnt vmcnt(20) lgkmcnt(0)
    ds_read_b64_tr_b16 a[24:25], v9 offset:6144
    ds_read_b64_tr_b16 a[26:27], v9 offset:7168
    ds_read_b64_tr_b16 a[28:29], v9 offset:6152
    ds_read_b64_tr_b16 a[30:31], v9 offset:7176
    s_add_u32 m0, s24, 4096
    s_nop 0
    buffer_load_dwordx4 v8, s[40:43], s25 offen lds
    s_add_u32 s25, s25, 16384
    s_add_u32 m0, s24, 5120
    s_nop 0
    buffer_load_dwordx4 v8, s[40:43], s25 offen lds
    s_add_u32 s25, s25, 16384
    s_waitcnt vmcnt(20) lgkmcnt(0)
    ds_read_b64_tr_b16 a[32:33], v9 offset:8192
    ds_read_b64_tr_b16 a[34:35], v9 offset:9216
    ds_read_b64_tr_b16 a[36:37], v9 offset:8200
    ds_read_b64_tr_b16 a[38:39], v9 offset:9224
    s_add_u32 m0, s24, 6144
    s_nop 0
    buffer_load_dwordx4 v8, s[40:43], s25 offen lds
    s_add_u32 s25, s25, 16384
    s_add_u32 m0, s24, 7168
    s_nop 0
    buffer_load_dwordx4 v8, s[40:43], s25 offen lds
    s_add_u32 s25, s25, 16384
    s_waitcnt vmcnt(20) lgkmcnt(0)
    ds_read_b64_tr_b16 a[40:41], v9 offset:10240
    ds_read_b64_tr_b16 a[42:43], v9 offset:11264
    ds_read_b64_tr_b16 a[44:45], v9 offset:10248
    ds_read_b64_tr_b16 a[46:47], v9 offset:11272
    s_waitcnt vmcnt(18) lgkmcnt(0)
    ds_read_b64_tr_b16 a[48:49], v9 offset:12288
    ds_read_b64_tr_b16 a[50:51], v9 offset:13312
    ds_read_b64_tr_b16 a[52:53], v9 offset:12296
    ds_read_b64_tr_b16 a[54:55], v9 offset:13320
    s_waitcnt vmcnt(16) lgkmcnt(0)
    ds_read_b64_tr_b16 a[56:57], v9 offset:14336
    ds_read_b64_tr_b16 a[58:59], v9 offset:15360
    ds_read_b64_tr_b16 a[60:61], v9 offset:14344
    ds_read_b64_tr_b16 a[62:63], v9 offset:15368
    s_waitcnt vmcnt(14) lgkmcnt(0)
    ds_read_b64_tr_b16 a[64:65], v9 offset:16384
    ds_read_b64_tr_b16 a[66:67], v9 offset:17408
    ds_read_b64_tr_b16 a[68:69], v9 offset:16392
    ds_read_b64_tr_b16 a[70:71], v9 offset:17416
    s_waitcnt vmcnt(12) lgkmcnt(0)
    ds_read_b64_tr_b16 a[72:73], v9 offset:18432
    ds_read_b64_tr_b16 a[74:75], v9 offset:19456
    ds_read_b64_tr_b16 a[76:77], v9 offset:18440
    ds_read_b64_tr_b16 a[78:79], v9 offset:19464
    s_waitcnt vmcnt(10) lgkmcnt(0)
    ds_read_b64_tr_b16 a[80:81], v9 offset:20480
    ds_read_b64_tr_b16 a[82:83], v9 offset:21504
    ds_read_b64_tr_b16 a[84:85], v9 offset:20488
    ds_read_b64_tr_b16 a[86:87], v9 offset:21512
    s_waitcnt vmcnt(8) lgkmcnt(0)
    ds_read_b64_tr_b16 a[88:89], v9 offset:22528
    ds_read_b64_tr_b16 a[90:91], v9 offset:23552
    ds_read_b64_tr_b16 a[92:93], v9 offset:22536
    ds_read_b64_tr_b16 a[94:95], v9 offset:23560
    s_waitcnt vmcnt(6) lgkmcnt(0)
    ds_read_b64_tr_b16 a[96:97], v9 offset:0
    ds_read_b64_tr_b16 a[98:99], v9 offset:1024
    ds_read_b64_tr_b16 a[100:101], v9 offset:8
    ds_read_b64_tr_b16 a[102:103], v9 offset:1032
    s_waitcnt vmcnt(4) lgkmcnt(0)
    ds_read_b64_tr_b16 a[104:105], v9 offset:2048
    ds_read_b64_tr_b16 a[106:107], v9 offset:3072
    ds_read_b64_tr_b16 a[108:109], v9 offset:2056
    ds_read_b64_tr_b16 a[110:111], v9 offset:3080
    s_waitcnt vmcnt(2) lgkmcnt(0)
    ds_read_b64_tr_b16 a[112:113], v9 offset:4096
    ds_read_b64_tr_b16 a[114:115], v9 offset:5120
    ds_read_b64_tr_b16 a[116:117], v9 offset:4104
    ds_read_b64_tr_b16 a[118:119], v9 offset:5128
    s_waitcnt vmcnt(0) lgkmcnt(0)
    ds_read_b64_tr_b16 a[120:121], v9 offset:6144
    ds_read_b64_tr_b16 a[122:123], v9 offset:7168
    ds_read_b64_tr_b16 a[124:125], v9 offset:6152
    ds_read_b64_tr_b16 a[126:127], v9 offset:7176
    s_waitcnt lgkmcnt(0)
T6_rest:
    s_load_dwordx2 s[40:41], s[0:1], 88
    s_mov_b32 s42, 704512
    s_mov_b32 s43, 0x20000
    v_lshrrev_b32 v8, 6, v6
    v_lshlrev_b32 v8, 10, v8
    v_and_b32 v9, 48, v6
    v_add_u32 v8, v8, v9
    s_lshl_b32 s24, s19, 8
    s_lshl_b32 s25, s17, 6
    s_add_u32 s25, s25, s24
    s_add_u32 s25, s25, 524288
    s_mul_i32 s24, s17, 24576
    v_add_u32 v9, s24, v6
    s_waitcnt lgkmcnt(0)
    s_add_u32 m0, s24, 0
    s_nop 0
    buffer_load_dwordx4 v8, s[40:43], s25 offen lds
    s_add_u32 s25, s25, 16384
    s_add_u32 m0, s24, 1024
    s_nop 0
    buffer_load_dwordx4 v8, s[40:43], s25 offen lds
    s_add_u32 s25, s25, 16384
    s_add_u32 m0, s24, 2048
    s_nop 0
    buffer_load_dwordx4 v8, s[40:43], s25 offen lds
    s_add_u32 s25, s25, 16384
    s_add_u32 m0, s24, 3072
    s_nop 0
    buffer_load_dwordx4 v8, s[40:43], s25 offen lds
    s_add_u32 s25, s25, 16384
    s_add_u32 m0, s24, 4096
    s_nop 0
    buffer_load_dwordx4 v8, s[40:43], s25 offen lds
    s_add_u32 s25, s25, 16384
    s_add_u32 m0, s24, 5120
    s_nop 0
    buffer_load_dwordx4 v8, s[40:43], s25 offen lds
    s_add_u32 s25, s25, 16384
    s_add_u32 m0, s24, 6144
    s_nop 0
    buffer_load_dwordx4 v8, s[40:43], s25 offen lds
    s_add_u32 s25, s25, 16384
    s_add_u32 m0, s24, 7168
    s_nop 0
    buffer_load_dwordx4 v8, s[40:43], s25 offen lds
    s_add_u32 s25, s25, 16384
    s_add_u32 m0, s24, 8192
    s_nop 0
    buffer_load_dwordx4 v8, s[40:43], s25 offen lds
    s_add_u32 s25, s25, 16384
    s_add_u32 m0, s24, 9216
    s_nop 0
    buffer_load_dwordx4 v8, s[40:43], s25 offen lds
    s_add_u32 s25, s25, 16384
    s_add_u32 m0, s24, 10240
    s_nop 0
    buffer_load_dwordx4 v8, s[40:43], s25 offen lds
    s_add_u32 s25, s25, 16384
    s_add_u32 m0, s24, 11264
    s_nop 0
    buffer_load_dwordx4 v8, s[40:43], s25 offen lds
    s_add_u32 s25, s25, 16384
    s_waitcnt vmcnt(10) lgkmcnt(0)
    ds_read_b64_tr_b16 a[128:129], v9 offset:0
    ds_read_b64_tr_b16 a[130:131], v9 offset:1024
    ds_read_b64_tr_b16 a[132:133], v9 offset:8
    ds_read_b64_tr_b16 a[134:135], v9 offset:1032
    s_waitcnt vmcnt(8) lgkmcnt(0)
    ds_read_b64_tr_b16 a[136:137], v9 offset:2048
    ds_read_b64_tr_b16 a[138:139], v9 offset:3072
    ds_read_b64_tr_b16 a[140:141], v9 offset:2056
    ds_read_b64_tr_b16 a[142:143], v9 offset:3080
    s_waitcnt vmcnt(6) lgkmcnt(0)
    ds_read_b64_tr_b16 a[144:145], v9 offset:4096
    ds_read_b64_tr_b16 a[146:147], v9 offset:5120
    ds_read_b64_tr_b16 a[148:149], v9 offset:4104
    ds_read_b64_tr_b16 a[150:151], v9 offset:5128
    s_waitcnt vmcnt(4) lgkmcnt(0)
    ds_read_b64_tr_b16 a[152:153], v9 offset:6144
    ds_read_b64_tr_b16 a[154:155], v9 offset:7168
    ds_read_b64_tr_b16 a[156:157], v9 offset:6152
    ds_read_b64_tr_b16 a[158:159], v9 offset:7176
    s_waitcnt vmcnt(2) lgkmcnt(0)
    ds_read_b64_tr_b16 a[160:161], v9 offset:8192
    ds_read_b64_tr_b16 a[162:163], v9 offset:9216
    ds_read_b64_tr_b16 a[164:165], v9 offset:8200
    ds_read_b64_tr_b16 a[166:167], v9 offset:9224
    s_waitcnt vmcnt(0) lgkmcnt(0)
    ds_read_b64_tr_b16 a[168:169], v9 offset:10240
    ds_read_b64_tr_b16 a[170:171], v9 offset:11264
    ds_read_b64_tr_b16 a[172:173], v9 offset:10248
    ds_read_b64_tr_b16 a[174:175], v9 offset:11272
    s_waitcnt lgkmcnt(0)
    s_load_dwordx2 s[8:9], s[0:1], 96
    s_mov_b32 s10, 2097152
    s_mov_b32 s11, 0x20000
    s_waitcnt lgkmcnt(0)
    v_lshlrev_b32 v10, 10, v2
    v_lshl_add_u32 v10, v3, 4, v10
    s_lshl_b32 s26, s18, 15
    s_lshl_b32 s24, s19, 8
    s_add_u32 s26, s26, s24
    s_lshl_b32 s24, s17, 6
    s_add_u32 s26, s26, s24
    s_add_u32 s27, s26, 16384
    s_add_u32 s28, s26, 54525952
    s_add_u32 s29, s27, 54525952
    v_add_u32 v8, 98304, v6
    s_lshl_b32 s24, s17, 11
    v_add_u32 v9, s24, v8
    s_mul_i32 s31, s18, 49152
    s_add_u32 s31, s31, s24
    s_add_u32 s31, s31, 75497472
    s_add_u32 s32, s31, 8192
    s_add_u32 s33, s31, 16384
    s_add_u32 s34, s31, 24576
    s_add_u32 s35, s31, 32768
    s_add_u32 s36, s31, 40960
    s_lshl_b32 s37, s18, 7
    s_add_u32 s37, s37, 16384
    s_cmp_lg_u32 s17, 0
    s_cbranch_scc1 wte_47
    v_mov_b32 v13, 23552
wt_46:
    buffer_load_dword v12, v13, s[4:7], 0 offen sc1
    s_add_u32 s23, s23, 1
    s_waitcnt vmcnt(0)
    v_readfirstlane_b32 s24, v12
    s_cmp_gt_u32 s23, 262144
    s_cbranch_scc1 wte_47
    s_cmp_ge_u32 s24, 1
    s_cbranch_scc1 wte_47
    s_sleep 32
    s_branch wt_46
wte_47:
    s_barrier
    v_mov_b32 v12, 0
T6_ca:
    buffer_load_dword v13, v12, s[4:7], s33 offen offset:1024 sc1
    buffer_load_dword v14, v12, s[4:7], s37 offen sc1
    s_add_u32 s23, s23, 1
    s_cmp_gt_u32 s23, 262144
    s_waitcnt vmcnt(0)
    s_cbranch_scc1 T6_cea
    v_add_u32 v14, -1, v14
    v_max_u32 v13, v13, v14
    v_cmp_eq_u32 vcc, -1, v13
    s_cbranch_vccz T6_cea
    s_sleep 1
    s_branch T6_ca
T6_cea:
    buffer_load_dwordx4 v[64:67], v6, s[4:7], s31 offen offset:0 sc1
    buffer_load_dwordx4 v[68:71], v6, s[4:7], s31 offen offset:1024 sc1
    buffer_load_dwordx4 v[72:75], v6, s[4:7], s32 offen offset:0 sc1
    buffer_load_dwordx4 v[76:79], v6, s[4:7], s32 offen offset:1024 sc1
    buffer_load_dwordx4 v[80:83], v6, s[4:7], s33 offen offset:0 sc1
    buffer_load_dwordx4 v[84:87], v6, s[4:7], s33 offen offset:1024 sc1
    s_waitcnt vmcnt(0)
    buffer_load_dword v13, v12, s[4:7], s36 offen offset:1024 sc1
T6_w0:
    s_add_u32 s23, s23, 1
    s_cmp_gt_u32 s23, 262144
    s_cbranch_scc1 T6_d0
    v_max3_u32 v11, v64, v65, v66
    v_max3_u32 v11, v11, v67, v68
    v_max3_u32 v11, v11, v69, v70
    v_max3_u32 v11, v11, v71, v72
    v_max3_u32 v11, v11, v73, v74
    v_max3_u32 v11, v11, v75, v76
    v_max3_u32 v11, v11, v77, v78
    v_max3_u32 v11, v11, v79, v80
    v_max3_u32 v11, v11, v81, v82
    v_max3_u32 v11, v11, v83, v84
    v_max3_u32 v11, v11, v85, v86
    v_max_u32 v11, v11, v87
    v_cmp_eq_u32 vcc, -1, v11
    s_cbranch_vccz T6_d0
    buffer_load_dwordx4 v[64:67], v6, s[4:7], s31 offen offset:0 sc1
    buffer_load_dwordx4 v[68:71], v6, s[4:7], s31 offen offset:1024 sc1
    buffer_load_dwordx4 v[72:75], v6, s[4:7], s32 offen offset:0 sc1
    buffer_load_dwordx4 v[76:79], v6, s[4:7], s32 offen offset:1024 sc1
    buffer_load_dwordx4 v[80:83], v6, s[4:7], s33 offen offset:0 sc1
    buffer_load_dwordx4 v[84:87], v6, s[4:7], s33 offen offset:1024 sc1
    s_waitcnt vmcnt(0)
    s_branch T6_w0
T6_d0:
    ds_write_b128 v9, v[64:67] offset:0
    ds_write_b128 v9, v[68:71] offset:1024
    ds_write_b128 v9, v[72:75] offset:8192
    ds_write_b128 v9, v[76:79] offset:9216
    ds_write_b128 v9, v[80:83] offset:16384
    ds_write_b128 v9, v[84:87] offset:17408
    s_waitcnt lgkmcnt(0)
    s_barrier
    s_waitcnt vmcnt(0)
    v_cmp_eq_u32 vcc, -1, v13
    s_cbranch_vccnz T6_late
    ds_read_b128 v[32:35], v8 offset:0
    ds_read_b128 v[36:39], v8 offset:1024
    ds_read_b128 v[40:43], v8 offset:2048
    ds_read_b128 v[44:47], v8 offset:3072
    s_waitcnt lgkmcnt(2)
    v_mfma_f32_16x16x32_bf16 v[16:19], a[0:3], v[32:35], 0
    ds_read_b128 v[48:51], v8 offset:4096
    v_mfma_f32_16x16x32_bf16 v[20:23], a[4:7], v[32:35], 0
    ds_read_b128 v[52:55], v8 offset:5120
    v_mfma_f32_16x16x32_bf16 v[24:27], a[0:3], v[36:39], 0
    buffer_load_dwordx4 v[88:91], v6, s[4:7], s34 offen offset:0 sc1
    v_mfma_f32_16x16x32_bf16 v[28:31], a[4:7], v[36:39], 0
    s_waitcnt lgkmcnt(2)
    v_mfma_f32_16x16x32_bf16 v[16:19], a[8:11], v[40:43], v[16:19]
    ds_read_b128 v[32:35], v8 offset:6144
    v_mfma_f32_16x16x32_bf16 v[20:23], a[12:15], v[40:43], v[20:23]
    ds_read_b128 v[36:39], v8 offset:7168
    v_mfma_f32_16x16x32_bf16 v[24:27], a[8:11], v[44:47], v[24:27]
    buffer_load_dwordx4 v[92:95], v6, s[4:7], s34 offen offset:1024 sc1
    v_mfma_f32_16x16x32_bf16 v[28:31], a[12:15], v[44:47], v[28:31]
    s_waitcnt lgkmcnt(2)
    v_mfma_f32_16x16x32_bf16 v[16:19], a[16:19], v[48:51], v[16:19]
    ds_read_b128 v[40:43], v8 offset:8192
    v_mfma_f32_16x16x32_bf16 v[20:23], a[20:23], v[48:51], v[20:23]
    ds_read_b128 v[44:47], v8 offset:9216
    v_mfma_f32_16x16x32_bf16 v[24:27], a[16:19], v[52:55], v[24:27]
    buffer_load_dwordx4 v[96:99], v6, s[4:7], s35 offen offset:0 sc1
    v_mfma_f32_16x16x32_bf16 v[28:31], a[20:23], v[52:55], v[28:31]
    s_waitcnt lgkmcnt(2)
    v_mfma_f32_16x16x32_bf16 v[16:19], a[24:27], v[32:35], v[16:19]
    ds_read_b128 v[48:51], v8 offset:10240
    v_mfma_f32_16x16x32_bf16 v[20:23], a[28:31], v[32:35], v[20:23]
    ds_read_b128 v[52:55], v8 offset:11264
    v_mfma_f32_16x16x32_bf16 v[24:27], a[24:27], v[36:39], v[24:27]
    buffer_load_dwordx4 v[100:103], v6, s[4:7], s35 offen offset:1024 sc1
    v_mfma_f32_16x16x32_bf16 v[28:31], a[28:31], v[36:39], v[28:31]
    s_waitcnt lgkmcnt(2)
    v_mfma_f32_16x16x32_bf16 v[16:19], a[32:35], v[40:43], v[16:19]
    ds_read_b128 v[32:35], v8 offset:12288
    v_mfma_f32_16x16x32_bf16 v[20:23], a[36:39], v[40:43], v[20:23]
    ds_read_b128 v[36:39], v8 offset:13312
    v_mfma_f32_16x16x32_bf16 v[24:27], a[32:35], v[44:47], v[24:27]
    buffer_load_dwordx4 v[104:107], v6, s[4:7], s36 offen offset:0 sc1
    v_mfma_f32_16x16x32_bf16 v[28:31], a[36:39], v[44:47], v[28:31]
    s_waitcnt lgkmcnt(2)
    v_mfma_f32_16x16x32_bf16 v[16:19], a[40:43], v[48:51], v[16:19]
    ds_read_b128 v[40:43], v8 offset:14336
    v_mfma_f32_16x16x32_bf16 v[20:23], a[44:47], v[48:51], v[20:23]
    ds_read_b128 v[44:47], v8 offset:15360
    v_mfma_f32_16x16x32_bf16 v[24:27], a[40:43], v[52:55], v[24:27]
    buffer_load_dwordx4 v[108:111], v6, s[4:7], s36 offen offset:1024 sc1
    v_mfma_f32_16x16x32_bf16 v[28:31], a[44:47], v[52:55], v[28:31]
    s_waitcnt lgkmcnt(2)
    v_mfma_f32_16x16x32_bf16 v[16:19], a[48:51], v[32:35], v[16:19]
    ds_read_b128 v[48:51], v8 offset:16384
    v_mfma_f32_16x16x32_bf16 v[20:23], a[52:55], v[32:35], v[20:23]
    ds_read_b128 v[52:55], v8 offset:17408
    v_mfma_f32_16x16x32_bf16 v[24:27], a[48:51], v[36:39], v[24:27]
    buffer_load_dwordx4 v[56:59], v10, s[4:7], s28 offen sc1
    v_mfma_f32_16x16x32_bf16 v[28:31], a[52:55], v[36:39], v[28:31]
    s_waitcnt lgkmcnt(2)
    v_mfma_f32_16x16x32_bf16 v[16:19], a[56:59], v[40:43], v[16:19]
    ds_read_b128 v[32:35], v8 offset:18432
    v_mfma_f32_16x16x32_bf16 v[20:23], a[60:63], v[40:43], v[20:23]
    ds_read_b128 v[36:39], v8 offset:19456
    v_mfma_f32_16x16x32_bf16 v[24:27], a[56:59], v[44:47], v[24:27]
    buffer_load_dwordx4 v[60:63], v10, s[4:7], s29 offen sc1
    v_mfma_f32_16x16x32_bf16 v[28:31], a[60:63], v[44:47], v[28:31]
    s_waitcnt lgkmcnt(2)
    v_mfma_f32_16x16x32_bf16 v[16:19], a[64:67], v[48:51], v[16:19]
    ds_read_b128 v[40:43], v8 offset:20480
    v_mfma_f32_16x16x32_bf16 v[20:23], a[68:71], v[48:51], v[20:23]
    ds_read_b128 v[44:47], v8 offset:21504
    v_mfma_f32_16x16x32_bf16 v[24:27], a[64:67], v[52:55], v[24:27]
    v_mfma_f32_16x16x32_bf16 v[28:31], a[68:71], v[52:55], v[28:31]
    s_waitcnt lgkmcnt(2)
    v_mfma_f32_16x16x32_bf16 v[16:19], a[72:75], v[32:35], v[16:19]
    ds_read_b128 v[48:51], v8 offset:22528
    v_mfma_f32_16x16x32_bf16 v[20:23], a[76:79], v[32:35], v[20:23]
    ds_read_b128 v[52:55], v8 offset:23552
    v_mfma_f32_16x16x32_bf16 v[24:27], a[72:75], v[36:39], v[24:27]
    v_mfma_f32_16x16x32_bf16 v[28:31], a[76:79], v[36:39], v[28:31]
    s_waitcnt lgkmcnt(2)
    v_mfma_f32_16x16x32_bf16 v[16:19], a[80:83], v[40:43], v[16:19]
    v_mfma_f32_16x16x32_bf16 v[20:23], a[84:87], v[40:43], v[20:23]
    v_mfma_f32_16x16x32_bf16 v[24:27], a[80:83], v[44:47], v[24:27]
    v_mfma_f32_16x16x32_bf16 v[28:31], a[84:87], v[44:47], v[28:31]
    s_waitcnt lgkmcnt(0)
    v_mfma_f32_16x16x32_bf16 v[16:19], a[88:91], v[48:51], v[16:19]
    v_mfma_f32_16x16x32_bf16 v[20:23], a[92:95], v[48:51], v[20:23]
    v_mfma_f32_16x16x32_bf16 v[24:27], a[88:91], v[52:55], v[24:27]
    v_mfma_f32_16x16x32_bf16 v[28:31], a[92:95], v[52:55], v[28:31]
    s_branch T6_join
T6_late:
    ds_read_b128 v[32:35], v8 offset:0
    ds_read_b128 v[36:39], v8 offset:1024
    ds_read_b128 v[40:43], v8 offset:2048
    ds_read_b128 v[44:47], v8 offset:3072
    s_waitcnt lgkmcnt(2)
    v_mfma_f32_16x16x32_bf16 v[16:19], a[0:3], v[32:35], 0
    ds_read_b128 v[48:51], v8 offset:4096
    v_mfma_f32_16x16x32_bf16 v[20:23], a[4:7], v[32:35], 0
    ds_read_b128 v[52:55], v8 offset:5120
    v_mfma_f32_16x16x32_bf16 v[24:27], a[0:3], v[36:39], 0
    buffer_load_dwordx4 v[56:59], v10, s[4:7], s28 offen sc1
    v_mfma_f32_16x16x32_bf16 v[28:31], a[4:7], v[36:39], 0
    s_waitcnt lgkmcnt(2)
    v_mfma_f32_16x16x32_bf16 v[16:19], a[8:11], v[40:43], v[16:19]
    ds_read_b128 v[32:35], v8 offset:6144
    v_mfma_f32_16x16x32_bf16 v[20:23], a[12:15], v[40:43], v[20:23]
    ds_read_b128 v[36:39], v8 offset:7168
    v_mfma_f32_16x16x32_bf16 v[24:27], a[8:11], v[44:47], v[24:27]
    buffer_load_dwordx4 v[60:63], v10, s[4:7], s29 offen sc1
    v_mfma_f32_16x16x32_bf16 v[28:31], a[12:15], v[44:47], v[28:31]
    s_waitcnt lgkmcnt(2)
    v_mfma_f32_16x16x32_bf16 v[16:19], a[16:19], v[48:51], v[16:19]
    ds_read_b128 v[40:43], v8 offset:8192
    v_mfma_f32_16x16x32_bf16 v[20:23], a[20:23], v[48:51], v[20:23]
    ds_read_b128 v[44:47], v8 offset:9216
    v_mfma_f32_16x16x32_bf16 v[24:27], a[16:19], v[52:55], v[24:27]
    v_mfma_f32_16x16x32_bf16 v[28:31], a[20:23], v[52:55], v[28:31]
    s_waitcnt lgkmcnt(2)
    v_mfma_f32_16x16x32_bf16 v[16:19], a[24:27], v[32:35], v[16:19]
    ds_read_b128 v[48:51], v8 offset:10240
    v_mfma_f32_16x16x32_bf16 v[20:23], a[28:31], v[32:35], v[20:23]
    ds_read_b128 v[52:55], v8 offset:11264
    v_mfma_f32_16x16x32_bf16 v[24:27], a[24:27], v[36:39], v[24:27]
    v_mfma_f32_16x16x32_bf16 v[28:31], a[28:31], v[36:39], v[28:31]
    s_waitcnt lgkmcnt(2)
    v_mfma_f32_16x16x32_bf16 v[16:19], a[32:35], v[40:43], v[16:19]
    ds_read_b128 v[32:35], v8 offset:12288
    v_mfma_f32_16x16x32_bf16 v[20:23], a[36:39], v[40:43], v[20:23]
    ds_read_b128 v[36:39], v8 offset:13312
    v_mfma_f32_16x16x32_bf16 v[24:27], a[32:35], v[44:47], v[24:27]
    v_mfma_f32_16x16x32_bf16 v[28:31], a[36:39], v[44:47], v[28:31]
    s_waitcnt lgkmcnt(2)
    v_mfma_f32_16x16x32_bf16 v[16:19], a[40:43], v[48:51], v[16:19]
    ds_read_b128 v[40:43], v8 offset:14336
    v_mfma_f32_16x16x32_bf16 v[20:23], a[44:47], v[48:51], v[20:23]
    ds_read_b128 v[44:47], v8 offset:15360
    v_mfma_f32_16x16x32_bf16 v[24:27], a[40:43], v[52:55], v[24:27]
    v_mfma_f32_16x16x32_bf16 v[28:31], a[44:47], v[52:55], v[28:31]
    s_waitcnt lgkmcnt(2)
    v_mfma_f32_16x16x32_bf16 v[16:19], a[48:51], v[32:35], v[16:19]
    ds_read_b128 v[48:51], v8 offset:16384
    v_mfma_f32_16x16x32_bf16 v[20:23], a[52:55], v[32:35], v[20:23]
    ds_read_b128 v[52:55], v8 offset:17408
    v_mfma_f32_16x16x32_bf16 v[24:27], a[48:51], v[36:39], v[24:27]
    v_mfma_f32_16x16x32_bf16 v[28:31], a[52:55], v[36:39], v[28:31]
    s_waitcnt lgkmcnt(2)
    v_mfma_f32_16x16x32_bf16 v[16:19], a[56:59], v[40:43], v[16:19]
    ds_read_b128 v[32:35], v8 offset:18432
    v_mfma_f32_16x16x32_bf16 v[20:23], a[60:63], v[40:43], v[20:23]
    ds_read_b128 v[36:39], v8 offset:19456
    v_mfma_f32_16x16x32_bf16 v[24:27], a[56:59], v[44:47], v[24:27]
    v_mfma_f32_16x16x32_bf16 v[28:31], a[60:63], v[44:47], v[28:31]
    s_waitcnt lgkmcnt(2)
    v_mfma_f32_16x16x32_bf16 v[16:19], a[64:67], v[48:51], v[16:19]
    ds_read_b128 v[40:43], v8 offset:20480
    v_mfma_f32_16x16x32_bf16 v[20:23], a[68:71], v[48:51], v[20:23]
    ds_read_b128 v[44:47], v8 offset:21504
    v_mfma_f32_16x16x32_bf16 v[24:27], a[64:67], v[52:55], v[24:27]
    v_mfma_f32_16x16x32_bf16 v[28:31], a[68:71], v[52:55], v[28:31]
    s_waitcnt lgkmcnt(2)
    v_mfma_f32_16x16x32_bf16 v[16:19], a[72:75], v[32:35], v[16:19]
    ds_read_b128 v[48:51], v8 offset:22528
    v_mfma_f32_16x16x32_bf16 v[20:23], a[76:79], v[32:35], v[20:23]
    ds_read_b128 v[52:55], v8 offset:23552
    v_mfma_f32_16x16x32_bf16 v[24:27], a[72:75], v[36:39], v[24:27]
    v_mfma_f32_16x16x32_bf16 v[28:31], a[76:79], v[36:39], v[28:31]
    s_waitcnt lgkmcnt(2)
    v_mfma_f32_16x16x32_bf16 v[16:19], a[80:83], v[40:43], v[16:19]
    v_mfma_f32_16x16x32_bf16 v[20:23], a[84:87], v[40:43], v[20:23]
    v_mfma_f32_16x16x32_bf16 v[24:27], a[80:83], v[44:47], v[24:27]
    v_mfma_f32_16x16x32_bf16 v[28:31], a[84:87], v[44:47], v[28:31]
    s_waitcnt lgkmcnt(0)
    v_mfma_f32_16x16x32_bf16 v[16:19], a[88:91], v[48:51], v[16:19]
    v_mfma_f32_16x16x32_bf16 v[20:23], a[92:95], v[48:51], v[20:23]
    v_mfma_f32_16x16x32_bf16 v[24:27], a[88:91], v[52:55], v[24:27]
    v_mfma_f32_16x16x32_bf16 v[28:31], a[92:95], v[52:55], v[28:31]
T6_cb:
    buffer_load_dword v13, v12, s[4:7], s36 offen offset:1024 sc1
    s_add_u32 s23, s23, 1
    s_cmp_gt_u32 s23, 262144
    s_waitcnt vmcnt(0)
    s_cbranch_scc1 T6_ceb
    v_cmp_eq_u32 vcc, -1, v13
    s_cbranch_vccz T6_ceb
    s_branch T6_cb
T6_ceb:
    buffer_load_dwordx4 v[88:91], v6, s[4:7], s34 offen offset:0 sc1
    buffer_load_dwordx4 v[92:95], v6, s[4:7], s34 offen offset:1024 sc1
    buffer_load_dwordx4 v[96:99], v6, s[4:7], s35 offen offset:0 sc1
    buffer_load_dwordx4 v[100:103], v6, s[4:7], s35 offen offset:1024 sc1
    buffer_load_dwordx4 v[104:107], v6, s[4:7], s36 offen offset:0 sc1
    buffer_load_dwordx4 v[108:111], v6, s[4:7], s36 offen offset:1024 sc1
T6_join:
    s_waitcnt vmcnt(0)
T6_w1:
    s_add_u32 s23, s23, 1
    s_cmp_gt_u32 s23, 262144
    s_cbranch_scc1 T6_d1
    v_max3_u32 v11, v88, v89, v90
    v_max3_u32 v11, v11, v91, v92
    v_max3_u32 v11, v11, v93, v94
    v_max3_u32 v11, v11, v95, v96
    v_max3_u32 v11, v11, v97, v98
    v_max3_u32 v11, v11, v99, v100
    v_max3_u32 v11, v11, v101, v102
    v_max3_u32 v11, v11, v103, v104
    v_max3_u32 v11, v11, v105, v106
    v_max3_u32 v11, v11, v107, v108
    v_max3_u32 v11, v11, v109, v110
    v_max_u32 v11, v11, v111
    v_cmp_eq_u32 vcc, -1, v11
    s_cbranch_vccz T6_d1
    buffer_load_dwordx4 v[88:91], v6, s[4:7], s34 offen offset:0 sc1
    buffer_load_dwordx4 v[92:95], v6, s[4:7], s34 offen offset:1024 sc1
    buffer_load_dwordx4 v[96:99], v6, s[4:7], s35 offen offset:0 sc1
    buffer_load_dwordx4 v[100:103], v6, s[4:7], s35 offen offset:1024 sc1
    buffer_load_dwordx4 v[104:107], v6, s[4:7], s36 offen offset:0 sc1
    buffer_load_dwordx4 v[108:111], v6, s[4:7], s36 offen offset:1024 sc1
    s_waitcnt vmcnt(0)
    s_branch T6_w1
T6_d1:
    ds_write_b128 v9, v[88:91] offset:24576
    ds_write_b128 v9, v[92:95] offset:25600
    ds_write_b128 v9, v[96:99] offset:32768
    ds_write_b128 v9, v[100:103] offset:33792
    ds_write_b128 v9, v[104:107] offset:40960
    ds_write_b128 v9, v[108:111] offset:41984
    s_waitcnt lgkmcnt(0)
    s_barrier
    ds_read_b128 v[32:35], v8 offset:24576
    ds_read_b128 v[36:39], v8 offset:25600
    ds_read_b128 v[40:43], v8 offset:26624
    ds_read_b128 v[44:47], v8 offset:27648
    s_waitcnt lgkmcnt(2)
    v_mfma_f32_16x16x32_bf16 v[16:19], a[96:99], v[32:35], v[16:19]
    ds_read_b128 v[48:51], v8 offset:28672
    v_mfma_f32_16x16x32_bf16 v[20:23], a[100:103], v[32:35], v[20:23]
    ds_read_b128 v[52:55], v8 offset:29696
    v_mfma_f32_16x16x32_bf16 v[24:27], a[96:99], v[36:39], v[24:27]
    v_mfma_f32_16x16x32_bf16 v[28:31], a[100:103], v[36:39], v[28:31]
    s_waitcnt lgkmcnt(2)
    v_mfma_f32_16x16x32_bf16 v[16:19], a[104:107], v[40:43], v[16:19]
    ds_read_b128 v[32:35], v8 offset:30720
    v_mfma_f32_16x16x32_bf16 v[20:23], a[108:111], v[40:43], v[20:23]
    ds_read_b128 v[36:39], v8 offset:31744
    v_mfma_f32_16x16x32_bf16 v[24:27], a[104:107], v[44:47], v[24:27]
    v_mfma_f32_16x16x32_bf16 v[28:31], a[108:111], v[44:47], v[28:31]
    s_waitcnt lgkmcnt(2)
    v_mfma_f32_16x16x32_bf16 v[16:19], a[112:115], v[48:51], v[16:19]
    ds_read_b128 v[40:43], v8 offset:32768
    v_mfma_f32_16x16x32_bf16 v[20:23], a[116:119], v[48:51], v[20:23]
    ds_read_b128 v[44:47], v8 offset:33792
    v_mfma_f32_16x16x32_bf16 v[24:27], a[112:115], v[52:55], v[24:27]
    v_mfma_f32_16x16x32_bf16 v[28:31], a[116:119], v[52:55], v[28:31]
    s_waitcnt lgkmcnt(2)
    v_mfma_f32_16x16x32_bf16 v[16:19], a[120:123], v[32:35], v[16:19]
    ds_read_b128 v[48:51], v8 offset:34816
    v_mfma_f32_16x16x32_bf16 v[20:23], a[124:127], v[32:35], v[20:23]
    ds_read_b128 v[52:55], v8 offset:35840
    v_mfma_f32_16x16x32_bf16 v[24:27], a[120:123], v[36:39], v[24:27]
    v_mfma_f32_16x16x32_bf16 v[28:31], a[124:127], v[36:39], v[28:31]
    s_waitcnt lgkmcnt(2)
    v_mfma_f32_16x16x32_bf16 v[16:19], a[128:131], v[40:43], v[16:19]
    ds_read_b128 v[32:35], v8 offset:36864
    v_mfma_f32_16x16x32_bf16 v[20:23], a[132:135], v[40:43], v[20:23]
    ds_read_b128 v[36:39], v8 offset:37888
    v_mfma_f32_16x16x32_bf16 v[24:27], a[128:131], v[44:47], v[24:27]
    v_mfma_f32_16x16x32_bf16 v[28:31], a[132:135], v[44:47], v[28:31]
    s_waitcnt lgkmcnt(2)
    v_mfma_f32_16x16x32_bf16 v[16:19], a[136:139], v[48:51], v[16:19]
    ds_read_b128 v[40:43], v8 offset:38912
    v_mfma_f32_16x16x32_bf16 v[20:23], a[140:143], v[48:51], v[20:23]
    ds_read_b128 v[44:47], v8 offset:39936
    v_mfma_f32_16x16x32_bf16 v[24:27], a[136:139], v[52:55], v[24:27]
    v_mfma_f32_16x16x32_bf16 v[28:31], a[140:143], v[52:55], v[28:31]
    s_waitcnt lgkmcnt(2)
    v_mfma_f32_16x16x32_bf16 v[16:19], a[144:147], v[32:35], v[16:19]
    ds_read_b128 v[48:51], v8 offset:40960
    v_mfma_f32_16x16x32_bf16 v[20:23], a[148:151], v[32:35], v[20:23]
    ds_read_b128 v[52:55], v8 offset:41984
    v_mfma_f32_16x16x32_bf16 v[24:27], a[144:147], v[36:39], v[24:27]
    v_mfma_f32_16x16x32_bf16 v[28:31], a[148:151], v[36:39], v[28:31]
    s_waitcnt lgkmcnt(2)
    v_mfma_f32_16x16x32_bf16 v[16:19], a[152:155], v[40:43], v[16:19]
    ds_read_b128 v[32:35], v8 offset:43008
    v_mfma_f32_16x16x32_bf16 v[20:23], a[156:159], v[40:43], v[20:23]
    ds_read_b128 v[36:39], v8 offset:44032
    v_mfma_f32_16x16x32_bf16 v[24:27], a[152:155], v[44:47], v[24:27]
    v_mfma_f32_16x16x32_bf16 v[28:31], a[156:159], v[44:47], v[28:31]
    s_waitcnt lgkmcnt(2)
    v_mfma_f32_16x16x32_bf16 v[16:19], a[160:163], v[48:51], v[16:19]
    v_mfma_f32_16x16x32_bf16 v[20:23], a[164:167], v[48:51], v[20:23]
    v_mfma_f32_16x16x32_bf16 v[24:27], a[160:163], v[52:55], v[24:27]
    v_mfma_f32_16x16x32_bf16 v[28:31], a[164:167], v[52:55], v[28:31]
    s_waitcnt lgkmcnt(0)
    v_mfma_f32_16x16x32_bf16 v[16:19], a[168:171], v[32:35], v[16:19]
    v_mfma_f32_16x16x32_bf16 v[20:23], a[172:175], v[32:35], v[20:23]
    v_mfma_f32_16x16x32_bf16 v[24:27], a[168:171], v[36:39], v[24:27]
    v_mfma_f32_16x16x32_bf16 v[28:31], a[172:175], v[36:39], v[28:31]
    s_waitcnt vmcnt(0)
    v_lshlrev_b32 v112, 16, v56
    v_and_b32 v113, 0xffff0000, v56
    v_lshlrev_b32 v114, 16, v57
    v_and_b32 v115, 0xffff0000, v57
    v_lshlrev_b32 v116, 16, v58
    v_and_b32 v117, 0xffff0000, v58
    v_lshlrev_b32 v118, 16, v59
    v_and_b32 v119, 0xffff0000, v59
    v_cvt_pk_bf16_f32 v120, v16, v17
    v_cvt_pk_bf16_f32 v121, v18, v19
    v_cvt_pk_bf16_f32 v122, v20, v21
    v_cvt_pk_bf16_f32 v123, v22, v23
    v_lshlrev_b32 v16, 16, v120
    v_and_b32 v17, 0xffff0000, v120
    v_lshlrev_b32 v18, 16, v121
    v_and_b32 v19, 0xffff0000, v121
    v_lshlrev_b32 v20, 16, v122
    v_and_b32 v21, 0xffff0000, v122
    v_lshlrev_b32 v22, 16, v123
    v_and_b32 v23, 0xffff0000, v123
    v_pk_add_f32 v[16:17], v[16:17], v[112:113]
    v_pk_add_f32 v[18:19], v[18:19], v[114:115]
    v_pk_add_f32 v[20:21], v[20:21], v[116:117]
    v_pk_add_f32 v[22:23], v[22:23], v[118:119]
    v_cvt_pk_bf16_f32 v16, v16, v17
    v_cvt_pk_bf16_f32 v17, v18, v19
    v_cvt_pk_bf16_f32 v18, v20, v21
    v_cvt_pk_bf16_f32 v19, v22, v23
    buffer_store_dwordx4 v[16:19], v10, s[8:11], s26 offen
    v_lshlrev_b32 v112, 16, v60
    v_and_b32 v113, 0xffff0000, v60
    v_lshlrev_b32 v114, 16, v61
    v_and_b32 v115, 0xffff0000, v61
    v_lshlrev_b32 v116, 16, v62
    v_and_b32 v117, 0xffff0000, v62
    v_lshlrev_b32 v118, 16, v63
    v_and_b32 v119, 0xffff0000, v63
    v_cvt_pk_bf16_f32 v120, v24, v25
    v_cvt_pk_bf16_f32 v121, v26, v27
    v_cvt_pk_bf16_f32 v122, v28, v29
    v_cvt_pk_bf16_f32 v123, v30, v31
    v_lshlrev_b32 v24, 16, v120
    v_and_b32 v25, 0xffff0000, v120
    v_lshlrev_b32 v26, 16, v121
    v_and_b32 v27, 0xffff0000, v121
    v_lshlrev_b32 v28, 16, v122
    v_and_b32 v29, 0xffff0000, v122
    v_lshlrev_b32 v30, 16, v123
    v_and_b32 v31, 0xffff0000, v123
    v_pk_add_f32 v[24:25], v[24:25], v[112:113]
    v_pk_add_f32 v[26:27], v[26:27], v[114:115]
    v_pk_add_f32 v[28:29], v[28:29], v[116:117]
    v_pk_add_f32 v[30:31], v[30:31], v[118:119]
    v_cvt_pk_bf16_f32 v24, v24, v25
    v_cvt_pk_bf16_f32 v25, v26, v27
    v_cvt_pk_bf16_f32 v26, v28, v29
    v_cvt_pk_bf16_f32 v27, v30, v31
    buffer_store_dwordx4 v[24:27], v10, s[8:11], s27 offen
    s_endpgm
L_post:
    s_load_dwordx2 s[8:9], s[0:1], 0
    s_mov_b32 s10, 2097152
    s_mov_b32 s11, 0x20000
    s_waitcnt lgkmcnt(0)
    s_lshl_b32 s25, s17, 12
    s_lshl_b32 s24, s16, 14
    s_add_u32 s24, s24, s25
    s_lshl_b32 s25, s17, 14
    v_add_u32 v9, s25, v6
    v_lshlrev_b32 v10, 3, v0
    v_mov_b64 v[12:13], 0
    s_lshl_b32 s26, s16, 11
    buffer_store_dwordx2 v[12:13], v10, s[4:7], s26 offen sc1
    s_add_u32 m0, s25, 0
    s_add_u32 s26, s24, 0
    buffer_load_dwordx4 v6, s[8:11], s26 offen offset:0 lds
    buffer_load_dwordx4 v6, s[8:11], s26 offen offset:1024 lds
    buffer_load_dwordx4 v6, s[8:11], s26 offen offset:2048 lds
    buffer_load_dwordx4 v6, s[8:11], s26 offen offset:3072 lds
    s_add_u32 m0, s25, 4096
    s_add_u32 s26, s24, 524288
    buffer_load_dwordx4 v6, s[8:11], s26 offen offset:0 lds
    buffer_load_dwordx4 v6, s[8:11], s26 offen offset:1024 lds
    buffer_load_dwordx4 v6, s[8:11], s26 offen offset:2048 lds
    buffer_load_dwordx4 v6, s[8:11], s26 offen offset:3072 lds
    s_add_u32 m0, s25, 8192
    s_add_u32 s26, s24, 1048576
    buffer_load_dwordx4 v6, s[8:11], s26 offen offset:0 lds
    buffer_load_dwordx4 v6, s[8:11], s26 offen offset:1024 lds
    buffer_load_dwordx4 v6, s[8:11], s26 offen offset:2048 lds
    buffer_load_dwordx4 v6, s[8:11], s26 offen offset:3072 lds
    s_add_u32 m0, s25, 12288
    s_add_u32 s26, s24, 1572864
    buffer_load_dwordx4 v6, s[8:11], s26 offen offset:0 lds
    buffer_load_dwordx4 v6, s[8:11], s26 offen offset:1024 lds
    buffer_load_dwordx4 v6, s[8:11], s26 offen offset:2048 lds
    buffer_load_dwordx4 v6, s[8:11], s26 offen offset:3072 lds
    s_add_u32 s24, s24, 52428800
    s_mov_b32 s28, 0
    s_waitcnt vmcnt(12)
S_ln:
    ds_read_b128 v[16:19], v9 offset:0
    ds_read_b128 v[40:43], v9 offset:1024
    ds_read_b128 v[64:67], v9 offset:2048
    ds_read_b128 v[88:91], v9 offset:3072
    v_add_u32 v9, 4096, v9
    s_waitcnt lgkmcnt(0)
    v_lshlrev_b32 v20, 16, v16
    v_lshlrev_b32 v44, 16, v40
    v_lshlrev_b32 v68, 16, v64
    v_lshlrev_b32 v92, 16, v88
    v_and_b32 v21, 0xffff0000, v16
    v_and_b32 v45, 0xffff0000, v40
    v_and_b32 v69, 0xffff0000, v64
    v_and_b32 v93, 0xffff0000, v88
    v_lshlrev_b32 v22, 16, v17
    v_lshlrev_b32 v46, 16, v41
    v_lshlrev_b32 v70, 16, v65
    v_lshlrev_b32 v94, 16, v89
    v_and_b32 v23, 0xffff0000, v17
    v_and_b32 v47, 0xffff0000, v41
    v_and_b32 v71, 0xffff0000, v65
    v_and_b32 v95, 0xffff0000, v89
    v_lshlrev_b32 v24, 16, v18
    v_lshlrev_b32 v48, 16, v42
    v_lshlrev_b32 v72, 16, v66
    v_lshlrev_b32 v96, 16, v90
    v_and_b32 v25, 0xffff0000, v18
    v_and_b32 v49, 0xffff0000, v42
    v_and_b32 v73, 0xffff0000, v66
    v_and_b32 v97, 0xffff0000, v90
    v_lshlrev_b32 v26, 16, v19
    v_lshlrev_b32 v50, 16, v43
    v_lshlrev_b32 v74, 16, v67
    v_lshlrev_b32 v98, 16, v91
    v_and_b32 v27, 0xffff0000, v19
    v_and_b32 v51, 0xffff0000, v43
    v_and_b32 v75, 0xffff0000, v67
    v_and_b32 v99, 0xffff0000, v91
    v_add_f32 v28, v20, v21
    v_add_f32 v52, v44, v45
    v_add_f32 v76, v68, v69
    v_add_f32 v100, v92, v93
    v_add_f32 v28, v28, v22
    v_add_f32 v52, v52, v46
    v_add_f32 v76, v76, v70
    v_add_f32 v100, v100, v94
    v_add_f32 v28, v28, v23
    v_add_f32 v52, v52, v47
    v_add_f32 v76, v76, v71
    v_add_f32 v100, v100, v95
    v_add_f32 v28, v28, v24
    v_add_f32 v52, v52, v48
    v_add_f32 v76, v76, v72
    v_add_f32 v100, v100, v96
    v_add_f32 v28, v28, v25
    v_add_f32 v52, v52, v49
    v_add_f32 v76, v76, v73
    v_add_f32 v100, v100, v97
    v_add_f32 v28, v28, v26
    v_add_f32 v52, v52, v50
    v_add_f32 v76, v76, v74
    v_add_f32 v100, v100, v98
    v_add_f32 v28, v28, v27
    v_add_f32 v52, v52, v51
    v_add_f32 v76, v76, v75
    v_add_f32 v100, v100, v99
    v_add_f32_dpp v28, v28, v28 row_ror:8 row_mask:0xf bank_mask:0xf
    v_add_f32_dpp v52, v52, v52 row_ror:8 row_mask:0xf bank_mask:0xf
    v_add_f32_dpp v76, v76, v76 row_ror:8 row_mask:0xf bank_mask:0xf
    v_add_f32_dpp v100, v100, v100 row_ror:8 row_mask:0xf bank_mask:0xf
    v_add_f32_dpp v28, v28, v28 row_ror:4 row_mask:0xf bank_mask:0xf
    v_add_f32_dpp v52, v52, v52 row_ror:4 row_mask:0xf bank_mask:0xf
    v_add_f32_dpp v76, v76, v76 row_ror:4 row_mask:0xf bank_mask:0xf
    v_add_f32_dpp v100, v100, v100 row_ror:4 row_mask:0xf bank_mask:0xf
    v_add_f32_dpp v28, v28, v28 row_ror:2 row_mask:0xf bank_mask:0xf
    v_add_f32_dpp v52, v52, v52 row_ror:2 row_mask:0xf bank_mask:0xf
    v_add_f32_dpp v76, v76, v76 row_ror:2 row_mask:0xf bank_mask:0xf
    v_add_f32_dpp v100, v100, v100 row_ror:2 row_mask:0xf bank_mask:0xf
    v_add_f32_dpp v28, v28, v28 row_ror:1 row_mask:0xf bank_mask:0xf
    v_add_f32_dpp v52, v52, v52 row_ror:1 row_mask:0xf bank_mask:0xf
    v_add_f32_dpp v76, v76, v76 row_ror:1 row_mask:0xf bank_mask:0xf
    v_add_f32_dpp v100, v100, v100 row_ror:1 row_mask:0xf bank_mask:0xf
    v_mov_b32 v30, v28
    v_mov_b32 v54, v52
    v_mov_b32 v78, v76
    v_mov_b32 v102, v100
    v_permlane16_swap_b32 v28, v30
    v_permlane16_swap_b32 v52, v54
    v_permlane16_swap_b32 v76, v78
    v_permlane16_swap_b32 v100, v102
    v_add_f32 v28, v28, v30
    v_add_f32 v52, v52, v54
    v_add_f32 v76, v76, v78
    v_add_f32 v100, v100, v102
    v_mov_b32 v30, v28
    v_mov_b32 v54, v52
    v_mov_b32 v78, v76
    v_mov_b32 v102, v100
    v_permlane32_swap_b32 v28, v30
    v_permlane32_swap_b32 v52, v54
    v_permlane32_swap_b32 v76, v78
    v_permlane32_swap_b32 v100, v102
    v_add_f32 v28, v28, v30
    v_add_f32 v52, v52, v54
    v_add_f32 v76, v76, v78
    v_add_f32 v100, v100, v102
    v_mul_f32 v28, 0x3b000000, v28
    v_mul_f32 v52, 0x3b000000, v52
    v_mul_f32 v76, 0x3b000000, v76
    v_mul_f32 v100, 0x3b000000, v100
    v_sub_f32 v32, v20, v28
    v_sub_f32 v56, v44, v52
    v_sub_f32 v80, v68, v76
    v_sub_f32 v104, v92, v100
    v_sub_f32 v33, v21, v28
    v_sub_f32 v57, v45, v52
    v_sub_f32 v81, v69, v76
    v_sub_f32 v105, v93, v100
    v_sub_f32 v34, v22, v28
    v_sub_f32 v58, v46, v52
    v_sub_f32 v82, v70, v76
    v_sub_f32 v106, v94, v100
    v_sub_f32 v35, v23, v28
    v_sub_f32 v59, v47, v52
    v_sub_f32 v83, v71, v76
    v_sub_f32 v107, v95, v100
    v_sub_f32 v36, v24, v28
    v_sub_f32 v60, v48, v52
    v_sub_f32 v84, v72, v76
    v_sub_f32 v108, v96, v100
    v_sub_f32 v37, v25, v28
    v_sub_f32 v61, v49, v52
    v_sub_f32 v85, v73, v76
    v_sub_f32 v109, v97, v100
    v_sub_f32 v38, v26, v28
    v_sub_f32 v62, v50, v52
    v_sub_f32 v86, v74, v76
    v_sub_f32 v110, v98, v100
    v_sub_f32 v39, v27, v28
    v_sub_f32 v63, v51, v52
    v_sub_f32 v87, v75, v76
    v_sub_f32 v111, v99, v100
    v_mul_f32 v29, v32, v32
    v_mul_f32 v53, v56, v56
    v_mul_f32 v77, v80, v80
    v_mul_f32 v101, v104, v104
    v_fmac_f32 v29, v33, v33
    v_fmac_f32 v53, v57, v57
    v_fmac_f32 v77, v81, v81
    v_fmac_f32 v101, v105, v105
    v_fmac_f32 v29, v34, v34
    v_fmac_f32 v53, v58, v58
    v_fmac_f32 v77, v82, v82
    v_fmac_f32 v101, v106, v106
    v_fmac_f32 v29, v35, v35
    v_fmac_f32 v53, v59, v59
    v_fmac_f32 v77, v83, v83
    v_fmac_f32 v101, v107, v107
    v_fmac_f32 v29, v36, v36
    v_fmac_f32 v53, v60, v60
    v_fmac_f32 v77, v84, v84
    v_fmac_f32 v101, v108, v108
    v_fmac_f32 v29, v37, v37
    v_fmac_f32 v53, v61, v61
    v_fmac_f32 v77, v85, v85
    v_fmac_f32 v101, v109, v109
    v_fmac_f32 v29, v38, v38
    v_fmac_f32 v53, v62, v62
    v_fmac_f32 v77, v86, v86
    v_fmac_f32 v101, v110, v110
    v_fmac_f32 v29, v39, v39
    v_fmac_f32 v53, v63, v63
    v_fmac_f32 v77, v87, v87
    v_fmac_f32 v101, v111, v111
    v_add_f32_dpp v29, v29, v29 row_ror:8 row_mask:0xf bank_mask:0xf
    v_add_f32_dpp v53, v53, v53 row_ror:8 row_mask:0xf bank_mask:0xf
    v_add_f32_dpp v77, v77, v77 row_ror:8 row_mask:0xf bank_mask:0xf
    v_add_f32_dpp v101, v101, v101 row_ror:8 row_mask:0xf bank_mask:0xf
    v_add_f32_dpp v29, v29, v29 row_ror:4 row_mask:0xf bank_mask:0xf
    v_add_f32_dpp v53, v53, v53 row_ror:4 row_mask:0xf bank_mask:0xf
    v_add_f32_dpp v77, v77, v77 row_ror:4 row_mask:0xf bank_mask:0xf
    v_add_f32_dpp v101, v101, v101 row_ror:4 row_mask:0xf bank_mask:0xf
    v_add_f32_dpp v29, v29, v29 row_ror:2 row_mask:0xf bank_mask:0xf
    v_add_f32_dpp v53, v53, v53 row_ror:2 row_mask:0xf bank_mask:0xf
    v_add_f32_dpp v77, v77, v77 row_ror:2 row_mask:0xf bank_mask:0xf
    v_add_f32_dpp v101, v101, v101 row_ror:2 row_mask:0xf bank_mask:0xf
    v_add_f32_dpp v29, v29, v29 row_ror:1 row_mask:0xf bank_mask:0xf
    v_add_f32_dpp v53, v53, v53 row_ror:1 row_mask:0xf bank_mask:0xf
    v_add_f32_dpp v77, v77, v77 row_ror:1 row_mask:0xf bank_mask:0xf
    v_add_f32_dpp v101, v101, v101 row_ror:1 row_mask:0xf bank_mask:0xf
    v_mov_b32 v30, v29
    v_mov_b32 v54, v53
    v_mov_b32 v78, v77
    v_mov_b32 v102, v101
    v_permlane16_swap_b32 v29, v30
    v_permlane16_swap_b32 v53, v54
    v_permlane16_swap_b32 v77, v78
    v_permlane16_swap_b32 v101, v102
    v_add_f32 v29, v29, v30
    v_add_f32 v53, v53, v54
    v_add_f32 v77, v77, v78
    v_add_f32 v101, v101, v102
    v_mov_b32 v30, v29
    v_mov_b32 v54, v53
    v_mov_b32 v78, v77
    v_mov_b32 v102, v101
    v_permlane32_swap_b32 v29, v30
    v_permlane32_swap_b32 v53, v54
    v_permlane32_swap_b32 v77, v78
    v_permlane32_swap_b32 v101, v102
    v_add_f32 v29, v29, v30
    v_add_f32 v53, v53, v54
    v_add_f32 v77, v77, v78
    v_add_f32 v101, v101, v102
    v_mul_f32 v29, 0x3b000000, v29
    v_mul_f32 v53, 0x3b000000, v53
    v_mul_f32 v77, 0x3b000000, v77
    v_mul_f32 v101, 0x3b000000, v101
    v_cvt_pk_bf16_f32 v28, v28, v28
    v_cvt_pk_bf16_f32 v52, v52, v52
    v_cvt_pk_bf16_f32 v76, v76, v76
    v_cvt_pk_bf16_f32 v100, v100, v100
    v_and_b32 v28, 0xffff0000, v28
    v_and_b32 v52, 0xffff0000, v52
    v_and_b32 v76, 0xffff0000, v76
    v_and_b32 v100, 0xffff0000, v100
    v_cvt_pk_bf16_f32 v29, v29, v29
    v_cvt_pk_bf16_f32 v53, v53, v53
    v_cvt_pk_bf16_f32 v77, v77, v77
    v_cvt_pk_bf16_f32 v101, v101, v101
    v_and_b32 v29, 0xffff0000, v29
    v_and_b32 v53, 0xffff0000, v53
    v_and_b32 v77, 0xffff0000, v77
    v_and_b32 v101, 0xffff0000, v101
    v_add_f32 v29, 0x3727c5ac, v29
    v_add_f32 v53, 0x3727c5ac, v53
    v_add_f32 v77, 0x3727c5ac, v77
    v_add_f32 v101, 0x3727c5ac, v101
    v_cvt_pk_bf16_f32 v29, v29, v29
    v_cvt_pk_bf16_f32 v53, v53, v53
    v_cvt_pk_bf16_f32 v77, v77, v77
    v_cvt_pk_bf16_f32 v101, v101, v101
    v_and_b32 v29, 0xffff0000, v29
    v_and_b32 v53, 0xffff0000, v53
    v_and_b32 v77, 0xffff0000, v77
    v_and_b32 v101, 0xffff0000, v101
    v_sqrt_f32 v29, v29
    v_sqrt_f32 v53, v53
    v_sqrt_f32 v77, v77
    v_sqrt_f32 v101, v101
    v_cvt_pk_bf16_f32 v29, v29, v29
    v_cvt_pk_bf16_f32 v53, v53, v53
    v_cvt_pk_bf16_f32 v77, v77, v77
    v_cvt_pk_bf16_f32 v101, v101, v101
    v_and_b32 v29, 0xffff0000, v29
    v_and_b32 v53, 0xffff0000, v53
    v_and_b32 v77, 0xffff0000, v77
    v_and_b32 v101, 0xffff0000, v101
    v_rcp_f32 v29, v29
    v_rcp_f32 v53, v53
    v_rcp_f32 v77, v77
    v_rcp_f32 v101, v101
    v_sub_f32 v32, v20, v28
    v_sub_f32 v56, v44, v52
    v_sub_f32 v80, v68, v76
    v_sub_f32 v104, v92, v100
    v_sub_f32 v33, v21, v28
    v_sub_f32 v57, v45, v52
    v_sub_f32 v81, v69, v76
    v_sub_f32 v105, v93, v100
    v_sub_f32 v34, v22, v28
    v_sub_f32 v58, v46, v52
    v_sub_f32 v82, v70, v76
    v_sub_f32 v106, v94, v100
    v_sub_f32 v35, v23, v28
    v_sub_f32 v59, v47, v52
    v_sub_f32 v83, v71, v76
    v_sub_f32 v107, v95, v100
    v_sub_f32 v36, v24, v28
    v_sub_f32 v60, v48, v52
    v_sub_f32 v84, v72, v76
    v_sub_f32 v108, v96, v100
    v_sub_f32 v37, v25, v28
    v_sub_f32 v61, v49, v52
    v_sub_f32 v85, v73, v76
    v_sub_f32 v109, v97, v100
    v_sub_f32 v38, v26, v28
    v_sub_f32 v62, v50, v52
    v_sub_f32 v86, v74, v76
    v_sub_f32 v110, v98, v100
    v_sub_f32 v39, v27, v28
    v_sub_f32 v63, v51, v52
    v_sub_f32 v87, v75, v76
    v_sub_f32 v111, v99, v100
    v_cvt_pk_bf16_f32 v16, v32, v33
    v_cvt_pk_bf16_f32 v40, v56, v57
    v_cvt_pk_bf16_f32 v64, v80, v81
    v_cvt_pk_bf16_f32 v88, v104, v105
    v_cvt_pk_bf16_f32 v17, v34, v35
    v_cvt_pk_bf16_f32 v41, v58, v59
    v_cvt_pk_bf16_f32 v65, v82, v83
    v_cvt_pk_bf16_f32 v89, v106, v107
    v_cvt_pk_bf16_f32 v18, v36, v37
    v_cvt_pk_bf16_f32 v42, v60, v61
    v_cvt_pk_bf16_f32 v66, v84, v85
    v_cvt_pk_bf16_f32 v90, v108, v109
    v_cvt_pk_bf16_f32 v19, v38, v39
    v_cvt_pk_bf16_f32 v43, v62, v63
    v_cvt_pk_bf16_f32 v67, v86, v87
    v_cvt_pk_bf16_f32 v91, v110, v111
    v_lshlrev_b32 v32, 16, v16
    v_lshlrev_b32 v56, 16, v40
    v_lshlrev_b32 v80, 16, v64
    v_lshlrev_b32 v104, 16, v88
    v_and_b32 v33, 0xffff0000, v16
    v_and_b32 v57, 0xffff0000, v40
    v_and_b32 v81, 0xffff0000, v64
    v_and_b32 v105, 0xffff0000, v88
    v_lshlrev_b32 v34, 16, v17
    v_lshlrev_b32 v58, 16, v41
    v_lshlrev_b32 v82, 16, v65
    v_lshlrev_b32 v106, 16, v89
    v_and_b32 v35, 0xffff0000, v17
    v_and_b32 v59, 0xffff0000, v41
    v_and_b32 v83, 0xffff0000, v65
    v_and_b32 v107, 0xffff0000, v89
    v_lshlrev_b32 v36, 16, v18
    v_lshlrev_b32 v60, 16, v42
    v_lshlrev_b32 v84, 16, v66
    v_lshlrev_b32 v108, 16, v90
    v_and_b32 v37, 0xffff0000, v18
    v_and_b32 v61, 0xffff0000, v42
    v_and_b32 v85, 0xffff0000, v66
    v_and_b32 v109, 0xffff0000, v90
    v_lshlrev_b32 v38, 16, v19
    v_lshlrev_b32 v62, 16, v43
    v_lshlrev_b32 v86, 16, v67
    v_lshlrev_b32 v110, 16, v91
    v_and_b32 v39, 0xffff0000, v19
    v_and_b32 v63, 0xffff0000, v43
    v_and_b32 v87, 0xffff0000, v67
    v_and_b32 v111, 0xffff0000, v91
    v_mul_f32 v32, v32, v29
    v_mul_f32 v56, v56, v53
    v_mul_f32 v80, v80, v77
    v_mul_f32 v104, v104, v101
    v_mul_f32 v33, v33, v29
    v_mul_f32 v57, v57, v53
    v_mul_f32 v81, v81, v77
    v_mul_f32 v105, v105, v101
    v_mul_f32 v34, v34, v29
    v_mul_f32 v58, v58, v53
    v_mul_f32 v82, v82, v77
    v_mul_f32 v106, v106, v101
    v_mul_f32 v35, v35, v29
    v_mul_f32 v59, v59, v53
    v_mul_f32 v83, v83, v77
    v_mul_f32 v107, v107, v101
    v_mul_f32 v36, v36, v29
    v_mul_f32 v60, v60, v53
    v_mul_f32 v84, v84, v77
    v_mul_f32 v108, v108, v101
    v_mul_f32 v37, v37, v29
    v_mul_f32 v61, v61, v53
    v_mul_f32 v85, v85, v77
    v_mul_f32 v109, v109, v101
    v_mul_f32 v38, v38, v29
    v_mul_f32 v62, v62, v53
    v_mul_f32 v86, v86, v77
    v_mul_f32 v110, v110, v101
    v_mul_f32 v39, v39, v29
    v_mul_f32 v63, v63, v53
    v_mul_f32 v87, v87, v77
    v_mul_f32 v111, v111, v101
    v_cvt_pk_bf16_f32 v16, v32, v33
    v_cvt_pk_bf16_f32 v40, v56, v57
    v_cvt_pk_bf16_f32 v64, v80, v81
    v_cvt_pk_bf16_f32 v88, v104, v105
    v_cvt_pk_bf16_f32 v17, v34, v35
    v_cvt_pk_bf16_f32 v41, v58, v59
    v_cvt_pk_bf16_f32 v65, v82, v83
    v_cvt_pk_bf16_f32 v89, v106, v107
    v_cvt_pk_bf16_f32 v18, v36, v37
    v_cvt_pk_bf16_f32 v42, v60, v61
    v_cvt_pk_bf16_f32 v66, v84, v85
    v_cvt_pk_bf16_f32 v90, v108, v109
    v_cvt_pk_bf16_f32 v19, v38, v39
    v_cvt_pk_bf16_f32 v43, v62, v63
    v_cvt_pk_bf16_f32 v67, v86, v87
    v_cvt_pk_bf16_f32 v91, v110, v111
    buffer_store_dwordx4 v[16:19], v6, s[4:7], s24 offen offset:0 sc1
    buffer_store_dwordx4 v[40:43], v6, s[4:7], s24 offen offset:1024 sc1
    buffer_store_dwordx4 v[64:67], v6, s[4:7], s24 offen offset:2048 sc1
    buffer_store_dwordx4 v[88:91], v6, s[4:7], s24 offen offset:3072 sc1
    s_add_u32 s24, s24, 524288
    s_add_u32 s28, s28, 1
    s_cmp_lg_u32 s28, 1
    s_cbranch_scc1 S_ln2
    s_waitcnt vmcnt(0)
    s_barrier
    s_cmp_lg_u32 s17, 0
    s_cbranch_scc1 sig_48
    v_mov_b32 v10, 2
    v_mov_b32 v11, 200
    s_mov_b64 exec, 1
    buffer_atomic_add v10, v11, s[12:15], 0 offen
    s_mov_b64 exec, -1
sig_48:
S_ln2:
    s_cmp_lt_u32 s28, 4
    s_cbranch_scc1 S_ln
    s_waitcnt vmcnt(0)
    s_barrier
    s_cmp_lg_u32 s17, 0
    s_cbranch_scc1 sig_49
    v_mov_b32 v10, 2
    v_mov_b32 v11, 212
    s_mov_b64 exec, 1
    buffer_atomic_add v10, v11, s[12:15], 0 offen
    s_mov_b64 exec, -1
sig_49:
    s_lshl_b32 s26, s39, 5
    s_add_u32 s26, s26, s16
    s_sub_u32 s26, s26, 32
    s_mul_i32 s26, s26, 18944
    v_lshlrev_b32 v7, 4, v0
    s_mov_b32 s46, 4194304
    s_mov_b32 s47, 0x20000
    s_mov_b32 s44, s48
    s_mov_b32 s45, s49
    s_mov_b32 s27, s26
    buffer_load_dwordx4 v[128:131], v7, s[44:47], s27 offen
    s_add_u32 s27, s27, 4096
    buffer_load_dwordx4 v[132:135], v7, s[44:47], s27 offen
    s_add_u32 s27, s27, 4096
    buffer_load_dwordx4 v[136:139], v7, s[44:47], s27 offen
    s_add_u32 s27, s27, 4096
    buffer_load_dwordx4 v[140:143], v7, s[44:47], s27 offen
    s_add_u32 s27, s27, 4096
    buffer_load_dwordx4 v[144:147], v7, s[44:47], s27 offen
    s_add_u32 s27, s27, 4096
    s_mov_b32 s44, s54
    s_mov_b32 s45, s55
    s_mov_b32 s27, s26
    buffer_load_dwordx4 v[148:151], v7, s[44:47], s27 offen
    s_add_u32 s27, s27, 4096
    buffer_load_dwordx4 v[152:155], v7, s[44:47], s27 offen
    s_add_u32 s27, s27, 4096
    buffer_load_dwordx4 v[156:159], v7, s[44:47], s27 offen
    s_add_u32 s27, s27, 4096
    buffer_load_dwordx4 v[160:163], v7, s[44:47], s27 offen
    s_add_u32 s27, s27, 4096
    buffer_load_dwordx4 v[164:167], v7, s[44:47], s27 offen
    s_add_u32 s27, s27, 4096
    s_load_dwordx2 s[44:45], s[0:1], 64
    s_mov_b32 s46, 1409024
    s_lshl_b32 s27, s39, 5
    s_add_u32 s27, s27, s16
    s_sub_u32 s27, s27, 32
    s_mul_i32 s27, s27, 6400
    s_add_u32 s26, s27, 4096
    s_waitcnt lgkmcnt(0)
    buffer_load_dwordx4 v[128:131], v7, s[44:47], s27 offen
    buffer_load_dwordx4 v[128:131], v7, s[44:47], s26 offen
    v_mov_b32 v12, -1
    v_mov_b32 v13, -1
    v_mov_b32 v14, -1
    v_mov_b32 v15, -1
    v_lshlrev_b32 v10, 4, v0
    s_mul_i32 s24, s16, 176128
    s_add_u32 s24, s24, 58720256
    s_mov_b32 s25, 0
si_50:
    s_waitcnt vmcnt(1)
    buffer_store_dwordx4 v[12:15], v10, s[4:7], s24 offen sc1
    s_add_u32 s24, s24, 4096
    s_add_u32 s25, s25, 1
    s_cmp_lt_u32 s25, 43
    s_cbranch_scc1 si_50
    s_mul_i32 s24, s16, 32768
    s_add_u32 s24, s24, 65011712
    s_mov_b32 s25, 0
si_51:
    s_waitcnt vmcnt(1)
    buffer_store_dwordx4 v[12:15], v10, s[4:7], s24 offen sc1
    s_add_u32 s24, s24, 4096
    s_add_u32 s25, s25, 1
    s_cmp_lt_u32 s25, 8
    s_cbranch_scc1 si_51
    s_mul_i32 s24, s16, 98304
    s_add_u32 s24, s24, 75497472
    s_mov_b32 s25, 0
si_52:
    s_waitcnt vmcnt(1)
    buffer_store_dwordx4 v[12:15], v10, s[4:7], s24 offen sc1
    s_add_u32 s24, s24, 4096
    s_add_u32 s25, s25, 1
    s_cmp_lt_u32 s25, 24
    s_cbranch_scc1 si_52
    s_waitcnt vmcnt(0)
    s_barrier
    s_cmp_lg_u32 s17, 0
    s_cbranch_scc1 sig_53
    v_mov_b32 v10, 2
    v_mov_b32 v11, 208
    s_mov_b64 exec, 1
    buffer_atomic_add v10, v11, s[12:15], 0 offen
    s_mov_b64 exec, -1
sig_53:
    v_mov_b32 v11, 208
wt_54:
    buffer_load_dword v10, v11, s[12:15], 0 offen sc1
    s_add_u32 s23, s23, 1
    s_waitcnt vmcnt(0)
    v_readfirstlane_b32 s24, v10
    s_cmp_gt_u32 s23, 262144
    s_cbranch_scc1 wte_55
    s_cmp_ge_u32 s24, 64
    s_cbranch_scc1 wte_55
    s_sleep 16
    s_branch wt_54
wte_55:
    s_mov_b32 s38, 0
    s_branch L_helper
L_post2:
    s_sub_u32 s18, s39, 6
    s_lshl_b32 s18, s18, 5
    s_add_u32 s18, s18, s16
    s_mul_i32 s37, s18, 49152
    s_lshl_b32 s24, s17, 11
    s_add_u32 s37, s37, s24
    s_add_u32 s37, s37, 75497472
    s_mov_b32 s19, 0
    s_load_dwordx2 s[40:41], s[0:1], 88
    s_mov_b32 s42, 704512
    s_mov_b32 s43, 0x20000
    v_lshrrev_b32 v248, 6, v6
    v_lshlrev_b32 v248, 10, v248
    v_and_b32 v249, 48, v6
    v_add_u32 v248, v248, v249
    s_lshl_b32 s24, s19, 8
    s_lshl_b32 s25, s17, 6
    s_add_u32 s25, s25, s24
    s_add_u32 s25, s25, 0
    s_mul_i32 s24, s17, 24576
    v_add_u32 v249, s24, v6
    s_waitcnt lgkmcnt(0)
    s_add_u32 m0, s24, 0
    s_nop 0
    buffer_load_dwordx4 v248, s[40:43], s25 offen lds
    s_add_u32 s25, s25, 16384
    s_add_u32 m0, s24, 1024
    s_nop 0
    buffer_load_dwordx4 v248, s[40:43], s25 offen lds
    s_add_u32 s25, s25, 16384
    s_add_u32 m0, s24, 2048
    s_nop 0
    buffer_load_dwordx4 v248, s[40:43], s25 offen lds
    s_add_u32 s25, s25, 16384
    s_add_u32 m0, s24, 3072
    s_nop 0
    buffer_load_dwordx4 v248, s[40:43], s25 offen lds
    s_add_u32 s25, s25, 16384
    s_add_u32 m0, s24, 4096
    s_nop 0
    buffer_load_dwordx4 v248, s[40:43], s25 offen lds
    s_add_u32 s25, s25, 16384
    s_add_u32 m0, s24, 5120
    s_nop 0
    buffer_load_dwordx4 v248, s[40:43], s25 offen lds
    s_add_u32 s25, s25, 16384
    s_add_u32 m0, s24, 6144
    s_nop 0
    buffer_load_dwordx4 v248, s[40:43], s25 offen lds
    s_add_u32 s25, s25, 16384
    s_add_u32 m0, s24, 7168
    s_nop 0
    buffer_load_dwordx4 v248, s[40:43], s25 offen lds
    s_add_u32 s25, s25, 16384
    s_add_u32 m0, s24, 8192
    s_nop 0
    buffer_load_dwordx4 v248, s[40:43], s25 offen lds
    s_add_u32 s25, s25, 16384
    s_add_u32 m0, s24, 9216
    s_nop 0
    buffer_load_dwordx4 v248, s[40:43], s25 offen lds
    s_add_u32 s25, s25, 16384
    s_add_u32 m0, s24, 10240
    s_nop 0
    buffer_load_dwordx4 v248, s[40:43], s25 offen lds
    s_add_u32 s25, s25, 16384
    s_add_u32 m0, s24, 11264
    s_nop 0
    buffer_load_dwordx4 v248, s[40:43], s25 offen lds
    s_add_u32 s25, s25, 16384
    s_add_u32 m0, s24, 12288
    s_nop 0
    buffer_load_dwordx4 v248, s[40:43], s25 offen lds
    s_add_u32 s25, s25, 16384
    s_add_u32 m0, s24, 13312
    s_nop 0
    buffer_load_dwordx4 v248, s[40:43], s25 offen lds
    s_add_u32 s25, s25, 16384
    s_add_u32 m0, s24, 14336
    s_nop 0
    buffer_load_dwordx4 v248, s[40:43], s25 offen lds
    s_add_u32 s25, s25, 16384
    s_add_u32 m0, s24, 15360
    s_nop 0
    buffer_load_dwordx4 v248, s[40:43], s25 offen lds
    s_add_u32 s25, s25, 16384
    s_add_u32 m0, s24, 16384
    s_nop 0
    buffer_load_dwordx4 v248, s[40:43], s25 offen lds
    s_add_u32 s25, s25, 16384
    s_add_u32 m0, s24, 17408
    s_nop 0
    buffer_load_dwordx4 v248, s[40:43], s25 offen lds
    s_add_u32 s25, s25, 16384
    s_add_u32 m0, s24, 18432
    s_nop 0
    buffer_load_dwordx4 v248, s[40:43], s25 offen lds
    s_add_u32 s25, s25, 16384
    s_add_u32 m0, s24, 19456
    s_nop 0
    buffer_load_dwordx4 v248, s[40:43], s25 offen lds
    s_add_u32 s25, s25, 16384
    s_add_u32 m0, s24, 20480
    s_nop 0
    buffer_load_dwordx4 v248, s[40:43], s25 offen lds
    s_add_u32 s25, s25, 16384
    s_add_u32 m0, s24, 21504
    s_nop 0
    buffer_load_dwordx4 v248, s[40:43], s25 offen lds
    s_add_u32 s25, s25, 16384
    s_waitcnt vmcnt(20) lgkmcnt(0)
    ds_read_b64_tr_b16 a[0:1], v249 offset:0
    ds_read_b64_tr_b16 a[2:3], v249 offset:1024
    ds_read_b64_tr_b16 a[4:5], v249 offset:8
    ds_read_b64_tr_b16 a[6:7], v249 offset:1032
    s_add_u32 m0, s24, 22528
    s_nop 0
    buffer_load_dwordx4 v248, s[40:43], s25 offen lds
    s_add_u32 s25, s25, 16384
    s_add_u32 m0, s24, 23552
    s_nop 0
    buffer_load_dwordx4 v248, s[40:43], s25 offen lds
    s_add_u32 s25, s25, 16384
    s_waitcnt vmcnt(20) lgkmcnt(0)
    ds_read_b64_tr_b16 a[8:9], v249 offset:2048
    ds_read_b64_tr_b16 a[10:11], v249 offset:3072
    ds_read_b64_tr_b16 a[12:13], v249 offset:2056
    ds_read_b64_tr_b16 a[14:15], v249 offset:3080
    s_add_u32 m0, s24, 0
    s_nop 0
    buffer_load_dwordx4 v248, s[40:43], s25 offen lds
    s_add_u32 s25, s25, 16384
    s_add_u32 m0, s24, 1024
    s_nop 0
    buffer_load_dwordx4 v248, s[40:43], s25 offen lds
    s_add_u32 s25, s25, 16384
    s_waitcnt vmcnt(20) lgkmcnt(0)
    ds_read_b64_tr_b16 a[16:17], v249 offset:4096
    ds_read_b64_tr_b16 a[18:19], v249 offset:5120
    ds_read_b64_tr_b16 a[20:21], v249 offset:4104
    ds_read_b64_tr_b16 a[22:23], v249 offset:5128
    s_add_u32 m0, s24, 2048
    s_nop 0
    buffer_load_dwordx4 v248, s[40:43], s25 offen lds
    s_add_u32 s25, s25, 16384
    s_add_u32 m0, s24, 3072
    s_nop 0
    buffer_load_dwordx4 v248, s[40:43], s25 offen lds
    s_add_u32 s25, s25, 16384
    s_waitcnt vmcnt(20) lgkmcnt(0)
    ds_read_b64_tr_b16 a[24:25], v249 offset:6144
    ds_read_b64_tr_b16 a[26:27], v249 offset:7168
    ds_read_b64_tr_b16 a[28:29], v249 offset:6152
    ds_read_b64_tr_b16 a[30:31], v249 offset:7176
    s_add_u32 m0, s24, 4096
    s_nop 0
    buffer_load_dwordx4 v248, s[40:43], s25 offen lds
    s_add_u32 s25, s25, 16384
    s_add_u32 m0, s24, 5120
    s_nop 0
    buffer_load_dwordx4 v248, s[40:43], s25 offen lds
    s_add_u32 s25, s25, 16384
    s_waitcnt vmcnt(20) lgkmcnt(0)
    ds_read_b64_tr_b16 a[32:33], v249 offset:8192
    ds_read_b64_tr_b16 a[34:35], v249 offset:9216
    ds_read_b64_tr_b16 a[36:37], v249 offset:8200
    ds_read_b64_tr_b16 a[38:39], v249 offset:9224
    s_add_u32 m0, s24, 6144
    s_nop 0
    buffer_load_dwordx4 v248, s[40:43], s25 offen lds
    s_add_u32 s25, s25, 16384
    s_add_u32 m0, s24, 7168
    s_nop 0
    buffer_load_dwordx4 v248, s[40:43], s25 offen lds
    s_add_u32 s25, s25, 16384
    s_waitcnt vmcnt(20) lgkmcnt(0)
    ds_read_b64_tr_b16 a[40:41], v249 offset:10240
    ds_read_b64_tr_b16 a[42:43], v249 offset:11264
    ds_read_b64_tr_b16 a[44:45], v249 offset:10248
    ds_read_b64_tr_b16 a[46:47], v249 offset:11272
    s_add_u32 m0, s24, 8192
    s_nop 0
    buffer_load_dwordx4 v248, s[40:43], s25 offen lds
    s_add_u32 s25, s25, 16384
    s_add_u32 m0, s24, 9216
    s_nop 0
    buffer_load_dwordx4 v248, s[40:43], s25 offen lds
    s_add_u32 s25, s25, 16384
    s_waitcnt vmcnt(20) lgkmcnt(0)
    ds_read_b64_tr_b16 a[48:49], v249 offset:12288
    ds_read_b64_tr_b16 a[50:51], v249 offset:13312
    ds_read_b64_tr_b16 a[52:53], v249 offset:12296
    ds_read_b64_tr_b16 a[54:55], v249 offset:13320
    s_add_u32 m0, s24, 10240
    s_nop 0
    buffer_load_dwordx4 v248, s[40:43], s25 offen lds
    s_add_u32 s25, s25, 16384
    s_add_u32 m0, s24, 11264
    s_nop 0
    buffer_load_dwordx4 v248, s[40:43], s25 offen lds
    s_add_u32 s25, s25, 16384
    s_waitcnt vmcnt(20) lgkmcnt(0)
    ds_read_b64_tr_b16 a[56:57], v249 offset:14336
    ds_read_b64_tr_b16 a[58:59], v249 offset:15360
    ds_read_b64_tr_b16 a[60:61], v249 offset:14344
    ds_read_b64_tr_b16 a[62:63], v249 offset:15368
    s_add_u32 m0, s24, 12288
    s_nop 0
    buffer_load_dwordx4 v248, s[40:43], s25 offen lds
    s_add_u32 s25, s25, 16384
    s_add_u32 m0, s24, 13312
    s_nop 0
    buffer_load_dwordx4 v248, s[40:43], s25 offen lds
    s_add_u32 s25, s25, 16384
    s_waitcnt vmcnt(20) lgkmcnt(0)
    ds_read_b64_tr_b16 a[64:65], v249 offset:16384
    ds_read_b64_tr_b16 a[66:67], v249 offset:17408
    ds_read_b64_tr_b16 a[68:69], v249 offset:16392
    ds_read_b64_tr_b16 a[70:71], v249 offset:17416
    s_add_u32 m0, s24, 14336
    s_nop 0
    buffer_load_dwordx4 v248, s[40:43], s25 offen lds
    s_add_u32 s25, s25, 16384
    s_add_u32 m0, s24, 15360
    s_nop 0
    buffer_load_dwordx4 v248, s[40:43], s25 offen lds
    s_add_u32 s25, s25, 16384
    s_waitcnt vmcnt(20) lgkmcnt(0)
    ds_read_b64_tr_b16 a[72:73], v249 offset:18432
    ds_read_b64_tr_b16 a[74:75], v249 offset:19456
    ds_read_b64_tr_b16 a[76:77], v249 offset:18440
    ds_read_b64_tr_b16 a[78:79], v249 offset:19464
    s_add_u32 m0, s24, 16384
    s_nop 0
    buffer_load_dwordx4 v248, s[40:43], s25 offen lds
    s_add_u32 s25, s25, 16384
    s_add_u32 m0, s24, 17408
    s_nop 0
    buffer_load_dwordx4 v248, s[40:43], s25 offen lds
    s_add_u32 s25, s25, 16384
    s_waitcnt vmcnt(20) lgkmcnt(0)
    ds_read_b64_tr_b16 a[80:81], v249 offset:20480
    ds_read_b64_tr_b16 a[82:83], v249 offset:21504
    ds_read_b64_tr_b16 a[84:85], v249 offset:20488
    ds_read_b64_tr_b16 a[86:87], v249 offset:21512
    s_add_u32 m0, s24, 18432
    s_nop 0
    buffer_load_dwordx4 v248, s[40:43], s25 offen lds
    s_add_u32 s25, s25, 16384
    s_add_u32 m0, s24, 19456
    s_nop 0
    buffer_load_dwordx4 v248, s[40:43], s25 offen lds
    s_add_u32 s25, s25, 16384
    s_waitcnt vmcnt(20) lgkmcnt(0)
    ds_read_b64_tr_b16 a[88:89], v249 offset:22528
    ds_read_b64_tr_b16 a[90:91], v249 offset:23552
    ds_read_b64_tr_b16 a[92:93], v249 offset:22536
    ds_read_b64_tr_b16 a[94:95], v249 offset:23560
    s_waitcnt vmcnt(18) lgkmcnt(0)
    ds_read_b64_tr_b16 a[96:97], v249 offset:0
    ds_read_b64_tr_b16 a[98:99], v249 offset:1024
    ds_read_b64_tr_b16 a[100:101], v249 offset:8
    ds_read_b64_tr_b16 a[102:103], v249 offset:1032
    s_waitcnt vmcnt(16) lgkmcnt(0)
    ds_read_b64_tr_b16 a[104:105], v249 offset:2048
    ds_read_b64_tr_b16 a[106:107], v249 offset:3072
    ds_read_b64_tr_b16 a[108:109], v249 offset:2056
    ds_read_b64_tr_b16 a[110:111], v249 offset:3080
    s_waitcnt vmcnt(14) lgkmcnt(0)
    ds_read_b64_tr_b16 a[112:113], v249 offset:4096
    ds_read_b64_tr_b16 a[114:115], v249 offset:5120
    ds_read_b64_tr_b16 a[116:117], v249 offset:4104
    ds_read_b64_tr_b16 a[118:119], v249 offset:5128
    s_waitcnt vmcnt(12) lgkmcnt(0)
    ds_read_b64_tr_b16 a[120:121], v249 offset:6144
    ds_read_b64_tr_b16 a[122:123], v249 offset:7168
    ds_read_b64_tr_b16 a[124:125], v249 offset:6152
    ds_read_b64_tr_b16 a[126:127], v249 offset:7176
    s_waitcnt vmcnt(10) lgkmcnt(0)
    ds_read_b64_tr_b16 a[128:129], v249 offset:8192
    ds_read_b64_tr_b16 a[130:131], v249 offset:9216
    ds_read_b64_tr_b16 a[132:133], v249 offset:8200
    ds_read_b64_tr_b16 a[134:135], v249 offset:9224
    s_waitcnt vmcnt(8) lgkmcnt(0)
    ds_read_b64_tr_b16 a[136:137], v249 offset:10240
    ds_read_b64_tr_b16 a[138:139], v249 offset:11264
    ds_read_b64_tr_b16 a[140:141], v249 offset:10248
    ds_read_b64_tr_b16 a[142:143], v249 offset:11272
    s_waitcnt vmcnt(6) lgkmcnt(0)
    ds_read_b64_tr_b16 a[144:145], v249 offset:12288
    ds_read_b64_tr_b16 a[146:147], v249 offset:13312
    ds_read_b64_tr_b16 a[148:149], v249 offset:12296
    ds_read_b64_tr_b16 a[150:151], v249 offset:13320
    s_waitcnt vmcnt(4) lgkmcnt(0)
    ds_read_b64_tr_b16 a[152:153], v249 offset:14336
    ds_read_b64_tr_b16 a[154:155], v249 offset:15360
    ds_read_b64_tr_b16 a[156:157], v249 offset:14344
    ds_read_b64_tr_b16 a[158:159], v249 offset:15368
    s_waitcnt vmcnt(2) lgkmcnt(0)
    ds_read_b64_tr_b16 a[160:161], v249 offset:16384
    ds_read_b64_tr_b16 a[162:163], v249 offset:17408
    ds_read_b64_tr_b16 a[164:165], v249 offset:16392
    ds_read_b64_tr_b16 a[166:167], v249 offset:17416
    s_waitcnt vmcnt(0) lgkmcnt(0)
    ds_read_b64_tr_b16 a[168:169], v249 offset:18432
    ds_read_b64_tr_b16 a[170:171], v249 offset:19456
    ds_read_b64_tr_b16 a[172:173], v249 offset:18440
    ds_read_b64_tr_b16 a[174:175], v249 offset:19464
    s_waitcnt lgkmcnt(0)
    s_load_dwordx2 s[8:9], s[0:1], 72
    s_mov_b32 s10, 8388608
    s_mov_b32 s11, 0x20000
    s_waitcnt lgkmcnt(0)
    s_lshl_b32 s21, s18, 17
    s_lshl_b32 s24, s17, 15
    s_add_u32 s24, s24, s21
    v_mov_b32 v248, 1073741824
    s_lshl_b32 s24, s17, 1
    s_add_u32 s24, s24, 40
    s_cmp_lt_u32 s24, 43
    s_cselect_b64 vcc, -1, 0
    v_cndmask_b32 v7, v248, v6, vcc
    s_lshl_b32 s24, s17, 1
    s_add_u32 s24, s24, 41
    s_cmp_lt_u32 s24, 43
    s_cselect_b64 vcc, -1, 0
    v_cndmask_b32 v8, v248, v6, vcc
    s_mul_i32 s24, s17, 12
    s_add_u32 s24, s24, 0
    v_add_u32 v249, s24, v3
    v_cmp_gt_u32 vcc, 43, v249
    s_lshl_b32 s24, s24, 8
    v_add_u32 v249, s24, v6
    v_cndmask_b32 v9, v248, v249, vcc
    s_mul_i32 s24, s17, 12
    s_add_u32 s24, s24, 4
    v_add_u32 v249, s24, v3
    v_cmp_gt_u32 vcc, 43, v249
    s_lshl_b32 s24, s24, 8
    v_add_u32 v249, s24, v6
    v_cndmask_b32 v10, v248, v249, vcc
    s_mul_i32 s24, s17, 12
    s_add_u32 s24, s24, 8
    v_add_u32 v249, s24, v3
    v_cmp_gt_u32 vcc, 43, v249
    s_lshl_b32 s24, s24, 8
    v_add_u32 v249, s24, v6
    v_cndmask_b32 v11, v248, v249, vcc
    v_lshlrev_b32 v12, 12, v2
    v_lshl_add_u32 v12, v3, 4, v12
    v_lshlrev_b32 v14, 4, v2
    v_add_u32 v14, 147456, v14
    s_lshl_b32 s24, s17, 8
    v_add_u32 v13, s24, v14
    s_add_u32 s24, s24, 149504
    v_lshlrev_b32 v15, 3, v2
    v_add_u32 v15, s24, v15
    v_lshlrev_b32 v16, 5, v3
    v_add_u32 v16, s24, v16
    s_load_dwordx2 s[48:49], s[0:1], 80
    s_mov_b32 s50, 4096
    s_mov_b32 s51, 0x20000
    v_lshlrev_b32 v248, 1, v2
    s_lshl_b32 s24, s18, 6
    s_waitcnt lgkmcnt(0)
    buffer_load_ushort v0, v248, s[48:51], s24 offen
    buffer_load_ushort v1, v248, s[48:51], s24 offen offset:32
    s_waitcnt vmcnt(0)
    v_cmp_eq_u32 vcc, 0, v3
    v_lshlrev_b32 v0, 16, v0
    v_xor_b32 v0, 0x80000000, v0
    v_cndmask_b32 v0, 0, v0, vcc
    v_lshlrev_b32 v1, 16, v1
    v_xor_b32 v1, 0x80000000, v1
    v_cndmask_b32 v1, 0, v1, vcc
    v_mov_b64 v[20:21], 0
    v_mov_b64 v[22:23], 0
    v_mov_b64 v[24:25], 0
    v_mov_b64 v[26:27], 0
    v_mov_b64 v[28:29], 0
    v_mov_b64 v[30:31], 0
    v_mov_b64 v[32:33], 0
    v_mov_b64 v[34:35], 0
    v_mov_b64 v[36:37], 0
    v_mov_b64 v[38:39], 0
    v_mov_b64 v[40:41], 0
    v_mov_b64 v[42:43], 0
    v_mov_b64 v[44:45], 0
    v_mov_b64 v[46:47], 0
    v_mov_b64 v[48:49], 0
    v_mov_b64 v[50:51], 0
    v_mov_b64 v[52:53], 0
    v_mov_b64 v[54:55], 0
    v_mov_b64 v[56:57], 0
    v_mov_b64 v[58:59], 0
    v_mov_b64 v[60:61], 0
    v_mov_b64 v[62:63], 0
    v_mov_b64 v[64:65], 0
    v_mov_b64 v[66:67], 0
    v_mov_b64 v[68:69], 0
    v_mov_b64 v[70:71], 0
    v_mov_b64 v[72:73], 0
    v_mov_b64 v[74:75], 0
    v_mov_b64 v[76:77], 0
    v_mov_b64 v[78:79], 0
    v_mov_b64 v[80:81], 0
    v_mov_b64 v[82:83], 0
    v_mov_b64 v[84:85], 0
    v_mov_b64 v[86:87], 0
    v_mov_b64 v[88:89], 0
    v_mov_b64 v[90:91], 0
    v_mov_b64 v[92:93], 0
    v_mov_b64 v[94:95], 0
    v_mov_b64 v[96:97], 0
    v_mov_b64 v[98:99], 0
    v_mov_b64 v[100:101], 0
    v_mov_b64 v[102:103], 0
    v_mov_b64 v[104:105], 0
    v_mov_b64 v[106:107], 0
    v_mov_b64 v[108:109], 0
    v_mov_b64 v[110:111], 0
    v_mov_b64 v[112:113], 0
    v_mov_b64 v[114:115], 0
    s_mov_b32 s36, 0
    s_mov_b32 s22, 0
    s_mov_b32 s32, 0
    s_lshl_b32 s20, s17, 11
    s_add_u32 s20, s20, 58764288
    s_mul_i32 s33, s18, 88064
    s_lshl_b32 s27, s17, 11
    s_add_u32 s33, s33, s27
    s_add_u32 s33, s33, 58720256
    s_lshl_b32 s34, s18, 2
    s_add_u32 s34, s34, s17
    s_mul_i32 s34, s34, 86
    s_lshr_b32 s34, s34, 8
    s_lshl_b32 s34, s34, 7
    v_mov_b32 v4, s34
    s_mov_b32 s27, 65011712
    s_cmp_lg_u32 s17, 0
    s_cbranch_scc1 wte_57
    v_mov_b32 v249, 208
wt_56:
    buffer_load_dword v248, v249, s[12:15], 0 offen sc1
    s_add_u32 s23, s23, 1
    s_waitcnt vmcnt(0)
    v_readfirstlane_b32 s24, v248
    s_cmp_gt_u32 s23, 262144
    s_cbranch_scc1 wte_57
    s_cmp_ge_u32 s24, 64
    s_cbranch_scc1 wte_57
    s_sleep 4
    s_branch wt_56
wte_57:
    s_barrier
    s_add_u32 s24, s21, 65536
    buffer_load_dwordx4 v[240:243], v12, s[8:11], s21 offen
    buffer_load_dwordx4 v[244:247], v12, s[8:11], s24 offen
    s_add_u32 s21, s21, 64
P_loop:
    s_add_u32 s28, s27, 16384
    s_cmp_lg_u32 s32, 0
    s_cbranch_scc1 P_have0
P_poll0:
    buffer_load_dword v5, v4, s[4:7], s27 offen sc1
    s_add_u32 s23, s23, 1
    s_waitcnt vmcnt(0)
    v_cmp_eq_u32 vcc, -1, v5
    s_cbranch_vccz P_rdy0
    s_sleep 1
    s_cmp_gt_u32 s23, 262144
    s_cbranch_scc0 P_poll0
P_rdy0:
    s_mov_b32 s26, s20
    buffer_load_dwordx4 v[212:215], v9, s[4:7], s27 offen sc1
    buffer_load_dwordx4 v[216:219], v10, s[4:7], s27 offen sc1
    buffer_load_dwordx4 v[220:223], v11, s[4:7], s27 offen sc1
    buffer_load_dword v5, v4, s[4:7], s28 offen sc1
    buffer_load_dwordx4 v[116:119], v6, s[4:7], s26 offen offset:0 sc1
    buffer_load_dwordx4 v[120:123], v6, s[4:7], s26 offen offset:1024 sc1
    s_add_u32 s26, s26, 8192
    buffer_load_dwordx4 v[124:127], v6, s[4:7], s26 offen offset:0 sc1
    buffer_load_dwordx4 v[128:131], v6, s[4:7], s26 offen offset:1024 sc1
    s_add_u32 s26, s26, 8192
    buffer_load_dwordx4 v[132:135], v6, s[4:7], s26 offen offset:0 sc1
    buffer_load_dwordx4 v[136:139], v6, s[4:7], s26 offen offset:1024 sc1
    s_add_u32 s26, s26, 8192
    buffer_load_dwordx4 v[140:143], v6, s[4:7], s26 offen offset:0 sc1
    buffer_load_dwordx4 v[144:147], v6, s[4:7], s26 offen offset:1024 sc1
    s_add_u32 s26, s26, 8192
    buffer_load_dwordx4 v[148:151], v6, s[4:7], s26 offen offset:0 sc1
    buffer_load_dwordx4 v[152:155], v6, s[4:7], s26 offen offset:1024 sc1
    s_add_u32 s26, s26, 8192
    buffer_load_dwordx4 v[156:159], v7, s[4:7], s26 offen offset:0 sc1
    buffer_load_dwordx4 v[160:163], v8, s[4:7], s26 offen offset:1024 sc1
    s_waitcnt vmcnt(12)
P_have0:
    s_waitcnt vmcnt(14)
P_sv0:
    v_max3_u32 v248, v212, v213, v214
    v_max3_u32 v248, v248, v215, v216
    v_max3_u32 v248, v248, v217, v218
    v_max3_u32 v248, v248, v219, v220
    v_max3_u32 v248, v248, v221, v222
    v_max_u32 v248, v248, v223
    v_cmp_eq_u32 vcc, -1, v248
    s_cbranch_vccz P_sok0
    buffer_load_dwordx4 v[212:215], v9, s[4:7], s27 offen sc1
    buffer_load_dwordx4 v[216:219], v10, s[4:7], s27 offen sc1
    buffer_load_dwordx4 v[220:223], v11, s[4:7], s27 offen sc1
    s_add_u32 s23, s23, 1
    s_cmp_gt_u32 s23, 262144
    s_waitcnt vmcnt(0)
    s_cbranch_scc0 P_sv0
P_sok0:
    v_cmp_eq_u32 vcc, -1, v5
    s_mov_b32 s35, s32
    s_mov_b32 s32, 0
    s_cbranch_vccnz P_nopf0
    s_mov_b32 s32, 1
    s_add_u32 s26, s20, 88064
    s_add_u32 s29, s28, 16384
    v_pk_add_f32 v[224:225], v[212:213], v[216:217]
    v_pk_add_f32 v[226:227], v[214:215], v[218:219]
    v_pk_add_f32 v[224:225], v[224:225], v[220:221]
    v_pk_add_f32 v[226:227], v[226:227], v[222:223]
    buffer_load_dwordx4 v[212:215], v9, s[4:7], s28 offen sc1
    v_mov_b32 v228, v224
    v_mov_b32 v229, v225
    v_mov_b32 v230, v226
    v_mov_b32 v231, v227
    v_permlane16_swap_b32 v224, v228
    v_permlane16_swap_b32 v225, v229
    v_permlane16_swap_b32 v226, v230
    v_permlane16_swap_b32 v227, v231
    v_pk_add_f32 v[224:225], v[224:225], v[228:229]
    v_pk_add_f32 v[226:227], v[226:227], v[230:231]
    buffer_load_dwordx4 v[216:219], v10, s[4:7], s28 offen sc1
    v_mov_b32 v228, v224
    v_mov_b32 v229, v225
    v_mov_b32 v230, v226
    v_mov_b32 v231, v227
    v_permlane32_swap_b32 v224, v228
    v_permlane32_swap_b32 v225, v229
    v_permlane32_swap_b32 v226, v230
    v_permlane32_swap_b32 v227, v231
    v_pk_add_f32 v[224:225], v[224:225], v[228:229]
    v_pk_add_f32 v[226:227], v[226:227], v[230:231]
    ds_write_b128 v13, v[224:227] offset:0
    buffer_load_dwordx4 v[220:223], v11, s[4:7], s28 offen sc1
    buffer_load_dword v5, v4, s[4:7], s29 offen sc1
    s_waitcnt lgkmcnt(0)
    s_barrier
    ds_read_b128 v[224:227], v14 offset:0
    ds_read_b128 v[228:231], v14 offset:256
    ds_read_b128 v[232:235], v14 offset:512
    ds_read_b128 v[236:239], v14 offset:768
    buffer_load_dwordx4 v[164:167], v6, s[4:7], s26 offen offset:0 sc1
    s_waitcnt lgkmcnt(0)
    v_pk_add_f32 v[224:225], v[224:225], v[228:229]
    v_pk_add_f32 v[226:227], v[226:227], v[230:231]
    v_pk_add_f32 v[224:225], v[224:225], v[232:233]
    v_pk_add_f32 v[226:227], v[226:227], v[234:235]
    v_pk_add_f32 v[224:225], v[224:225], v[236:237]
    v_pk_add_f32 v[226:227], v[226:227], v[238:239]
    v_mul_f32 v224, 0x3abe82fa, v224
    v_mul_f32 v225, 0x3abe82fa, v225
    v_mul_f32 v226, 0x3abe82fa, v226
    v_mul_f32 v227, 0x3abe82fa, v227
    buffer_load_dwordx4 v[168:171], v6, s[4:7], s26 offen offset:1024 sc1
    s_add_u32 s26, s26, 8192
    v_fma_f32 v225, -v224, v224, v225
    v_max_f32 v225, 0, v225
    v_cvt_pk_bf16_f32 v224, v224, v224
    v_and_b32 v224, 0xffff0000, v224
    v_cvt_pk_bf16_f32 v225, v225, v225
    v_and_b32 v225, 0xffff0000, v225
    v_add_f32 v225, 0x3727c5ac, v225
    v_cvt_pk_bf16_f32 v225, v225, v225
    v_and_b32 v225, 0xffff0000, v225
    v_sqrt_f32 v225, v225
    s_nop 0
    v_cvt_pk_bf16_f32 v225, v225, v225
    v_and_b32 v225, 0xffff0000, v225
    v_rcp_f32 v225, v225
    buffer_load_dwordx4 v[172:175], v6, s[4:7], s26 offen offset:0 sc1
    v_fma_f32 v227, -v226, v226, v227
    v_max_f32 v227, 0, v227
    v_cvt_pk_bf16_f32 v226, v226, v226
    v_and_b32 v226, 0xffff0000, v226
    v_cvt_pk_bf16_f32 v227, v227, v227
    v_and_b32 v227, 0xffff0000, v227
    v_add_f32 v227, 0x3727c5ac, v227
    v_cvt_pk_bf16_f32 v227, v227, v227
    v_and_b32 v227, 0xffff0000, v227
    v_sqrt_f32 v227, v227
    s_nop 0
    v_cvt_pk_bf16_f32 v227, v227, v227
    v_and_b32 v227, 0xffff0000, v227
    v_rcp_f32 v227, v227
    ds_write2_b32 v15, v224, v226 offset0:0 offset1:1
    ds_write2_b32 v15, v225, v227 offset0:32 offset1:33
    buffer_load_dwordx4 v[176:179], v6, s[4:7], s26 offen offset:1024 sc1
    s_add_u32 s26, s26, 8192
    s_waitcnt lgkmcnt(0)
    ds_read_b128 v[232:235], v16 offset:128
    ds_read_b128 v[224:227], v16 offset:0
    ds_read_b128 v[236:239], v16 offset:144
    ds_read_b128 v[228:231], v16 offset:16
    s_waitcnt vmcnt(8)
P_val01:
    v_max3_u32 v248, v116, v117, v118
    v_max3_u32 v248, v248, v119, v120
    v_max3_u32 v248, v248, v121, v122
    v_max3_u32 v248, v248, v123, v124
    v_max3_u32 v248, v248, v125, v126
    v_max3_u32 v248, v248, v127, v128
    v_max3_u32 v248, v248, v129, v130
    v_max3_u32 v248, v248, v131, v132
    v_max3_u32 v248, v248, v133, v134
    v_max3_u32 v248, v248, v135, v136
    v_max3_u32 v248, v248, v137, v138
    v_max3_u32 v248, v248, v139, v140
    v_max3_u32 v248, v248, v141, v142
    v_max3_u32 v248, v248, v143, v144
    v_max3_u32 v248, v248, v145, v146
    v_max3_u32 v248, v248, v147, v148
    v_max3_u32 v248, v248, v149, v150
    v_max3_u32 v248, v248, v151, v152
    v_max3_u32 v248, v248, v153, v154
    v_max3_u32 v248, v248, v155, v156
    v_max3_u32 v248, v248, v157, v158
    v_max3_u32 v248, v248, v159, v160
    v_max3_u32 v248, v248, v161, v162
    v_max_u32 v248, v248, v163
    v_cmp_eq_u32 vcc, -1, v248
    s_cbranch_vccz P_ok01
    s_mov_b32 s25, s20
    buffer_load_dwordx4 v[116:119], v6, s[4:7], s25 offen offset:0 sc1
    buffer_load_dwordx4 v[120:123], v6, s[4:7], s25 offen offset:1024 sc1
    s_add_u32 s25, s25, 8192
    buffer_load_dwordx4 v[124:127], v6, s[4:7], s25 offen offset:0 sc1
    buffer_load_dwordx4 v[128:131], v6, s[4:7], s25 offen offset:1024 sc1
    s_add_u32 s25, s25, 8192
    buffer_load_dwordx4 v[132:135], v6, s[4:7], s25 offen offset:0 sc1
    buffer_load_dwordx4 v[136:139], v6, s[4:7], s25 offen offset:1024 sc1
    s_add_u32 s25, s25, 8192
    buffer_load_dwordx4 v[140:143], v6, s[4:7], s25 offen offset:0 sc1
    buffer_load_dwordx4 v[144:147], v6, s[4:7], s25 offen offset:1024 sc1
    s_add_u32 s25, s25, 8192
    buffer_load_dwordx4 v[148:151], v6, s[4:7], s25 offen offset:0 sc1
    buffer_load_dwordx4 v[152:155], v6, s[4:7], s25 offen offset:1024 sc1
    s_add_u32 s25, s25, 8192
    buffer_load_dwordx4 v[156:159], v7, s[4:7], s25 offen offset:0 sc1
    buffer_load_dwordx4 v[160:163], v8, s[4:7], s25 offen offset:1024 sc1
    s_add_u32 s23, s23, 1
    s_cmp_gt_u32 s23, 262144
    s_waitcnt vmcnt(0)
    s_cbranch_scc0 P_val01
P_ok01:
    buffer_load_dwordx4 v[180:183], v6, s[4:7], s26 offen offset:0 sc1
    s_waitcnt lgkmcnt(0)
    v_lshlrev_b32 v248, 16, v240
    v_and_b32 v249, 0xffff0000, v240
    v_lshlrev_b32 v250, 16, v241
    v_and_b32 v251, 0xffff0000, v241
    v_lshlrev_b32 v252, 16, v242
    v_and_b32 v253, 0xffff0000, v242
    v_lshlrev_b32 v254, 16, v243
    v_and_b32 v255, 0xffff0000, v243
    v_pk_mul_f32 v[248:249], v[248:249], v[232:233]
    v_pk_mul_f32 v[250:251], v[250:251], v[234:235]
    v_pk_mul_f32 v[252:253], v[252:253], v[236:237]
    v_pk_mul_f32 v[254:255], v[254:255], v[238:239]
    v_cvt_pk_bf16_f32 v240, v248, v249
    v_cvt_pk_bf16_f32 v241, v250, v251
    v_cvt_pk_bf16_f32 v242, v252, v253
    v_cvt_pk_bf16_f32 v243, v254, v255
    buffer_load_dwordx4 v[184:187], v6, s[4:7], s26 offen offset:1024 sc1
    s_add_u32 s26, s26, 8192
    v_lshlrev_b32 v248, 16, v244
    v_and_b32 v249, 0xffff0000, v244
    v_lshlrev_b32 v250, 16, v245
    v_and_b32 v251, 0xffff0000, v245
    v_lshlrev_b32 v252, 16, v246
    v_and_b32 v253, 0xffff0000, v246
    v_lshlrev_b32 v254, 16, v247
    v_and_b32 v255, 0xffff0000, v247
    v_pk_mul_f32 v[248:249], v[248:249], v[232:233]
    v_pk_mul_f32 v[250:251], v[250:251], v[234:235]
    v_pk_mul_f32 v[252:253], v[252:253], v[236:237]
    v_pk_mul_f32 v[254:255], v[254:255], v[238:239]
    v_cvt_pk_bf16_f32 v244, v248, v249
    v_cvt_pk_bf16_f32 v245, v250, v251
    v_cvt_pk_bf16_f32 v246, v252, v253
    v_cvt_pk_bf16_f32 v247, v254, v255
    buffer_load_dwordx4 v[188:191], v6, s[4:7], s26 offen offset:0 sc1
    v_mfma_f32_16x16x32_bf16 v[20:23], v[116:119], v[240:243], v[20:23]
    v_lshlrev_b32 v248, 16, v240
    v_fmac_f32 v0, v248, v224
    v_mfma_f32_16x16x32_bf16 v[28:31], v[116:119], v[244:247], v[28:31]
    v_and_b32 v249, 0xffff0000, v240
    v_fmac_f32 v0, v249, v225
    v_mfma_f32_16x16x32_bf16 v[24:27], v[120:123], v[240:243], v[24:27]
    buffer_load_dwordx4 v[192:195], v6, s[4:7], s26 offen offset:1024 sc1
    s_add_u32 s26, s26, 8192
    v_lshlrev_b32 v248, 16, v241
    v_fmac_f32 v0, v248, v226
    v_mfma_f32_16x16x32_bf16 v[32:35], v[120:123], v[244:247], v[32:35]
    v_and_b32 v249, 0xffff0000, v241
    v_fmac_f32 v0, v249, v227
    v_mfma_f32_16x16x32_bf16 v[36:39], v[124:127], v[240:243], v[36:39]
    v_lshlrev_b32 v248, 16, v242
    v_fmac_f32 v0, v248, v228
    v_mfma_f32_16x16x32_bf16 v[44:47], v[124:127], v[244:247], v[44:47]
    v_and_b32 v249, 0xffff0000, v242
    v_fmac_f32 v0, v249, v229
    v_mfma_f32_16x16x32_bf16 v[40:43], v[128:131], v[240:243], v[40:43]
    buffer_load_dwordx4 v[196:199], v6, s[4:7], s26 offen offset:0 sc1
    v_lshlrev_b32 v248, 16, v243
    v_fmac_f32 v0, v248, v230
    v_mfma_f32_16x16x32_bf16 v[48:51], v[128:131], v[244:247], v[48:51]
    v_and_b32 v249, 0xffff0000, v243
    v_fmac_f32 v0, v249, v231
    v_mfma_f32_16x16x32_bf16 v[52:55], v[132:135], v[240:243], v[52:55]
    v_lshlrev_b32 v248, 16, v244
    v_fmac_f32 v1, v248, v224
    v_mfma_f32_16x16x32_bf16 v[60:63], v[132:135], v[244:247], v[60:63]
    v_and_b32 v249, 0xffff0000, v244
    v_fmac_f32 v1, v249, v225
    v_mfma_f32_16x16x32_bf16 v[56:59], v[136:139], v[240:243], v[56:59]
    buffer_load_dwordx4 v[200:203], v6, s[4:7], s26 offen offset:1024 sc1
    s_add_u32 s26, s26, 8192
    v_lshlrev_b32 v248, 16, v245
    v_fmac_f32 v1, v248, v226
    v_mfma_f32_16x16x32_bf16 v[64:67], v[136:139], v[244:247], v[64:67]
    v_and_b32 v249, 0xffff0000, v245
    v_fmac_f32 v1, v249, v227
    v_mfma_f32_16x16x32_bf16 v[68:71], v[140:143], v[240:243], v[68:71]
    v_lshlrev_b32 v248, 16, v246
    v_fmac_f32 v1, v248, v228
    v_mfma_f32_16x16x32_bf16 v[76:79], v[140:143], v[244:247], v[76:79]
    v_and_b32 v249, 0xffff0000, v246
    v_fmac_f32 v1, v249, v229
    v_mfma_f32_16x16x32_bf16 v[72:75], v[144:147], v[240:243], v[72:75]
    buffer_load_dwordx4 v[204:207], v7, s[4:7], s26 offen offset:0 sc1
    v_lshlrev_b32 v248, 16, v247
    v_fmac_f32 v1, v248, v230
    v_mfma_f32_16x16x32_bf16 v[80:83], v[144:147], v[244:247], v[80:83]
    v_and_b32 v249, 0xffff0000, v247
    v_fmac_f32 v1, v249, v231
    v_mfma_f32_16x16x32_bf16 v[84:87], v[148:151], v[240:243], v[84:87]
    v_mfma_f32_16x16x32_bf16 v[92:95], v[148:151], v[244:247], v[92:95]
    v_mfma_f32_16x16x32_bf16 v[88:91], v[152:155], v[240:243], v[88:91]
    buffer_load_dwordx4 v[208:211], v8, s[4:7], s26 offen offset:1024 sc1
    v_mfma_f32_16x16x32_bf16 v[96:99], v[152:155], v[244:247], v[96:99]
    v_mfma_f32_16x16x32_bf16 v[100:103], v[156:159], v[240:243], v[100:103]
    v_mfma_f32_16x16x32_bf16 v[108:111], v[156:159], v[244:247], v[108:111]
    v_mfma_f32_16x16x32_bf16 v[104:107], v[160:163], v[240:243], v[104:107]
    v_mfma_f32_16x16x32_bf16 v[112:115], v[160:163], v[244:247], v[112:115]
    s_cmp_eq_u32 s36, s18
    s_cbranch_scc0 P_noz101
    s_lshl_b32 s24, s17, 11
    s_add_u32 s24, s24, 98304
    s_mov_b32 s25, s33
    s_add_u32 m0, s24, 0
    s_nop 0
    buffer_load_dwordx4 v6, s[4:7], s25 offen offset:0 sc1 lds
    buffer_load_dwordx4 v6, s[4:7], s25 offen offset:1024 sc1 lds
    s_add_u32 s25, s25, 8192
    s_add_u32 m0, s24, 8192
    s_nop 0
    buffer_load_dwordx4 v6, s[4:7], s25 offen offset:0 sc1 lds
    buffer_load_dwordx4 v6, s[4:7], s25 offen offset:1024 sc1 lds
    s_add_u32 s25, s25, 8192
    s_add_u32 m0, s24, 16384
    s_nop 0
    buffer_load_dwordx4 v6, s[4:7], s25 offen offset:0 sc1 lds
    buffer_load_dwordx4 v6, s[4:7], s25 offen offset:1024 sc1 lds
    s_add_u32 s25, s25, 8192
    s_add_u32 m0, s24, 24576
    s_nop 0
    buffer_load_dwordx4 v6, s[4:7], s25 offen offset:0 sc1 lds
    buffer_load_dwordx4 v6, s[4:7], s25 offen offset:1024 sc1 lds
    s_add_u32 s25, s25, 8192
    s_add_u32 m0, s24, 32768
    s_nop 0
    buffer_load_dwordx4 v6, s[4:7], s25 offen offset:0 sc1 lds
    buffer_load_dwordx4 v6, s[4:7], s25 offen offset:1024 sc1 lds
    s_add_u32 s25, s25, 8192
    s_add_u32 m0, s24, 40960
    s_nop 0
    buffer_load_dwordx4 v7, s[4:7], s25 offen offset:0 sc1 lds
    buffer_load_dwordx4 v8, s[4:7], s25 offen offset:1024 sc1 lds
    s_add_u32 s25, s25, 8192
    s_waitcnt vmcnt(12)
P_noz101:
    s_add_u32 s24, s21, 65536
    buffer_load_dwordx4 v[240:243], v12, s[8:11], s21 offen
    buffer_load_dwordx4 v[244:247], v12, s[8:11], s24 offen
    s_add_u32 s21, s21, 64
    s_branch P_done0
P_nopf0:
    v_pk_add_f32 v[224:225], v[212:213], v[216:217]
    v_pk_add_f32 v[226:227], v[214:215], v[218:219]
    v_pk_add_f32 v[224:225], v[224:225], v[220:221]
    v_pk_add_f32 v[226:227], v[226:227], v[222:223]
    v_mov_b32 v228, v224
    v_mov_b32 v229, v225
    v_mov_b32 v230, v226
    v_mov_b32 v231, v227
    v_permlane16_swap_b32 v224, v228
    v_permlane16_swap_b32 v225, v229
    v_permlane16_swap_b32 v226, v230
    v_permlane16_swap_b32 v227, v231
    v_pk_add_f32 v[224:225], v[224:225], v[228:229]
    v_pk_add_f32 v[226:227], v[226:227], v[230:231]
    v_mov_b32 v228, v224
    v_mov_b32 v229, v225
    v_mov_b32 v230, v226
    v_mov_b32 v231, v227
    v_permlane32_swap_b32 v224, v228
    v_permlane32_swap_b32 v225, v229
    v_permlane32_swap_b32 v226, v230
    v_permlane32_swap_b32 v227, v231
    v_pk_add_f32 v[224:225], v[224:225], v[228:229]
    v_pk_add_f32 v[226:227], v[226:227], v[230:231]
    ds_write_b128 v13, v[224:227] offset:0
    s_waitcnt lgkmcnt(0)
    s_barrier
    ds_read_b128 v[224:227], v14 offset:0
    ds_read_b128 v[228:231], v14 offset:256
    ds_read_b128 v[232:235], v14 offset:512
    ds_read_b128 v[236:239], v14 offset:768
    buffer_load_dword v5, v4, s[4:7], s28 offen sc1
    s_waitcnt lgkmcnt(0)
    v_pk_add_f32 v[224:225], v[224:225], v[228:229]
    v_pk_add_f32 v[226:227], v[226:227], v[230:231]
    v_pk_add_f32 v[224:225], v[224:225], v[232:233]
    v_pk_add_f32 v[226:227], v[226:227], v[234:235]
    v_pk_add_f32 v[224:225], v[224:225], v[236:237]
    v_pk_add_f32 v[226:227], v[226:227], v[238:239]
    v_mul_f32 v224, 0x3abe82fa, v224
    v_mul_f32 v225, 0x3abe82fa, v225
    v_mul_f32 v226, 0x3abe82fa, v226
    v_mul_f32 v227, 0x3abe82fa, v227
    v_fma_f32 v225, -v224, v224, v225
    v_max_f32 v225, 0, v225
    v_cvt_pk_bf16_f32 v224, v224, v224
    v_and_b32 v224, 0xffff0000, v224
    v_cvt_pk_bf16_f32 v225, v225, v225
    v_and_b32 v225, 0xffff0000, v225
    v_add_f32 v225, 0x3727c5ac, v225
    v_cvt_pk_bf16_f32 v225, v225, v225
    v_and_b32 v225, 0xffff0000, v225
    v_sqrt_f32 v225, v225
    s_nop 0
    v_cvt_pk_bf16_f32 v225, v225, v225
    v_and_b32 v225, 0xffff0000, v225
    v_rcp_f32 v225, v225
    v_fma_f32 v227, -v226, v226, v227
    v_max_f32 v227, 0, v227
    v_cvt_pk_bf16_f32 v226, v226, v226
    v_and_b32 v226, 0xffff0000, v226
    v_cvt_pk_bf16_f32 v227, v227, v227
    v_and_b32 v227, 0xffff0000, v227
    v_add_f32 v227, 0x3727c5ac, v227
    v_cvt_pk_bf16_f32 v227, v227, v227
    v_and_b32 v227, 0xffff0000, v227
    v_sqrt_f32 v227, v227
    s_nop 0
    v_cvt_pk_bf16_f32 v227, v227, v227
    v_and_b32 v227, 0xffff0000, v227
    v_rcp_f32 v227, v227
    ds_write2_b32 v15, v224, v226 offset0:0 offset1:1
    ds_write2_b32 v15, v225, v227 offset0:32 offset1:33
    s_waitcnt lgkmcnt(0)
    ds_read_b128 v[232:235], v16 offset:128
    ds_read_b128 v[224:227], v16 offset:0
    ds_read_b128 v[236:239], v16 offset:144
    ds_read_b128 v[228:231], v16 offset:16
    s_cmp_eq_u32 s35, 0
    s_cbranch_scc1 P_wf00
    s_waitcnt vmcnt(1)
P_wf00:
    v_lshlrev_b32 v248, 16, v240
    v_and_b32 v249, 0xffff0000, v240
    v_lshlrev_b32 v250, 16, v241
    v_and_b32 v251, 0xffff0000, v241
    v_lshlrev_b32 v252, 16, v242
    v_and_b32 v253, 0xffff0000, v242
    v_lshlrev_b32 v254, 16, v243
    v_and_b32 v255, 0xffff0000, v243
    v_lshlrev_b32 v212, 16, v244
    v_and_b32 v213, 0xffff0000, v244
    v_lshlrev_b32 v214, 16, v245
    v_and_b32 v215, 0xffff0000, v245
    v_lshlrev_b32 v216, 16, v246
    v_and_b32 v217, 0xffff0000, v246
    v_lshlrev_b32 v218, 16, v247
    v_and_b32 v219, 0xffff0000, v247
    s_waitcnt lgkmcnt(0)
    v_pk_mul_f32 v[248:249], v[248:249], v[232:233]
    v_pk_mul_f32 v[250:251], v[250:251], v[234:235]
    v_pk_mul_f32 v[252:253], v[252:253], v[236:237]
    v_pk_mul_f32 v[254:255], v[254:255], v[238:239]
    v_pk_mul_f32 v[212:213], v[212:213], v[232:233]
    v_pk_mul_f32 v[214:215], v[214:215], v[234:235]
    v_pk_mul_f32 v[216:217], v[216:217], v[236:237]
    v_pk_mul_f32 v[218:219], v[218:219], v[238:239]
    v_cvt_pk_bf16_f32 v232, v248, v249
    v_cvt_pk_bf16_f32 v233, v250, v251
    v_cvt_pk_bf16_f32 v234, v252, v253
    v_cvt_pk_bf16_f32 v235, v254, v255
    v_cvt_pk_bf16_f32 v236, v212, v213
    v_cvt_pk_bf16_f32 v237, v214, v215
    v_cvt_pk_bf16_f32 v238, v216, v217
    v_cvt_pk_bf16_f32 v239, v218, v219
    s_waitcnt vmcnt(0)
P_val00:
    v_max3_u32 v248, v116, v117, v118
    v_max3_u32 v248, v248, v119, v120
    v_max3_u32 v248, v248, v121, v122
    v_max3_u32 v248, v248, v123, v124
    v_max3_u32 v248, v248, v125, v126
    v_max3_u32 v248, v248, v127, v128
    v_max3_u32 v248, v248, v129, v130
    v_max3_u32 v248, v248, v131, v132
    v_max3_u32 v248, v248, v133, v134
    v_max3_u32 v248, v248, v135, v136
    v_max3_u32 v248, v248, v137, v138
    v_max3_u32 v248, v248, v139, v140
    v_max3_u32 v248, v248, v141, v142
    v_max3_u32 v248, v248, v143, v144
    v_max3_u32 v248, v248, v145, v146
    v_max3_u32 v248, v248, v147, v148
    v_max3_u32 v248, v248, v149, v150
    v_max3_u32 v248, v248, v151, v152
    v_max3_u32 v248, v248, v153, v154
    v_max3_u32 v248, v248, v155, v156
    v_max3_u32 v248, v248, v157, v158
    v_max3_u32 v248, v248, v159, v160
    v_max3_u32 v248, v248, v161, v162
    v_max_u32 v248, v248, v163
    v_cmp_eq_u32 vcc, -1, v248
    s_cbranch_vccz P_ok00
    s_mov_b32 s25, s20
    buffer_load_dwordx4 v[116:119], v6, s[4:7], s25 offen offset:0 sc1
    buffer_load_dwordx4 v[120:123], v6, s[4:7], s25 offen offset:1024 sc1
    s_add_u32 s25, s25, 8192
    buffer_load_dwordx4 v[124:127], v6, s[4:7], s25 offen offset:0 sc1
    buffer_load_dwordx4 v[128:131], v6, s[4:7], s25 offen offset:1024 sc1
    s_add_u32 s25, s25, 8192
    buffer_load_dwordx4 v[132:135], v6, s[4:7], s25 offen offset:0 sc1
    buffer_load_dwordx4 v[136:139], v6, s[4:7], s25 offen offset:1024 sc1
    s_add_u32 s25, s25, 8192
    buffer_load_dwordx4 v[140:143], v6, s[4:7], s25 offen offset:0 sc1
    buffer_load_dwordx4 v[144:147], v6, s[4:7], s25 offen offset:1024 sc1
    s_add_u32 s25, s25, 8192
    buffer_load_dwordx4 v[148:151], v6, s[4:7], s25 offen offset:0 sc1
    buffer_load_dwordx4 v[152:155], v6, s[4:7], s25 offen offset:1024 sc1
    s_add_u32 s25, s25, 8192
    buffer_load_dwordx4 v[156:159], v7, s[4:7], s25 offen offset:0 sc1
    buffer_load_dwordx4 v[160:163], v8, s[4:7], s25 offen offset:1024 sc1
    s_add_u32 s23, s23, 1
    s_cmp_gt_u32 s23, 262144
    s_waitcnt vmcnt(0)
    s_cbranch_scc0 P_val00
P_ok00:
    s_cmp_eq_u32 s36, s18
    s_cbranch_scc0 P_noz100
    s_lshl_b32 s24, s17, 11
    s_add_u32 s24, s24, 98304
    s_mov_b32 s25, s33
    s_add_u32 m0, s24, 0
    s_nop 0
    buffer_load_dwordx4 v6, s[4:7], s25 offen offset:0 sc1 lds
    buffer_load_dwordx4 v6, s[4:7], s25 offen offset:1024 sc1 lds
    s_add_u32 s25, s25, 8192
    s_add_u32 m0, s24, 8192
    s_nop 0
    buffer_load_dwordx4 v6, s[4:7], s25 offen offset:0 sc1 lds
    buffer_load_dwordx4 v6, s[4:7], s25 offen offset:1024 sc1 lds
    s_add_u32 s25, s25, 8192
    s_add_u32 m0, s24, 16384
    s_nop 0
    buffer_load_dwordx4 v6, s[4:7], s25 offen offset:0 sc1 lds
    buffer_load_dwordx4 v6, s[4:7], s25 offen offset:1024 sc1 lds
    s_add_u32 s25, s25, 8192
    s_add_u32 m0, s24, 24576
    s_nop 0
    buffer_load_dwordx4 v6, s[4:7], s25 offen offset:0 sc1 lds
    buffer_load_dwordx4 v6, s[4:7], s25 offen offset:1024 sc1 lds
    s_add_u32 s25, s25, 8192
    s_add_u32 m0, s24, 32768
    s_nop 0
    buffer_load_dwordx4 v6, s[4:7], s25 offen offset:0 sc1 lds
    buffer_load_dwordx4 v6, s[4:7], s25 offen offset:1024 sc1 lds
    s_add_u32 s25, s25, 8192
    s_add_u32 m0, s24, 40960
    s_nop 0
    buffer_load_dwordx4 v7, s[4:7], s25 offen offset:0 sc1 lds
    buffer_load_dwordx4 v8, s[4:7], s25 offen offset:1024 sc1 lds
    s_add_u32 s25, s25, 8192
P_noz100:
    s_add_u32 s24, s21, 65536
    buffer_load_dwordx4 v[240:243], v12, s[8:11], s21 offen
    buffer_load_dwordx4 v[244:247], v12, s[8:11], s24 offen
    s_add_u32 s21, s21, 64
    v_cmp_eq_u32 vcc, -1, v5
    s_cbranch_vccnz P_plain00
    s_mov_b32 s32, 1
    s_add_u32 s26, s20, 88064
    s_add_u32 s29, s28, 16384
    v_mfma_f32_16x16x32_bf16 v[20:23], v[116:119], v[232:235], v[20:23]
    buffer_load_dwordx4 v[212:215], v9, s[4:7], s28 offen sc1
    v_lshlrev_b32 v248, 16, v232
    v_fmac_f32 v0, v248, v224
    v_mfma_f32_16x16x32_bf16 v[28:31], v[116:119], v[236:239], v[28:31]
    v_and_b32 v249, 0xffff0000, v232
    v_fmac_f32 v0, v249, v225
    v_mfma_f32_16x16x32_bf16 v[24:27], v[120:123], v[232:235], v[24:27]
    v_lshlrev_b32 v248, 16, v233
    v_fmac_f32 v0, v248, v226
    v_mfma_f32_16x16x32_bf16 v[32:35], v[120:123], v[236:239], v[32:35]
    v_and_b32 v249, 0xffff0000, v233
    v_fmac_f32 v0, v249, v227
    v_mfma_f32_16x16x32_bf16 v[36:39], v[124:127], v[232:235], v[36:39]
    buffer_load_dwordx4 v[216:219], v10, s[4:7], s28 offen sc1
    v_lshlrev_b32 v248, 16, v234
    v_fmac_f32 v0, v248, v228
    v_mfma_f32_16x16x32_bf16 v[44:47], v[124:127], v[236:239], v[44:47]
    v_and_b32 v249, 0xffff0000, v234
    v_fmac_f32 v0, v249, v229
    v_mfma_f32_16x16x32_bf16 v[40:43], v[128:131], v[232:235], v[40:43]
    v_lshlrev_b32 v248, 16, v235
    v_fmac_f32 v0, v248, v230
    v_mfma_f32_16x16x32_bf16 v[48:51], v[128:131], v[236:239], v[48:51]
    v_and_b32 v249, 0xffff0000, v235
    v_fmac_f32 v0, v249, v231
    v_mfma_f32_16x16x32_bf16 v[52:55], v[132:135], v[232:235], v[52:55]
    buffer_load_dwordx4 v[220:223], v11, s[4:7], s28 offen sc1
    v_lshlrev_b32 v248, 16, v236
    v_fmac_f32 v1, v248, v224
    v_mfma_f32_16x16x32_bf16 v[60:63], v[132:135], v[236:239], v[60:63]
    v_and_b32 v249, 0xffff0000, v236
    v_fmac_f32 v1, v249, v225
    v_mfma_f32_16x16x32_bf16 v[56:59], v[136:139], v[232:235], v[56:59]
    v_lshlrev_b32 v248, 16, v237
    v_fmac_f32 v1, v248, v226
    v_mfma_f32_16x16x32_bf16 v[64:67], v[136:139], v[236:239], v[64:67]
    v_and_b32 v249, 0xffff0000, v237
    v_fmac_f32 v1, v249, v227
    v_mfma_f32_16x16x32_bf16 v[68:71], v[140:143], v[232:235], v[68:71]
    buffer_load_dword v5, v4, s[4:7], s29 offen sc1
    v_lshlrev_b32 v248, 16, v238
    v_fmac_f32 v1, v248, v228
    v_mfma_f32_16x16x32_bf16 v[76:79], v[140:143], v[236:239], v[76:79]
    v_and_b32 v249, 0xffff0000, v238
    v_fmac_f32 v1, v249, v229
    v_mfma_f32_16x16x32_bf16 v[72:75], v[144:147], v[232:235], v[72:75]
    v_lshlrev_b32 v248, 16, v239
    v_fmac_f32 v1, v248, v230
    v_mfma_f32_16x16x32_bf16 v[80:83], v[144:147], v[236:239], v[80:83]
    v_and_b32 v249, 0xffff0000, v239
    v_fmac_f32 v1, v249, v231
    v_mfma_f32_16x16x32_bf16 v[84:87], v[148:151], v[232:235], v[84:87]
    buffer_load_dwordx4 v[164:167], v6, s[4:7], s26 offen offset:0 sc1
    v_mfma_f32_16x16x32_bf16 v[92:95], v[148:151], v[236:239], v[92:95]
    v_mfma_f32_16x16x32_bf16 v[88:91], v[152:155], v[232:235], v[88:91]
    v_mfma_f32_16x16x32_bf16 v[96:99], v[152:155], v[236:239], v[96:99]
    v_mfma_f32_16x16x32_bf16 v[100:103], v[156:159], v[232:235], v[100:103]
    buffer_load_dwordx4 v[168:171], v6, s[4:7], s26 offen offset:1024 sc1
    s_add_u32 s26, s26, 8192
    v_mfma_f32_16x16x32_bf16 v[108:111], v[156:159], v[236:239], v[108:111]
    v_mfma_f32_16x16x32_bf16 v[104:107], v[160:163], v[232:235], v[104:107]
    v_mfma_f32_16x16x32_bf16 v[112:115], v[160:163], v[236:239], v[112:115]
    buffer_load_dwordx4 v[172:175], v6, s[4:7], s26 offen offset:0 sc1
    buffer_load_dwordx4 v[176:179], v6, s[4:7], s26 offen offset:1024 sc1
    s_add_u32 s26, s26, 8192
    buffer_load_dwordx4 v[180:183], v6, s[4:7], s26 offen offset:0 sc1
    buffer_load_dwordx4 v[184:187], v6, s[4:7], s26 offen offset:1024 sc1
    s_add_u32 s26, s26, 8192
    buffer_load_dwordx4 v[188:191], v6, s[4:7], s26 offen offset:0 sc1
    buffer_load_dwordx4 v[192:195], v6, s[4:7], s26 offen offset:1024 sc1
    s_add_u32 s26, s26, 8192
    buffer_load_dwordx4 v[196:199], v6, s[4:7], s26 offen offset:0 sc1
    buffer_load_dwordx4 v[200:203], v6, s[4:7], s26 offen offset:1024 sc1
    s_add_u32 s26, s26, 8192
    buffer_load_dwordx4 v[204:207], v7, s[4:7], s26 offen offset:0 sc1
    buffer_load_dwordx4 v[208:211], v8, s[4:7], s26 offen offset:1024 sc1
    s_waitcnt vmcnt(12)
    s_branch P_done0
P_plain00:
    v_mfma_f32_16x16x32_bf16 v[20:23], v[116:119], v[232:235], v[20:23]
    v_lshlrev_b32 v248, 16, v232
    v_fmac_f32 v0, v248, v224
    v_mfma_f32_16x16x32_bf16 v[28:31], v[116:119], v[236:239], v[28:31]
    v_and_b32 v249, 0xffff0000, v232
    v_fmac_f32 v0, v249, v225
    v_mfma_f32_16x16x32_bf16 v[24:27], v[120:123], v[232:235], v[24:27]
    v_lshlrev_b32 v248, 16, v233
    v_fmac_f32 v0, v248, v226
    v_mfma_f32_16x16x32_bf16 v[32:35], v[120:123], v[236:239], v[32:35]
    v_and_b32 v249, 0xffff0000, v233
    v_fmac_f32 v0, v249, v227
    v_mfma_f32_16x16x32_bf16 v[36:39], v[124:127], v[232:235], v[36:39]
    v_lshlrev_b32 v248, 16, v234
    v_fmac_f32 v0, v248, v228
    v_mfma_f32_16x16x32_bf16 v[44:47], v[124:127], v[236:239], v[44:47]
    v_and_b32 v249, 0xffff0000, v234
    v_fmac_f32 v0, v249, v229
    v_mfma_f32_16x16x32_bf16 v[40:43], v[128:131], v[232:235], v[40:43]
    v_lshlrev_b32 v248, 16, v235
    v_fmac_f32 v0, v248, v230
    v_mfma_f32_16x16x32_bf16 v[48:51], v[128:131], v[236:239], v[48:51]
    v_and_b32 v249, 0xffff0000, v235
    v_fmac_f32 v0, v249, v231
    v_mfma_f32_16x16x32_bf16 v[52:55], v[132:135], v[232:235], v[52:55]
    v_lshlrev_b32 v248, 16, v236
    v_fmac_f32 v1, v248, v224
    v_mfma_f32_16x16x32_bf16 v[60:63], v[132:135], v[236:239], v[60:63]
    v_and_b32 v249, 0xffff0000, v236
    v_fmac_f32 v1, v249, v225
    v_mfma_f32_16x16x32_bf16 v[56:59], v[136:139], v[232:235], v[56:59]
    v_lshlrev_b32 v248, 16, v237
    v_fmac_f32 v1, v248, v226
    v_mfma_f32_16x16x32_bf16 v[64:67], v[136:139], v[236:239], v[64:67]
    v_and_b32 v249, 0xffff0000, v237
    v_fmac_f32 v1, v249, v227
    v_mfma_f32_16x16x32_bf16 v[68:71], v[140:143], v[232:235], v[68:71]
    v_lshlrev_b32 v248, 16, v238
    v_fmac_f32 v1, v248, v228
    v_mfma_f32_16x16x32_bf16 v[76:79], v[140:143], v[236:239], v[76:79]
    v_and_b32 v249, 0xffff0000, v238
    v_fmac_f32 v1, v249, v229
    v_mfma_f32_16x16x32_bf16 v[72:75], v[144:147], v[232:235], v[72:75]
    v_lshlrev_b32 v248, 16, v239
    v_fmac_f32 v1, v248, v230
    v_mfma_f32_16x16x32_bf16 v[80:83], v[144:147], v[236:239], v[80:83]
    v_and_b32 v249, 0xffff0000, v239
    v_fmac_f32 v1, v249, v231
    v_mfma_f32_16x16x32_bf16 v[84:87], v[148:151], v[232:235], v[84:87]
    v_mfma_f32_16x16x32_bf16 v[92:95], v[148:151], v[236:239], v[92:95]
    v_mfma_f32_16x16x32_bf16 v[88:91], v[152:155], v[232:235], v[88:91]
    v_mfma_f32_16x16x32_bf16 v[96:99], v[152:155], v[236:239], v[96:99]
    v_mfma_f32_16x16x32_bf16 v[100:103], v[156:159], v[232:235], v[100:103]
    v_mfma_f32_16x16x32_bf16 v[108:111], v[156:159], v[236:239], v[108:111]
    v_mfma_f32_16x16x32_bf16 v[104:107], v[160:163], v[232:235], v[104:107]
    v_mfma_f32_16x16x32_bf16 v[112:115], v[160:163], v[236:239], v[112:115]
P_done0:
    s_add_u32 s20, s20, 88064
    s_add_u32 s27, s27, 16384
    s_add_u32 s36, s36, 1
    s_add_u32 s28, s27, 16384
    s_cmp_lg_u32 s32, 0
    s_cbranch_scc1 P_have1
P_poll1:
    buffer_load_dword v5, v4, s[4:7], s27 offen sc1
    s_add_u32 s23, s23, 1
    s_waitcnt vmcnt(0)
    v_cmp_eq_u32 vcc, -1, v5
    s_cbranch_vccz P_rdy1
    s_sleep 1
    s_cmp_gt_u32 s23, 262144
    s_cbranch_scc0 P_poll1
P_rdy1:
    s_mov_b32 s26, s20
    buffer_load_dwordx4 v[212:215], v9, s[4:7], s27 offen sc1
    buffer_load_dwordx4 v[216:219], v10, s[4:7], s27 offen sc1
    buffer_load_dwordx4 v[220:223], v11, s[4:7], s27 offen sc1
    buffer_load_dword v5, v4, s[4:7], s28 offen sc1
    buffer_load_dwordx4 v[164:167], v6, s[4:7], s26 offen offset:0 sc1
    buffer_load_dwordx4 v[168:171], v6, s[4:7], s26 offen offset:1024 sc1
    s_add_u32 s26, s26, 8192
    buffer_load_dwordx4 v[172:175], v6, s[4:7], s26 offen offset:0 sc1
    buffer_load_dwordx4 v[176:179], v6, s[4:7], s26 offen offset:1024 sc1
    s_add_u32 s26, s26, 8192
    buffer_load_dwordx4 v[180:183], v6, s[4:7], s26 offen offset:0 sc1
    buffer_load_dwordx4 v[184:187], v6, s[4:7], s26 offen offset:1024 sc1
    s_add_u32 s26, s26, 8192
    buffer_load_dwordx4 v[188:191], v6, s[4:7], s26 offen offset:0 sc1
    buffer_load_dwordx4 v[192:195], v6, s[4:7], s26 offen offset:1024 sc1
    s_add_u32 s26, s26, 8192
    buffer_load_dwordx4 v[196:199], v6, s[4:7], s26 offen offset:0 sc1
    buffer_load_dwordx4 v[200:203], v6, s[4:7], s26 offen offset:1024 sc1
    s_add_u32 s26, s26, 8192
    buffer_load_dwordx4 v[204:207], v7, s[4:7], s26 offen offset:0 sc1
    buffer_load_dwordx4 v[208:211], v8, s[4:7], s26 offen offset:1024 sc1
    s_waitcnt vmcnt(12)
P_have1:
    s_waitcnt vmcnt(14)
P_sv1:
    v_max3_u32 v248, v212, v213, v214
    v_max3_u32 v248, v248, v215, v216
    v_max3_u32 v248, v248, v217, v218
    v_max3_u32 v248, v248, v219, v220
    v_max3_u32 v248, v248, v221, v222
    v_max_u32 v248, v248, v223
    v_cmp_eq_u32 vcc, -1, v248
    s_cbranch_vccz P_sok1
    buffer_load_dwordx4 v[212:215], v9, s[4:7], s27 offen sc1
    buffer_load_dwordx4 v[216:219], v10, s[4:7], s27 offen sc1
    buffer_load_dwordx4 v[220:223], v11, s[4:7], s27 offen sc1
    s_add_u32 s23, s23, 1
    s_cmp_gt_u32 s23, 262144
    s_waitcnt vmcnt(0)
    s_cbranch_scc0 P_sv1
P_sok1:
    v_cmp_eq_u32 vcc, -1, v5
    s_mov_b32 s35, s32
    s_mov_b32 s32, 0
    s_cbranch_vccnz P_nopf1
    s_cmp_eq_u32 s36, 63
    s_cbranch_scc1 P_nopf1
    s_mov_b32 s32, 1
    s_add_u32 s26, s20, 88064
    s_add_u32 s29, s28, 16384
    v_pk_add_f32 v[224:225], v[212:213], v[216:217]
    v_pk_add_f32 v[226:227], v[214:215], v[218:219]
    v_pk_add_f32 v[224:225], v[224:225], v[220:221]
    v_pk_add_f32 v[226:227], v[226:227], v[222:223]
    buffer_load_dwordx4 v[212:215], v9, s[4:7], s28 offen sc1
    v_mov_b32 v228, v224
    v_mov_b32 v229, v225
    v_mov_b32 v230, v226
    v_mov_b32 v231, v227
    v_permlane16_swap_b32 v224, v228
    v_permlane16_swap_b32 v225, v229
    v_permlane16_swap_b32 v226, v230
    v_permlane16_swap_b32 v227, v231
    v_pk_add_f32 v[224:225], v[224:225], v[228:229]
    v_pk_add_f32 v[226:227], v[226:227], v[230:231]
    buffer_load_dwordx4 v[216:219], v10, s[4:7], s28 offen sc1
    v_mov_b32 v228, v224
    v_mov_b32 v229, v225
    v_mov_b32 v230, v226
    v_mov_b32 v231, v227
    v_permlane32_swap_b32 v224, v228
    v_permlane32_swap_b32 v225, v229
    v_permlane32_swap_b32 v226, v230
    v_permlane32_swap_b32 v227, v231
    v_pk_add_f32 v[224:225], v[224:225], v[228:229]
    v_pk_add_f32 v[226:227], v[226:227], v[230:231]
    ds_write_b128 v13, v[224:227] offset:1024
    buffer_load_dwordx4 v[220:223], v11, s[4:7], s28 offen sc1
    buffer_load_dword v5, v4, s[4:7], s29 offen sc1
    s_waitcnt lgkmcnt(0)
    s_barrier
    ds_read_b128 v[224:227], v14 offset:1024
    ds_read_b128 v[228:231], v14 offset:1280
    ds_read_b128 v[232:235], v14 offset:1536
    ds_read_b128 v[236:239], v14 offset:1792
    buffer_load_dwordx4 v[116:119], v6, s[4:7], s26 offen offset:0 sc1
    s_waitcnt lgkmcnt(0)
    v_pk_add_f32 v[224:225], v[224:225], v[228:229]
    v_pk_add_f32 v[226:227], v[226:227], v[230:231]
    v_pk_add_f32 v[224:225], v[224:225], v[232:233]
    v_pk_add_f32 v[226:227], v[226:227], v[234:235]
    v_pk_add_f32 v[224:225], v[224:225], v[236:237]
    v_pk_add_f32 v[226:227], v[226:227], v[238:239]
    v_mul_f32 v224, 0x3abe82fa, v224
    v_mul_f32 v225, 0x3abe82fa, v225
    v_mul_f32 v226, 0x3abe82fa, v226
    v_mul_f32 v227, 0x3abe82fa, v227
    buffer_load_dwordx4 v[120:123], v6, s[4:7], s26 offen offset:1024 sc1
    s_add_u32 s26, s26, 8192
    v_fma_f32 v225, -v224, v224, v225
    v_max_f32 v225, 0, v225
    v_cvt_pk_bf16_f32 v224, v224, v224
    v_and_b32 v224, 0xffff0000, v224
    v_cvt_pk_bf16_f32 v225, v225, v225
    v_and_b32 v225, 0xffff0000, v225
    v_add_f32 v225, 0x3727c5ac, v225
    v_cvt_pk_bf16_f32 v225, v225, v225
    v_and_b32 v225, 0xffff0000, v225
    v_sqrt_f32 v225, v225
    s_nop 0
    v_cvt_pk_bf16_f32 v225, v225, v225
    v_and_b32 v225, 0xffff0000, v225
    v_rcp_f32 v225, v225
    buffer_load_dwordx4 v[124:127], v6, s[4:7], s26 offen offset:0 sc1
    v_fma_f32 v227, -v226, v226, v227
    v_max_f32 v227, 0, v227
    v_cvt_pk_bf16_f32 v226, v226, v226
    v_and_b32 v226, 0xffff0000, v226
    v_cvt_pk_bf16_f32 v227, v227, v227
    v_and_b32 v227, 0xffff0000, v227
    v_add_f32 v227, 0x3727c5ac, v227
    v_cvt_pk_bf16_f32 v227, v227, v227
    v_and_b32 v227, 0xffff0000, v227
    v_sqrt_f32 v227, v227
    s_nop 0
    v_cvt_pk_bf16_f32 v227, v227, v227
    v_and_b32 v227, 0xffff0000, v227
    v_rcp_f32 v227, v227
    ds_write2_b32 v15, v224, v226 offset0:0 offset1:1
    ds_write2_b32 v15, v225, v227 offset0:32 offset1:33
    buffer_load_dwordx4 v[128:131], v6, s[4:7], s26 offen offset:1024 sc1
    s_add_u32 s26, s26, 8192
    s_waitcnt lgkmcnt(0)
    ds_read_b128 v[232:235], v16 offset:128
    ds_read_b128 v[224:227], v16 offset:0
    ds_read_b128 v[236:239], v16 offset:144
    ds_read_b128 v[228:231], v16 offset:16
    s_waitcnt vmcnt(8)
P_val11:
    v_max3_u32 v248, v164, v165, v166
    v_max3_u32 v248, v248, v167, v168
    v_max3_u32 v248, v248, v169, v170
    v_max3_u32 v248, v248, v171, v172
    v_max3_u32 v248, v248, v173, v174
    v_max3_u32 v248, v248, v175, v176
    v_max3_u32 v248, v248, v177, v178
    v_max3_u32 v248, v248, v179, v180
    v_max3_u32 v248, v248, v181, v182
    v_max3_u32 v248, v248, v183, v184
    v_max3_u32 v248, v248, v185, v186
    v_max3_u32 v248, v248, v187, v188
    v_max3_u32 v248, v248, v189, v190
    v_max3_u32 v248, v248, v191, v192
    v_max3_u32 v248, v248, v193, v194
    v_max3_u32 v248, v248, v195, v196
    v_max3_u32 v248, v248, v197, v198
    v_max3_u32 v248, v248, v199, v200
    v_max3_u32 v248, v248, v201, v202
    v_max3_u32 v248, v248, v203, v204
    v_max3_u32 v248, v248, v205, v206
    v_max3_u32 v248, v248, v207, v208
    v_max3_u32 v248, v248, v209, v210
    v_max_u32 v248, v248, v211
    v_cmp_eq_u32 vcc, -1, v248
    s_cbranch_vccz P_ok11
    s_mov_b32 s25, s20
    buffer_load_dwordx4 v[164:167], v6, s[4:7], s25 offen offset:0 sc1
    buffer_load_dwordx4 v[168:171], v6, s[4:7], s25 offen offset:1024 sc1
    s_add_u32 s25, s25, 8192
    buffer_load_dwordx4 v[172:175], v6, s[4:7], s25 offen offset:0 sc1
    buffer_load_dwordx4 v[176:179], v6, s[4:7], s25 offen offset:1024 sc1
    s_add_u32 s25, s25, 8192
    buffer_load_dwordx4 v[180:183], v6, s[4:7], s25 offen offset:0 sc1
    buffer_load_dwordx4 v[184:187], v6, s[4:7], s25 offen offset:1024 sc1
    s_add_u32 s25, s25, 8192
    buffer_load_dwordx4 v[188:191], v6, s[4:7], s25 offen offset:0 sc1
    buffer_load_dwordx4 v[192:195], v6, s[4:7], s25 offen offset:1024 sc1
    s_add_u32 s25, s25, 8192
    buffer_load_dwordx4 v[196:199], v6, s[4:7], s25 offen offset:0 sc1
    buffer_load_dwordx4 v[200:203], v6, s[4:7], s25 offen offset:1024 sc1
    s_add_u32 s25, s25, 8192
    buffer_load_dwordx4 v[204:207], v7, s[4:7], s25 offen offset:0 sc1
    buffer_load_dwordx4 v[208:211], v8, s[4:7], s25 offen offset:1024 sc1
    s_add_u32 s23, s23, 1
    s_cmp_gt_u32 s23, 262144
    s_waitcnt vmcnt(0)
    s_cbranch_scc0 P_val11
P_ok11:
    buffer_load_dwordx4 v[132:135], v6, s[4:7], s26 offen offset:0 sc1
    s_waitcnt lgkmcnt(0)
    v_lshlrev_b32 v248, 16, v240
    v_and_b32 v249, 0xffff0000, v240
    v_lshlrev_b32 v250, 16, v241
    v_and_b32 v251, 0xffff0000, v241
    v_lshlrev_b32 v252, 16, v242
    v_and_b32 v253, 0xffff0000, v242
    v_lshlrev_b32 v254, 16, v243
    v_and_b32 v255, 0xffff0000, v243
    v_pk_mul_f32 v[248:249], v[248:249], v[232:233]
    v_pk_mul_f32 v[250:251], v[250:251], v[234:235]
    v_pk_mul_f32 v[252:253], v[252:253], v[236:237]
    v_pk_mul_f32 v[254:255], v[254:255], v[238:239]
    v_cvt_pk_bf16_f32 v240, v248, v249
    v_cvt_pk_bf16_f32 v241, v250, v251
    v_cvt_pk_bf16_f32 v242, v252, v253
    v_cvt_pk_bf16_f32 v243, v254, v255
    buffer_load_dwordx4 v[136:139], v6, s[4:7], s26 offen offset:1024 sc1
    s_add_u32 s26, s26, 8192
    v_lshlrev_b32 v248, 16, v244
    v_and_b32 v249, 0xffff0000, v244
    v_lshlrev_b32 v250, 16, v245
    v_and_b32 v251, 0xffff0000, v245
    v_lshlrev_b32 v252, 16, v246
    v_and_b32 v253, 0xffff0000, v246
    v_lshlrev_b32 v254, 16, v247
    v_and_b32 v255, 0xffff0000, v247
    v_pk_mul_f32 v[248:249], v[248:249], v[232:233]
    v_pk_mul_f32 v[250:251], v[250:251], v[234:235]
    v_pk_mul_f32 v[252:253], v[252:253], v[236:237]
    v_pk_mul_f32 v[254:255], v[254:255], v[238:239]
    v_cvt_pk_bf16_f32 v244, v248, v249
    v_cvt_pk_bf16_f32 v245, v250, v251
    v_cvt_pk_bf16_f32 v246, v252, v253
    v_cvt_pk_bf16_f32 v247, v254, v255
    buffer_load_dwordx4 v[140:143], v6, s[4:7], s26 offen offset:0 sc1
    v_mfma_f32_16x16x32_bf16 v[20:23], v[164:167], v[240:243], v[20:23]
    v_lshlrev_b32 v248, 16, v240
    v_fmac_f32 v0, v248, v224
    v_mfma_f32_16x16x32_bf16 v[28:31], v[164:167], v[244:247], v[28:31]
    v_and_b32 v249, 0xffff0000, v240
    v_fmac_f32 v0, v249, v225
    v_mfma_f32_16x16x32_bf16 v[24:27], v[168:171], v[240:243], v[24:27]
    buffer_load_dwordx4 v[144:147], v6, s[4:7], s26 offen offset:1024 sc1
    s_add_u32 s26, s26, 8192
    v_lshlrev_b32 v248, 16, v241
    v_fmac_f32 v0, v248, v226
    v_mfma_f32_16x16x32_bf16 v[32:35], v[168:171], v[244:247], v[32:35]
    v_and_b32 v249, 0xffff0000, v241
    v_fmac_f32 v0, v249, v227
    v_mfma_f32_16x16x32_bf16 v[36:39], v[172:175], v[240:243], v[36:39]
    v_lshlrev_b32 v248, 16, v242
    v_fmac_f32 v0, v248, v228
    v_mfma_f32_16x16x32_bf16 v[44:47], v[172:175], v[244:247], v[44:47]
    v_and_b32 v249, 0xffff0000, v242
    v_fmac_f32 v0, v249, v229
    v_mfma_f32_16x16x32_bf16 v[40:43], v[176:179], v[240:243], v[40:43]
    buffer_load_dwordx4 v[148:151], v6, s[4:7], s26 offen offset:0 sc1
    v_lshlrev_b32 v248, 16, v243
    v_fmac_f32 v0, v248, v230
    v_mfma_f32_16x16x32_bf16 v[48:51], v[176:179], v[244:247], v[48:51]
    v_and_b32 v249, 0xffff0000, v243
    v_fmac_f32 v0, v249, v231
    v_mfma_f32_16x16x32_bf16 v[52:55], v[180:183], v[240:243], v[52:55]
    v_lshlrev_b32 v248, 16, v244
    v_fmac_f32 v1, v248, v224
    v_mfma_f32_16x16x32_bf16 v[60:63], v[180:183], v[244:247], v[60:63]
    v_and_b32 v249, 0xffff0000, v244
    v_fmac_f32 v1, v249, v225
    v_mfma_f32_16x16x32_bf16 v[56:59], v[184:187], v[240:243], v[56:59]
    buffer_load_dwordx4 v[152:155], v6, s[4:7], s26 offen offset:1024 sc1
    s_add_u32 s26, s26, 8192
    v_lshlrev_b32 v248, 16, v245
    v_fmac_f32 v1, v248, v226
    v_mfma_f32_16x16x32_bf16 v[64:67], v[184:187], v[244:247], v[64:67]
    v_and_b32 v249, 0xffff0000, v245
    v_fmac_f32 v1, v249, v227
    v_mfma_f32_16x16x32_bf16 v[68:71], v[188:191], v[240:243], v[68:71]
    v_lshlrev_b32 v248, 16, v246
    v_fmac_f32 v1, v248, v228
    v_mfma_f32_16x16x32_bf16 v[76:79], v[188:191], v[244:247], v[76:79]
    v_and_b32 v249, 0xffff0000, v246
    v_fmac_f32 v1, v249, v229
    v_mfma_f32_16x16x32_bf16 v[72:75], v[192:195], v[240:243], v[72:75]
    buffer_load_dwordx4 v[156:159], v7, s[4:7], s26 offen offset:0 sc1
    v_lshlrev_b32 v248, 16, v247
    v_fmac_f32 v1, v248, v230
    v_mfma_f32_16x16x32_bf16 v[80:83], v[192:195], v[244:247], v[80:83]
    v_and_b32 v249, 0xffff0000, v247
    v_fmac_f32 v1, v249, v231
    v_mfma_f32_16x16x32_bf16 v[84:87], v[196:199], v[240:243], v[84:87]
    v_mfma_f32_16x16x32_bf16 v[92:95], v[196:199], v[244:247], v[92:95]
    v_mfma_f32_16x16x32_bf16 v[88:91], v[200:203], v[240:243], v[88:91]
    buffer_load_dwordx4 v[160:163], v8, s[4:7], s26 offen offset:1024 sc1
    v_mfma_f32_16x16x32_bf16 v[96:99], v[200:203], v[244:247], v[96:99]
    v_mfma_f32_16x16x32_bf16 v[100:103], v[204:207], v[240:243], v[100:103]
    v_mfma_f32_16x16x32_bf16 v[108:111], v[204:207], v[244:247], v[108:111]
    v_mfma_f32_16x16x32_bf16 v[104:107], v[208:211], v[240:243], v[104:107]
    v_mfma_f32_16x16x32_bf16 v[112:115], v[208:211], v[244:247], v[112:115]
    s_cmp_eq_u32 s36, s18
    s_cbranch_scc0 P_noz111
    s_lshl_b32 s24, s17, 11
    s_add_u32 s24, s24, 98304
    s_mov_b32 s25, s33
    s_add_u32 m0, s24, 0
    s_nop 0
    buffer_load_dwordx4 v6, s[4:7], s25 offen offset:0 sc1 lds
    buffer_load_dwordx4 v6, s[4:7], s25 offen offset:1024 sc1 lds
    s_add_u32 s25, s25, 8192
    s_add_u32 m0, s24, 8192
    s_nop 0
    buffer_load_dwordx4 v6, s[4:7], s25 offen offset:0 sc1 lds
    buffer_load_dwordx4 v6, s[4:7], s25 offen offset:1024 sc1 lds
    s_add_u32 s25, s25, 8192
    s_add_u32 m0, s24, 16384
    s_nop 0
    buffer_load_dwordx4 v6, s[4:7], s25 offen offset:0 sc1 lds
    buffer_load_dwordx4 v6, s[4:7], s25 offen offset:1024 sc1 lds
    s_add_u32 s25, s25, 8192
    s_add_u32 m0, s24, 24576
    s_nop 0
    buffer_load_dwordx4 v6, s[4:7], s25 offen offset:0 sc1 lds
    buffer_load_dwordx4 v6, s[4:7], s25 offen offset:1024 sc1 lds
    s_add_u32 s25, s25, 8192
    s_add_u32 m0, s24, 32768
    s_nop 0
    buffer_load_dwordx4 v6, s[4:7], s25 offen offset:0 sc1 lds
    buffer_load_dwordx4 v6, s[4:7], s25 offen offset:1024 sc1 lds
    s_add_u32 s25, s25, 8192
    s_add_u32 m0, s24, 40960
    s_nop 0
    buffer_load_dwordx4 v7, s[4:7], s25 offen offset:0 sc1 lds
    buffer_load_dwordx4 v8, s[4:7], s25 offen offset:1024 sc1 lds
    s_add_u32 s25, s25, 8192
    s_waitcnt vmcnt(12)
P_noz111:
    s_add_u32 s24, s21, 65536
    buffer_load_dwordx4 v[240:243], v12, s[8:11], s21 offen
    buffer_load_dwordx4 v[244:247], v12, s[8:11], s24 offen
    s_add_u32 s21, s21, 64
    s_branch P_done1
P_nopf1:
    v_pk_add_f32 v[224:225], v[212:213], v[216:217]
    v_pk_add_f32 v[226:227], v[214:215], v[218:219]
    v_pk_add_f32 v[224:225], v[224:225], v[220:221]
    v_pk_add_f32 v[226:227], v[226:227], v[222:223]
    v_mov_b32 v228, v224
    v_mov_b32 v229, v225
    v_mov_b32 v230, v226
    v_mov_b32 v231, v227
    v_permlane16_swap_b32 v224, v228
    v_permlane16_swap_b32 v225, v229
    v_permlane16_swap_b32 v226, v230
    v_permlane16_swap_b32 v227, v231
    v_pk_add_f32 v[224:225], v[224:225], v[228:229]
    v_pk_add_f32 v[226:227], v[226:227], v[230:231]
    v_mov_b32 v228, v224
    v_mov_b32 v229, v225
    v_mov_b32 v230, v226
    v_mov_b32 v231, v227
    v_permlane32_swap_b32 v224, v228
    v_permlane32_swap_b32 v225, v229
    v_permlane32_swap_b32 v226, v230
    v_permlane32_swap_b32 v227, v231
    v_pk_add_f32 v[224:225], v[224:225], v[228:229]
    v_pk_add_f32 v[226:227], v[226:227], v[230:231]
    ds_write_b128 v13, v[224:227] offset:1024
    s_waitcnt lgkmcnt(0)
    s_barrier
    ds_read_b128 v[224:227], v14 offset:1024
    ds_read_b128 v[228:231], v14 offset:1280
    ds_read_b128 v[232:235], v14 offset:1536
    ds_read_b128 v[236:239], v14 offset:1792
    buffer_load_dword v5, v4, s[4:7], s28 offen sc1
    s_waitcnt lgkmcnt(0)
    v_pk_add_f32 v[224:225], v[224:225], v[228:229]
    v_pk_add_f32 v[226:227], v[226:227], v[230:231]
    v_pk_add_f32 v[224:225], v[224:225], v[232:233]
    v_pk_add_f32 v[226:227], v[226:227], v[234:235]
    v_pk_add_f32 v[224:225], v[224:225], v[236:237]
    v_pk_add_f32 v[226:227], v[226:227], v[238:239]
    v_mul_f32 v224, 0x3abe82fa, v224
    v_mul_f32 v225, 0x3abe82fa, v225
    v_mul_f32 v226, 0x3abe82fa, v226
    v_mul_f32 v227, 0x3abe82fa, v227
    v_fma_f32 v225, -v224, v224, v225
    v_max_f32 v225, 0, v225
    v_cvt_pk_bf16_f32 v224, v224, v224
    v_and_b32 v224, 0xffff0000, v224
    v_cvt_pk_bf16_f32 v225, v225, v225
    v_and_b32 v225, 0xffff0000, v225
    v_add_f32 v225, 0x3727c5ac, v225
    v_cvt_pk_bf16_f32 v225, v225, v225
    v_and_b32 v225, 0xffff0000, v225
    v_sqrt_f32 v225, v225
    s_nop 0
    v_cvt_pk_bf16_f32 v225, v225, v225
    v_and_b32 v225, 0xffff0000, v225
    v_rcp_f32 v225, v225
    v_fma_f32 v227, -v226, v226, v227
    v_max_f32 v227, 0, v227
    v_cvt_pk_bf16_f32 v226, v226, v226
    v_and_b32 v226, 0xffff0000, v226
    v_cvt_pk_bf16_f32 v227, v227, v227
    v_and_b32 v227, 0xffff0000, v227
    v_add_f32 v227, 0x3727c5ac, v227
    v_cvt_pk_bf16_f32 v227, v227, v227
    v_and_b32 v227, 0xffff0000, v227
    v_sqrt_f32 v227, v227
    s_nop 0
    v_cvt_pk_bf16_f32 v227, v227, v227
    v_and_b32 v227, 0xffff0000, v227
    v_rcp_f32 v227, v227
    ds_write2_b32 v15, v224, v226 offset0:0 offset1:1
    ds_write2_b32 v15, v225, v227 offset0:32 offset1:33
    s_waitcnt lgkmcnt(0)
    ds_read_b128 v[232:235], v16 offset:128
    ds_read_b128 v[224:227], v16 offset:0
    ds_read_b128 v[236:239], v16 offset:144
    ds_read_b128 v[228:231], v16 offset:16
    s_cmp_eq_u32 s35, 0
    s_cbranch_scc1 P_wf10
    s_waitcnt vmcnt(1)
P_wf10:
    v_lshlrev_b32 v248, 16, v240
    v_and_b32 v249, 0xffff0000, v240
    v_lshlrev_b32 v250, 16, v241
    v_and_b32 v251, 0xffff0000, v241
    v_lshlrev_b32 v252, 16, v242
    v_and_b32 v253, 0xffff0000, v242
    v_lshlrev_b32 v254, 16, v243
    v_and_b32 v255, 0xffff0000, v243
    v_lshlrev_b32 v212, 16, v244
    v_and_b32 v213, 0xffff0000, v244
    v_lshlrev_b32 v214, 16, v245
    v_and_b32 v215, 0xffff0000, v245
    v_lshlrev_b32 v216, 16, v246
    v_and_b32 v217, 0xffff0000, v246
    v_lshlrev_b32 v218, 16, v247
    v_and_b32 v219, 0xffff0000, v247
    s_waitcnt lgkmcnt(0)
    v_pk_mul_f32 v[248:249], v[248:249], v[232:233]
    v_pk_mul_f32 v[250:251], v[250:251], v[234:235]
    v_pk_mul_f32 v[252:253], v[252:253], v[236:237]
    v_pk_mul_f32 v[254:255], v[254:255], v[238:239]
    v_pk_mul_f32 v[212:213], v[212:213], v[232:233]
    v_pk_mul_f32 v[214:215], v[214:215], v[234:235]
    v_pk_mul_f32 v[216:217], v[216:217], v[236:237]
    v_pk_mul_f32 v[218:219], v[218:219], v[238:239]
    v_cvt_pk_bf16_f32 v232, v248, v249
    v_cvt_pk_bf16_f32 v233, v250, v251
    v_cvt_pk_bf16_f32 v234, v252, v253
    v_cvt_pk_bf16_f32 v235, v254, v255
    v_cvt_pk_bf16_f32 v236, v212, v213
    v_cvt_pk_bf16_f32 v237, v214, v215
    v_cvt_pk_bf16_f32 v238, v216, v217
    v_cvt_pk_bf16_f32 v239, v218, v219
    s_waitcnt vmcnt(0)
P_val10:
    v_max3_u32 v248, v164, v165, v166
    v_max3_u32 v248, v248, v167, v168
    v_max3_u32 v248, v248, v169, v170
    v_max3_u32 v248, v248, v171, v172
    v_max3_u32 v248, v248, v173, v174
    v_max3_u32 v248, v248, v175, v176
    v_max3_u32 v248, v248, v177, v178
    v_max3_u32 v248, v248, v179, v180
    v_max3_u32 v248, v248, v181, v182
    v_max3_u32 v248, v248, v183, v184
    v_max3_u32 v248, v248, v185, v186
    v_max3_u32 v248, v248, v187, v188
    v_max3_u32 v248, v248, v189, v190
    v_max3_u32 v248, v248, v191, v192
    v_max3_u32 v248, v248, v193, v194
    v_max3_u32 v248, v248, v195, v196
    v_max3_u32 v248, v248, v197, v198
    v_max3_u32 v248, v248, v199, v200
    v_max3_u32 v248, v248, v201, v202
    v_max3_u32 v248, v248, v203, v204
    v_max3_u32 v248, v248, v205, v206
    v_max3_u32 v248, v248, v207, v208
    v_max3_u32 v248, v248, v209, v210
    v_max_u32 v248, v248, v211
    v_cmp_eq_u32 vcc, -1, v248
    s_cbranch_vccz P_ok10
    s_mov_b32 s25, s20
    buffer_load_dwordx4 v[164:167], v6, s[4:7], s25 offen offset:0 sc1
    buffer_load_dwordx4 v[168:171], v6, s[4:7], s25 offen offset:1024 sc1
    s_add_u32 s25, s25, 8192
    buffer_load_dwordx4 v[172:175], v6, s[4:7], s25 offen offset:0 sc1
    buffer_load_dwordx4 v[176:179], v6, s[4:7], s25 offen offset:1024 sc1
    s_add_u32 s25, s25, 8192
    buffer_load_dwordx4 v[180:183], v6, s[4:7], s25 offen offset:0 sc1
    buffer_load_dwordx4 v[184:187], v6, s[4:7], s25 offen offset:1024 sc1
    s_add_u32 s25, s25, 8192
    buffer_load_dwordx4 v[188:191], v6, s[4:7], s25 offen offset:0 sc1
    buffer_load_dwordx4 v[192:195], v6, s[4:7], s25 offen offset:1024 sc1
    s_add_u32 s25, s25, 8192
    buffer_load_dwordx4 v[196:199], v6, s[4:7], s25 offen offset:0 sc1
    buffer_load_dwordx4 v[200:203], v6, s[4:7], s25 offen offset:1024 sc1
    s_add_u32 s25, s25, 8192
    buffer_load_dwordx4 v[204:207], v7, s[4:7], s25 offen offset:0 sc1
    buffer_load_dwordx4 v[208:211], v8, s[4:7], s25 offen offset:1024 sc1
    s_add_u32 s23, s23, 1
    s_cmp_gt_u32 s23, 262144
    s_waitcnt vmcnt(0)
    s_cbranch_scc0 P_val10
P_ok10:
    s_cmp_eq_u32 s36, s18
    s_cbranch_scc0 P_noz110
    s_lshl_b32 s24, s17, 11
    s_add_u32 s24, s24, 98304
    s_mov_b32 s25, s33
    s_add_u32 m0, s24, 0
    s_nop 0
    buffer_load_dwordx4 v6, s[4:7], s25 offen offset:0 sc1 lds
    buffer_load_dwordx4 v6, s[4:7], s25 offen offset:1024 sc1 lds
    s_add_u32 s25, s25, 8192
    s_add_u32 m0, s24, 8192
    s_nop 0
    buffer_load_dwordx4 v6, s[4:7], s25 offen offset:0 sc1 lds
    buffer_load_dwordx4 v6, s[4:7], s25 offen offset:1024 sc1 lds
    s_add_u32 s25, s25, 8192
    s_add_u32 m0, s24, 16384
    s_nop 0
    buffer_load_dwordx4 v6, s[4:7], s25 offen offset:0 sc1 lds
    buffer_load_dwordx4 v6, s[4:7], s25 offen offset:1024 sc1 lds
    s_add_u32 s25, s25, 8192
    s_add_u32 m0, s24, 24576
    s_nop 0
    buffer_load_dwordx4 v6, s[4:7], s25 offen offset:0 sc1 lds
    buffer_load_dwordx4 v6, s[4:7], s25 offen offset:1024 sc1 lds
    s_add_u32 s25, s25, 8192
    s_add_u32 m0, s24, 32768
    s_nop 0
    buffer_load_dwordx4 v6, s[4:7], s25 offen offset:0 sc1 lds
    buffer_load_dwordx4 v6, s[4:7], s25 offen offset:1024 sc1 lds
    s_add_u32 s25, s25, 8192
    s_add_u32 m0, s24, 40960
    s_nop 0
    buffer_load_dwordx4 v7, s[4:7], s25 offen offset:0 sc1 lds
    buffer_load_dwordx4 v8, s[4:7], s25 offen offset:1024 sc1 lds
    s_add_u32 s25, s25, 8192
P_noz110:
    s_add_u32 s24, s21, 65536
    buffer_load_dwordx4 v[240:243], v12, s[8:11], s21 offen
    buffer_load_dwordx4 v[244:247], v12, s[8:11], s24 offen
    s_add_u32 s21, s21, 64
    v_cmp_eq_u32 vcc, -1, v5
    s_cbranch_vccnz P_plain10
    s_cmp_eq_u32 s36, 63
    s_cbranch_scc1 P_plain10
    s_mov_b32 s32, 1
    s_add_u32 s26, s20, 88064
    s_add_u32 s29, s28, 16384
    v_mfma_f32_16x16x32_bf16 v[20:23], v[164:167], v[232:235], v[20:23]
    buffer_load_dwordx4 v[212:215], v9, s[4:7], s28 offen sc1
    v_lshlrev_b32 v248, 16, v232
    v_fmac_f32 v0, v248, v224
    v_mfma_f32_16x16x32_bf16 v[28:31], v[164:167], v[236:239], v[28:31]
    v_and_b32 v249, 0xffff0000, v232
    v_fmac_f32 v0, v249, v225
    v_mfma_f32_16x16x32_bf16 v[24:27], v[168:171], v[232:235], v[24:27]
    v_lshlrev_b32 v248, 16, v233
    v_fmac_f32 v0, v248, v226
    v_mfma_f32_16x16x32_bf16 v[32:35], v[168:171], v[236:239], v[32:35]
    v_and_b32 v249, 0xffff0000, v233
    v_fmac_f32 v0, v249, v227
    v_mfma_f32_16x16x32_bf16 v[36:39], v[172:175], v[232:235], v[36:39]
    buffer_load_dwordx4 v[216:219], v10, s[4:7], s28 offen sc1
    v_lshlrev_b32 v248, 16, v234
    v_fmac_f32 v0, v248, v228
    v_mfma_f32_16x16x32_bf16 v[44:47], v[172:175], v[236:239], v[44:47]
    v_and_b32 v249, 0xffff0000, v234
    v_fmac_f32 v0, v249, v229
    v_mfma_f32_16x16x32_bf16 v[40:43], v[176:179], v[232:235], v[40:43]
    v_lshlrev_b32 v248, 16, v235
    v_fmac_f32 v0, v248, v230
    v_mfma_f32_16x16x32_bf16 v[48:51], v[176:179], v[236:239], v[48:51]
    v_and_b32 v249, 0xffff0000, v235
    v_fmac_f32 v0, v249, v231
    v_mfma_f32_16x16x32_bf16 v[52:55], v[180:183], v[232:235], v[52:55]
    buffer_load_dwordx4 v[220:223], v11, s[4:7], s28 offen sc1
    v_lshlrev_b32 v248, 16, v236
    v_fmac_f32 v1, v248, v224
    v_mfma_f32_16x16x32_bf16 v[60:63], v[180:183], v[236:239], v[60:63]
    v_and_b32 v249, 0xffff0000, v236
    v_fmac_f32 v1, v249, v225
    v_mfma_f32_16x16x32_bf16 v[56:59], v[184:187], v[232:235], v[56:59]
    v_lshlrev_b32 v248, 16, v237
    v_fmac_f32 v1, v248, v226
    v_mfma_f32_16x16x32_bf16 v[64:67], v[184:187], v[236:239], v[64:67]
    v_and_b32 v249, 0xffff0000, v237
    v_fmac_f32 v1, v249, v227
    v_mfma_f32_16x16x32_bf16 v[68:71], v[188:191], v[232:235], v[68:71]
    buffer_load_dword v5, v4, s[4:7], s29 offen sc1
    v_lshlrev_b32 v248, 16, v238
    v_fmac_f32 v1, v248, v228
    v_mfma_f32_16x16x32_bf16 v[76:79], v[188:191], v[236:239], v[76:79]
    v_and_b32 v249, 0xffff0000, v238
    v_fmac_f32 v1, v249, v229
    v_mfma_f32_16x16x32_bf16 v[72:75], v[192:195], v[232:235], v[72:75]
    v_lshlrev_b32 v248, 16, v239
    v_fmac_f32 v1, v248, v230
    v_mfma_f32_16x16x32_bf16 v[80:83], v[192:195], v[236:239], v[80:83]
    v_and_b32 v249, 0xffff0000, v239
    v_fmac_f32 v1, v249, v231
    v_mfma_f32_16x16x32_bf16 v[84:87], v[196:199], v[232:235], v[84:87]
    buffer_load_dwordx4 v[116:119], v6, s[4:7], s26 offen offset:0 sc1
    v_mfma_f32_16x16x32_bf16 v[92:95], v[196:199], v[236:239], v[92:95]
    v_mfma_f32_16x16x32_bf16 v[88:91], v[200:203], v[232:235], v[88:91]
    v_mfma_f32_16x16x32_bf16 v[96:99], v[200:203], v[236:239], v[96:99]
    v_mfma_f32_16x16x32_bf16 v[100:103], v[204:207], v[232:235], v[100:103]
    buffer_load_dwordx4 v[120:123], v6, s[4:7], s26 offen offset:1024 sc1
    s_add_u32 s26, s26, 8192
    v_mfma_f32_16x16x32_bf16 v[108:111], v[204:207], v[236:239], v[108:111]
    v_mfma_f32_16x16x32_bf16 v[104:107], v[208:211], v[232:235], v[104:107]
    v_mfma_f32_16x16x32_bf16 v[112:115], v[208:211], v[236:239], v[112:115]
    buffer_load_dwordx4 v[124:127], v6, s[4:7], s26 offen offset:0 sc1
    buffer_load_dwordx4 v[128:131], v6, s[4:7], s26 offen offset:1024 sc1
    s_add_u32 s26, s26, 8192
    buffer_load_dwordx4 v[132:135], v6, s[4:7], s26 offen offset:0 sc1
    buffer_load_dwordx4 v[136:139], v6, s[4:7], s26 offen offset:1024 sc1
    s_add_u32 s26, s26, 8192
    buffer_load_dwordx4 v[140:143], v6, s[4:7], s26 offen offset:0 sc1
    buffer_load_dwordx4 v[144:147], v6, s[4:7], s26 offen offset:1024 sc1
    s_add_u32 s26, s26, 8192
    buffer_load_dwordx4 v[148:151], v6, s[4:7], s26 offen offset:0 sc1
    buffer_load_dwordx4 v[152:155], v6, s[4:7], s26 offen offset:1024 sc1
    s_add_u32 s26, s26, 8192
    buffer_load_dwordx4 v[156:159], v7, s[4:7], s26 offen offset:0 sc1
    buffer_load_dwordx4 v[160:163], v8, s[4:7], s26 offen offset:1024 sc1
    s_waitcnt vmcnt(12)
    s_branch P_done1
P_plain10:
    v_mfma_f32_16x16x32_bf16 v[20:23], v[164:167], v[232:235], v[20:23]
    v_lshlrev_b32 v248, 16, v232
    v_fmac_f32 v0, v248, v224
    v_mfma_f32_16x16x32_bf16 v[28:31], v[164:167], v[236:239], v[28:31]
    v_and_b32 v249, 0xffff0000, v232
    v_fmac_f32 v0, v249, v225
    v_mfma_f32_16x16x32_bf16 v[24:27], v[168:171], v[232:235], v[24:27]
    v_lshlrev_b32 v248, 16, v233
    v_fmac_f32 v0, v248, v226
    v_mfma_f32_16x16x32_bf16 v[32:35], v[168:171], v[236:239], v[32:35]
    v_and_b32 v249, 0xffff0000, v233
    v_fmac_f32 v0, v249, v227
    v_mfma_f32_16x16x32_bf16 v[36:39], v[172:175], v[232:235], v[36:39]
    v_lshlrev_b32 v248, 16, v234
    v_fmac_f32 v0, v248, v228
    v_mfma_f32_16x16x32_bf16 v[44:47], v[172:175], v[236:239], v[44:47]
    v_and_b32 v249, 0xffff0000, v234
    v_fmac_f32 v0, v249, v229
    v_mfma_f32_16x16x32_bf16 v[40:43], v[176:179], v[232:235], v[40:43]
    v_lshlrev_b32 v248, 16, v235
    v_fmac_f32 v0, v248, v230
    v_mfma_f32_16x16x32_bf16 v[48:51], v[176:179], v[236:239], v[48:51]
    v_and_b32 v249, 0xffff0000, v235
    v_fmac_f32 v0, v249, v231
    v_mfma_f32_16x16x32_bf16 v[52:55], v[180:183], v[232:235], v[52:55]
    v_lshlrev_b32 v248, 16, v236
    v_fmac_f32 v1, v248, v224
    v_mfma_f32_16x16x32_bf16 v[60:63], v[180:183], v[236:239], v[60:63]
    v_and_b32 v249, 0xffff0000, v236
    v_fmac_f32 v1, v249, v225
    v_mfma_f32_16x16x32_bf16 v[56:59], v[184:187], v[232:235], v[56:59]
    v_lshlrev_b32 v248, 16, v237
    v_fmac_f32 v1, v248, v226
    v_mfma_f32_16x16x32_bf16 v[64:67], v[184:187], v[236:239], v[64:67]
    v_and_b32 v249, 0xffff0000, v237
    v_fmac_f32 v1, v249, v227
    v_mfma_f32_16x16x32_bf16 v[68:71], v[188:191], v[232:235], v[68:71]
    v_lshlrev_b32 v248, 16, v238
    v_fmac_f32 v1, v248, v228
    v_mfma_f32_16x16x32_bf16 v[76:79], v[188:191], v[236:239], v[76:79]
    v_and_b32 v249, 0xffff0000, v238
    v_fmac_f32 v1, v249, v229
    v_mfma_f32_16x16x32_bf16 v[72:75], v[192:195], v[232:235], v[72:75]
    v_lshlrev_b32 v248, 16, v239
    v_fmac_f32 v1, v248, v230
    v_mfma_f32_16x16x32_bf16 v[80:83], v[192:195], v[236:239], v[80:83]
    v_and_b32 v249, 0xffff0000, v239
    v_fmac_f32 v1, v249, v231
    v_mfma_f32_16x16x32_bf16 v[84:87], v[196:199], v[232:235], v[84:87]
    v_mfma_f32_16x16x32_bf16 v[92:95], v[196:199], v[236:239], v[92:95]
    v_mfma_f32_16x16x32_bf16 v[88:91], v[200:203], v[232:235], v[88:91]
    v_mfma_f32_16x16x32_bf16 v[96:99], v[200:203], v[236:239], v[96:99]
    v_mfma_f32_16x16x32_bf16 v[100:103], v[204:207], v[232:235], v[100:103]
    v_mfma_f32_16x16x32_bf16 v[108:111], v[204:207], v[236:239], v[108:111]
    v_mfma_f32_16x16x32_bf16 v[104:107], v[208:211], v[232:235], v[104:107]
    v_mfma_f32_16x16x32_bf16 v[112:115], v[208:211], v[236:239], v[112:115]
P_done1:
    s_add_u32 s20, s20, 88064
    s_add_u32 s27, s27, 16384
    s_add_u32 s36, s36, 1
    s_cmp_lt_u32 s36, 64
    s_cbranch_scc1 P_loop
    v_add_u32 v212, 98304, v6
    s_lshl_b32 s24, s17, 11
    v_add_u32 v13, s24, v212
    s_waitcnt vmcnt(2)
    ds_read_b128 v[116:119], v13 offset:0
    ds_read_b128 v[120:123], v13 offset:1024
    ds_read_b128 v[124:127], v13 offset:8192
    ds_read_b128 v[128:131], v13 offset:9216
    ds_read_b128 v[132:135], v13 offset:16384
    ds_read_b128 v[136:139], v13 offset:17408
    ds_read_b128 v[140:143], v13 offset:24576
    ds_read_b128 v[144:147], v13 offset:25600
    ds_read_b128 v[148:151], v13 offset:32768
    ds_read_b128 v[152:155], v13 offset:33792
    ds_read_b128 v[156:159], v13 offset:40960
    ds_read_b128 v[160:163], v13 offset:41984
    v_mov_b32 v248, v0
    s_nop 1
    v_permlane16_swap_b32 v0, v248
    v_add_f32 v0, v0, v248
    v_mov_b32 v248, v1
    s_nop 1
    v_permlane16_swap_b32 v1, v248
    v_add_f32 v1, v1, v248
    v_mov_b32 v248, v0
    s_nop 1
    v_permlane32_swap_b32 v0, v248
    v_add_f32 v0, v0, v248
    v_mov_b32 v248, v1
    s_nop 1
    v_permlane32_swap_b32 v1, v248
    v_add_f32 v1, v1, v248
P_z1c:
    s_waitcnt lgkmcnt(0)
    v_max3_u32 v248, v116, v117, v118
    v_max3_u32 v248, v248, v119, v120
    v_max3_u32 v248, v248, v121, v122
    v_max3_u32 v248, v248, v123, v124
    v_max3_u32 v248, v248, v125, v126
    v_max3_u32 v248, v248, v127, v128
    v_max3_u32 v248, v248, v129, v130
    v_max3_u32 v248, v248, v131, v132
    v_max3_u32 v248, v248, v133, v134
    v_max3_u32 v248, v248, v135, v136
    v_max3_u32 v248, v248, v137, v138
    v_max3_u32 v248, v248, v139, v140
    v_max3_u32 v248, v248, v141, v142
    v_max3_u32 v248, v248, v143, v144
    v_max3_u32 v248, v248, v145, v146
    v_max3_u32 v248, v248, v147, v148
    v_max3_u32 v248, v248, v149, v150
    v_max3_u32 v248, v248, v151, v152
    v_max3_u32 v248, v248, v153, v154
    v_max3_u32 v248, v248, v155, v156
    v_max3_u32 v248, v248, v157, v158
    v_max3_u32 v248, v248, v159, v160
    v_max3_u32 v248, v248, v161, v162
    v_max_u32 v248, v248, v163
    v_cmp_eq_u32 vcc, -1, v248
    s_cbranch_vccz P_z1ok
    s_lshl_b32 s24, s17, 11
    s_add_u32 s24, s24, 98304
    s_mov_b32 s25, s33
    s_add_u32 m0, s24, 0
    s_nop 0
    buffer_load_dwordx4 v6, s[4:7], s25 offen offset:0 sc1 lds
    buffer_load_dwordx4 v6, s[4:7], s25 offen offset:1024 sc1 lds
    s_add_u32 s25, s25, 8192
    s_add_u32 m0, s24, 8192
    s_nop 0
    buffer_load_dwordx4 v6, s[4:7], s25 offen offset:0 sc1 lds
    buffer_load_dwordx4 v6, s[4:7], s25 offen offset:1024 sc1 lds
    s_add_u32 s25, s25, 8192
    s_add_u32 m0, s24, 16384
    s_nop 0
    buffer_load_dwordx4 v6, s[4:7], s25 offen offset:0 sc1 lds
    buffer_load_dwordx4 v6, s[4:7], s25 offen offset:1024 sc1 lds
    s_add_u32 s25, s25, 8192
    s_add_u32 m0, s24, 24576
    s_nop 0
    buffer_load_dwordx4 v6, s[4:7], s25 offen offset:0 sc1 lds
    buffer_load_dwordx4 v6, s[4:7], s25 offen offset:1024 sc1 lds
    s_add_u32 s25, s25, 8192
    s_add_u32 m0, s24, 32768
    s_nop 0
    buffer_load_dwordx4 v6, s[4:7], s25 offen offset:0 sc1 lds
    buffer_load_dwordx4 v6, s[4:7], s25 offen offset:1024 sc1 lds
    s_add_u32 s25, s25, 8192
    s_add_u32 m0, s24, 40960
    s_nop 0
    buffer_load_dwordx4 v7, s[4:7], s25 offen offset:0 sc1 lds
    buffer_load_dwordx4 v8, s[4:7], s25 offen offset:1024 sc1 lds
    s_add_u32 s25, s25, 8192
    s_add_u32 s23, s23, 1
    s_cmp_gt_u32 s23, 262144
    s_waitcnt vmcnt(0)
    s_cbranch_scc1 P_z1ok
    ds_read_b128 v[116:119], v13 offset:0
    ds_read_b128 v[120:123], v13 offset:1024
    ds_read_b128 v[124:127], v13 offset:8192
    ds_read_b128 v[128:131], v13 offset:9216
    ds_read_b128 v[132:135], v13 offset:16384
    ds_read_b128 v[136:139], v13 offset:17408
    ds_read_b128 v[140:143], v13 offset:24576
    ds_read_b128 v[144:147], v13 offset:25600
    ds_read_b128 v[148:151], v13 offset:32768
    ds_read_b128 v[152:155], v13 offset:33792
    ds_read_b128 v[156:159], v13 offset:40960
    ds_read_b128 v[160:163], v13 offset:41984
    s_branch P_z1c
P_z1ok:
    v_pk_add_f32 v[20:21], v[20:21], v[0:1] op_sel:[0,0] op_sel_hi:[1,0] neg_lo:[0,1] neg_hi:[0,1]
    v_pk_add_f32 v[22:23], v[22:23], v[0:1] op_sel:[0,0] op_sel_hi:[1,0] neg_lo:[0,1] neg_hi:[0,1]
    v_pk_add_f32 v[24:25], v[24:25], v[0:1] op_sel:[0,0] op_sel_hi:[1,0] neg_lo:[0,1] neg_hi:[0,1]
    v_pk_add_f32 v[26:27], v[26:27], v[0:1] op_sel:[0,0] op_sel_hi:[1,0] neg_lo:[0,1] neg_hi:[0,1]
    v_cvt_pk_bf16_f32 v224, v20, v21
    v_cvt_pk_bf16_f32 v225, v22, v23
    v_cvt_pk_bf16_f32 v226, v24, v25
    v_cvt_pk_bf16_f32 v227, v26, v27
    v_lshlrev_b32 v20, 16, v224
    v_and_b32 v21, 0xffff0000, v224
    v_lshlrev_b32 v22, 16, v225
    v_and_b32 v23, 0xffff0000, v225
    v_lshlrev_b32 v24, 16, v226
    v_and_b32 v25, 0xffff0000, v226
    v_lshlrev_b32 v26, 16, v227
    v_and_b32 v27, 0xffff0000, v227
    v_lshlrev_b32 v248, 16, v116
    v_and_b32 v249, 0xffff0000, v116
    v_lshlrev_b32 v250, 16, v117
    v_and_b32 v251, 0xffff0000, v117
    v_lshlrev_b32 v252, 16, v120
    v_and_b32 v253, 0xffff0000, v120
    v_lshlrev_b32 v254, 16, v121
    v_and_b32 v255, 0xffff0000, v121
    v_pk_mul_f32 v[20:21], v[20:21], v[248:249]
    v_pk_mul_f32 v[22:23], v[22:23], v[250:251]
    v_pk_mul_f32 v[24:25], v[24:25], v[252:253]
    v_pk_mul_f32 v[26:27], v[26:27], v[254:255]
    v_cvt_pk_bf16_f32 v20, v20, v21
    v_cvt_pk_bf16_f32 v21, v22, v23
    v_cvt_pk_bf16_f32 v22, v24, v25
    v_cvt_pk_bf16_f32 v23, v26, v27
    buffer_store_dwordx4 v[20:23], v6, s[4:7], s37 offen offset:0 sc1
    v_pk_add_f32 v[28:29], v[28:29], v[0:1] op_sel:[0,1] op_sel_hi:[1,1] neg_lo:[0,1] neg_hi:[0,1]
    v_pk_add_f32 v[30:31], v[30:31], v[0:1] op_sel:[0,1] op_sel_hi:[1,1] neg_lo:[0,1] neg_hi:[0,1]
    v_pk_add_f32 v[32:33], v[32:33], v[0:1] op_sel:[0,1] op_sel_hi:[1,1] neg_lo:[0,1] neg_hi:[0,1]
    v_pk_add_f32 v[34:35], v[34:35], v[0:1] op_sel:[0,1] op_sel_hi:[1,1] neg_lo:[0,1] neg_hi:[0,1]
    v_cvt_pk_bf16_f32 v224, v28, v29
    v_cvt_pk_bf16_f32 v225, v30, v31
    v_cvt_pk_bf16_f32 v226, v32, v33
    v_cvt_pk_bf16_f32 v227, v34, v35
    v_lshlrev_b32 v28, 16, v224
    v_and_b32 v29, 0xffff0000, v224
    v_lshlrev_b32 v30, 16, v225
    v_and_b32 v31, 0xffff0000, v225
    v_lshlrev_b32 v32, 16, v226
    v_and_b32 v33, 0xffff0000, v226
    v_lshlrev_b32 v34, 16, v227
    v_and_b32 v35, 0xffff0000, v227
    v_lshlrev_b32 v248, 16, v118
    v_and_b32 v249, 0xffff0000, v118
    v_lshlrev_b32 v250, 16, v119
    v_and_b32 v251, 0xffff0000, v119
    v_lshlrev_b32 v252, 16, v122
    v_and_b32 v253, 0xffff0000, v122
    v_lshlrev_b32 v254, 16, v123
    v_and_b32 v255, 0xffff0000, v123
    v_pk_mul_f32 v[28:29], v[28:29], v[248:249]
    v_pk_mul_f32 v[30:31], v[30:31], v[250:251]
    v_pk_mul_f32 v[32:33], v[32:33], v[252:253]
    v_pk_mul_f32 v[34:35], v[34:35], v[254:255]
    v_cvt_pk_bf16_f32 v28, v28, v29
    v_cvt_pk_bf16_f32 v29, v30, v31
    v_cvt_pk_bf16_f32 v30, v32, v33
    v_cvt_pk_bf16_f32 v31, v34, v35
    buffer_store_dwordx4 v[28:31], v6, s[4:7], s37 offen offset:1024 sc1
    s_add_u32 s37, s37, 8192
    v_pk_add_f32 v[36:37], v[36:37], v[0:1] op_sel:[0,0] op_sel_hi:[1,0] neg_lo:[0,1] neg_hi:[0,1]
    v_pk_add_f32 v[38:39], v[38:39], v[0:1] op_sel:[0,0] op_sel_hi:[1,0] neg_lo:[0,1] neg_hi:[0,1]
    v_pk_add_f32 v[40:41], v[40:41], v[0:1] op_sel:[0,0] op_sel_hi:[1,0] neg_lo:[0,1] neg_hi:[0,1]
    v_pk_add_f32 v[42:43], v[42:43], v[0:1] op_sel:[0,0] op_sel_hi:[1,0] neg_lo:[0,1] neg_hi:[0,1]
    v_cvt_pk_bf16_f32 v224, v36, v37
    v_cvt_pk_bf16_f32 v225, v38, v39
    v_cvt_pk_bf16_f32 v226, v40, v41
    v_cvt_pk_bf16_f32 v227, v42, v43
    v_lshlrev_b32 v36, 16, v224
    v_and_b32 v37, 0xffff0000, v224
    v_lshlrev_b32 v38, 16, v225
    v_and_b32 v39, 0xffff0000, v225
    v_lshlrev_b32 v40, 16, v226
    v_and_b32 v41, 0xffff0000, v226
    v_lshlrev_b32 v42, 16, v227
    v_and_b32 v43, 0xffff0000, v227
    v_lshlrev_b32 v248, 16, v124
    v_and_b32 v249, 0xffff0000, v124
    v_lshlrev_b32 v250, 16, v125
    v_and_b32 v251, 0xffff0000, v125
    v_lshlrev_b32 v252, 16, v128
    v_and_b32 v253, 0xffff0000, v128
    v_lshlrev_b32 v254, 16, v129
    v_and_b32 v255, 0xffff0000, v129
    v_pk_mul_f32 v[36:37], v[36:37], v[248:249]
    v_pk_mul_f32 v[38:39], v[38:39], v[250:251]
    v_pk_mul_f32 v[40:41], v[40:41], v[252:253]
    v_pk_mul_f32 v[42:43], v[42:43], v[254:255]
    v_cvt_pk_bf16_f32 v36, v36, v37
    v_cvt_pk_bf16_f32 v37, v38, v39
    v_cvt_pk_bf16_f32 v38, v40, v41
    v_cvt_pk_bf16_f32 v39, v42, v43
    buffer_store_dwordx4 v[36:39], v6, s[4:7], s37 offen offset:0 sc1
    v_pk_add_f32 v[44:45], v[44:45], v[0:1] op_sel:[0,1] op_sel_hi:[1,1] neg_lo:[0,1] neg_hi:[0,1]
    v_pk_add_f32 v[46:47], v[46:47], v[0:1] op_sel:[0,1] op_sel_hi:[1,1] neg_lo:[0,1] neg_hi:[0,1]
    v_pk_add_f32 v[48:49], v[48:49], v[0:1] op_sel:[0,1] op_sel_hi:[1,1] neg_lo:[0,1] neg_hi:[0,1]
    v_pk_add_f32 v[50:51], v[50:51], v[0:1] op_sel:[0,1] op_sel_hi:[1,1] neg_lo:[0,1] neg_hi:[0,1]
    v_cvt_pk_bf16_f32 v224, v44, v45
    v_cvt_pk_bf16_f32 v225, v46, v47
    v_cvt_pk_bf16_f32 v226, v48, v49
    v_cvt_pk_bf16_f32 v227, v50, v51
    v_lshlrev_b32 v44, 16, v224
    v_and_b32 v45, 0xffff0000, v224
    v_lshlrev_b32 v46, 16, v225
    v_and_b32 v47, 0xffff0000, v225
    v_lshlrev_b32 v48, 16, v226
    v_and_b32 v49, 0xffff0000, v226
    v_lshlrev_b32 v50, 16, v227
    v_and_b32 v51, 0xffff0000, v227
    v_lshlrev_b32 v248, 16, v126
    v_and_b32 v249, 0xffff0000, v126
    v_lshlrev_b32 v250, 16, v127
    v_and_b32 v251, 0xffff0000, v127
    v_lshlrev_b32 v252, 16, v130
    v_and_b32 v253, 0xffff0000, v130
    v_lshlrev_b32 v254, 16, v131
    v_and_b32 v255, 0xffff0000, v131
    v_pk_mul_f32 v[44:45], v[44:45], v[248:249]
    v_pk_mul_f32 v[46:47], v[46:47], v[250:251]
    v_pk_mul_f32 v[48:49], v[48:49], v[252:253]
    v_pk_mul_f32 v[50:51], v[50:51], v[254:255]
    v_cvt_pk_bf16_f32 v44, v44, v45
    v_cvt_pk_bf16_f32 v45, v46, v47
    v_cvt_pk_bf16_f32 v46, v48, v49
    v_cvt_pk_bf16_f32 v47, v50, v51
    buffer_store_dwordx4 v[44:47], v6, s[4:7], s37 offen offset:1024 sc1
    s_add_u32 s37, s37, 8192
    v_pk_add_f32 v[52:53], v[52:53], v[0:1] op_sel:[0,0] op_sel_hi:[1,0] neg_lo:[0,1] neg_hi:[0,1]
    v_pk_add_f32 v[54:55], v[54:55], v[0:1] op_sel:[0,0] op_sel_hi:[1,0] neg_lo:[0,1] neg_hi:[0,1]
    v_pk_add_f32 v[56:57], v[56:57], v[0:1] op_sel:[0,0] op_sel_hi:[1,0] neg_lo:[0,1] neg_hi:[0,1]
    v_pk_add_f32 v[58:59], v[58:59], v[0:1] op_sel:[0,0] op_sel_hi:[1,0] neg_lo:[0,1] neg_hi:[0,1]
    v_cvt_pk_bf16_f32 v224, v52, v53
    v_cvt_pk_bf16_f32 v225, v54, v55
    v_cvt_pk_bf16_f32 v226, v56, v57
    v_cvt_pk_bf16_f32 v227, v58, v59
    v_lshlrev_b32 v52, 16, v224
    v_and_b32 v53, 0xffff0000, v224
    v_lshlrev_b32 v54, 16, v225
    v_and_b32 v55, 0xffff0000, v225
    v_lshlrev_b32 v56, 16, v226
    v_and_b32 v57, 0xffff0000, v226
    v_lshlrev_b32 v58, 16, v227
    v_and_b32 v59, 0xffff0000, v227
    v_lshlrev_b32 v248, 16, v132
    v_and_b32 v249, 0xffff0000, v132
    v_lshlrev_b32 v250, 16, v133
    v_and_b32 v251, 0xffff0000, v133
    v_lshlrev_b32 v252, 16, v136
    v_and_b32 v253, 0xffff0000, v136
    v_lshlrev_b32 v254, 16, v137
    v_and_b32 v255, 0xffff0000, v137
    v_pk_mul_f32 v[52:53], v[52:53], v[248:249]
    v_pk_mul_f32 v[54:55], v[54:55], v[250:251]
    v_pk_mul_f32 v[56:57], v[56:57], v[252:253]
    v_pk_mul_f32 v[58:59], v[58:59], v[254:255]
    v_cvt_pk_bf16_f32 v52, v52, v53
    v_cvt_pk_bf16_f32 v53, v54, v55
    v_cvt_pk_bf16_f32 v54, v56, v57
    v_cvt_pk_bf16_f32 v55, v58, v59
    buffer_store_dwordx4 v[52:55], v6, s[4:7], s37 offen offset:0 sc1
    v_pk_add_f32 v[60:61], v[60:61], v[0:1] op_sel:[0,1] op_sel_hi:[1,1] neg_lo:[0,1] neg_hi:[0,1]
    v_pk_add_f32 v[62:63], v[62:63], v[0:1] op_sel:[0,1] op_sel_hi:[1,1] neg_lo:[0,1] neg_hi:[0,1]
    v_pk_add_f32 v[64:65], v[64:65], v[0:1] op_sel:[0,1] op_sel_hi:[1,1] neg_lo:[0,1] neg_hi:[0,1]
    v_pk_add_f32 v[66:67], v[66:67], v[0:1] op_sel:[0,1] op_sel_hi:[1,1] neg_lo:[0,1] neg_hi:[0,1]
    v_cvt_pk_bf16_f32 v224, v60, v61
    v_cvt_pk_bf16_f32 v225, v62, v63
    v_cvt_pk_bf16_f32 v226, v64, v65
    v_cvt_pk_bf16_f32 v227, v66, v67
    v_lshlrev_b32 v60, 16, v224
    v_and_b32 v61, 0xffff0000, v224
    v_lshlrev_b32 v62, 16, v225
    v_and_b32 v63, 0xffff0000, v225
    v_lshlrev_b32 v64, 16, v226
    v_and_b32 v65, 0xffff0000, v226
    v_lshlrev_b32 v66, 16, v227
    v_and_b32 v67, 0xffff0000, v227
    v_lshlrev_b32 v248, 16, v134
    v_and_b32 v249, 0xffff0000, v134
    v_lshlrev_b32 v250, 16, v135
    v_and_b32 v251, 0xffff0000, v135
    v_lshlrev_b32 v252, 16, v138
    v_and_b32 v253, 0xffff0000, v138
    v_lshlrev_b32 v254, 16, v139
    v_and_b32 v255, 0xffff0000, v139
    v_pk_mul_f32 v[60:61], v[60:61], v[248:249]
    v_pk_mul_f32 v[62:63], v[62:63], v[250:251]
    v_pk_mul_f32 v[64:65], v[64:65], v[252:253]
    v_pk_mul_f32 v[66:67], v[66:67], v[254:255]
    v_cvt_pk_bf16_f32 v60, v60, v61
    v_cvt_pk_bf16_f32 v61, v62, v63
    v_cvt_pk_bf16_f32 v62, v64, v65
    v_cvt_pk_bf16_f32 v63, v66, v67
    buffer_store_dwordx4 v[60:63], v6, s[4:7], s37 offen offset:1024 sc1
    s_add_u32 s37, s37, 8192
    v_pk_add_f32 v[68:69], v[68:69], v[0:1] op_sel:[0,0] op_sel_hi:[1,0] neg_lo:[0,1] neg_hi:[0,1]
    v_pk_add_f32 v[70:71], v[70:71], v[0:1] op_sel:[0,0] op_sel_hi:[1,0] neg_lo:[0,1] neg_hi:[0,1]
    v_pk_add_f32 v[72:73], v[72:73], v[0:1] op_sel:[0,0] op_sel_hi:[1,0] neg_lo:[0,1] neg_hi:[0,1]
    v_pk_add_f32 v[74:75], v[74:75], v[0:1] op_sel:[0,0] op_sel_hi:[1,0] neg_lo:[0,1] neg_hi:[0,1]
    v_cvt_pk_bf16_f32 v224, v68, v69
    v_cvt_pk_bf16_f32 v225, v70, v71
    v_cvt_pk_bf16_f32 v226, v72, v73
    v_cvt_pk_bf16_f32 v227, v74, v75
    v_lshlrev_b32 v68, 16, v224
    v_and_b32 v69, 0xffff0000, v224
    v_lshlrev_b32 v70, 16, v225
    v_and_b32 v71, 0xffff0000, v225
    v_lshlrev_b32 v72, 16, v226
    v_and_b32 v73, 0xffff0000, v226
    v_lshlrev_b32 v74, 16, v227
    v_and_b32 v75, 0xffff0000, v227
    v_lshlrev_b32 v248, 16, v140
    v_and_b32 v249, 0xffff0000, v140
    v_lshlrev_b32 v250, 16, v141
    v_and_b32 v251, 0xffff0000, v141
    v_lshlrev_b32 v252, 16, v144
    v_and_b32 v253, 0xffff0000, v144
    v_lshlrev_b32 v254, 16, v145
    v_and_b32 v255, 0xffff0000, v145
    v_pk_mul_f32 v[68:69], v[68:69], v[248:249]
    v_pk_mul_f32 v[70:71], v[70:71], v[250:251]
    v_pk_mul_f32 v[72:73], v[72:73], v[252:253]
    v_pk_mul_f32 v[74:75], v[74:75], v[254:255]
    v_cvt_pk_bf16_f32 v68, v68, v69
    v_cvt_pk_bf16_f32 v69, v70, v71
    v_cvt_pk_bf16_f32 v70, v72, v73
    v_cvt_pk_bf16_f32 v71, v74, v75
    buffer_store_dwordx4 v[68:71], v6, s[4:7], s37 offen offset:0 sc1
    v_pk_add_f32 v[76:77], v[76:77], v[0:1] op_sel:[0,1] op_sel_hi:[1,1] neg_lo:[0,1] neg_hi:[0,1]
    v_pk_add_f32 v[78:79], v[78:79], v[0:1] op_sel:[0,1] op_sel_hi:[1,1] neg_lo:[0,1] neg_hi:[0,1]
    v_pk_add_f32 v[80:81], v[80:81], v[0:1] op_sel:[0,1] op_sel_hi:[1,1] neg_lo:[0,1] neg_hi:[0,1]
    v_pk_add_f32 v[82:83], v[82:83], v[0:1] op_sel:[0,1] op_sel_hi:[1,1] neg_lo:[0,1] neg_hi:[0,1]
    v_cvt_pk_bf16_f32 v224, v76, v77
    v_cvt_pk_bf16_f32 v225, v78, v79
    v_cvt_pk_bf16_f32 v226, v80, v81
    v_cvt_pk_bf16_f32 v227, v82, v83
    v_lshlrev_b32 v76, 16, v224
    v_and_b32 v77, 0xffff0000, v224
    v_lshlrev_b32 v78, 16, v225
    v_and_b32 v79, 0xffff0000, v225
    v_lshlrev_b32 v80, 16, v226
    v_and_b32 v81, 0xffff0000, v226
    v_lshlrev_b32 v82, 16, v227
    v_and_b32 v83, 0xffff0000, v227
    v_lshlrev_b32 v248, 16, v142
    v_and_b32 v249, 0xffff0000, v142
    v_lshlrev_b32 v250, 16, v143
    v_and_b32 v251, 0xffff0000, v143
    v_lshlrev_b32 v252, 16, v146
    v_and_b32 v253, 0xffff0000, v146
    v_lshlrev_b32 v254, 16, v147
    v_and_b32 v255, 0xffff0000, v147
    v_pk_mul_f32 v[76:77], v[76:77], v[248:249]
    v_pk_mul_f32 v[78:79], v[78:79], v[250:251]
    v_pk_mul_f32 v[80:81], v[80:81], v[252:253]
    v_pk_mul_f32 v[82:83], v[82:83], v[254:255]
    v_cvt_pk_bf16_f32 v76, v76, v77
    v_cvt_pk_bf16_f32 v77, v78, v79
    v_cvt_pk_bf16_f32 v78, v80, v81
    v_cvt_pk_bf16_f32 v79, v82, v83
    buffer_store_dwordx4 v[76:79], v6, s[4:7], s37 offen offset:1024 sc1
    s_add_u32 s37, s37, 8192
    v_pk_add_f32 v[84:85], v[84:85], v[0:1] op_sel:[0,0] op_sel_hi:[1,0] neg_lo:[0,1] neg_hi:[0,1]
    v_pk_add_f32 v[86:87], v[86:87], v[0:1] op_sel:[0,0] op_sel_hi:[1,0] neg_lo:[0,1] neg_hi:[0,1]
    v_pk_add_f32 v[88:89], v[88:89], v[0:1] op_sel:[0,0] op_sel_hi:[1,0] neg_lo:[0,1] neg_hi:[0,1]
    v_pk_add_f32 v[90:91], v[90:91], v[0:1] op_sel:[0,0] op_sel_hi:[1,0] neg_lo:[0,1] neg_hi:[0,1]
    v_cvt_pk_bf16_f32 v224, v84, v85
    v_cvt_pk_bf16_f32 v225, v86, v87
    v_cvt_pk_bf16_f32 v226, v88, v89
    v_cvt_pk_bf16_f32 v227, v90, v91
    v_lshlrev_b32 v84, 16, v224
    v_and_b32 v85, 0xffff0000, v224
    v_lshlrev_b32 v86, 16, v225
    v_and_b32 v87, 0xffff0000, v225
    v_lshlrev_b32 v88, 16, v226
    v_and_b32 v89, 0xffff0000, v226
    v_lshlrev_b32 v90, 16, v227
    v_and_b32 v91, 0xffff0000, v227
    v_lshlrev_b32 v248, 16, v148
    v_and_b32 v249, 0xffff0000, v148
    v_lshlrev_b32 v250, 16, v149
    v_and_b32 v251, 0xffff0000, v149
    v_lshlrev_b32 v252, 16, v152
    v_and_b32 v253, 0xffff0000, v152
    v_lshlrev_b32 v254, 16, v153
    v_and_b32 v255, 0xffff0000, v153
    v_pk_mul_f32 v[84:85], v[84:85], v[248:249]
    v_pk_mul_f32 v[86:87], v[86:87], v[250:251]
    v_pk_mul_f32 v[88:89], v[88:89], v[252:253]
    v_pk_mul_f32 v[90:91], v[90:91], v[254:255]
    v_cvt_pk_bf16_f32 v84, v84, v85
    v_cvt_pk_bf16_f32 v85, v86, v87
    v_cvt_pk_bf16_f32 v86, v88, v89
    v_cvt_pk_bf16_f32 v87, v90, v91
    buffer_store_dwordx4 v[84:87], v6, s[4:7], s37 offen offset:0 sc1
    v_pk_add_f32 v[92:93], v[92:93], v[0:1] op_sel:[0,1] op_sel_hi:[1,1] neg_lo:[0,1] neg_hi:[0,1]
    v_pk_add_f32 v[94:95], v[94:95], v[0:1] op_sel:[0,1] op_sel_hi:[1,1] neg_lo:[0,1] neg_hi:[0,1]
    v_pk_add_f32 v[96:97], v[96:97], v[0:1] op_sel:[0,1] op_sel_hi:[1,1] neg_lo:[0,1] neg_hi:[0,1]
    v_pk_add_f32 v[98:99], v[98:99], v[0:1] op_sel:[0,1] op_sel_hi:[1,1] neg_lo:[0,1] neg_hi:[0,1]
    v_cvt_pk_bf16_f32 v224, v92, v93
    v_cvt_pk_bf16_f32 v225, v94, v95
    v_cvt_pk_bf16_f32 v226, v96, v97
    v_cvt_pk_bf16_f32 v227, v98, v99
    v_lshlrev_b32 v92, 16, v224
    v_and_b32 v93, 0xffff0000, v224
    v_lshlrev_b32 v94, 16, v225
    v_and_b32 v95, 0xffff0000, v225
    v_lshlrev_b32 v96, 16, v226
    v_and_b32 v97, 0xffff0000, v226
    v_lshlrev_b32 v98, 16, v227
    v_and_b32 v99, 0xffff0000, v227
    v_lshlrev_b32 v248, 16, v150
    v_and_b32 v249, 0xffff0000, v150
    v_lshlrev_b32 v250, 16, v151
    v_and_b32 v251, 0xffff0000, v151
    v_lshlrev_b32 v252, 16, v154
    v_and_b32 v253, 0xffff0000, v154
    v_lshlrev_b32 v254, 16, v155
    v_and_b32 v255, 0xffff0000, v155
    v_pk_mul_f32 v[92:93], v[92:93], v[248:249]
    v_pk_mul_f32 v[94:95], v[94:95], v[250:251]
    v_pk_mul_f32 v[96:97], v[96:97], v[252:253]
    v_pk_mul_f32 v[98:99], v[98:99], v[254:255]
    v_cvt_pk_bf16_f32 v92, v92, v93
    v_cvt_pk_bf16_f32 v93, v94, v95
    v_cvt_pk_bf16_f32 v94, v96, v97
    v_cvt_pk_bf16_f32 v95, v98, v99
    buffer_store_dwordx4 v[92:95], v6, s[4:7], s37 offen offset:1024 sc1
    s_add_u32 s37, s37, 8192
    v_pk_add_f32 v[100:101], v[100:101], v[0:1] op_sel:[0,0] op_sel_hi:[1,0] neg_lo:[0,1] neg_hi:[0,1]
    v_pk_add_f32 v[102:103], v[102:103], v[0:1] op_sel:[0,0] op_sel_hi:[1,0] neg_lo:[0,1] neg_hi:[0,1]
    v_pk_add_f32 v[104:105], v[104:105], v[0:1] op_sel:[0,0] op_sel_hi:[1,0] neg_lo:[0,1] neg_hi:[0,1]
    v_pk_add_f32 v[106:107], v[106:107], v[0:1] op_sel:[0,0] op_sel_hi:[1,0] neg_lo:[0,1] neg_hi:[0,1]
    v_cvt_pk_bf16_f32 v224, v100, v101
    v_cvt_pk_bf16_f32 v225, v102, v103
    v_cvt_pk_bf16_f32 v226, v104, v105
    v_cvt_pk_bf16_f32 v227, v106, v107
    v_lshlrev_b32 v100, 16, v224
    v_and_b32 v101, 0xffff0000, v224
    v_lshlrev_b32 v102, 16, v225
    v_and_b32 v103, 0xffff0000, v225
    v_lshlrev_b32 v104, 16, v226
    v_and_b32 v105, 0xffff0000, v226
    v_lshlrev_b32 v106, 16, v227
    v_and_b32 v107, 0xffff0000, v227
    v_lshlrev_b32 v248, 16, v156
    v_and_b32 v249, 0xffff0000, v156
    v_lshlrev_b32 v250, 16, v157
    v_and_b32 v251, 0xffff0000, v157
    v_lshlrev_b32 v252, 16, v160
    v_and_b32 v253, 0xffff0000, v160
    v_lshlrev_b32 v254, 16, v161
    v_and_b32 v255, 0xffff0000, v161
    v_pk_mul_f32 v[100:101], v[100:101], v[248:249]
    v_pk_mul_f32 v[102:103], v[102:103], v[250:251]
    v_pk_mul_f32 v[104:105], v[104:105], v[252:253]
    v_pk_mul_f32 v[106:107], v[106:107], v[254:255]
    v_cvt_pk_bf16_f32 v100, v100, v101
    v_cvt_pk_bf16_f32 v101, v102, v103
    v_cvt_pk_bf16_f32 v102, v104, v105
    v_cvt_pk_bf16_f32 v103, v106, v107
    buffer_store_dwordx4 v[100:103], v6, s[4:7], s37 offen offset:0 sc1
    v_pk_add_f32 v[108:109], v[108:109], v[0:1] op_sel:[0,1] op_sel_hi:[1,1] neg_lo:[0,1] neg_hi:[0,1]
    v_pk_add_f32 v[110:111], v[110:111], v[0:1] op_sel:[0,1] op_sel_hi:[1,1] neg_lo:[0,1] neg_hi:[0,1]
    v_pk_add_f32 v[112:113], v[112:113], v[0:1] op_sel:[0,1] op_sel_hi:[1,1] neg_lo:[0,1] neg_hi:[0,1]
    v_pk_add_f32 v[114:115], v[114:115], v[0:1] op_sel:[0,1] op_sel_hi:[1,1] neg_lo:[0,1] neg_hi:[0,1]
    v_cvt_pk_bf16_f32 v224, v108, v109
    v_cvt_pk_bf16_f32 v225, v110, v111
    v_cvt_pk_bf16_f32 v226, v112, v113
    v_cvt_pk_bf16_f32 v227, v114, v115
    v_lshlrev_b32 v108, 16, v224
    v_and_b32 v109, 0xffff0000, v224
    v_lshlrev_b32 v110, 16, v225
    v_and_b32 v111, 0xffff0000, v225
    v_lshlrev_b32 v112, 16, v226
    v_and_b32 v113, 0xffff0000, v226
    v_lshlrev_b32 v114, 16, v227
    v_and_b32 v115, 0xffff0000, v227
    v_lshlrev_b32 v248, 16, v158
    v_and_b32 v249, 0xffff0000, v158
    v_lshlrev_b32 v250, 16, v159
    v_and_b32 v251, 0xffff0000, v159
    v_lshlrev_b32 v252, 16, v162
    v_and_b32 v253, 0xffff0000, v162
    v_lshlrev_b32 v254, 16, v163
    v_and_b32 v255, 0xffff0000, v163
    v_pk_mul_f32 v[108:109], v[108:109], v[248:249]
    v_pk_mul_f32 v[110:111], v[110:111], v[250:251]
    v_pk_mul_f32 v[112:113], v[112:113], v[252:253]
    v_pk_mul_f32 v[114:115], v[114:115], v[254:255]
    v_cvt_pk_bf16_f32 v108, v108, v109
    v_cvt_pk_bf16_f32 v109, v110, v111
    v_cvt_pk_bf16_f32 v110, v112, v113
    v_cvt_pk_bf16_f32 v111, v114, v115
    buffer_store_dwordx4 v[108:111], v6, s[4:7], s37 offen offset:1024 sc1
    s_add_u32 s37, s37, 8192
    ds_write_b128 v13, v[20:23] offset:0
    ds_write_b128 v13, v[28:31] offset:1024
    ds_write_b128 v13, v[36:39] offset:8192
    ds_write_b128 v13, v[44:47] offset:9216
    ds_write_b128 v13, v[52:55] offset:16384
    ds_write_b128 v13, v[60:63] offset:17408
    ds_write_b128 v13, v[68:71] offset:24576
    ds_write_b128 v13, v[76:79] offset:25600
    ds_write_b128 v13, v[84:87] offset:32768
    ds_write_b128 v13, v[92:95] offset:33792
    ds_write_b128 v13, v[100:103] offset:40960
    ds_write_b128 v13, v[108:111] offset:41984
    s_load_dwordx2 s[8:9], s[0:1], 96
    s_mov_b32 s10, 2097152
    s_mov_b32 s11, 0x20000
    s_waitcnt lgkmcnt(0)
    s_barrier
    ds_read_b128 v[172:175], v212 offset:0
    ds_read_b128 v[176:179], v212 offset:1024
    ds_read_b128 v[180:183], v212 offset:2048
    ds_read_b128 v[184:187], v212 offset:3072
    s_waitcnt lgkmcnt(2)
    v_mfma_f32_16x16x32_bf16 v[196:199], a[0:3], v[172:175], 0
    ds_read_b128 v[188:191], v212 offset:4096
    v_mfma_f32_16x16x32_bf16 v[200:203], a[4:7], v[172:175], 0
    ds_read_b128 v[192:195], v212 offset:5120
    v_mfma_f32_16x16x32_bf16 v[204:207], a[0:3], v[176:179], 0
    v_mfma_f32_16x16x32_bf16 v[208:211], a[4:7], v[176:179], 0
    s_waitcnt lgkmcnt(2)
    v_mfma_f32_16x16x32_bf16 v[196:199], a[8:11], v[180:183], v[196:199]
    ds_read_b128 v[172:175], v212 offset:6144
    v_mfma_f32_16x16x32_bf16 v[200:203], a[12:15], v[180:183], v[200:203]
    ds_read_b128 v[176:179], v212 offset:7168
    v_mfma_f32_16x16x32_bf16 v[204:207], a[8:11], v[184:187], v[204:207]
    v_mfma_f32_16x16x32_bf16 v[208:211], a[12:15], v[184:187], v[208:211]
    s_waitcnt lgkmcnt(2)
    v_mfma_f32_16x16x32_bf16 v[196:199], a[16:19], v[188:191], v[196:199]
    ds_read_b128 v[180:183], v212 offset:8192
    v_mfma_f32_16x16x32_bf16 v[200:203], a[20:23], v[188:191], v[200:203]
    ds_read_b128 v[184:187], v212 offset:9216
    v_mfma_f32_16x16x32_bf16 v[204:207], a[16:19], v[192:195], v[204:207]
    v_mfma_f32_16x16x32_bf16 v[208:211], a[20:23], v[192:195], v[208:211]
    s_waitcnt lgkmcnt(2)
    v_mfma_f32_16x16x32_bf16 v[196:199], a[24:27], v[172:175], v[196:199]
    ds_read_b128 v[188:191], v212 offset:10240
    v_mfma_f32_16x16x32_bf16 v[200:203], a[28:31], v[172:175], v[200:203]
    ds_read_b128 v[192:195], v212 offset:11264
    v_mfma_f32_16x16x32_bf16 v[204:207], a[24:27], v[176:179], v[204:207]
    v_mfma_f32_16x16x32_bf16 v[208:211], a[28:31], v[176:179], v[208:211]
    s_waitcnt lgkmcnt(2)
    v_mfma_f32_16x16x32_bf16 v[196:199], a[32:35], v[180:183], v[196:199]
    ds_read_b128 v[172:175], v212 offset:12288
    v_mfma_f32_16x16x32_bf16 v[200:203], a[36:39], v[180:183], v[200:203]
    ds_read_b128 v[176:179], v212 offset:13312
    v_mfma_f32_16x16x32_bf16 v[204:207], a[32:35], v[184:187], v[204:207]
    v_mfma_f32_16x16x32_bf16 v[208:211], a[36:39], v[184:187], v[208:211]
    s_waitcnt lgkmcnt(2)
    v_mfma_f32_16x16x32_bf16 v[196:199], a[40:43], v[188:191], v[196:199]
    ds_read_b128 v[180:183], v212 offset:14336
    v_mfma_f32_16x16x32_bf16 v[200:203], a[44:47], v[188:191], v[200:203]
    ds_read_b128 v[184:187], v212 offset:15360
    v_mfma_f32_16x16x32_bf16 v[204:207], a[40:43], v[192:195], v[204:207]
    v_mfma_f32_16x16x32_bf16 v[208:211], a[44:47], v[192:195], v[208:211]
    s_waitcnt lgkmcnt(2)
    v_mfma_f32_16x16x32_bf16 v[196:199], a[48:51], v[172:175], v[196:199]
    ds_read_b128 v[188:191], v212 offset:16384
    v_mfma_f32_16x16x32_bf16 v[200:203], a[52:55], v[172:175], v[200:203]
    ds_read_b128 v[192:195], v212 offset:17408
    v_mfma_f32_16x16x32_bf16 v[204:207], a[48:51], v[176:179], v[204:207]
    v_mfma_f32_16x16x32_bf16 v[208:211], a[52:55], v[176:179], v[208:211]
    s_waitcnt lgkmcnt(2)
    v_mfma_f32_16x16x32_bf16 v[196:199], a[56:59], v[180:183], v[196:199]
    ds_read_b128 v[172:175], v212 offset:18432
    v_mfma_f32_16x16x32_bf16 v[200:203], a[60:63], v[180:183], v[200:203]
    ds_read_b128 v[176:179], v212 offset:19456
    v_mfma_f32_16x16x32_bf16 v[204:207], a[56:59], v[184:187], v[204:207]
    v_mfma_f32_16x16x32_bf16 v[208:211], a[60:63], v[184:187], v[208:211]
    s_waitcnt lgkmcnt(2)
    v_mfma_f32_16x16x32_bf16 v[196:199], a[64:67], v[188:191], v[196:199]
    ds_read_b128 v[180:183], v212 offset:20480
    v_mfma_f32_16x16x32_bf16 v[200:203], a[68:71], v[188:191], v[200:203]
    ds_read_b128 v[184:187], v212 offset:21504
    v_mfma_f32_16x16x32_bf16 v[204:207], a[64:67], v[192:195], v[204:207]
    v_mfma_f32_16x16x32_bf16 v[208:211], a[68:71], v[192:195], v[208:211]
    s_waitcnt lgkmcnt(2)
    v_mfma_f32_16x16x32_bf16 v[196:199], a[72:75], v[172:175], v[196:199]
    ds_read_b128 v[188:191], v212 offset:22528
    v_mfma_f32_16x16x32_bf16 v[200:203], a[76:79], v[172:175], v[200:203]
    ds_read_b128 v[192:195], v212 offset:23552
    v_mfma_f32_16x16x32_bf16 v[204:207], a[72:75], v[176:179], v[204:207]
    v_mfma_f32_16x16x32_bf16 v[208:211], a[76:79], v[176:179], v[208:211]
    s_waitcnt lgkmcnt(2)
    v_mfma_f32_16x16x32_bf16 v[196:199], a[80:83], v[180:183], v[196:199]
    ds_read_b128 v[172:175], v212 offset:24576
    v_mfma_f32_16x16x32_bf16 v[200:203], a[84:87], v[180:183], v[200:203]
    ds_read_b128 v[176:179], v212 offset:25600
    v_mfma_f32_16x16x32_bf16 v[204:207], a[80:83], v[184:187], v[204:207]
    v_mfma_f32_16x16x32_bf16 v[208:211], a[84:87], v[184:187], v[208:211]
    s_waitcnt lgkmcnt(2)
    v_mfma_f32_16x16x32_bf16 v[196:199], a[88:91], v[188:191], v[196:199]
    ds_read_b128 v[180:183], v212 offset:26624
    v_mfma_f32_16x16x32_bf16 v[200:203], a[92:95], v[188:191], v[200:203]
    ds_read_b128 v[184:187], v212 offset:27648
    v_mfma_f32_16x16x32_bf16 v[204:207], a[88:91], v[192:195], v[204:207]
    v_mfma_f32_16x16x32_bf16 v[208:211], a[92:95], v[192:195], v[208:211]
    s_waitcnt lgkmcnt(2)
    v_mfma_f32_16x16x32_bf16 v[196:199], a[96:99], v[172:175], v[196:199]
    ds_read_b128 v[188:191], v212 offset:28672
    v_mfma_f32_16x16x32_bf16 v[200:203], a[100:103], v[172:175], v[200:203]
    ds_read_b128 v[192:195], v212 offset:29696
    v_mfma_f32_16x16x32_bf16 v[204:207], a[96:99], v[176:179], v[204:207]
    v_mfma_f32_16x16x32_bf16 v[208:211], a[100:103], v[176:179], v[208:211]
    s_waitcnt lgkmcnt(2)
    v_mfma_f32_16x16x32_bf16 v[196:199], a[104:107], v[180:183], v[196:199]
    ds_read_b128 v[172:175], v212 offset:30720
    v_mfma_f32_16x16x32_bf16 v[200:203], a[108:111], v[180:183], v[200:203]
    ds_read_b128 v[176:179], v212 offset:31744
    v_mfma_f32_16x16x32_bf16 v[204:207], a[104:107], v[184:187], v[204:207]
    v_mfma_f32_16x16x32_bf16 v[208:211], a[108:111], v[184:187], v[208:211]
    s_waitcnt lgkmcnt(2)
    v_mfma_f32_16x16x32_bf16 v[196:199], a[112:115], v[188:191], v[196:199]
    ds_read_b128 v[180:183], v212 offset:32768
    v_mfma_f32_16x16x32_bf16 v[200:203], a[116:119], v[188:191], v[200:203]
    ds_read_b128 v[184:187], v212 offset:33792
    v_mfma_f32_16x16x32_bf16 v[204:207], a[112:115], v[192:195], v[204:207]
    v_mfma_f32_16x16x32_bf16 v[208:211], a[116:119], v[192:195], v[208:211]
    s_waitcnt lgkmcnt(2)
    v_mfma_f32_16x16x32_bf16 v[196:199], a[120:123], v[172:175], v[196:199]
    ds_read_b128 v[188:191], v212 offset:34816
    v_mfma_f32_16x16x32_bf16 v[200:203], a[124:127], v[172:175], v[200:203]
    ds_read_b128 v[192:195], v212 offset:35840
    v_mfma_f32_16x16x32_bf16 v[204:207], a[120:123], v[176:179], v[204:207]
    v_mfma_f32_16x16x32_bf16 v[208:211], a[124:127], v[176:179], v[208:211]
    s_waitcnt lgkmcnt(2)
    v_mfma_f32_16x16x32_bf16 v[196:199], a[128:131], v[180:183], v[196:199]
    ds_read_b128 v[172:175], v212 offset:36864
    v_mfma_f32_16x16x32_bf16 v[200:203], a[132:135], v[180:183], v[200:203]
    ds_read_b128 v[176:179], v212 offset:37888
    v_mfma_f32_16x16x32_bf16 v[204:207], a[128:131], v[184:187], v[204:207]
    v_mfma_f32_16x16x32_bf16 v[208:211], a[132:135], v[184:187], v[208:211]
    s_waitcnt lgkmcnt(2)
    v_mfma_f32_16x16x32_bf16 v[196:199], a[136:139], v[188:191], v[196:199]
    ds_read_b128 v[180:183], v212 offset:38912
    v_mfma_f32_16x16x32_bf16 v[200:203], a[140:143], v[188:191], v[200:203]
    ds_read_b128 v[184:187], v212 offset:39936
    v_mfma_f32_16x16x32_bf16 v[204:207], a[136:139], v[192:195], v[204:207]
    v_mfma_f32_16x16x32_bf16 v[208:211], a[140:143], v[192:195], v[208:211]
    s_waitcnt lgkmcnt(2)
    v_mfma_f32_16x16x32_bf16 v[196:199], a[144:147], v[172:175], v[196:199]
    ds_read_b128 v[188:191], v212 offset:40960
    v_mfma_f32_16x16x32_bf16 v[200:203], a[148:151], v[172:175], v[200:203]
    ds_read_b128 v[192:195], v212 offset:41984
    v_mfma_f32_16x16x32_bf16 v[204:207], a[144:147], v[176:179], v[204:207]
    v_mfma_f32_16x16x32_bf16 v[208:211], a[148:151], v[176:179], v[208:211]
    s_waitcnt lgkmcnt(2)
    v_mfma_f32_16x16x32_bf16 v[196:199], a[152:155], v[180:183], v[196:199]
    ds_read_b128 v[172:175], v212 offset:43008
    v_mfma_f32_16x16x32_bf16 v[200:203], a[156:159], v[180:183], v[200:203]
    ds_read_b128 v[176:179], v212 offset:44032
    v_mfma_f32_16x16x32_bf16 v[204:207], a[152:155], v[184:187], v[204:207]
    v_mfma_f32_16x16x32_bf16 v[208:211], a[156:159], v[184:187], v[208:211]
    s_waitcnt lgkmcnt(2)
    v_mfma_f32_16x16x32_bf16 v[196:199], a[160:163], v[188:191], v[196:199]
    v_mfma_f32_16x16x32_bf16 v[200:203], a[164:167], v[188:191], v[200:203]
    v_mfma_f32_16x16x32_bf16 v[204:207], a[160:163], v[192:195], v[204:207]
    v_mfma_f32_16x16x32_bf16 v[208:211], a[164:167], v[192:195], v[208:211]
    s_waitcnt lgkmcnt(0)
    v_mfma_f32_16x16x32_bf16 v[196:199], a[168:171], v[172:175], v[196:199]
    v_mfma_f32_16x16x32_bf16 v[200:203], a[172:175], v[172:175], v[200:203]
    v_mfma_f32_16x16x32_bf16 v[204:207], a[168:171], v[176:179], v[204:207]
    v_mfma_f32_16x16x32_bf16 v[208:211], a[172:175], v[176:179], v[208:211]
    s_lshl_b32 s28, s18, 7
    s_add_u32 s28, s28, 16384
    v_mov_b32 v249, s28
wt_58:
    buffer_load_dword v248, v249, s[4:7], 0 offen sc1
    s_add_u32 s23, s23, 1
    s_waitcnt vmcnt(0)
    v_readfirstlane_b32 s24, v248
    s_cmp_gt_u32 s23, 262144
    s_cbranch_scc1 wte_59
    s_cmp_ge_u32 s24, 1
    s_cbranch_scc1 wte_59
    s_branch wt_58
wte_59:
    v_lshlrev_b32 v213, 10, v2
    v_lshl_add_u32 v213, v3, 4, v213
    s_lshl_b32 s26, s18, 15
    s_lshl_b32 s24, s19, 8
    s_add_u32 s26, s26, s24
    s_lshl_b32 s24, s17, 6
    s_add_u32 s26, s26, s24
    s_add_u32 s27, s26, 16384
    s_add_u32 s28, s26, 54525952
    s_add_u32 s29, s27, 54525952
    buffer_load_dwordx4 v[164:167], v213, s[4:7], s28 offen sc1
    buffer_load_dwordx4 v[168:171], v213, s[4:7], s29 offen sc1
    s_waitcnt vmcnt(0)
    v_lshlrev_b32 v224, 16, v164
    v_and_b32 v225, 0xffff0000, v164
    v_lshlrev_b32 v226, 16, v165
    v_and_b32 v227, 0xffff0000, v165
    v_lshlrev_b32 v228, 16, v166
    v_and_b32 v229, 0xffff0000, v166
    v_lshlrev_b32 v230, 16, v167
    v_and_b32 v231, 0xffff0000, v167
    v_cvt_pk_bf16_f32 v232, v196, v197
    v_cvt_pk_bf16_f32 v233, v198, v199
    v_cvt_pk_bf16_f32 v234, v200, v201
    v_cvt_pk_bf16_f32 v235, v202, v203
    v_lshlrev_b32 v196, 16, v232
    v_and_b32 v197, 0xffff0000, v232
    v_lshlrev_b32 v198, 16, v233
    v_and_b32 v199, 0xffff0000, v233
    v_lshlrev_b32 v200, 16, v234
    v_and_b32 v201, 0xffff0000, v234
    v_lshlrev_b32 v202, 16, v235
    v_and_b32 v203, 0xffff0000, v235
    v_pk_add_f32 v[196:197], v[196:197], v[224:225]
    v_pk_add_f32 v[198:199], v[198:199], v[226:227]
    v_pk_add_f32 v[200:201], v[200:201], v[228:229]
    v_pk_add_f32 v[202:203], v[202:203], v[230:231]
    v_cvt_pk_bf16_f32 v196, v196, v197
    v_cvt_pk_bf16_f32 v197, v198, v199
    v_cvt_pk_bf16_f32 v198, v200, v201
    v_cvt_pk_bf16_f32 v199, v202, v203
    buffer_store_dwordx4 v[196:199], v213, s[8:11], s26 offen
    v_lshlrev_b32 v224, 16, v168
    v_and_b32 v225, 0xffff0000, v168
    v_lshlrev_b32 v226, 16, v169
    v_and_b32 v227, 0xffff0000, v169
    v_lshlrev_b32 v228, 16, v170
    v_and_b32 v229, 0xffff0000, v170
    v_lshlrev_b32 v230, 16, v171
    v_and_b32 v231, 0xffff0000, v171
    v_cvt_pk_bf16_f32 v232, v204, v205
    v_cvt_pk_bf16_f32 v233, v206, v207
    v_cvt_pk_bf16_f32 v234, v208, v209
    v_cvt_pk_bf16_f32 v235, v210, v211
    v_lshlrev_b32 v204, 16, v232
    v_and_b32 v205, 0xffff0000, v232
    v_lshlrev_b32 v206, 16, v233
    v_and_b32 v207, 0xffff0000, v233
    v_lshlrev_b32 v208, 16, v234
    v_and_b32 v209, 0xffff0000, v234
    v_lshlrev_b32 v210, 16, v235
    v_and_b32 v211, 0xffff0000, v235
    v_pk_add_f32 v[204:205], v[204:205], v[224:225]
    v_pk_add_f32 v[206:207], v[206:207], v[226:227]
    v_pk_add_f32 v[208:209], v[208:209], v[228:229]
    v_pk_add_f32 v[210:211], v[210:211], v[230:231]
    v_cvt_pk_bf16_f32 v204, v204, v205
    v_cvt_pk_bf16_f32 v205, v206, v207
    v_cvt_pk_bf16_f32 v206, v208, v209
    v_cvt_pk_bf16_f32 v207, v210, v211
    buffer_store_dwordx4 v[204:207], v213, s[8:11], s27 offen
L_end:
    s_endpgm
.section .rodata,"a"
.p2align 6
.amdhsa_kernel sequential_preLN__memory_aug_recurrent_mem_tr__mixer_gmlp__prompt_kernel
  .amdhsa_next_free_vgpr 512
  .amdhsa_next_free_sgpr 100
  .amdhsa_accum_offset 256
  .amdhsa_group_segment_fixed_size 0
  .amdhsa_kernarg_size 120
  .amdhsa_user_sgpr_count 2
  .amdhsa_user_sgpr_kernarg_segment_ptr 1
  .amdhsa_system_sgpr_workgroup_id_x 1
.end_amdhsa_kernel
```
